```python
import torch

def _softmax(x, axis=-1):
    return torch.softmax(x, dim=axis)
def _gelu(x):
    return torch.nn.functional.gelu(x, approximate="tanh")
def _silu(x):
    return torch.nn.functional.silu(x)
def _sigmoid(x):
    return torch.sigmoid(x)
def _layernorm(x, axis=-1, eps=1e-5):
    m = x.mean(dim=axis, keepdim=True)
    v = x.var(dim=axis, keepdim=True, unbiased=False)
    return (x - m) / torch.sqrt(v + eps)
def _scatter_add(tgt, idx, src, axis=0):
    return tgt.clone().index_add_(axis, idx, src)
def _segment_sum(src, seg, n):
    out = torch.zeros((n,) + src.shape[1:], dtype=src.dtype)
    return out.index_add_(0, seg, src)
def _pad(x, pw):
    flat = tuple(v for pair in reversed(pw) for v in pair)
    return torch.nn.functional.pad(x, flat)

kernel_name = 'interleave_layers__sliding_local_dilated__mixer_token_mlp__prompt'

def setup_inputs():

    _w = (lambda a: (lambda t: t.to(torch.bfloat16) if t.is_floating_point() else t)(torch.as_tensor(a)))
    def _A_setup():
        B, S, D = 1, 2048, 512
        return {
            "x": _w((lambda *s: torch.randn(*s, dtype=torch.bfloat16) * 0.05)(B, S, D)),
            "wqkv": _w((lambda *s: torch.randn(*s, dtype=torch.bfloat16) * 0.05)(D, 3 * D)),
            "wo": _w((lambda *s: torch.randn(*s, dtype=torch.bfloat16) * 0.05)(D, D)),
        }
    _A_in = _A_setup()

    def _B_setup():
        B, S, D, F = 1, 2048, 512, 1792
        return {
            "x": _w((lambda *s: torch.randn(*s, dtype=torch.bfloat16) * 0.05)(B, S, D)),
            "w1": _w((lambda *s: torch.randn(*s, dtype=torch.bfloat16) * 0.8)(S, F) * (S ** -0.5)),
            "b1": _w((lambda *s: torch.randn(*s, dtype=torch.bfloat16) * 0.8)(F) * 0.02),
            "w2": _w((lambda *s: torch.randn(*s, dtype=torch.bfloat16) * 0.8)(F, S) * (F ** -0.5)),
            "b2": _w((lambda *s: torch.randn(*s, dtype=torch.bfloat16) * 0.8)(S) * 0.02),
        }
    _B_in = _B_setup()

    return {
        "A_x": _A_in["x"],
        "A_wqkv": _A_in["wqkv"],
        "A_wo": _A_in["wo"],
        "B_x": _B_in["x"],
        "B_w1": _B_in["w1"],
        "B_b1": _B_in["b1"],
        "B_w2": _B_in["w2"],
        "B_b2": _B_in["b2"],
    }

def reference(A_x, A_wqkv, A_wo, B_x, B_w1, B_b1, B_w2, B_b2):
    def _A_ref(x, wqkv, wo):
        B, S, D = x.shape
        H = 32; Dh = D // H
        W, dil = 8, 2
        qkv = (lambda x, *d: x.permute(*d))((x @ wqkv).reshape(B, S, 3, H, Dh), 2, 0, 3, 1, 4)
        q, k, v = qkv[0], qkv[1], qkv[2]
        scale = Dh ** -0.5
        pos = torch.arange(S)
        off = torch.arange(W) * dil
        idx = pos[:, None] - off[None, :]
        mask = idx >= 0
        idx_c = torch.where(mask, idx, 0).reshape(-1)
        kg = k[:, :, idx_c, :].reshape(B, H, S, W, Dh)
        vg = v[:, :, idx_c, :].reshape(B, H, S, W, Dh)
        logits = torch.einsum("bhsd,bhswd->bhsw", q, kg) * scale
        logits = torch.where(mask[None, None, :, :], logits, -1e9)
        attn = _softmax(logits, axis=-1)
        o = torch.einsum("bhsw,bhswd->bhsd", attn, vg)
        return (lambda x, *d: x.permute(*d))(o, 0, 2, 1, 3).reshape(B, S, D) @ wo

    def _B_ref(x, w1, b1, w2, b2):
        B, S, D = x.shape
        h = _layernorm(x, axis=-1)
        u = torch.einsum("bsd,sf->bdf", h, w1) + b1
        u = _gelu(u)
        y = torch.einsum("bdf,fs->bds", u, w2) + b2
        return (lambda x, *d: x.permute(*d))(y, 0, 2, 1)

    x = A_x
    x = x + _A_ref(_layernorm(x, axis=-1), A_wqkv, A_wo)
    x = x + _B_ref(_layernorm(x, axis=-1), B_w1, B_b1, B_w2, B_b2)
    x = x + _A_ref(_layernorm(x, axis=-1), A_wqkv, A_wo)
    x = x + _B_ref(_layernorm(x, axis=-1), B_w1, B_b1, B_w2, B_b2)
    return x
```

```asm
; @launch grid=(256,1,1) block=(256,1,1) lds=163840
.amdgcn_target "amdgcn-amd-amdhsa--gfx950"
.text
.globl interleave_layers__sliding_local_dilated__mixer_token_mlp__prompt_kernel
.p2align 8
.type interleave_layers__sliding_local_dilated__mixer_token_mlp__prompt_kernel,@function
interleave_layers__sliding_local_dilated__mixer_token_mlp__prompt_kernel:
  s_cmp_ge_u32 s2, 256
  s_cbranch_scc1 L_end
  s_load_dwordx4 s[64:67], s[0:1], 64
  s_load_dwordx16 s[48:63], s[0:1], 0
  s_load_dwordx2 s[68:69], s[0:1], 80
  v_lshrrev_b32 v1, 6, v0
  v_and_b32 v228, 63, v0
  s_and_b32 s70, s2, 7
  s_lshr_b32 s71, s2, 3
  v_readfirstlane_b32 s77, v1
  s_getpc_b64 s[4:5]
L_pc:
  s_lshl_b32 s3, s71, 2
  s_add_u32 s3, s3, s77
  s_lshl_b32 s3, s3, 3
  v_and_b32 v252, 7, v228
  v_add_u32 v252, s3, v252
  v_lshlrev_b32 v252, 7, v252
  v_min_u32 v252, L_end-L_pc, v252
  v_mov_b32 v13, s5
  v_add_co_u32 v12, vcc, s4, v252
  v_addc_co_u32 v13, vcc, 0, v13, vcc
  global_load_dword v212, v[12:13], off
  v_and_b32 v2, 15, v228
  v_lshrrev_b32 v3, 4, v228
  v_lshrrev_b32 v4, 3, v228
  v_and_b32 v5, 7, v228
  v_lshrrev_b32 v6, 5, v228
  s_lshl_b32 s96, s2, 2
  s_add_u32 s96, s96, s77
  s_lshl_b32 s3, s96, 10
  s_cmp_lt_u32 s2, 8
  s_cselect_b32 s3, s3, 0x20000000
  v_lshlrev_b32 v7, 4, v228
  v_add_u32 v7, s3, v7
  v_mov_b32 v16, 0
  v_mov_b32 v17, 0
  v_mov_b32 v18, 0
  v_mov_b32 v19, 0
  s_lshl_b32 s3, s70, 5
  v_mov_b32 v20, s3
  v_mov_b32 v21, 1
  s_waitcnt lgkmcnt(0)
  s_mov_b32 s44, s66
  s_mov_b32 s45, s67
  s_mov_b32 s46, 256
  s_mov_b32 s47, 0x00020000
  s_mov_b32 s8, s48
  s_mov_b32 s9, s49
  s_mov_b32 s10, 2097152
  s_mov_b32 s11, 0x00020000
  s_mov_b32 s12, s50
  s_mov_b32 s13, s51
  s_mov_b32 s14, 1572864
  s_mov_b32 s15, 0x00020000
  s_lshl_b32 s94, s71, 2
  s_add_u32 s94, s94, s77
  s_mul_i32 s94, s94, 12288
  v_min_u32 v252, 11, v228
  v_lshlrev_b32 v252, 10, v252
  buffer_load_dword v212, v252, s[12:15], s94 offen offset:384
  v_min_u32 v252, 11, v228
  v_lshlrev_b32 v252, 7, v252
  s_mul_i32 s94, s96, 1536
  buffer_load_dword v212, v252, s[12:15], s94 offen
  v_min_u32 v252, 15, v228
  v_lshlrev_b32 v252, 7, v252
  s_mul_i32 s94, s96, 2048
  buffer_load_dword v212, v252, s[8:11], s94 offen
  s_mov_b32 s28, s68
  s_mov_b32 s29, s69
  s_mov_b32 s30, 268435456
  s_mov_b32 s31, 0x00020000
  buffer_store_dwordx4 v[16:19], v7, s[28:31], 0 offen sc1
  s_mov_b32 s16, s52
  s_mov_b32 s17, s53
  s_mov_b32 s18, 524288
  s_mov_b32 s19, 0x00020000
  s_mov_b32 s20, s56
  s_mov_b32 s21, s57
  s_mov_b32 s22, 7340032
  s_mov_b32 s23, 0x00020000
  s_mov_b32 s36, s58
  s_mov_b32 s37, s59
  s_mov_b32 s38, 3584
  s_mov_b32 s39, 0x00020000
  s_mov_b32 s24, s60
  s_mov_b32 s25, s61
  s_mov_b32 s26, 7340032
  s_mov_b32 s27, 0x00020000
  s_mov_b32 s40, s62
  s_mov_b32 s41, s63
  s_mov_b32 s42, 4096
  s_mov_b32 s43, 0x00020000
  s_mov_b32 s32, s64
  s_mov_b32 s33, s65
  s_mov_b32 s34, 2097152
  s_mov_b32 s35, 0x00020000
  s_mov_b32 s57, 0
  v_xor_b32 v7, v5, v4
  v_lshlrev_b32 v7, 4, v7
  v_lshl_add_u32 v255, v4, 10, v7
  s_lshl_b32 s3, s77, 3
  v_add_u32 v8, s3, v4
  v_lshrrev_b32 v9, 2, v8
  v_lshrrev_b32 v10, 3, v8
  v_xor_b32 v9, v9, v10
  v_and_b32 v9, 1, v9
  v_lshlrev_b32 v9, 1, v9
  v_bfe_u32 v10, v8, 1, 1
  v_or_b32 v9, v9, v10
  v_lshlrev_b32 v9, 1, v9
  v_xor_b32 v9, v5, v9
  v_lshlrev_b32 v9, 4, v9
  v_mul_u32_u24 v8, 3072, v8
  v_add_u32 v219, v8, v9
  s_lshl_b32 s60, s77, 10
  s_mul_i32 s68, s77, 3072
  s_add_u32 s68, s68, 65536
  s_lshr_b32 s78, s77, 1
  s_and_b32 s79, s77, 1
  v_lshlrev_b32 v213, 4, v228
  v_xor_b32 v7, v3, v5
  v_lshlrev_b32 v7, 4, v7
  v_lshl_add_u32 v7, v2, 7, v7
  v_mov_b32 v253, v7
  v_xor_b32 v254, 64, v7
  s_lshl_b32 s3, s79, 6
  v_xor_b32 v7, s3, v7
  s_lshl_b32 s3, s78, 11
  v_add_u32 v215, s3, v7
  v_mov_b32 v238, 0x3f803f80
  v_mov_b32 v239, 0x3f803f80
  v_mov_b32 v240, 0x3f803f80
  v_mov_b32 v241, 0x3f803f80
  v_mov_b32 v251, 1
  v_and_b32 v1, 15, v228
  v_lshrrev_b32 v2, 4, v228
  v_lshlrev_b32 v2, 2, v2
  v_sub_u32 v1, v1, v2
  v_mov_b32 v3, 0xff61b1e6
  v_mov_b32 v6, 0
  v_mov_b32 v202, 0
  v_mov_b32 v203, 0
  v_mov_b32 v204, 0
  v_mov_b32 v205, 0
  v_subrev_u32 v4, 0, v1
  v_and_b32 v5, 0x80000001, v4
  v_mov_b32 v2, 0xffff
  v_cmp_eq_u32 vcc, 0, v5
  s_nop 1
  v_cndmask_b32 v194, v3, v6, vcc
  v_cndmask_b32 v204, v204, v2, vcc
  v_cmp_eq_u32 vcc, 0x80000000, v5
  s_nop 1
  v_cndmask_b32 v198, v3, v6, vcc
  v_cndmask_b32 v202, v202, v2, vcc
  v_subrev_u32 v4, 1, v1
  v_and_b32 v5, 0x80000001, v4
  v_mov_b32 v2, 0xffff0000
  v_cmp_eq_u32 vcc, 0, v5
  s_nop 1
  v_cndmask_b32 v195, v3, v6, vcc
  v_cndmask_b32 v204, v204, v2, vcc
  v_cmp_eq_u32 vcc, 0x80000000, v5
  s_nop 1
  v_cndmask_b32 v199, v3, v6, vcc
  v_cndmask_b32 v202, v202, v2, vcc
  v_subrev_u32 v4, 2, v1
  v_and_b32 v5, 0x80000001, v4
  v_mov_b32 v2, 0xffff
  v_cmp_eq_u32 vcc, 0, v5
  s_nop 1
  v_cndmask_b32 v196, v3, v6, vcc
  v_cndmask_b32 v205, v205, v2, vcc
  v_cmp_eq_u32 vcc, 0x80000000, v5
  s_nop 1
  v_cndmask_b32 v200, v3, v6, vcc
  v_cndmask_b32 v203, v203, v2, vcc
  v_subrev_u32 v4, 3, v1
  v_and_b32 v5, 0x80000001, v4
  v_mov_b32 v2, 0xffff0000
  v_cmp_eq_u32 vcc, 0, v5
  s_nop 1
  v_cndmask_b32 v197, v3, v6, vcc
  v_cndmask_b32 v205, v205, v2, vcc
  v_cmp_eq_u32 vcc, 0x80000000, v5
  s_nop 1
  v_cndmask_b32 v201, v3, v6, vcc
  v_cndmask_b32 v203, v203, v2, vcc
  v_lshrrev_b32 v1, 4, v228
  v_bfe_u32 v2, v228, 2, 2
  v_and_b32 v3, 3, v228
  v_lshl_add_u32 v4, v1, 3, v2
  v_add_u32 v4, 0, v4
  v_lshrrev_b32 v5, 2, v4
  v_lshrrev_b32 v6, 3, v4
  v_xor_b32 v5, v5, v6
  v_and_b32 v5, 1, v5
  v_lshlrev_b32 v5, 1, v5
  v_bfe_u32 v6, v4, 1, 1
  v_or_b32 v5, v5, v6
  v_xor_b32 v5, s77, v5
  v_lshlrev_b32 v5, 5, v5
  v_lshl_add_u32 v5, v4, 7, v5
  v_lshl_add_u32 v5, v3, 3, v5
  v_lshrrev_b32 v4, 3, v4
  v_lshl_add_u32 v5, v4, 11, v5
  v_add_u32 v234, 65536, v5
  v_add_u32 v235, 114688, v5
  v_lshl_add_u32 v4, v1, 3, v2
  v_add_u32 v4, 4, v4
  v_lshrrev_b32 v5, 2, v4
  v_lshrrev_b32 v6, 3, v4
  v_xor_b32 v5, v5, v6
  v_and_b32 v5, 1, v5
  v_lshlrev_b32 v5, 1, v5
  v_bfe_u32 v6, v4, 1, 1
  v_or_b32 v5, v5, v6
  v_xor_b32 v5, s77, v5
  v_lshlrev_b32 v5, 5, v5
  v_lshl_add_u32 v5, v4, 7, v5
  v_lshl_add_u32 v5, v3, 3, v5
  v_lshrrev_b32 v4, 3, v4
  v_lshl_add_u32 v5, v4, 11, v5
  v_add_u32 v236, 65536, v5
  v_add_u32 v237, 114688, v5
  v_and_b32 v2, 15, v228
  v_lshrrev_b32 v3, 4, v228
  v_lshrrev_b32 v4, 3, v228
  v_and_b32 v5, 7, v228
  v_lshrrev_b32 v6, 5, v228
  s_lshl_b32 s3, s70, 2
  s_lshr_b32 s76, s71, 4
  s_add_u32 s3, s3, s76
  s_lshr_b32 s4, s71, 2
  s_and_b32 s4, s4, 2
  s_add_u32 s72, s3, s4
  s_and_b32 s73, s71, 7
  s_lshl_b32 s67, s73, 7
  s_and_b32 s4, s77, 1
  s_lshl_b32 s4, s4, 13
  s_lshr_b32 s3, s77, 1
  s_lshl_b32 s3, s3, 7
  s_add_u32 s4, s4, s3
  s_lshl_b32 s3, s72, 16
  s_add_u32 s7, s3, s4
  s_sub_u32 s3, s3, 16384
  s_max_i32 s3, s3, 0
  s_add_u32 s6, s3, s4
  s_add_u32 m0, s68, 0
  s_nop 0
  buffer_load_dwordx4 v219, s[12:15], s67 offen lds
  s_add_u32 m0, s68, 1024
  s_add_u32 s94, s67, 1024
  buffer_load_dwordx4 v219, s[12:15], s94 offen lds
  s_add_u32 m0, s68, 2048
  s_add_u32 s94, s67, 2048
  buffer_load_dwordx4 v219, s[12:15], s94 offen lds
  s_and_b32 s3, s70, 1
  s_lshl_b32 s3, s3, 1
  s_and_b32 s4, s71, 1
  s_add_u32 s74, s3, s4
  s_lshr_b32 s3, s70, 1
  s_bfe_u32 s4, s71, 0x30001
  s_sub_u32 s5, 8, s76
  s_mul_i32 s3, s3, s5
  s_sub_u32 s5, s5, 1
  s_min_u32 s48, s4, s5
  s_add_u32 s75, s3, s48
  s_cmp_eq_u32 s48, s4
  s_cselect_b32 s49, 15, 0
  s_cselect_b32 s50, 0, 20971520
  s_cmp_eq_u32 s75, 31
  s_cselect_b32 s3, 1, 3
  s_cmp_eq_u32 s76, 1
  s_cselect_b32 s95, s49, s3
  s_mov_b32 s3, 1024
  s_cselect_b32 s65, 114688, s3
  s_mov_b32 s3, 4096
  s_cselect_b32 s51, 3584, s3
  s_cselect_b32 s80, s20, s24
  s_cselect_b32 s81, s21, s25
  s_cselect_b32 s82, 7340032, 0
  s_mov_b32 s83, 0x00020000
  s_mov_b32 s82, 7340032
  s_lshl_b32 s100, s74, 1
  s_lshl_b32 s59, s51, 3
  s_mul_i32 s5, s100, s59
  s_lshl_b32 s5, s5, 3
  s_lshl_b32 s3, s75, 7
  s_mul_i32 s61, s77, 1835008
  s_add_u32 s98, s61, s3
  s_add_u32 s99, s98, 1835008
  s_add_u32 s98, s98, s5
  v_and_b32 v7, 1, v3
  v_lshlrev_b32 v7, 2, v7
  v_xor_b32 v7, v5, v7
  v_lshlrev_b32 v7, 4, v7
  v_mul_u32_u24 v8, s51, v4
  v_add_u32 v217, v8, v7
  v_lshl_add_u32 v218, v4, 10, v7
  s_lshl_b32 s69, s77, 13
  s_add_u32 s69, s69, s67
  v_lshrrev_b32 v7, 2, v2
  v_lshl_add_u32 v8, v6, 2, v7
  v_lshlrev_b32 v8, 7, v8
  v_and_b32 v9, 1, v3
  v_lshl_add_u32 v8, v9, 5, v8
  v_and_b32 v9, 3, v228
  v_lshl_add_u32 v8, v9, 3, v8
  v_lshrrev_b32 v9, 1, v7
  v_xor_b32 v9, s78, v9
  v_lshl_add_u32 v220, v9, 6, v8
  v_add_u32 v214, 65536, v220
  s_mul_i32 s56, s77, 8192
  s_add_u32 s56, s56, 131072
  s_and_b32 s3, s79, s76
  s_lshl_b32 s3, s3, 5
  v_add_u32 v221, s56, v220
  v_xor_b32 v221, s3, v221
  v_xor_b32 v222, 64, v221
  s_lshl_b32 s3, s72, 2
  v_add_u32 v7, s3, v228
  v_lshlrev_b32 v223, 7, v7
  s_add_u32 s3, s3, s77
  s_lshl_b32 s3, s3, 7
  v_mov_b32 v226, s3
  s_lshr_b32 s5, s70, 1
  s_lshl_b32 s3, s76, 2
  s_add_u32 s3, s3, s74
  s_lshl_b32 s3, s3, 2
  s_add_u32 s3, s3, s5
  s_lshl_b32 s3, s3, 2
  s_add_u32 s3, s3, s77
  s_add_u32 s3, s3, 128
  s_lshl_b32 s3, s3, 7
  v_mov_b32 v210, s3
  v_lshlrev_b32 v7, 2, v228
  s_lshr_b32 s3, s73, 1
  s_lshl_b32 s3, s3, 4
  s_lshr_b32 s4, s72, 3
  s_add_u32 s3, s3, s4
  s_add_u32 s3, s3, 192
  v_add_u32 v8, s3, v7
  v_lshlrev_b32 v224, 7, v8
  s_lshl_b32 s3, s74, 4
  s_add_u32 s3, s3, s5
  s_add_u32 s3, s3, 128
  s_lshl_b32 s4, s75, 2
  s_add_u32 s4, s4, s74
  s_cmp_eq_u32 s76, 1
  s_cselect_b32 s3, s3, s4
  v_add_u32 v8, s3, v7
  v_lshlrev_b32 v225, 7, v8
  v_and_b32 v10, 1, v3
  v_lshlrev_b32 v10, 14, v10
  v_lshl_add_u32 v10, v2, 4, v10
  v_lshl_add_u32 v227, v6, 8, v10
  v_mov_b32 v8, s76
  v_cmp_eq_u32 vcc, 1, v8
  s_nop 1
  v_cndmask_b32 v232, v227, v213, vcc
  v_lshl_add_u32 v7, v6, 4, v2
  v_and_b32 v8, 1, v3
  v_lshl_add_u32 v7, v8, 5, v7
  v_lshlrev_b32 v229, 4, v7
  s_mul_i32 s3, s77, 6144
  v_add_u32 v230, s3, v213
  s_lshl_b32 s3, s79, 8
  v_xor_b32 v231, s3, v213
  s_cmp_eq_u32 s72, 0
  s_cselect_b32 s97, 1, 2
  v_and_b32 v7, 3, v228
  v_cmp_eq_u32 s[84:85], 1, v7
  v_cmp_eq_u32 s[86:87], 2, v7
  v_cmp_eq_u32 s[88:89], 3, v7
  v_lshrrev_b32 v7, 2, v2
  v_cmp_eq_u32 s[92:93], v3, v7
  s_lshl_b32 s0, s72, 16
  s_lshl_b32 s3, s73, 12
  s_add_u32 s0, s0, s3
  s_add_u32 s0, s0, s60
  s_add_u32 s0, s0, 2097152
  s_lshl_b32 s1, s73, 1
  s_add_u32 s1, s1, s78
  s_lshl_b32 s1, s1, 7
  s_and_b32 s3, s73, 6
  s_sub_u32 s3, s72, s3
  s_and_b32 s3, s3, 7
  s_and_b32 s4, s72, 24
  s_add_u32 s3, s3, s4
  s_lshl_b32 s3, s3, 2
  s_add_u32 s1, s1, s3
  s_lshl_b32 s3, s79, 1
  s_add_u32 s1, s1, s3
  s_lshl_b32 s1, s1, 10
  s_add_u32 s1, s1, 6291456
  s_lshr_b32 s4, s70, 1
  s_mul_i32 s4, s4, 7
  s_sub_u32 s4, s75, s4
  s_cmp_lt_u32 s4, s100
  s_cselect_b32 s3, 7, 0
  s_add_u32 s3, s3, s75
  s_sub_u32 s3, s3, s100
  s_mul_i32 s48, s74, 448
  s_lshl_b32 s3, s3, 2
  s_add_u32 s48, s48, s3
  s_add_u32 s48, s48, s77
  s_lshl_b32 s48, s48, 10
  s_add_u32 s48, s48, 8388608
  s_add_u32 s48, s48, s50
  s_lshl_b32 s4, s75, 1
  s_add_u32 s4, s4, s78
  s_lshl_b32 s4, s4, 15
  s_lshl_b32 s3, s74, 12
  s_add_u32 s63, s4, s3
  s_lshl_b32 s3, s79, 9
  s_add_u32 s63, s63, s3
  s_lshl_b32 s3, s74, 8
  s_add_u32 s64, s4, s3
  s_lshl_b32 s3, s79, 5
  s_add_u32 s64, s64, s3
  s_add_u32 s3, s63, 10485760
  s_cmp_eq_u32 s76, 1
  s_cselect_b32 s62, s48, s3
  v_mov_b32 v206, -1
  v_mov_b32 v207, -1
  v_mov_b32 v208, -1
  v_mov_b32 v209, -1
  s_add_u32 m0, s60, 24576
  s_nop 0
  buffer_load_dwordx4 v255, s[8:11], s6 offen lds
  s_add_u32 m0, s60, 28672
  s_nop 0
  buffer_load_dwordx4 v255, s[8:11], s7 offen lds
  s_add_u32 m0, s60, 32768
  s_add_u32 s94, s7, 16384
  buffer_load_dwordx4 v255, s[8:11], s94 offen lds
  s_add_u32 m0, s60, 36864
  s_add_u32 s94, s7, 32768
  buffer_load_dwordx4 v255, s[8:11], s94 offen lds
  s_add_u32 m0, s60, 40960
  s_add_u32 s94, s7, 49152
  buffer_load_dwordx4 v255, s[8:11], s94 offen lds
  s_add_u32 m0, s68, 12288
  s_add_u32 s94, s67, 98304
  buffer_load_dwordx4 v219, s[12:15], s94 offen lds
  s_add_u32 m0, s68, 13312
  s_add_u32 s94, s67, 99328
  buffer_load_dwordx4 v219, s[12:15], s94 offen lds
  s_add_u32 m0, s68, 14336
  s_add_u32 s94, s67, 100352
  buffer_load_dwordx4 v219, s[12:15], s94 offen lds
  s_add_u32 m0, s68, 24576
  s_add_u32 s94, s67, 196608
  buffer_load_dwordx4 v219, s[12:15], s94 offen lds
  s_add_u32 m0, s68, 25600
  s_add_u32 s94, s67, 197632
  buffer_load_dwordx4 v219, s[12:15], s94 offen lds
  s_add_u32 m0, s68, 26624
  s_add_u32 s94, s67, 198656
  buffer_load_dwordx4 v219, s[12:15], s94 offen lds
  s_lshl_b32 s94, s72, 1
  s_add_u32 s94, s94, s79
  s_lshl_b32 s94, s94, 3
  s_add_u32 s94, s94, s73
  s_lshl_b32 s94, s94, 1
  s_add_u32 s94, s94, s78
  s_lshl_b32 s94, s94, 8
  s_add_u32 s94, s94, 1048576
  v_lshlrev_b32 v252, 2, v228
  buffer_store_dword v206, v252, s[28:31], s94 offen sc1
  s_add_u32 s94, s0, 0
  buffer_store_dwordx4 v[206:209], v213, s[28:31], s94 offen sc1
  s_add_u32 s94, s0, 32768
  buffer_store_dwordx4 v[206:209], v213, s[28:31], s94 offen sc1
  s_waitcnt vmcnt(9)
  s_barrier
  ds_read_b128 v[48:51], v215 offset:24576
  ds_read_b128 v[52:55], v215 offset:28672
  ds_read_b128 v[56:59], v215 offset:32768
  ds_read_b128 v[60:63], v215 offset:36864
  ds_read_b128 v[64:67], v215 offset:40960
  ds_read_b64_tr_b16 v[164:165], v234 offset:0
  ds_read_b64_tr_b16 v[166:167], v236 offset:0
  ds_read_b64_tr_b16 v[168:169], v234 offset:1024
  ds_read_b64_tr_b16 v[170:171], v236 offset:1024
  ds_read_b64_tr_b16 v[172:173], v234 offset:2048
  ds_read_b64_tr_b16 v[174:175], v236 offset:2048
  s_add_u32 m0, s60, 45056
  s_add_u32 s94, s6, 256
  buffer_load_dwordx4 v255, s[8:11], s94 offen lds
  ds_read_b128 v[8:11], v253 offset:24576
  ds_read_b128 v[12:15], v253 offset:28672
  ds_read_b128 v[16:19], v253 offset:32768
  ds_read_b128 v[20:23], v253 offset:36864
  ds_read_b128 v[24:27], v253 offset:40960
  s_waitcnt lgkmcnt(14)
  s_add_u32 m0, s60, 49152
  s_add_u32 s94, s7, 256
  buffer_load_dwordx4 v255, s[8:11], s94 offen lds
  v_mfma_f32_16x16x32_bf16 v[124:127], v[238:241], v[48:51], 0
  v_mfma_f32_16x16x32_bf16 v[144:147], v[48:51], v[48:51], 0
  v_mfma_f32_16x16x32_bf16 v[128:131], v[238:241], v[52:55], 0
  v_mfma_f32_16x16x32_bf16 v[148:151], v[52:55], v[52:55], 0
  s_add_u32 m0, s60, 53248
  s_add_u32 s94, s7, 16640
  buffer_load_dwordx4 v255, s[8:11], s94 offen lds
  s_waitcnt lgkmcnt(13)
  v_mfma_f32_16x16x32_bf16 v[132:135], v[238:241], v[56:59], 0
  v_mfma_f32_16x16x32_bf16 v[152:155], v[56:59], v[56:59], 0
  s_waitcnt lgkmcnt(12)
  v_mfma_f32_16x16x32_bf16 v[136:139], v[238:241], v[60:63], 0
  v_mfma_f32_16x16x32_bf16 v[156:159], v[60:63], v[60:63], 0
  s_add_u32 m0, s60, 57344
  s_add_u32 s94, s7, 33024
  buffer_load_dwordx4 v255, s[8:11], s94 offen lds
  s_waitcnt lgkmcnt(11)
  v_mfma_f32_16x16x32_bf16 v[140:143], v[238:241], v[64:67], 0
  v_mfma_f32_16x16x32_bf16 v[160:163], v[64:67], v[64:67], 0
  s_cmp_lg_u32 s77, 0
  s_cbranch_scc1 L_arr_1
  s_cmp_ge_u32 s2, 8
  s_cbranch_scc1 L_arr_1
  v_mov_b32 v1, 0
  s_mov_b64 exec, 1
  buffer_atomic_add v251, v1, s[44:47], 0 offen sc1
  s_mov_b64 exec, -1
L_arr_1:
  s_waitcnt lgkmcnt(5)
  s_waitcnt lgkmcnt(3)
  v_mfma_f32_16x16x32_bf16 v[84:87], v[168:171], v[8:11], 0
  s_waitcnt vmcnt(10)
  s_barrier
  ds_read_b64_tr_b16 v[176:177], v234 offset:12288
  v_mfma_f32_16x16x32_bf16 v[104:107], v[8:11], v[172:175], 0
  s_add_u32 m0, s60, 61440
  s_add_u32 s94, s7, 49408
  buffer_load_dwordx4 v255, s[8:11], s94 offen lds
  ds_read_b64_tr_b16 v[178:179], v236 offset:12288
  v_mfma_f32_16x16x32_bf16 v[68:71], v[164:167], v[12:15], 0
  ds_read_b64_tr_b16 v[180:181], v234 offset:13312
  v_mfma_f32_16x16x32_bf16 v[88:91], v[168:171], v[12:15], 0
  ds_read_b64_tr_b16 v[182:183], v236 offset:13312
  v_mfma_f32_16x16x32_bf16 v[108:111], v[12:15], v[172:175], 0
  ds_read_b64_tr_b16 v[184:185], v234 offset:14336
  s_waitcnt lgkmcnt(5)
  v_mfma_f32_16x16x32_bf16 v[72:75], v[164:167], v[16:19], 0
  s_add_u32 m0, s68, 36864
  s_add_u32 s94, s67, 294912
  buffer_load_dwordx4 v219, s[12:15], s94 offen lds
  ds_read_b64_tr_b16 v[186:187], v236 offset:14336
  v_mfma_f32_16x16x32_bf16 v[92:95], v[168:171], v[16:19], 0
  ds_read_b128 v[28:31], v254 offset:24576
  v_mfma_f32_16x16x32_bf16 v[112:115], v[16:19], v[172:175], 0
  ds_read_b128 v[32:35], v254 offset:28672
  v_mfma_f32_16x16x32_bf16 v[76:79], v[164:167], v[20:23], 0
  ds_read_b128 v[36:39], v254 offset:32768
  v_mfma_f32_16x16x32_bf16 v[96:99], v[168:171], v[20:23], 0
  s_add_u32 m0, s68, 37888
  s_add_u32 s94, s67, 295936
  buffer_load_dwordx4 v219, s[12:15], s94 offen lds
  ds_read_b128 v[40:43], v254 offset:36864
  v_mfma_f32_16x16x32_bf16 v[116:119], v[20:23], v[172:175], 0
  ds_read_b128 v[44:47], v254 offset:40960
  v_mfma_f32_16x16x32_bf16 v[80:83], v[164:167], v[24:27], 0
  v_mfma_f32_16x16x32_bf16 v[100:103], v[168:171], v[24:27], 0
  v_mfma_f32_16x16x32_bf16 v[120:123], v[24:27], v[172:175], 0
  s_add_u32 m0, s68, 38912
  s_add_u32 s94, s67, 296960
  buffer_load_dwordx4 v219, s[12:15], s94 offen lds
  v_mfma_f32_16x16x32_bf16 v[242:245], v[164:167], v[238:241], 0
  v_mfma_f32_16x16x32_bf16 v[246:249], v[168:171], v[238:241], 0
  v_mfma_f32_16x16x32_bf16 v[188:191], v[238:241], v[172:175], 0
  s_waitcnt lgkmcnt(5)
  s_waitcnt lgkmcnt(3)
  v_mfma_f32_16x16x32_bf16 v[84:87], v[180:183], v[28:31], v[84:87]
  s_add_u32 m0, s68, 49152
  s_add_u32 s94, s67, 393216
  buffer_load_dwordx4 v219, s[12:15], s94 offen lds
  s_waitcnt vmcnt(12)
  s_barrier
  ds_read_b64_tr_b16 v[164:165], v234 offset:24576
  v_mfma_f32_16x16x32_bf16 v[104:107], v[28:31], v[184:187], v[104:107]
  ds_read_b64_tr_b16 v[166:167], v236 offset:24576
  s_add_u32 m0, s68, 50176
  s_add_u32 s94, s67, 394240
  buffer_load_dwordx4 v219, s[12:15], s94 offen lds
  v_mfma_f32_16x16x32_bf16 v[68:71], v[176:179], v[32:35], v[68:71]
  ds_read_b64_tr_b16 v[168:169], v234 offset:25600
  v_mfma_f32_16x16x32_bf16 v[88:91], v[180:183], v[32:35], v[88:91]
  ds_read_b64_tr_b16 v[170:171], v236 offset:25600
  v_mfma_f32_16x16x32_bf16 v[108:111], v[32:35], v[184:187], v[108:111]
  ds_read_b64_tr_b16 v[172:173], v234 offset:26624
  s_waitcnt lgkmcnt(5)
  v_mfma_f32_16x16x32_bf16 v[72:75], v[176:179], v[36:39], v[72:75]
  s_add_u32 m0, s68, 51200
  s_add_u32 s94, s67, 395264
  buffer_load_dwordx4 v219, s[12:15], s94 offen lds
  ds_read_b64_tr_b16 v[174:175], v236 offset:26624
  v_mfma_f32_16x16x32_bf16 v[92:95], v[180:183], v[36:39], v[92:95]
  ds_read_b128 v[8:11], v253 offset:26624
  v_mfma_f32_16x16x32_bf16 v[112:115], v[36:39], v[184:187], v[112:115]
  ds_read_b128 v[12:15], v253 offset:30720
  v_mfma_f32_16x16x32_bf16 v[76:79], v[176:179], v[40:43], v[76:79]
  ds_read_b128 v[16:19], v253 offset:34816
  v_mfma_f32_16x16x32_bf16 v[96:99], v[180:183], v[40:43], v[96:99]
  s_add_u32 m0, s68, 0
  s_add_u32 s94, s67, 491520
  buffer_load_dwordx4 v219, s[12:15], s94 offen lds
  ds_read_b128 v[20:23], v253 offset:38912
  v_mfma_f32_16x16x32_bf16 v[116:119], v[40:43], v[184:187], v[116:119]
  ds_read_b128 v[24:27], v253 offset:43008
  v_mfma_f32_16x16x32_bf16 v[80:83], v[176:179], v[44:47], v[80:83]
  v_mfma_f32_16x16x32_bf16 v[100:103], v[180:183], v[44:47], v[100:103]
  v_mfma_f32_16x16x32_bf16 v[120:123], v[44:47], v[184:187], v[120:123]
  s_add_u32 m0, s68, 1024
  s_add_u32 s94, s67, 492544
  buffer_load_dwordx4 v219, s[12:15], s94 offen lds
  v_mfma_f32_16x16x32_bf16 v[242:245], v[176:179], v[238:241], v[242:245]
  v_mfma_f32_16x16x32_bf16 v[246:249], v[180:183], v[238:241], v[246:249]
  v_mfma_f32_16x16x32_bf16 v[188:191], v[238:241], v[184:187], v[188:191]
  s_waitcnt lgkmcnt(5)
  s_waitcnt lgkmcnt(3)
  v_mfma_f32_16x16x32_bf16 v[84:87], v[168:171], v[8:11], v[84:87]
  s_add_u32 m0, s68, 2048
  s_add_u32 s94, s67, 493568
  buffer_load_dwordx4 v219, s[12:15], s94 offen lds
  s_waitcnt vmcnt(6)
  s_add_u32 m0, s68, 12288
  s_add_u32 s94, s67, 589824
  buffer_load_dwordx4 v219, s[12:15], s94 offen lds
  s_barrier
  ds_read_b64_tr_b16 v[176:177], v234 offset:36864
  v_mfma_f32_16x16x32_bf16 v[104:107], v[8:11], v[172:175], v[104:107]
  ds_read_b64_tr_b16 v[178:179], v236 offset:36864
  v_mfma_f32_16x16x32_bf16 v[68:71], v[164:167], v[12:15], v[68:71]
  s_add_u32 m0, s68, 13312
  s_add_u32 s94, s67, 590848
  buffer_load_dwordx4 v219, s[12:15], s94 offen lds
  ds_read_b64_tr_b16 v[180:181], v234 offset:37888
  v_mfma_f32_16x16x32_bf16 v[88:91], v[168:171], v[12:15], v[88:91]
  ds_read_b64_tr_b16 v[182:183], v236 offset:37888
  v_mfma_f32_16x16x32_bf16 v[108:111], v[12:15], v[172:175], v[108:111]
  ds_read_b64_tr_b16 v[184:185], v234 offset:38912
  s_waitcnt lgkmcnt(5)
  v_mfma_f32_16x16x32_bf16 v[72:75], v[164:167], v[16:19], v[72:75]
  ds_read_b64_tr_b16 v[186:187], v236 offset:38912
  v_mfma_f32_16x16x32_bf16 v[92:95], v[168:171], v[16:19], v[92:95]
  s_add_u32 m0, s60, 0
  s_add_u32 s94, s6, 512
  buffer_load_dwordx4 v255, s[8:11], s94 offen lds
  ds_read_b128 v[28:31], v254 offset:26624
  v_mfma_f32_16x16x32_bf16 v[112:115], v[16:19], v[172:175], v[112:115]
  ds_read_b128 v[32:35], v254 offset:30720
  v_mfma_f32_16x16x32_bf16 v[76:79], v[164:167], v[20:23], v[76:79]
  ds_read_b128 v[36:39], v254 offset:34816
  v_mfma_f32_16x16x32_bf16 v[96:99], v[168:171], v[20:23], v[96:99]
  ds_read_b128 v[40:43], v254 offset:38912
  v_mfma_f32_16x16x32_bf16 v[116:119], v[20:23], v[172:175], v[116:119]
  s_add_u32 m0, s60, 4096
  s_add_u32 s94, s7, 512
  buffer_load_dwordx4 v255, s[8:11], s94 offen lds
  ds_read_b128 v[44:47], v254 offset:43008
  v_mfma_f32_16x16x32_bf16 v[80:83], v[164:167], v[24:27], v[80:83]
  v_mfma_f32_16x16x32_bf16 v[100:103], v[168:171], v[24:27], v[100:103]
  v_mfma_f32_16x16x32_bf16 v[120:123], v[24:27], v[172:175], v[120:123]
  v_mfma_f32_16x16x32_bf16 v[242:245], v[164:167], v[238:241], v[242:245]
  s_add_u32 m0, s60, 8192
  s_add_u32 s94, s7, 16896
  buffer_load_dwordx4 v255, s[8:11], s94 offen lds
  v_mfma_f32_16x16x32_bf16 v[246:249], v[168:171], v[238:241], v[246:249]
  v_mfma_f32_16x16x32_bf16 v[188:191], v[238:241], v[172:175], v[188:191]
  s_waitcnt lgkmcnt(5)
  s_waitcnt lgkmcnt(3)
  v_mfma_f32_16x16x32_bf16 v[84:87], v[180:183], v[28:31], v[84:87]
  s_waitcnt vmcnt(8)
  s_barrier
  ds_read_b128 v[48:51], v215 offset:45056
  v_mfma_f32_16x16x32_bf16 v[104:107], v[28:31], v[184:187], v[104:107]
  s_add_u32 m0, s60, 12288
  s_add_u32 s94, s7, 33280
  buffer_load_dwordx4 v255, s[8:11], s94 offen lds
  ds_read_b128 v[52:55], v215 offset:49152
  v_mfma_f32_16x16x32_bf16 v[68:71], v[176:179], v[32:35], v[68:71]
  ds_read_b128 v[56:59], v215 offset:53248
  v_mfma_f32_16x16x32_bf16 v[88:91], v[180:183], v[32:35], v[88:91]
  ds_read_b128 v[60:63], v215 offset:57344
  ds_read_b128 v[64:67], v215 offset:61440
  v_mfma_f32_16x16x32_bf16 v[108:111], v[32:35], v[184:187], v[108:111]
  ds_read_b64_tr_b16 v[164:165], v235 offset:0
  s_waitcnt lgkmcnt(6)
  v_mfma_f32_16x16x32_bf16 v[72:75], v[176:179], v[36:39], v[72:75]
  s_add_u32 m0, s60, 16384
  s_add_u32 s94, s7, 49664
  buffer_load_dwordx4 v255, s[8:11], s94 offen lds
  ds_read_b64_tr_b16 v[166:167], v237 offset:0
  v_mfma_f32_16x16x32_bf16 v[92:95], v[180:183], v[36:39], v[92:95]
  ds_read_b64_tr_b16 v[168:169], v235 offset:1024
  ds_read_b64_tr_b16 v[170:171], v237 offset:1024
  v_mfma_f32_16x16x32_bf16 v[112:115], v[36:39], v[184:187], v[112:115]
  ds_read_b64_tr_b16 v[172:173], v235 offset:2048
  v_mfma_f32_16x16x32_bf16 v[76:79], v[176:179], v[40:43], v[76:79]
  ds_read_b64_tr_b16 v[174:175], v237 offset:2048
  v_mfma_f32_16x16x32_bf16 v[96:99], v[180:183], v[40:43], v[96:99]
  s_add_u32 m0, s68, 14336
  s_add_u32 s94, s67, 591872
  buffer_load_dwordx4 v219, s[12:15], s94 offen lds
  ds_read_b128 v[8:11], v253 offset:45056
  ds_read_b128 v[12:15], v253 offset:49152
  v_mfma_f32_16x16x32_bf16 v[116:119], v[40:43], v[184:187], v[116:119]
  ds_read_b128 v[16:19], v253 offset:53248
  v_mfma_f32_16x16x32_bf16 v[80:83], v[176:179], v[44:47], v[80:83]
  ds_read_b128 v[20:23], v253 offset:57344
  v_mfma_f32_16x16x32_bf16 v[100:103], v[180:183], v[44:47], v[100:103]
  ds_read_b128 v[24:27], v253 offset:61440
  s_add_u32 m0, s68, 24576
  s_add_u32 s94, s67, 688128
  buffer_load_dwordx4 v219, s[12:15], s94 offen lds
  v_mfma_f32_16x16x32_bf16 v[120:123], v[44:47], v[184:187], v[120:123]
  v_mfma_f32_16x16x32_bf16 v[242:245], v[176:179], v[238:241], v[242:245]
  v_mfma_f32_16x16x32_bf16 v[246:249], v[180:183], v[238:241], v[246:249]
  v_mfma_f32_16x16x32_bf16 v[188:191], v[238:241], v[184:187], v[188:191]
  s_add_u32 m0, s68, 25600
  s_add_u32 s94, s67, 689152
  buffer_load_dwordx4 v219, s[12:15], s94 offen lds
  s_waitcnt lgkmcnt(14)
  v_mfma_f32_16x16x32_bf16 v[124:127], v[238:241], v[48:51], v[124:127]
  v_mfma_f32_16x16x32_bf16 v[144:147], v[48:51], v[48:51], v[144:147]
  v_mfma_f32_16x16x32_bf16 v[128:131], v[238:241], v[52:55], v[128:131]
  v_mfma_f32_16x16x32_bf16 v[148:151], v[52:55], v[52:55], v[148:151]
  s_add_u32 m0, s68, 26624
  s_add_u32 s94, s67, 690176
  buffer_load_dwordx4 v219, s[12:15], s94 offen lds
  s_waitcnt lgkmcnt(13)
  v_mfma_f32_16x16x32_bf16 v[132:135], v[238:241], v[56:59], v[132:135]
  v_mfma_f32_16x16x32_bf16 v[152:155], v[56:59], v[56:59], v[152:155]
  s_waitcnt lgkmcnt(12)
  v_mfma_f32_16x16x32_bf16 v[136:139], v[238:241], v[60:63], v[136:139]
  v_mfma_f32_16x16x32_bf16 v[156:159], v[60:63], v[60:63], v[156:159]
  s_add_u32 m0, s68, 36864
  s_add_u32 s94, s67, 786432
  buffer_load_dwordx4 v219, s[12:15], s94 offen lds
  s_waitcnt lgkmcnt(11)
  v_mfma_f32_16x16x32_bf16 v[140:143], v[238:241], v[64:67], v[140:143]
  v_mfma_f32_16x16x32_bf16 v[160:163], v[64:67], v[64:67], v[160:163]
  s_waitcnt lgkmcnt(5)
  s_waitcnt lgkmcnt(3)
  v_mfma_f32_16x16x32_bf16 v[84:87], v[168:171], v[8:11], v[84:87]
  s_waitcnt vmcnt(12)
  s_barrier
  ds_read_b64_tr_b16 v[176:177], v234 offset:0
  v_mfma_f32_16x16x32_bf16 v[104:107], v[8:11], v[172:175], v[104:107]
  s_add_u32 m0, s68, 37888
  s_add_u32 s94, s67, 787456
  buffer_load_dwordx4 v219, s[12:15], s94 offen lds
  ds_read_b64_tr_b16 v[178:179], v236 offset:0
  v_mfma_f32_16x16x32_bf16 v[68:71], v[164:167], v[12:15], v[68:71]
  ds_read_b64_tr_b16 v[180:181], v234 offset:1024
  v_mfma_f32_16x16x32_bf16 v[88:91], v[168:171], v[12:15], v[88:91]
  ds_read_b64_tr_b16 v[182:183], v236 offset:1024
  v_mfma_f32_16x16x32_bf16 v[108:111], v[12:15], v[172:175], v[108:111]
  ds_read_b64_tr_b16 v[184:185], v234 offset:2048
  s_waitcnt lgkmcnt(5)
  v_mfma_f32_16x16x32_bf16 v[72:75], v[164:167], v[16:19], v[72:75]
  s_add_u32 m0, s68, 38912
  s_add_u32 s94, s67, 788480
  buffer_load_dwordx4 v219, s[12:15], s94 offen lds
  ds_read_b64_tr_b16 v[186:187], v236 offset:2048
  v_mfma_f32_16x16x32_bf16 v[92:95], v[168:171], v[16:19], v[92:95]
  ds_read_b128 v[28:31], v254 offset:45056
  v_mfma_f32_16x16x32_bf16 v[112:115], v[16:19], v[172:175], v[112:115]
  ds_read_b128 v[32:35], v254 offset:49152
  v_mfma_f32_16x16x32_bf16 v[76:79], v[164:167], v[20:23], v[76:79]
  ds_read_b128 v[36:39], v254 offset:53248
  v_mfma_f32_16x16x32_bf16 v[96:99], v[168:171], v[20:23], v[96:99]
  s_add_u32 m0, s68, 49152
  s_add_u32 s94, s67, 884736
  buffer_load_dwordx4 v219, s[12:15], s94 offen lds
  ds_read_b128 v[40:43], v254 offset:57344
  v_mfma_f32_16x16x32_bf16 v[116:119], v[20:23], v[172:175], v[116:119]
  ds_read_b128 v[44:47], v254 offset:61440
  v_mfma_f32_16x16x32_bf16 v[80:83], v[164:167], v[24:27], v[80:83]
  v_mfma_f32_16x16x32_bf16 v[100:103], v[168:171], v[24:27], v[100:103]
  v_mfma_f32_16x16x32_bf16 v[120:123], v[24:27], v[172:175], v[120:123]
  s_add_u32 m0, s68, 50176
  s_add_u32 s94, s67, 885760
  buffer_load_dwordx4 v219, s[12:15], s94 offen lds
  v_mfma_f32_16x16x32_bf16 v[242:245], v[164:167], v[238:241], v[242:245]
  v_mfma_f32_16x16x32_bf16 v[246:249], v[168:171], v[238:241], v[246:249]
  v_mfma_f32_16x16x32_bf16 v[188:191], v[238:241], v[172:175], v[188:191]
  s_waitcnt lgkmcnt(5)
  s_waitcnt lgkmcnt(3)
  v_mfma_f32_16x16x32_bf16 v[84:87], v[180:183], v[28:31], v[84:87]
  s_add_u32 m0, s68, 51200
  s_add_u32 s94, s67, 886784
  buffer_load_dwordx4 v219, s[12:15], s94 offen lds
  s_waitcnt vmcnt(9)
  s_barrier
  ds_read_b64_tr_b16 v[164:165], v234 offset:12288
  v_mfma_f32_16x16x32_bf16 v[104:107], v[28:31], v[184:187], v[104:107]
  ds_read_b64_tr_b16 v[166:167], v236 offset:12288
  s_add_u32 m0, s68, 0
  s_add_u32 s94, s67, 983040
  buffer_load_dwordx4 v219, s[12:15], s94 offen lds
  v_mfma_f32_16x16x32_bf16 v[68:71], v[176:179], v[32:35], v[68:71]
  ds_read_b64_tr_b16 v[168:169], v234 offset:13312
  v_mfma_f32_16x16x32_bf16 v[88:91], v[180:183], v[32:35], v[88:91]
  ds_read_b64_tr_b16 v[170:171], v236 offset:13312
  v_mfma_f32_16x16x32_bf16 v[108:111], v[32:35], v[184:187], v[108:111]
  ds_read_b64_tr_b16 v[172:173], v234 offset:14336
  s_waitcnt lgkmcnt(5)
  v_mfma_f32_16x16x32_bf16 v[72:75], v[176:179], v[36:39], v[72:75]
  s_add_u32 m0, s68, 1024
  s_add_u32 s94, s67, 984064
  buffer_load_dwordx4 v219, s[12:15], s94 offen lds
  ds_read_b64_tr_b16 v[174:175], v236 offset:14336
  v_mfma_f32_16x16x32_bf16 v[92:95], v[180:183], v[36:39], v[92:95]
  ds_read_b128 v[8:11], v253 offset:47104
  v_mfma_f32_16x16x32_bf16 v[112:115], v[36:39], v[184:187], v[112:115]
  ds_read_b128 v[12:15], v253 offset:51200
  v_mfma_f32_16x16x32_bf16 v[76:79], v[176:179], v[40:43], v[76:79]
  ds_read_b128 v[16:19], v253 offset:55296
  v_mfma_f32_16x16x32_bf16 v[96:99], v[180:183], v[40:43], v[96:99]
  s_add_u32 m0, s68, 2048
  s_add_u32 s94, s67, 985088
  buffer_load_dwordx4 v219, s[12:15], s94 offen lds
  ds_read_b128 v[20:23], v253 offset:59392
  v_mfma_f32_16x16x32_bf16 v[116:119], v[40:43], v[184:187], v[116:119]
  ds_read_b128 v[24:27], v253 offset:63488
  v_mfma_f32_16x16x32_bf16 v[80:83], v[176:179], v[44:47], v[80:83]
  v_mfma_f32_16x16x32_bf16 v[100:103], v[180:183], v[44:47], v[100:103]
  v_mfma_f32_16x16x32_bf16 v[120:123], v[44:47], v[184:187], v[120:123]
  v_min_u32 v252, 3, v228
  v_lshlrev_b32 v252, 7, v252
  s_mul_i32 s94, s96, 512
  buffer_load_dword v212, v252, s[16:19], s94 offen
  v_mfma_f32_16x16x32_bf16 v[242:245], v[176:179], v[238:241], v[242:245]
  v_mfma_f32_16x16x32_bf16 v[246:249], v[180:183], v[238:241], v[246:249]
  v_mfma_f32_16x16x32_bf16 v[188:191], v[238:241], v[184:187], v[188:191]
  s_waitcnt lgkmcnt(5)
  s_waitcnt lgkmcnt(3)
  v_mfma_f32_16x16x32_bf16 v[84:87], v[168:171], v[8:11], v[84:87]
  s_waitcnt vmcnt(10)
  s_barrier
  ds_read_b64_tr_b16 v[176:177], v234 offset:24576
  v_mfma_f32_16x16x32_bf16 v[104:107], v[8:11], v[172:175], v[104:107]
  s_add_u32 m0, s68, 12288
  s_add_u32 s94, s67, 1081344
  buffer_load_dwordx4 v219, s[12:15], s94 offen lds
  ds_read_b64_tr_b16 v[178:179], v236 offset:24576
  v_mfma_f32_16x16x32_bf16 v[68:71], v[164:167], v[12:15], v[68:71]
  ds_read_b64_tr_b16 v[180:181], v234 offset:25600
  v_mfma_f32_16x16x32_bf16 v[88:91], v[168:171], v[12:15], v[88:91]
  ds_read_b64_tr_b16 v[182:183], v236 offset:25600
  v_mfma_f32_16x16x32_bf16 v[108:111], v[12:15], v[172:175], v[108:111]
  ds_read_b64_tr_b16 v[184:185], v234 offset:26624
  s_waitcnt lgkmcnt(5)
  v_mfma_f32_16x16x32_bf16 v[72:75], v[164:167], v[16:19], v[72:75]
  s_add_u32 m0, s68, 13312
  s_add_u32 s94, s67, 1082368
  buffer_load_dwordx4 v219, s[12:15], s94 offen lds
  ds_read_b64_tr_b16 v[186:187], v236 offset:26624
  v_mfma_f32_16x16x32_bf16 v[92:95], v[168:171], v[16:19], v[92:95]
  ds_read_b128 v[28:31], v254 offset:47104
  v_mfma_f32_16x16x32_bf16 v[112:115], v[16:19], v[172:175], v[112:115]
  ds_read_b128 v[32:35], v254 offset:51200
  v_mfma_f32_16x16x32_bf16 v[76:79], v[164:167], v[20:23], v[76:79]
  ds_read_b128 v[36:39], v254 offset:55296
  v_mfma_f32_16x16x32_bf16 v[96:99], v[168:171], v[20:23], v[96:99]
  s_add_u32 m0, s60, 24576
  s_add_u32 s94, s6, 768
  buffer_load_dwordx4 v255, s[8:11], s94 offen lds
  ds_read_b128 v[40:43], v254 offset:59392
  v_mfma_f32_16x16x32_bf16 v[116:119], v[20:23], v[172:175], v[116:119]
  ds_read_b128 v[44:47], v254 offset:63488
  v_mfma_f32_16x16x32_bf16 v[80:83], v[164:167], v[24:27], v[80:83]
  v_mfma_f32_16x16x32_bf16 v[100:103], v[168:171], v[24:27], v[100:103]
  v_mfma_f32_16x16x32_bf16 v[120:123], v[24:27], v[172:175], v[120:123]
  s_add_u32 m0, s60, 28672
  s_add_u32 s94, s7, 768
  buffer_load_dwordx4 v255, s[8:11], s94 offen lds
  v_mfma_f32_16x16x32_bf16 v[242:245], v[164:167], v[238:241], v[242:245]
  v_mfma_f32_16x16x32_bf16 v[246:249], v[168:171], v[238:241], v[246:249]
  v_mfma_f32_16x16x32_bf16 v[188:191], v[238:241], v[172:175], v[188:191]
  s_waitcnt lgkmcnt(5)
  s_waitcnt lgkmcnt(3)
  v_mfma_f32_16x16x32_bf16 v[84:87], v[180:183], v[28:31], v[84:87]
  s_add_u32 m0, s60, 32768
  s_add_u32 s94, s7, 17152
  buffer_load_dwordx4 v255, s[8:11], s94 offen lds
  s_waitcnt vmcnt(12)
  s_barrier
  ds_read_b128 v[48:51], v215 offset:0
  v_mfma_f32_16x16x32_bf16 v[104:107], v[28:31], v[184:187], v[104:107]
  ds_read_b128 v[52:55], v215 offset:4096
  s_add_u32 m0, s60, 36864
  s_add_u32 s94, s7, 33536
  buffer_load_dwordx4 v255, s[8:11], s94 offen lds
  v_mfma_f32_16x16x32_bf16 v[68:71], v[176:179], v[32:35], v[68:71]
  ds_read_b128 v[56:59], v215 offset:8192
  v_mfma_f32_16x16x32_bf16 v[88:91], v[180:183], v[32:35], v[88:91]
  ds_read_b128 v[60:63], v215 offset:12288
  ds_read_b128 v[64:67], v215 offset:16384
  v_mfma_f32_16x16x32_bf16 v[108:111], v[32:35], v[184:187], v[108:111]
  ds_read_b64_tr_b16 v[164:165], v234 offset:36864
  s_waitcnt lgkmcnt(6)
  v_mfma_f32_16x16x32_bf16 v[72:75], v[176:179], v[36:39], v[72:75]
  s_add_u32 m0, s60, 40960
  s_add_u32 s94, s7, 49920
  buffer_load_dwordx4 v255, s[8:11], s94 offen lds
  ds_read_b64_tr_b16 v[166:167], v236 offset:36864
  v_mfma_f32_16x16x32_bf16 v[92:95], v[180:183], v[36:39], v[92:95]
  ds_read_b64_tr_b16 v[168:169], v234 offset:37888
  ds_read_b64_tr_b16 v[170:171], v236 offset:37888
  v_mfma_f32_16x16x32_bf16 v[112:115], v[36:39], v[184:187], v[112:115]
  ds_read_b64_tr_b16 v[172:173], v234 offset:38912
  v_mfma_f32_16x16x32_bf16 v[76:79], v[176:179], v[40:43], v[76:79]
  ds_read_b64_tr_b16 v[174:175], v236 offset:38912
  v_min_u32 v252, 27, v228
  v_lshlrev_b32 v252, 7, v252
  s_mul_i32 s94, s96, 3584
  buffer_load_dword v212, v252, s[20:23], s94 offen
  v_mfma_f32_16x16x32_bf16 v[96:99], v[180:183], v[40:43], v[96:99]
  ds_read_b128 v[8:11], v253 offset:0
  ds_read_b128 v[12:15], v253 offset:4096
  v_mfma_f32_16x16x32_bf16 v[116:119], v[40:43], v[184:187], v[116:119]
  ds_read_b128 v[16:19], v253 offset:8192
  v_mfma_f32_16x16x32_bf16 v[80:83], v[176:179], v[44:47], v[80:83]
  ds_read_b128 v[20:23], v253 offset:12288
  v_mfma_f32_16x16x32_bf16 v[100:103], v[180:183], v[44:47], v[100:103]
  s_add_u32 m0, s68, 14336
  s_add_u32 s94, s67, 1083392
  buffer_load_dwordx4 v219, s[12:15], s94 offen lds
  ds_read_b128 v[24:27], v253 offset:16384
  v_mfma_f32_16x16x32_bf16 v[120:123], v[44:47], v[184:187], v[120:123]
  v_mfma_f32_16x16x32_bf16 v[242:245], v[176:179], v[238:241], v[242:245]
  v_mfma_f32_16x16x32_bf16 v[246:249], v[180:183], v[238:241], v[246:249]
  v_mfma_f32_16x16x32_bf16 v[188:191], v[238:241], v[184:187], v[188:191]
  s_add_u32 m0, s68, 24576
  s_add_u32 s94, s67, 1179648
  buffer_load_dwordx4 v219, s[12:15], s94 offen lds
  s_waitcnt lgkmcnt(14)
  v_mfma_f32_16x16x32_bf16 v[124:127], v[238:241], v[48:51], v[124:127]
  v_mfma_f32_16x16x32_bf16 v[144:147], v[48:51], v[48:51], v[144:147]
  v_mfma_f32_16x16x32_bf16 v[128:131], v[238:241], v[52:55], v[128:131]
  v_mfma_f32_16x16x32_bf16 v[148:151], v[52:55], v[52:55], v[148:151]
  s_add_u32 m0, s68, 25600
  s_add_u32 s94, s67, 1180672
  buffer_load_dwordx4 v219, s[12:15], s94 offen lds
  s_waitcnt lgkmcnt(13)
  v_mfma_f32_16x16x32_bf16 v[132:135], v[238:241], v[56:59], v[132:135]
  v_mfma_f32_16x16x32_bf16 v[152:155], v[56:59], v[56:59], v[152:155]
  s_waitcnt lgkmcnt(12)
  v_mfma_f32_16x16x32_bf16 v[136:139], v[238:241], v[60:63], v[136:139]
  v_mfma_f32_16x16x32_bf16 v[156:159], v[60:63], v[60:63], v[156:159]
  s_add_u32 m0, s68, 26624
  s_add_u32 s94, s67, 1181696
  buffer_load_dwordx4 v219, s[12:15], s94 offen lds
  s_waitcnt lgkmcnt(11)
  v_mfma_f32_16x16x32_bf16 v[140:143], v[238:241], v[64:67], v[140:143]
  v_mfma_f32_16x16x32_bf16 v[160:163], v[64:67], v[64:67], v[160:163]
  s_waitcnt lgkmcnt(5)
  s_waitcnt lgkmcnt(3)
  v_mfma_f32_16x16x32_bf16 v[84:87], v[168:171], v[8:11], v[84:87]
  s_waitcnt vmcnt(16)
  s_barrier
  ds_read_b64_tr_b16 v[176:177], v235 offset:0
  v_mfma_f32_16x16x32_bf16 v[104:107], v[8:11], v[172:175], v[104:107]
  s_add_u32 m0, s68, 36864
  s_add_u32 s94, s67, 1277952
  buffer_load_dwordx4 v219, s[12:15], s94 offen lds
  ds_read_b64_tr_b16 v[178:179], v237 offset:0
  v_mfma_f32_16x16x32_bf16 v[68:71], v[164:167], v[12:15], v[68:71]
  ds_read_b64_tr_b16 v[180:181], v235 offset:1024
  v_mfma_f32_16x16x32_bf16 v[88:91], v[168:171], v[12:15], v[88:91]
  ds_read_b64_tr_b16 v[182:183], v237 offset:1024
  v_mfma_f32_16x16x32_bf16 v[108:111], v[12:15], v[172:175], v[108:111]
  ds_read_b64_tr_b16 v[184:185], v235 offset:2048
  s_waitcnt lgkmcnt(5)
  v_mfma_f32_16x16x32_bf16 v[72:75], v[164:167], v[16:19], v[72:75]
  s_add_u32 m0, s68, 37888
  s_add_u32 s94, s67, 1278976
  buffer_load_dwordx4 v219, s[12:15], s94 offen lds
  ds_read_b64_tr_b16 v[186:187], v237 offset:2048
  v_min_u32 v252, 27, v228
  v_lshlrev_b32 v252, 7, v252
  s_mul_i32 s94, s96, 3584
  s_add_u32 s94, s94, 3670016
  buffer_load_dword v212, v252, s[20:23], s94 offen
  v_mfma_f32_16x16x32_bf16 v[92:95], v[168:171], v[16:19], v[92:95]
  ds_read_b128 v[28:31], v254 offset:0
  v_mfma_f32_16x16x32_bf16 v[112:115], v[16:19], v[172:175], v[112:115]
  ds_read_b128 v[32:35], v254 offset:4096
  v_mfma_f32_16x16x32_bf16 v[76:79], v[164:167], v[20:23], v[76:79]
  ds_read_b128 v[36:39], v254 offset:8192
  v_mfma_f32_16x16x32_bf16 v[96:99], v[168:171], v[20:23], v[96:99]
  s_add_u32 m0, s68, 38912
  s_add_u32 s94, s67, 1280000
  buffer_load_dwordx4 v219, s[12:15], s94 offen lds
  ds_read_b128 v[40:43], v254 offset:12288
  v_mfma_f32_16x16x32_bf16 v[116:119], v[20:23], v[172:175], v[116:119]
  ds_read_b128 v[44:47], v254 offset:16384
  v_mfma_f32_16x16x32_bf16 v[80:83], v[164:167], v[24:27], v[80:83]
  v_mfma_f32_16x16x32_bf16 v[100:103], v[168:171], v[24:27], v[100:103]
  v_mfma_f32_16x16x32_bf16 v[120:123], v[24:27], v[172:175], v[120:123]
  s_add_u32 m0, s60, 126976
  s_add_u32 s94, s69, 491520
  buffer_load_dwordx4 v218, s[16:19], s94 offen lds
  v_mfma_f32_16x16x32_bf16 v[242:245], v[164:167], v[238:241], v[242:245]
  v_mfma_f32_16x16x32_bf16 v[246:249], v[168:171], v[238:241], v[246:249]
  v_mfma_f32_16x16x32_bf16 v[188:191], v[238:241], v[172:175], v[188:191]
  s_waitcnt lgkmcnt(5)
  s_waitcnt lgkmcnt(3)
  v_mfma_f32_16x16x32_bf16 v[84:87], v[180:183], v[28:31], v[84:87]
  s_waitcnt vmcnt(18)
  s_barrier
  ds_read_b64_tr_b16 v[164:165], v234 offset:0
  v_mfma_f32_16x16x32_bf16 v[104:107], v[28:31], v[184:187], v[104:107]
  s_add_u32 m0, s68, 49152
  s_add_u32 s94, s67, 1376256
  buffer_load_dwordx4 v219, s[12:15], s94 offen lds
  ds_read_b64_tr_b16 v[166:167], v236 offset:0
  v_mfma_f32_16x16x32_bf16 v[68:71], v[176:179], v[32:35], v[68:71]
  ds_read_b64_tr_b16 v[168:169], v234 offset:1024
  v_mfma_f32_16x16x32_bf16 v[88:91], v[180:183], v[32:35], v[88:91]
  ds_read_b64_tr_b16 v[170:171], v236 offset:1024
  v_mfma_f32_16x16x32_bf16 v[108:111], v[32:35], v[184:187], v[108:111]
  ds_read_b64_tr_b16 v[172:173], v234 offset:2048
  s_waitcnt lgkmcnt(5)
  v_mfma_f32_16x16x32_bf16 v[72:75], v[176:179], v[36:39], v[72:75]
  s_add_u32 m0, s68, 50176
  s_add_u32 s94, s67, 1377280
  buffer_load_dwordx4 v219, s[12:15], s94 offen lds
  ds_read_b64_tr_b16 v[174:175], v236 offset:2048
  v_mfma_f32_16x16x32_bf16 v[92:95], v[180:183], v[36:39], v[92:95]
  ds_read_b128 v[8:11], v253 offset:2048
  v_mfma_f32_16x16x32_bf16 v[112:115], v[36:39], v[184:187], v[112:115]
  ds_read_b128 v[12:15], v253 offset:6144
  v_mfma_f32_16x16x32_bf16 v[76:79], v[176:179], v[40:43], v[76:79]
  ds_read_b128 v[16:19], v253 offset:10240
  v_mfma_f32_16x16x32_bf16 v[96:99], v[180:183], v[40:43], v[96:99]
  s_add_u32 m0, s68, 51200
  s_add_u32 s94, s67, 1378304
  buffer_load_dwordx4 v219, s[12:15], s94 offen lds
  ds_read_b128 v[20:23], v253 offset:14336
  v_mfma_f32_16x16x32_bf16 v[116:119], v[40:43], v[184:187], v[116:119]
  ds_read_b128 v[24:27], v253 offset:18432
  v_mfma_f32_16x16x32_bf16 v[80:83], v[176:179], v[44:47], v[80:83]
  v_mfma_f32_16x16x32_bf16 v[100:103], v[180:183], v[44:47], v[100:103]
  v_mfma_f32_16x16x32_bf16 v[120:123], v[44:47], v[184:187], v[120:123]
  v_mfma_f32_16x16x32_bf16 v[242:245], v[176:179], v[238:241], v[242:245]
  v_mfma_f32_16x16x32_bf16 v[246:249], v[180:183], v[238:241], v[246:249]
  v_mfma_f32_16x16x32_bf16 v[188:191], v[238:241], v[184:187], v[188:191]
  s_waitcnt lgkmcnt(5)
  s_waitcnt lgkmcnt(3)
  v_mfma_f32_16x16x32_bf16 v[84:87], v[168:171], v[8:11], v[84:87]
  s_waitcnt vmcnt(11)
  s_barrier
  ds_read_b64_tr_b16 v[176:177], v234 offset:12288
  v_mfma_f32_16x16x32_bf16 v[104:107], v[8:11], v[172:175], v[104:107]
  s_add_u32 m0, s68, 0
  s_add_u32 s94, s67, 1474560
  buffer_load_dwordx4 v219, s[12:15], s94 offen lds
  ds_read_b64_tr_b16 v[178:179], v236 offset:12288
  v_mfma_f32_16x16x32_bf16 v[68:71], v[164:167], v[12:15], v[68:71]
  ds_read_b64_tr_b16 v[180:181], v234 offset:13312
  v_mfma_f32_16x16x32_bf16 v[88:91], v[168:171], v[12:15], v[88:91]
  ds_read_b64_tr_b16 v[182:183], v236 offset:13312
  v_mfma_f32_16x16x32_bf16 v[108:111], v[12:15], v[172:175], v[108:111]
  ds_read_b64_tr_b16 v[184:185], v234 offset:14336
  s_waitcnt lgkmcnt(5)
  v_mfma_f32_16x16x32_bf16 v[72:75], v[164:167], v[16:19], v[72:75]
  s_add_u32 m0, s68, 1024
  s_add_u32 s94, s67, 1475584
  buffer_load_dwordx4 v219, s[12:15], s94 offen lds
  ds_read_b64_tr_b16 v[186:187], v236 offset:14336
  v_mfma_f32_16x16x32_bf16 v[92:95], v[168:171], v[16:19], v[92:95]
  ds_read_b128 v[28:31], v254 offset:2048
  v_mfma_f32_16x16x32_bf16 v[112:115], v[16:19], v[172:175], v[112:115]
  ds_read_b128 v[32:35], v254 offset:6144
  v_mfma_f32_16x16x32_bf16 v[76:79], v[164:167], v[20:23], v[76:79]
  ds_read_b128 v[36:39], v254 offset:10240
  v_mfma_f32_16x16x32_bf16 v[96:99], v[168:171], v[20:23], v[96:99]
  s_add_u32 m0, s68, 2048
  s_add_u32 s94, s67, 1476608
  buffer_load_dwordx4 v219, s[12:15], s94 offen lds
  ds_read_b128 v[40:43], v254 offset:14336
  v_mfma_f32_16x16x32_bf16 v[116:119], v[20:23], v[172:175], v[116:119]
  ds_read_b128 v[44:47], v254 offset:18432
  v_mfma_f32_16x16x32_bf16 v[80:83], v[164:167], v[24:27], v[80:83]
  v_mfma_f32_16x16x32_bf16 v[100:103], v[168:171], v[24:27], v[100:103]
  v_mfma_f32_16x16x32_bf16 v[120:123], v[24:27], v[172:175], v[120:123]
  v_mfma_f32_16x16x32_bf16 v[242:245], v[164:167], v[238:241], v[242:245]
  v_mfma_f32_16x16x32_bf16 v[246:249], v[168:171], v[238:241], v[246:249]
  v_mfma_f32_16x16x32_bf16 v[188:191], v[238:241], v[172:175], v[188:191]
  s_waitcnt lgkmcnt(5)
  s_waitcnt lgkmcnt(3)
  v_mfma_f32_16x16x32_bf16 v[84:87], v[180:183], v[28:31], v[84:87]
  s_waitcnt vmcnt(11)
  s_barrier
  ds_read_b128 v[48:51], v215 offset:24576
  v_mfma_f32_16x16x32_bf16 v[104:107], v[28:31], v[184:187], v[104:107]
  ds_read_b128 v[52:55], v215 offset:28672
  v_mfma_f32_16x16x32_bf16 v[68:71], v[176:179], v[32:35], v[68:71]
  ds_read_b128 v[56:59], v215 offset:32768
  v_mfma_f32_16x16x32_bf16 v[88:91], v[180:183], v[32:35], v[88:91]
  ds_read_b128 v[60:63], v215 offset:36864
  ds_read_b128 v[64:67], v215 offset:40960
  v_mfma_f32_16x16x32_bf16 v[108:111], v[32:35], v[184:187], v[108:111]
  s_add_u32 m0, s60, 77824
  s_add_u32 s94, s69, 98304
  buffer_load_dwordx4 v218, s[16:19], s94 offen lds
  ds_read_b64_tr_b16 v[164:165], v234 offset:24576
  s_waitcnt lgkmcnt(6)
  v_mfma_f32_16x16x32_bf16 v[72:75], v[176:179], v[36:39], v[72:75]
  ds_read_b64_tr_b16 v[166:167], v236 offset:24576
  v_mfma_f32_16x16x32_bf16 v[92:95], v[180:183], v[36:39], v[92:95]
  ds_read_b64_tr_b16 v[168:169], v234 offset:25600
  ds_read_b64_tr_b16 v[170:171], v236 offset:25600
  v_mfma_f32_16x16x32_bf16 v[112:115], v[36:39], v[184:187], v[112:115]
  ds_read_b64_tr_b16 v[172:173], v234 offset:26624
  s_add_u32 m0, s60, 81920
  s_add_u32 s94, s69, 131072
  buffer_load_dwordx4 v218, s[16:19], s94 offen lds
  v_mfma_f32_16x16x32_bf16 v[76:79], v[176:179], v[40:43], v[76:79]
  ds_read_b64_tr_b16 v[174:175], v236 offset:26624
  v_mfma_f32_16x16x32_bf16 v[96:99], v[180:183], v[40:43], v[96:99]
  ds_read_b128 v[8:11], v253 offset:24576
  ds_read_b128 v[12:15], v253 offset:28672
  v_mfma_f32_16x16x32_bf16 v[116:119], v[40:43], v[184:187], v[116:119]
  ds_read_b128 v[16:19], v253 offset:32768
  v_mfma_f32_16x16x32_bf16 v[80:83], v[176:179], v[44:47], v[80:83]
  s_add_u32 m0, s60, 86016
  s_add_u32 s94, s69, 163840
  buffer_load_dwordx4 v218, s[16:19], s94 offen lds
  ds_read_b128 v[20:23], v253 offset:36864
  v_mfma_f32_16x16x32_bf16 v[100:103], v[180:183], v[44:47], v[100:103]
  ds_read_b128 v[24:27], v253 offset:40960
  v_mfma_f32_16x16x32_bf16 v[120:123], v[44:47], v[184:187], v[120:123]
  v_mfma_f32_16x16x32_bf16 v[242:245], v[176:179], v[238:241], v[242:245]
  v_mfma_f32_16x16x32_bf16 v[246:249], v[180:183], v[238:241], v[246:249]
  v_mfma_f32_16x16x32_bf16 v[188:191], v[238:241], v[184:187], v[188:191]
  s_waitcnt lgkmcnt(14)
  v_mfma_f32_16x16x32_bf16 v[124:127], v[238:241], v[48:51], v[124:127]
  v_mfma_f32_16x16x32_bf16 v[144:147], v[48:51], v[48:51], v[144:147]
  v_mfma_f32_16x16x32_bf16 v[128:131], v[238:241], v[52:55], v[128:131]
  v_mfma_f32_16x16x32_bf16 v[148:151], v[52:55], v[52:55], v[148:151]
  s_waitcnt lgkmcnt(13)
  v_mfma_f32_16x16x32_bf16 v[132:135], v[238:241], v[56:59], v[132:135]
  v_mfma_f32_16x16x32_bf16 v[152:155], v[56:59], v[56:59], v[152:155]
  s_waitcnt lgkmcnt(12)
  v_mfma_f32_16x16x32_bf16 v[136:139], v[238:241], v[60:63], v[136:139]
  v_mfma_f32_16x16x32_bf16 v[156:159], v[60:63], v[60:63], v[156:159]
  s_waitcnt lgkmcnt(11)
  v_mfma_f32_16x16x32_bf16 v[140:143], v[238:241], v[64:67], v[140:143]
  v_mfma_f32_16x16x32_bf16 v[160:163], v[64:67], v[64:67], v[160:163]
  s_waitcnt lgkmcnt(5)
  s_waitcnt lgkmcnt(3)
  v_mfma_f32_16x16x32_bf16 v[84:87], v[168:171], v[8:11], v[84:87]
  s_waitcnt vmcnt(10)
  s_barrier
  ds_read_b64_tr_b16 v[176:177], v234 offset:36864
  ds_read_b64_tr_b16 v[178:179], v236 offset:36864
  v_mfma_f32_16x16x32_bf16 v[104:107], v[8:11], v[172:175], v[104:107]
  s_add_u32 m0, s60, 90112
  s_add_u32 s94, s69, 196608
  buffer_load_dwordx4 v218, s[16:19], s94 offen lds
  ds_read_b64_tr_b16 v[180:181], v234 offset:37888
  ds_read_b64_tr_b16 v[182:183], v236 offset:37888
  ds_read_b64_tr_b16 v[184:185], v234 offset:38912
  v_mfma_f32_16x16x32_bf16 v[68:71], v[164:167], v[12:15], v[68:71]
  ds_read_b64_tr_b16 v[186:187], v236 offset:38912
  ds_read_b128 v[28:31], v254 offset:24576
  v_mfma_f32_16x16x32_bf16 v[88:91], v[168:171], v[12:15], v[88:91]
  ds_read_b128 v[32:35], v254 offset:28672
  ds_read_b128 v[36:39], v254 offset:32768
  ds_read_b128 v[40:43], v254 offset:36864
  v_mfma_f32_16x16x32_bf16 v[108:111], v[12:15], v[172:175], v[108:111]
  s_add_u32 m0, s60, 94208
  s_add_u32 s94, s69, 229376
  buffer_load_dwordx4 v218, s[16:19], s94 offen lds
  ds_read_b128 v[44:47], v254 offset:40960
  s_mul_i32 s48, s77, 640
  v_and_b32 v1, 15, v228
  s_waitcnt lgkmcnt(11)
  v_mfma_f32_16x16x32_bf16 v[72:75], v[164:167], v[16:19], v[72:75]
  v_lshlrev_b32 v2, 3, v1
  v_add_u32 v2, s48, v2
  v_mfma_f32_16x16x32_bf16 v[92:95], v[168:171], v[16:19], v[92:95]
  v_add_u32 v206, 45056, v2
  v_lshlrev_b32 v2, 3, v228
  v_add_u32 v207, 45056, v2
  v_mfma_f32_16x16x32_bf16 v[112:115], v[16:19], v[172:175], v[112:115]
  s_add_u32 m0, s60, 98304
  s_add_u32 s94, s69, 262144
  buffer_load_dwordx4 v218, s[16:19], s94 offen lds
  s_add_u32 s48, s48, 47616
  v_lshlrev_b32 v2, 2, v1
  v_add_u32 v208, s48, v2
  v_mfma_f32_16x16x32_bf16 v[76:79], v[164:167], v[20:23], v[76:79]
  v_lshrrev_b32 v2, 4, v228
  v_lshlrev_b32 v2, 4, v2
  v_mfma_f32_16x16x32_bf16 v[96:99], v[168:171], v[20:23], v[96:99]
  v_add_u32 v209, s48, v2
  v_cndmask_b32 v125, v144, v145, s[84:85]
  v_cndmask_b32 v125, v125, v146, s[86:87]
  v_mfma_f32_16x16x32_bf16 v[116:119], v[20:23], v[172:175], v[116:119]
  s_mov_b32 s61, s98
  s_add_u32 m0, s56, 0
  s_nop 0
  buffer_load_dwordx4 v217, s[80:83], s61 offen lds
  v_cndmask_b32 v125, v125, v147, s[88:89]
  v_cndmask_b32 v129, v148, v149, s[84:85]
  v_cndmask_b32 v129, v129, v150, s[86:87]
  v_mfma_f32_16x16x32_bf16 v[80:83], v[164:167], v[24:27], v[80:83]
  v_cndmask_b32 v129, v129, v151, s[88:89]
  v_cndmask_b32 v133, v152, v153, s[84:85]
  v_mfma_f32_16x16x32_bf16 v[100:103], v[168:171], v[24:27], v[100:103]
  v_cndmask_b32 v133, v133, v154, s[86:87]
  v_cndmask_b32 v133, v133, v155, s[88:89]
  v_cndmask_b32 v137, v156, v157, s[84:85]
  v_mfma_f32_16x16x32_bf16 v[120:123], v[24:27], v[172:175], v[120:123]
  s_add_u32 s61, s61, s59
  s_add_u32 m0, s56, 1024
  s_nop 0
  buffer_load_dwordx4 v217, s[80:83], s61 offen lds
  v_cndmask_b32 v137, v137, v158, s[86:87]
  v_cndmask_b32 v137, v137, v159, s[88:89]
  v_cndmask_b32 v141, v160, v161, s[84:85]
  v_mfma_f32_16x16x32_bf16 v[242:245], v[164:167], v[238:241], v[242:245]
  v_cndmask_b32 v141, v141, v162, s[86:87]
  v_cndmask_b32 v141, v141, v163, s[88:89]
  v_mfma_f32_16x16x32_bf16 v[246:249], v[168:171], v[238:241], v[246:249]
  v_mfma_f32_16x16x32_bf16 v[188:191], v[238:241], v[172:175], v[188:191]
  s_add_u32 s61, s61, s59
  s_add_u32 m0, s56, 2048
  s_nop 0
  buffer_load_dwordx4 v217, s[80:83], s61 offen lds
  s_mov_b64 exec, s[92:93]
  ds_write_b64 v206, v[124:125] offset:0
  ds_write_b64 v206, v[128:129] offset:128
  ds_write_b64 v206, v[132:133] offset:256
  ds_write_b64 v206, v[136:137] offset:384
  ds_write_b64 v206, v[140:141] offset:512
  s_mov_b64 exec, -1
  s_add_u32 s61, s61, s59
  s_add_u32 m0, s56, 3072
  s_nop 0
  buffer_load_dwordx4 v217, s[80:83], s61 offen lds
  s_waitcnt lgkmcnt(10)
  s_waitcnt lgkmcnt(8)
  v_mfma_f32_16x16x32_bf16 v[84:87], v[180:183], v[28:31], v[84:87]
  s_waitcnt vmcnt(13)
  s_barrier
  ds_read_b64_tr_b16 v[164:165], v235 offset:0
  v_mfma_f32_16x16x32_bf16 v[104:107], v[28:31], v[184:187], v[104:107]
  s_add_u32 m0, s60, 102400
  s_add_u32 s94, s69, 294912
  buffer_load_dwordx4 v218, s[16:19], s94 offen lds
  ds_read_b64_tr_b16 v[166:167], v237 offset:0
  ds_read_b64_tr_b16 v[168:169], v235 offset:1024
  v_mfma_f32_16x16x32_bf16 v[68:71], v[176:179], v[32:35], v[68:71]
  ds_read_b64_tr_b16 v[170:171], v237 offset:1024
  v_mfma_f32_16x16x32_bf16 v[88:91], v[180:183], v[32:35], v[88:91]
  ds_read_b64_tr_b16 v[172:173], v235 offset:2048
  ds_read_b64_tr_b16 v[174:175], v237 offset:2048
  v_mfma_f32_16x16x32_bf16 v[108:111], v[32:35], v[184:187], v[108:111]
  ds_read_b128 v[8:11], v253 offset:26624
  s_add_u32 m0, s60, 106496
  s_add_u32 s94, s69, 327680
  buffer_load_dwordx4 v218, s[16:19], s94 offen lds
  s_waitcnt lgkmcnt(12)
  v_mfma_f32_16x16x32_bf16 v[72:75], v[176:179], v[36:39], v[72:75]
  ds_read_b128 v[12:15], v253 offset:30720
  ds_read_b128 v[16:19], v253 offset:34816
  v_mfma_f32_16x16x32_bf16 v[92:95], v[180:183], v[36:39], v[92:95]
  ds_read_b128 v[20:23], v253 offset:38912
  ds_read_b128 v[24:27], v253 offset:43008
  v_mfma_f32_16x16x32_bf16 v[112:115], v[36:39], v[184:187], v[112:115]
  v_and_b32 v1, 15, v228
  v_mfma_f32_16x16x32_bf16 v[76:79], v[176:179], v[40:43], v[76:79]
  s_add_u32 m0, s60, 110592
  s_add_u32 s94, s69, 360448
  buffer_load_dwordx4 v218, s[16:19], s94 offen lds
  v_lshlrev_b32 v1, 3, v1
  v_add_u32 v1, 45568, v1
  v_mfma_f32_16x16x32_bf16 v[96:99], v[180:183], v[40:43], v[96:99]
  s_waitcnt lgkmcnt(11)
  s_barrier
  v_mfma_f32_16x16x32_bf16 v[116:119], v[40:43], v[184:187], v[116:119]
  s_add_u32 s61, s61, s59
  s_add_u32 m0, s56, 4096
  s_nop 0
  buffer_load_dwordx4 v217, s[80:83], s61 offen lds
  ds_read_b64 v[48:49], v207 offset:0
  ds_read_b64 v[50:51], v207 offset:640
  v_mfma_f32_16x16x32_bf16 v[80:83], v[176:179], v[44:47], v[80:83]
  ds_read_b64 v[52:53], v207 offset:1280
  ds_read_b64 v[54:55], v207 offset:1920
  v_mfma_f32_16x16x32_bf16 v[100:103], v[180:183], v[44:47], v[100:103]
  ds_read_b64 v[56:57], v1 offset:0
  v_mfma_f32_16x16x32_bf16 v[120:123], v[44:47], v[184:187], v[120:123]
  ds_read_b64 v[58:59], v1 offset:640
  s_add_u32 s61, s61, s59
  s_add_u32 m0, s56, 5120
  s_nop 0
  buffer_load_dwordx4 v217, s[80:83], s61 offen lds
  ds_read_b64 v[60:61], v1 offset:1280
  v_mfma_f32_16x16x32_bf16 v[242:245], v[176:179], v[238:241], v[242:245]
  ds_read_b64 v[62:63], v1 offset:1920
  v_mfma_f32_16x16x32_bf16 v[246:249], v[180:183], v[238:241], v[246:249]
  v_mfma_f32_16x16x32_bf16 v[188:191], v[238:241], v[184:187], v[188:191]
  s_waitcnt lgkmcnt(13)
  s_waitcnt lgkmcnt(11)
  v_mfma_f32_16x16x32_bf16 v[84:87], v[168:171], v[8:11], v[84:87]
  s_add_u32 s61, s61, s59
  s_add_u32 m0, s56, 6144
  s_nop 0
  buffer_load_dwordx4 v217, s[80:83], s61 offen lds
  s_waitcnt vmcnt(16)
  s_barrier
  ds_read_b64_tr_b16 v[176:177], v234 offset:0
  ds_read_b64_tr_b16 v[178:179], v236 offset:0
  v_mfma_f32_16x16x32_bf16 v[104:107], v[8:11], v[172:175], v[104:107]
  s_add_u32 m0, s60, 114688
  s_add_u32 s94, s69, 393216
  buffer_load_dwordx4 v218, s[16:19], s94 offen lds
  ds_read_b64_tr_b16 v[180:181], v234 offset:1024
  ds_read_b64_tr_b16 v[182:183], v236 offset:1024
  v_mfma_f32_16x16x32_bf16 v[68:71], v[164:167], v[12:15], v[68:71]
  ds_read_b64_tr_b16 v[184:185], v234 offset:2048
  ds_read_b64_tr_b16 v[186:187], v236 offset:2048
  ds_read_b128 v[28:31], v254 offset:26624
  v_mfma_f32_16x16x32_bf16 v[88:91], v[168:171], v[12:15], v[88:91]
  ds_read_b128 v[32:35], v254 offset:30720
  ds_read_b128 v[36:39], v254 offset:34816
  v_mfma_f32_16x16x32_bf16 v[108:111], v[12:15], v[172:175], v[108:111]
  s_add_u32 m0, s60, 118784
  s_add_u32 s94, s69, 425984
  buffer_load_dwordx4 v218, s[16:19], s94 offen lds
  ds_read_b128 v[40:43], v254 offset:38912
  ds_read_b128 v[44:47], v254 offset:43008
  s_waitcnt lgkmcnt(11)
  v_pk_add_f32 v[48:49], v[48:49], v[50:51]
  v_mfma_f32_16x16x32_bf16 v[72:75], v[164:167], v[16:19], v[72:75]
  v_pk_add_f32 v[52:53], v[52:53], v[54:55]
  v_pk_add_f32 v[56:57], v[56:57], v[58:59]
  v_mfma_f32_16x16x32_bf16 v[92:95], v[168:171], v[16:19], v[92:95]
  s_waitcnt vmcnt(10)
  ds_read_b64_tr_b16 a[0:1], v221 offset:0
  ds_read_b64_tr_b16 a[2:3], v221 offset:1024
  v_pk_add_f32 v[60:61], v[60:61], v[62:63]
  v_pk_add_f32 v[48:49], v[48:49], v[52:53]
  v_pk_add_f32 v[56:57], v[56:57], v[60:61]
  v_mfma_f32_16x16x32_bf16 v[112:115], v[16:19], v[172:175], v[112:115]
  s_add_u32 m0, s60, 122880
  s_add_u32 s94, s69, 458752
  buffer_load_dwordx4 v218, s[16:19], s94 offen lds
  v_mul_f32 v48, 0xbb000000, v48
  v_mul_f32 v49, 0x3b000000, v49
  v_mfma_f32_16x16x32_bf16 v[76:79], v[164:167], v[20:23], v[76:79]
  ds_read_b64_tr_b16 a[4:5], v222 offset:0
  ds_read_b64_tr_b16 a[6:7], v222 offset:1024
  v_mul_f32 v56, 0xbb000000, v56
  v_mul_f32 v57, 0x3b000000, v57
  v_fma_f32 v49, -v48, v48, v49
  v_mfma_f32_16x16x32_bf16 v[96:99], v[168:171], v[20:23], v[96:99]
  v_fma_f32 v57, -v56, v56, v57
  v_max_f32 v49, 0, v49
  v_mfma_f32_16x16x32_bf16 v[116:119], v[20:23], v[172:175], v[116:119]
  s_add_u32 s61, s61, s59
  s_add_u32 m0, s56, 7168
  s_nop 0
  buffer_load_dwordx4 v217, s[80:83], s61 offen lds
  v_max_f32 v57, 0, v57
  v_add_f32 v49, 0x3727c5ac, v49
  v_add_f32 v57, 0x3727c5ac, v57
  v_mfma_f32_16x16x32_bf16 v[80:83], v[164:167], v[24:27], v[80:83]
  s_waitcnt vmcnt(10)
  ds_read_b64_tr_b16 a[8:9], v221 offset:2048
  ds_read_b64_tr_b16 a[10:11], v221 offset:3072
  v_rsq_f32 v49, v49
  v_rsq_f32 v57, v57
  v_mfma_f32_16x16x32_bf16 v[100:103], v[168:171], v[24:27], v[100:103]
  ds_read_b64_tr_b16 a[12:13], v222 offset:2048
  ds_read_b64_tr_b16 a[14:15], v222 offset:3072
  v_lshrrev_b32 v2, 4, v228
  v_lshl_add_u32 v2, v2, 6, v208
  ds_write2_b32 v2, v49, v48 offset0:0 offset1:80
  v_mfma_f32_16x16x32_bf16 v[120:123], v[24:27], v[172:175], v[120:123]
  s_waitcnt lgkmcnt(5)
  s_mul_i32 s82, s76, 7340032
  s_add_u32 s61, s98, 229376
  s_cmp_ge_u32 s61, s99
  s_cselect_b32 s94, 1835008, 0
  s_sub_u32 s61, s61, s94
  s_add_u32 m0, s56, 0
  s_nop 0
  buffer_load_dwordx4 v217, s[80:83], s61 offen lds
  ds_write2_b32 v208, v57, v56 offset0:64 offset1:144
  s_mov_b32 s94, 0
  v_mfma_f32_16x16x32_bf16 v[242:245], v[164:167], v[238:241], v[242:245]
  v_mov_b32 v252, 0
  buffer_load_dword v233, v252, s[44:47], s94 offen sc1
  v_mfma_f32_16x16x32_bf16 v[246:249], v[168:171], v[238:241], v[246:249]
  v_mfma_f32_16x16x32_bf16 v[188:191], v[238:241], v[172:175], v[188:191]
  v_mfma_f32_16x16x32_bf16 v[84:87], v[180:183], v[28:31], v[84:87]
  s_waitcnt lgkmcnt(0)
  s_add_u32 s61, s61, 28672
  s_add_u32 m0, s56, 1024
  s_nop 0
  buffer_load_dwordx4 v217, s[80:83], s61 offen lds
  ds_read2_b32 v[124:125], v208 offset0:0 offset1:80
  ds_read2_b32 v[128:129], v208 offset0:16 offset1:96
  v_mfma_f32_16x16x32_bf16 v[104:107], v[28:31], v[184:187], v[104:107]
  ds_read2_b32 v[132:133], v208 offset0:32 offset1:112
  v_mfma_f32_16x16x32_bf16 v[68:71], v[176:179], v[32:35], v[68:71]
  ds_read2_b32 v[136:137], v208 offset0:48 offset1:128
  ds_read2_b32 v[140:141], v208 offset0:64 offset1:144
  v_mfma_f32_16x16x32_bf16 v[88:91], v[180:183], v[32:35], v[88:91]
  ds_read_b128 v[144:147], v209 offset:0
  s_add_u32 s61, s61, 28672
  s_add_u32 m0, s56, 2048
  s_nop 0
  buffer_load_dwordx4 v217, s[80:83], s61 offen lds
  v_mfma_f32_16x16x32_bf16 v[108:111], v[32:35], v[184:187], v[108:111]
  ds_read_b128 v[48:51], v209 offset:320
  v_mfma_f32_16x16x32_bf16 v[72:75], v[176:179], v[36:39], v[72:75]
  ds_read_b128 v[148:151], v209 offset:64
  s_waitcnt vmcnt(9)
  ds_read_b64_tr_b16 a[16:17], v221 offset:4096
  ds_read_b64_tr_b16 a[18:19], v221 offset:5120
  ds_read_b128 v[52:55], v209 offset:384
  v_mfma_f32_16x16x32_bf16 v[92:95], v[180:183], v[36:39], v[92:95]
  s_add_u32 s61, s61, 28672
  s_add_u32 m0, s56, 3072
  s_nop 0
  buffer_load_dwordx4 v217, s[80:83], s61 offen lds
  ds_read_b128 v[152:155], v209 offset:128
  v_mfma_f32_16x16x32_bf16 v[112:115], v[36:39], v[184:187], v[112:115]
  ds_read_b64_tr_b16 a[20:21], v222 offset:4096
  ds_read_b64_tr_b16 a[22:23], v222 offset:5120
  ds_read_b128 v[56:59], v209 offset:448
  v_mfma_f32_16x16x32_bf16 v[76:79], v[176:179], v[40:43], v[76:79]
  ds_read_b128 v[156:159], v209 offset:192
  ds_read_b128 v[60:63], v209 offset:512
  v_mfma_f32_16x16x32_bf16 v[96:99], v[180:183], v[40:43], v[96:99]
  ds_read_b128 v[160:163], v209 offset:256
  v_mfma_f32_16x16x32_bf16 v[116:119], v[40:43], v[184:187], v[116:119]
  ds_read_b128 v[64:67], v209 offset:576
  v_mfma_f32_16x16x32_bf16 v[80:83], v[176:179], v[44:47], v[80:83]
  v_mfma_f32_16x16x32_bf16 v[100:103], v[180:183], v[44:47], v[100:103]
  v_mfma_f32_16x16x32_bf16 v[120:123], v[44:47], v[184:187], v[120:123]
  v_mfma_f32_16x16x32_bf16 v[242:245], v[176:179], v[238:241], v[242:245]
  v_mfma_f32_16x16x32_bf16 v[246:249], v[180:183], v[238:241], v[246:249]
  v_mfma_f32_16x16x32_bf16 v[188:191], v[238:241], v[184:187], v[188:191]
  s_waitcnt lgkmcnt(5)
  s_add_u32 s61, s61, 28672
  s_add_u32 m0, s56, 4096
  s_nop 0
  buffer_load_dwordx4 v217, s[80:83], s61 offen lds
  s_waitcnt lgkmcnt(0)
  s_barrier
  s_nop 0
  v_mov_b32 v250, v188
  s_xor_b32 s3, s77, 1
  s_mul_i32 s3, s3, 6144
  s_add_u32 m0, s60, 65536
  s_nop 0
  buffer_load_dwordx4 v218, s[16:19], s69 offen lds
  s_add_u32 s3, s3, 0
  v_add_u32 v253, s3, v213
  s_xor_b32 s3, s77, 2
  s_mul_i32 s3, s3, 6144
  s_add_u32 s3, s3, 2048
  v_add_u32 v254, s3, v213
  s_xor_b32 s3, s77, 3
  s_mul_i32 s3, s3, 6144
  s_add_u32 s3, s3, 4096
  v_add_u32 v255, s3, v213
  s_cmp_eq_u32 s72, 0
  s_cselect_b32 s48, 0xff61b1e6, 0
  s_add_u32 m0, s60, 69632
  s_add_u32 s94, s69, 32768
  buffer_load_dwordx4 v218, s[16:19], s94 offen lds
  v_min_f32 v176, s48, v198
  v_min_f32 v177, s48, v199
  v_min_f32 v178, s48, v200
  v_min_f32 v179, s48, v201
  v_pk_fma_f32 v[84:85], v[246:247], v[124:125], v[84:85] op_sel:[0,1,0]
  v_pk_fma_f32 v[86:87], v[248:249], v[124:125], v[86:87] op_sel:[0,1,0]
  s_waitcnt vmcnt(8)
  ds_read_b64_tr_b16 a[24:25], v221 offset:6144
  ds_read_b64_tr_b16 a[26:27], v221 offset:7168
  v_pk_mul_f32 v[84:85], v[84:85], v[124:125] op_sel_hi:[1,0]
  v_pk_mul_f32 v[86:87], v[86:87], v[124:125] op_sel_hi:[1,0]
  v_cvt_pk_bf16_f32 v10, v84, v85
  v_cvt_pk_bf16_f32 v11, v86, v87
  ds_read_b64_tr_b16 a[28:29], v222 offset:6144
  ds_read_b64_tr_b16 a[30:31], v222 offset:7168
  s_add_u32 m0, s60, 73728
  s_add_u32 s94, s69, 65536
  buffer_load_dwordx4 v218, s[16:19], s94 offen lds
  v_pk_fma_f32 v[88:89], v[246:247], v[128:129], v[88:89] op_sel:[0,1,0]
  v_pk_fma_f32 v[68:69], v[242:243], v[128:129], v[68:69] op_sel:[0,1,0]
  v_pk_fma_f32 v[90:91], v[248:249], v[128:129], v[90:91] op_sel:[0,1,0]
  v_pk_fma_f32 v[70:71], v[244:245], v[128:129], v[70:71] op_sel:[0,1,0]
  v_pk_mul_f32 v[88:89], v[88:89], v[128:129] op_sel_hi:[1,0]
  v_pk_mul_f32 v[90:91], v[90:91], v[128:129] op_sel_hi:[1,0]
  v_cvt_pk_bf16_f32 v12, v68, v69
  v_cvt_pk_bf16_f32 v13, v70, v71
  v_mul_f32 v128, 0x3eb8aa3b, v128
  v_cvt_pk_bf16_f32 v14, v88, v89
  v_cvt_pk_bf16_f32 v15, v90, v91
  s_add_u32 s61, s61, 28672
  s_add_u32 m0, s56, 5120
  s_nop 0
  buffer_load_dwordx4 v217, s[80:83], s61 offen lds
  v_pk_fma_f32 v[92:93], v[246:247], v[132:133], v[92:93] op_sel:[0,1,0]
  v_pk_fma_f32 v[72:73], v[242:243], v[132:133], v[72:73] op_sel:[0,1,0]
  v_pk_fma_f32 v[94:95], v[248:249], v[132:133], v[94:95] op_sel:[0,1,0]
  v_pk_fma_f32 v[74:75], v[244:245], v[132:133], v[74:75] op_sel:[0,1,0]
  v_pk_mul_f32 v[92:93], v[92:93], v[132:133] op_sel_hi:[1,0]
  v_pk_mul_f32 v[94:95], v[94:95], v[132:133] op_sel_hi:[1,0]
  v_cvt_pk_bf16_f32 v16, v72, v73
  v_cvt_pk_bf16_f32 v17, v74, v75
  v_mul_f32 v132, 0x3eb8aa3b, v132
  v_cvt_pk_bf16_f32 v18, v92, v93
  v_cvt_pk_bf16_f32 v19, v94, v95
  v_pk_fma_f32 v[96:97], v[246:247], v[136:137], v[96:97] op_sel:[0,1,0]
  v_pk_fma_f32 v[76:77], v[242:243], v[136:137], v[76:77] op_sel:[0,1,0]
  s_waitcnt lgkmcnt(0)
  s_add_u32 s61, s61, 28672
  s_add_u32 m0, s56, 6144
  s_nop 0
  buffer_load_dwordx4 v217, s[80:83], s61 offen lds
  v_pk_fma_f32 v[98:99], v[248:249], v[136:137], v[98:99] op_sel:[0,1,0]
  v_pk_fma_f32 v[78:79], v[244:245], v[136:137], v[78:79] op_sel:[0,1,0]
  v_pk_mul_f32 v[96:97], v[96:97], v[136:137] op_sel_hi:[1,0]
  v_pk_mul_f32 v[98:99], v[98:99], v[136:137] op_sel_hi:[1,0]
  v_cvt_pk_bf16_f32 v20, v76, v77
  v_cvt_pk_bf16_f32 v21, v78, v79
  v_mul_f32 v136, 0x3eb8aa3b, v136
  v_cvt_pk_bf16_f32 v22, v96, v97
  v_cvt_pk_bf16_f32 v23, v98, v99
  v_pk_fma_f32 v[100:101], v[246:247], v[140:141], v[100:101] op_sel:[0,1,0]
  v_pk_fma_f32 v[80:81], v[242:243], v[140:141], v[80:81] op_sel:[0,1,0]
  s_add_u32 s61, s61, 28672
  s_add_u32 m0, s56, 7168
  s_nop 0
  buffer_load_dwordx4 v217, s[80:83], s61 offen lds
  v_pk_fma_f32 v[102:103], v[248:249], v[140:141], v[102:103] op_sel:[0,1,0]
  s_waitcnt vmcnt(9)
  ds_read_b64_tr_b16 a[32:33], v221 offset:0
  ds_read_b64_tr_b16 a[34:35], v221 offset:1024
  v_pk_fma_f32 v[82:83], v[244:245], v[140:141], v[82:83] op_sel:[0,1,0]
  v_pk_mul_f32 v[100:101], v[100:101], v[140:141] op_sel_hi:[1,0]
  v_pk_mul_f32 v[102:103], v[102:103], v[140:141] op_sel_hi:[1,0]
  v_cvt_pk_bf16_f32 v24, v80, v81
  ds_read_b64_tr_b16 a[36:37], v222 offset:0
  ds_read_b64_tr_b16 a[38:39], v222 offset:1024
  v_cvt_pk_bf16_f32 v25, v82, v83
  v_mul_f32 v140, 0x3eb8aa3b, v140
  v_cvt_pk_bf16_f32 v26, v100, v101
  v_cvt_pk_bf16_f32 v27, v102, v103
  v_mfma_f32_16x16x16_bf16 v[68:71], v[10:11], v[12:13], v[176:179]
  v_mfma_f32_16x16x16_bf16 v[88:91], v[14:15], v[12:13], v[194:197]
  v_mfma_f32_16x16x16_bf16 v[72:75], v[14:15], v[16:17], v[198:201]
  v_mfma_f32_16x16x16_bf16 v[92:95], v[18:19], v[16:17], v[194:197]
  v_mfma_f32_16x16x16_bf16 v[76:79], v[18:19], v[20:21], v[198:201]
  v_mfma_f32_16x16x16_bf16 v[96:99], v[22:23], v[20:21], v[194:197]
  s_waitcnt vmcnt(7)
  ds_read_b64_tr_b16 a[40:41], v221 offset:2048
  ds_read_b64_tr_b16 a[42:43], v221 offset:3072
  v_mfma_f32_16x16x16_bf16 v[80:83], v[22:23], v[24:25], v[198:201]
  v_mfma_f32_16x16x16_bf16 v[100:103], v[26:27], v[24:25], v[194:197]
  s_waitcnt lgkmcnt(2)
  s_add_u32 s61, s98, 458752
  s_cmp_ge_u32 s61, s99
  s_cselect_b32 s94, 1835008, 0
  s_sub_u32 s61, s61, s94
  s_add_u32 m0, s56, 0
  s_nop 0
  buffer_load_dwordx4 v217, s[80:83], s61 offen lds
  v_pk_fma_f32 v[104:105], v[48:49], v[250:251], v[104:105] op_sel_hi:[1,0,1]
  v_pk_fma_f32 v[106:107], v[50:51], v[250:251], v[106:107] op_sel_hi:[1,0,1]
  v_pk_mul_f32 v[104:105], v[104:105], v[144:145]
  ds_read_b64_tr_b16 a[44:45], v222 offset:2048
  ds_read_b64_tr_b16 a[46:47], v222 offset:3072
  v_pk_mul_f32 v[106:107], v[106:107], v[146:147]
  v_cvt_pk_bf16_f32 v164, v104, v105
  v_cvt_pk_bf16_f32 v165, v106, v107
  v_pk_fma_f32 v[108:109], v[52:53], v[250:251], v[108:109] op_sel_hi:[1,0,1]
  v_pk_fma_f32 v[110:111], v[54:55], v[250:251], v[110:111] op_sel_hi:[1,0,1]
  s_add_u32 s61, s61, 28672
  s_add_u32 m0, s56, 1024
  s_nop 0
  buffer_load_dwordx4 v217, s[80:83], s61 offen lds
  v_pk_mul_f32 v[108:109], v[108:109], v[148:149]
  v_pk_mul_f32 v[110:111], v[110:111], v[150:151]
  v_cvt_pk_bf16_f32 v166, v108, v109
  v_cvt_pk_bf16_f32 v167, v110, v111
  v_pk_fma_f32 v[112:113], v[56:57], v[250:251], v[112:113] op_sel_hi:[1,0,1]
  v_pk_fma_f32 v[114:115], v[58:59], v[250:251], v[114:115] op_sel_hi:[1,0,1]
  v_pk_mul_f32 v[112:113], v[112:113], v[152:153]
  v_pk_mul_f32 v[114:115], v[114:115], v[154:155]
  v_cvt_pk_bf16_f32 v168, v112, v113
  v_cvt_pk_bf16_f32 v169, v114, v115
  v_pk_fma_f32 v[116:117], v[60:61], v[250:251], v[116:117] op_sel_hi:[1,0,1]
  v_pk_fma_f32 v[118:119], v[62:63], v[250:251], v[118:119] op_sel_hi:[1,0,1]
  v_pk_mul_f32 v[116:117], v[116:117], v[156:157]
  v_pk_mul_f32 v[118:119], v[118:119], v[158:159]
  v_cvt_pk_bf16_f32 v170, v116, v117
  v_cvt_pk_bf16_f32 v171, v118, v119
  v_pk_fma_f32 v[120:121], v[64:65], v[250:251], v[120:121] op_sel_hi:[1,0,1]
  v_pk_fma_f32 v[122:123], v[66:67], v[250:251], v[122:123] op_sel_hi:[1,0,1]
  v_pk_mul_f32 v[120:121], v[120:121], v[160:161]
  s_waitcnt lgkmcnt(0)
  s_add_u32 s61, s61, 28672
  s_add_u32 m0, s56, 2048
  s_nop 0
  buffer_load_dwordx4 v217, s[80:83], s61 offen lds
  v_pk_mul_f32 v[122:123], v[122:123], v[162:163]
  v_cvt_pk_bf16_f32 v172, v120, v121
  v_cvt_pk_bf16_f32 v173, v122, v123
  v_max3_f32 v32, v68, v69, v88
  v_max3_f32 v33, v70, v71, v90
  v_max3_f32 v36, v72, v73, v92
  v_max3_f32 v37, v74, v75, v94
  v_max3_f32 v40, v76, v77, v96
  v_max3_f32 v41, v78, v79, v98
  v_max3_f32 v44, v80, v81, v100
  v_max3_f32 v45, v82, v83, v102
  v_max_f32 v32, v32, v89
  s_add_u32 s61, s61, 28672
  s_add_u32 m0, s56, 3072
  s_nop 0
  buffer_load_dwordx4 v217, s[80:83], s61 offen lds
  v_max_f32 v33, v33, v91
  v_max_f32 v36, v36, v93
  v_max_f32 v37, v37, v95
  v_max_f32 v40, v40, v97
  v_max_f32 v41, v41, v99
  v_max_f32 v44, v44, v101
  v_max_f32 v45, v45, v103
  v_max_f32 v34, v32, v33
  v_max_f32 v38, v36, v37
  v_max_f32 v42, v40, v41
  v_max_f32 v46, v44, v45
  v_mov_b32 v35, v34
  v_mov_b32 v39, v38
  v_mov_b32 v43, v42
  v_mov_b32 v47, v46
  v_permlane16_swap_b32 v34, v35
  v_permlane16_swap_b32 v38, v39
  v_permlane16_swap_b32 v42, v43
  v_permlane16_swap_b32 v46, v47
  v_max_f32 v34, v34, v35
  v_max_f32 v38, v38, v39
  v_max_f32 v42, v42, v43
  v_max_f32 v46, v46, v47
  v_mov_b32 v35, v34
  v_mov_b32 v39, v38
  v_mov_b32 v43, v42
  v_mov_b32 v47, v46
  v_permlane32_swap_b32 v34, v35
  v_permlane32_swap_b32 v38, v39
  v_permlane32_swap_b32 v42, v43
  v_permlane32_swap_b32 v46, v47
  v_max_f32 v34, v34, v35
  s_waitcnt vmcnt(6)
  ds_read_b64_tr_b16 a[48:49], v221 offset:4096
  ds_read_b64_tr_b16 a[50:51], v221 offset:5120
  v_max_f32 v38, v38, v39
  v_max_f32 v42, v42, v43
  v_max_f32 v46, v46, v47
  v_pk_add_f32 v[32:33], v[32:33], v[34:35] op_sel_hi:[1,0] neg_lo:[0,1] neg_hi:[0,1]
  ds_read_b64_tr_b16 a[52:53], v222 offset:4096
  ds_read_b64_tr_b16 a[54:55], v222 offset:5120
  v_pk_add_f32 v[36:37], v[36:37], v[38:39] op_sel_hi:[1,0] neg_lo:[0,1] neg_hi:[0,1]
  v_pk_add_f32 v[40:41], v[40:41], v[42:43] op_sel_hi:[1,0] neg_lo:[0,1] neg_hi:[0,1]
  v_pk_add_f32 v[44:45], v[44:45], v[46:47] op_sel_hi:[1,0] neg_lo:[0,1] neg_hi:[0,1]
  v_pk_mul_f32 v[32:33], v[32:33], v[128:129] op_sel_hi:[1,0]
  v_pk_mul_f32 v[36:37], v[36:37], v[132:133] op_sel_hi:[1,0]
  v_pk_mul_f32 v[40:41], v[40:41], v[136:137] op_sel_hi:[1,0]
  v_pk_mul_f32 v[44:45], v[44:45], v[140:141] op_sel_hi:[1,0]
  v_exp_f32 v32, v32
  v_exp_f32 v33, v33
  v_exp_f32 v36, v36
  v_exp_f32 v37, v37
  v_exp_f32 v40, v40
  v_exp_f32 v41, v41
  v_exp_f32 v44, v44
  v_exp_f32 v45, v45
  v_cvt_pk_bf16_f32 v32, v32, v32
  v_cvt_pk_bf16_f32 v33, v33, v33
  v_cvt_pk_bf16_f32 v36, v36, v36
  v_cvt_pk_bf16_f32 v37, v37, v37
  s_waitcnt vmcnt(4)
  ds_read_b64_tr_b16 a[56:57], v221 offset:6144
  ds_read_b64_tr_b16 a[58:59], v221 offset:7168
  v_cvt_pk_bf16_f32 v40, v40, v40
  v_cvt_pk_bf16_f32 v41, v41, v41
  v_cvt_pk_bf16_f32 v44, v44, v44
  s_waitcnt lgkmcnt(2)
  s_add_u32 s61, s61, 28672
  s_add_u32 m0, s56, 4096
  s_nop 0
  buffer_load_dwordx4 v217, s[80:83], s61 offen lds
  v_cvt_pk_bf16_f32 v45, v45, v45
  ds_read_b64_tr_b16 a[60:61], v222 offset:6144
  ds_read_b64_tr_b16 a[62:63], v222 offset:7168
  v_and_b32 v108, v32, v202
  v_and_b32 v109, v33, v203
  v_and_b32 v110, v32, v204
  v_and_b32 v111, v33, v205
  v_and_b32 v112, v36, v202
  v_and_b32 v113, v37, v203
  v_and_b32 v114, v36, v204
  v_and_b32 v115, v37, v205
  s_add_u32 s61, s61, 28672
  s_add_u32 m0, s56, 5120
  s_nop 0
  buffer_load_dwordx4 v217, s[80:83], s61 offen lds
  v_and_b32 v116, v40, v202
  v_and_b32 v117, v41, v203
  v_and_b32 v118, v40, v204
  v_and_b32 v119, v41, v205
  v_and_b32 v120, v44, v202
  v_and_b32 v121, v45, v203
  v_and_b32 v122, v44, v204
  v_cmp_gt_u32 vcc, 8, v233
  s_cbranch_vccnz L_poll_68002_r
L_poll_68002:
  s_cmp_lg_u32 s77, 0
  s_cbranch_scc1 L_sig_68003
  s_mov_b32 exec_lo, 15
  s_mov_b32 exec_hi, 0
  buffer_atomic_add v251, v223, s[28:31], 0 offen offset:0 sc1
  s_mov_b64 exec, -1
L_sig_68003:
  v_and_b32 v123, v45, v205
  v_mfma_f32_16x16x32_bf16 v[68:71], v[238:241], v[108:111], 0
  v_mfma_f32_16x16x32_bf16 v[88:91], v[164:167], v[108:111], 0
  v_mfma_f32_16x16x32_bf16 v[72:75], v[238:241], v[112:115], 0
  v_mfma_f32_16x16x32_bf16 v[92:95], v[166:169], v[112:115], 0
  s_waitcnt lgkmcnt(0)
  s_add_u32 s61, s61, 28672
  s_add_u32 m0, s56, 6144
  s_nop 0
  buffer_load_dwordx4 v217, s[80:83], s61 offen lds
  v_mfma_f32_16x16x32_bf16 v[76:79], v[238:241], v[116:119], 0
  s_waitcnt vmcnt(5)
  ds_read_b64_tr_b16 a[64:65], v221 offset:0
  ds_read_b64_tr_b16 a[66:67], v221 offset:1024
  v_mfma_f32_16x16x32_bf16 v[96:99], v[168:171], v[116:119], 0
  v_mfma_f32_16x16x32_bf16 v[80:83], v[238:241], v[120:123], 0
  ds_read_b64_tr_b16 a[68:69], v222 offset:0
  ds_read_b64_tr_b16 a[70:71], v222 offset:1024
  v_mfma_f32_16x16x32_bf16 v[100:103], v[170:173], v[120:123], 0
  s_add_u32 s48, s0, 0
  s_add_u32 s49, s0, 32768
  v_rcp_f32 v68, v68
  v_rcp_f32 v72, v72
  v_rcp_f32 v76, v76
  v_rcp_f32 v80, v80
  v_pk_mul_f32 v[88:89], v[88:89], v[68:69] op_sel_hi:[1,0]
  v_pk_mul_f32 v[90:91], v[90:91], v[68:69] op_sel_hi:[1,0]
  v_pk_mul_f32 v[92:93], v[92:93], v[72:73] op_sel_hi:[1,0]
  v_pk_mul_f32 v[94:95], v[94:95], v[72:73] op_sel_hi:[1,0]
  s_add_u32 s61, s61, 28672
  s_add_u32 m0, s56, 7168
  s_nop 0
  buffer_load_dwordx4 v217, s[80:83], s61 offen lds
  v_pk_mul_f32 v[96:97], v[96:97], v[76:77] op_sel_hi:[1,0]
  v_pk_mul_f32 v[98:99], v[98:99], v[76:77] op_sel_hi:[1,0]
  v_pk_mul_f32 v[100:101], v[100:101], v[80:81] op_sel_hi:[1,0]
  v_pk_mul_f32 v[102:103], v[102:103], v[80:81] op_sel_hi:[1,0]
  v_cvt_pk_bf16_f32 v8, v88, v89
  v_cvt_pk_bf16_f32 v9, v90, v91
  v_cvt_pk_bf16_f32 v10, v92, v93
  s_waitcnt vmcnt(4)
  ds_read_b64_tr_b16 a[72:73], v221 offset:2048
  ds_read_b64_tr_b16 a[74:75], v221 offset:3072
  v_cvt_pk_bf16_f32 v11, v94, v95
  v_cvt_pk_bf16_f32 v12, v96, v97
  v_cvt_pk_bf16_f32 v13, v98, v99
  v_cvt_pk_bf16_f32 v14, v100, v101
  ds_read_b64_tr_b16 a[76:77], v222 offset:2048
  ds_read_b64_tr_b16 a[78:79], v222 offset:3072
  v_cvt_pk_bf16_f32 v15, v102, v103
  s_mov_b64 exec, 1
  v_mov_b32 v233, 0
  buffer_atomic_add v233, v226, s[28:31], 0 offen offset:0 sc0 sc1
  s_mov_b64 exec, -1
  v_permlane32_swap_b32 v8, v10
  v_permlane32_swap_b32 v9, v11
  buffer_store_dwordx4 v[8:11], v229, s[28:31], s48 offen sc1
  v_permlane32_swap_b32 v12, v14
  v_permlane32_swap_b32 v13, v15
  buffer_store_dwordx4 v[12:15], v229, s[28:31], s49 offen sc1
  s_lshl_b32 s48, s72, 1
  s_add_u32 s48, s48, s79
  s_lshl_b32 s48, s48, 15
  s_lshl_b32 s49, s73, 1
  s_add_u32 s49, s49, s78
  s_lshl_b32 s50, s49, 10
  s_add_u32 s52, s48, s50
  s_lshl_b32 s50, s49, 6
  s_add_u32 s50, s48, s50
  v_and_b32 v1, 31, v228
  v_lshlrev_b32 v1, 10, v1
  v_lshrrev_b32 v2, 5, v228
  v_lshl_add_u32 v1, v2, 3, v1
  buffer_load_dwordx2 v[164:165], v1, s[8:11], s50 offen offset:0
  buffer_load_dwordx2 v[166:167], v1, s[8:11], s50 offen offset:16
  buffer_load_dwordx2 v[168:169], v1, s[8:11], s50 offen offset:32
  buffer_load_dwordx2 v[170:171], v1, s[8:11], s50 offen offset:48
  s_lshl_b32 s48, s79, 15
  s_lshl_b32 s49, s78, 12
  s_add_u32 s53, s48, s49
  s_lshl_b32 s49, s72, 16
  s_add_u32 s58, s49, s53
  s_add_u32 s48, s48, 0
  s_add_u32 s53, s53, 0
  v_add_u32 v2, s48, v213
  v_add_u32 v3, s53, v213
  s_barrier
  ds_read_b64_tr_b16 v[8:9], v214 offset:0
  ds_read_b64_tr_b16 v[10:11], v214 offset:1024
  ds_read_b64_tr_b16 v[12:13], v214 offset:2048
  ds_read_b64_tr_b16 v[14:15], v214 offset:3072
  ds_read_b64_tr_b16 v[16:17], v214 offset:4096
  ds_read_b64_tr_b16 v[18:19], v214 offset:5120
  ds_read_b64_tr_b16 v[20:21], v214 offset:6144
  ds_read_b64_tr_b16 v[22:23], v214 offset:7168
  ds_read_b64_tr_b16 v[24:25], v214 offset:8192
  ds_read_b64_tr_b16 v[26:27], v214 offset:9216
  ds_read_b64_tr_b16 v[28:29], v214 offset:10240
  ds_read_b64_tr_b16 v[30:31], v214 offset:11264
  ds_read_b64_tr_b16 v[32:33], v214 offset:12288
  ds_read_b64_tr_b16 v[34:35], v214 offset:13312
  ds_read_b64_tr_b16 v[36:37], v214 offset:14336
  ds_read_b64_tr_b16 v[38:39], v214 offset:15360
  ds_read_b64_tr_b16 v[40:41], v214 offset:16384
  ds_read_b64_tr_b16 v[42:43], v214 offset:17408
  ds_read_b64_tr_b16 v[44:45], v214 offset:18432
  ds_read_b64_tr_b16 v[46:47], v214 offset:19456
  ds_read_b64_tr_b16 v[48:49], v214 offset:20480
  ds_read_b64_tr_b16 v[50:51], v214 offset:21504
  ds_read_b64_tr_b16 v[52:53], v214 offset:22528
  ds_read_b64_tr_b16 v[54:55], v214 offset:23552
  ds_read_b64_tr_b16 v[56:57], v214 offset:24576
  ds_read_b64_tr_b16 v[58:59], v214 offset:25600
  ds_read_b64_tr_b16 v[60:61], v214 offset:26624
  ds_read_b64_tr_b16 v[62:63], v214 offset:27648
  ds_read_b64_tr_b16 v[64:65], v214 offset:28672
  ds_read_b64_tr_b16 v[66:67], v214 offset:29696
  ds_read_b64_tr_b16 v[68:69], v214 offset:30720
  ds_read_b64_tr_b16 v[70:71], v214 offset:31744
  s_waitcnt vmcnt(6)
  v_readfirstlane_b32 s3, v233
  s_cmp_lt_u32 s3, 8
  s_cbranch_scc1 L_poll_70004_r
L_poll_70004:
  s_waitcnt vmcnt(4)
  s_add_u32 m0, s53, 0
  s_add_u32 s55, s58, 2097152
  buffer_load_dwordx4 v213, s[28:31], s55 offen sc1 lds
  buffer_load_dwordx4 v213, s[28:31], s55 offen offset:1024 sc1 lds
  buffer_load_dwordx4 v213, s[28:31], s55 offen offset:2048 sc1 lds
  buffer_load_dwordx4 v213, s[28:31], s55 offen offset:3072 sc1 lds
  s_add_u32 m0, s53, 8192
  s_add_u32 s55, s58, 2105344
  buffer_load_dwordx4 v213, s[28:31], s55 offen sc1 lds
  buffer_load_dwordx4 v213, s[28:31], s55 offen offset:1024 sc1 lds
  buffer_load_dwordx4 v213, s[28:31], s55 offen offset:2048 sc1 lds
  buffer_load_dwordx4 v213, s[28:31], s55 offen offset:3072 sc1 lds
  s_add_u32 m0, s53, 16384
  s_add_u32 s55, s58, 2113536
  buffer_load_dwordx4 v213, s[28:31], s55 offen sc1 lds
  buffer_load_dwordx4 v213, s[28:31], s55 offen offset:1024 sc1 lds
  buffer_load_dwordx4 v213, s[28:31], s55 offen offset:2048 sc1 lds
  buffer_load_dwordx4 v213, s[28:31], s55 offen offset:3072 sc1 lds
  ds_read_b64_tr_b16 v[72:73], v214 offset:32768
  ds_read_b64_tr_b16 v[74:75], v214 offset:33792
  ds_read_b64_tr_b16 v[76:77], v214 offset:34816
  ds_read_b64_tr_b16 v[78:79], v214 offset:35840
  ds_read_b64_tr_b16 v[80:81], v214 offset:36864
  ds_read_b64_tr_b16 v[82:83], v214 offset:37888
  ds_read_b64_tr_b16 v[84:85], v214 offset:38912
  ds_read_b64_tr_b16 v[86:87], v214 offset:39936
  ds_read_b64_tr_b16 v[88:89], v214 offset:40960
  ds_read_b64_tr_b16 v[90:91], v214 offset:41984
  ds_read_b64_tr_b16 v[92:93], v214 offset:43008
  ds_read_b64_tr_b16 v[94:95], v214 offset:44032
  ds_read_b64_tr_b16 v[96:97], v214 offset:45056
  ds_read_b64_tr_b16 v[98:99], v214 offset:46080
  ds_read_b64_tr_b16 v[100:101], v214 offset:47104
  ds_read_b64_tr_b16 v[102:103], v214 offset:48128
  ds_read_b64_tr_b16 v[104:105], v214 offset:49152
  ds_read_b64_tr_b16 v[106:107], v214 offset:50176
  ds_read_b64_tr_b16 v[108:109], v214 offset:51200
  ds_read_b64_tr_b16 v[110:111], v214 offset:52224
  ds_read_b64_tr_b16 v[112:113], v214 offset:53248
  ds_read_b64_tr_b16 v[114:115], v214 offset:54272
  ds_read_b64_tr_b16 v[116:117], v214 offset:55296
  ds_read_b64_tr_b16 v[118:119], v214 offset:56320
  ds_read_b64_tr_b16 v[120:121], v214 offset:57344
  ds_read_b64_tr_b16 v[122:123], v214 offset:58368
  ds_read_b64_tr_b16 v[124:125], v214 offset:59392
  ds_read_b64_tr_b16 v[126:127], v214 offset:60416
  ds_read_b64_tr_b16 v[128:129], v214 offset:61440
  ds_read_b64_tr_b16 v[130:131], v214 offset:62464
  ds_read_b64_tr_b16 v[132:133], v214 offset:63488
  ds_read_b64_tr_b16 v[134:135], v214 offset:64512
  s_waitcnt vmcnt(12)
  v_lshlrev_b32 v172, 16, v164
  v_and_b32 v173, 0xffff0000, v164
  v_lshlrev_b32 v174, 16, v165
  v_and_b32 v175, 0xffff0000, v165
  v_lshlrev_b32 v176, 16, v166
  v_and_b32 v177, 0xffff0000, v166
  v_lshlrev_b32 v178, 16, v167
  v_and_b32 v179, 0xffff0000, v167
  v_lshlrev_b32 v180, 16, v168
  v_and_b32 v181, 0xffff0000, v168
  v_lshlrev_b32 v182, 16, v169
  v_and_b32 v183, 0xffff0000, v169
  v_lshlrev_b32 v184, 16, v170
  v_and_b32 v185, 0xffff0000, v170
  v_lshlrev_b32 v186, 16, v171
  v_and_b32 v187, 0xffff0000, v171
  s_mul_i32 s49, s77, 2304
  s_add_u32 s49, s49, 65536
  v_and_b32 v5, 31, v228
  v_lshlrev_b32 v190, 3, v5
  v_mul_u32_u24 v5, 72, v5
  v_lshrrev_b32 v4, 5, v228
  v_lshl_add_u32 v5, v4, 3, v5
  v_add_u32 v188, s49, v5
  v_lshl_add_u32 v191, v4, 11, v190
  v_bfe_u32 v5, v228, 2, 2
  v_lshl_add_u32 v5, v4, 2, v5
  v_mul_u32_u24 v5, 72, v5
  v_bfe_u32 v4, v228, 4, 1
  v_lshl_add_u32 v5, v4, 5, v5
  v_and_b32 v4, 3, v228
  v_lshl_add_u32 v5, v4, 3, v5
  v_add_u32 v189, s49, v5
  s_lshl_b32 s50, s72, 1
  s_add_u32 s50, s50, s79
  s_lshl_b32 s50, s50, 4
  s_lshl_b32 s3, s73, 1
  s_add_u32 s50, s50, s3
  s_add_u32 s50, s50, s78
  s_lshl_b32 s50, s50, 8
  s_add_u32 s50, s50, 1048576
  s_add_u32 s52, s52, 4194304
  s_lshl_b32 s51, s72, 1
  s_add_u32 s51, s51, s79
  s_lshl_b32 s51, s51, 12
  s_add_u32 s51, s51, 1048576
  s_add_u32 s54, s1, 0
  s_add_u32 m0, s53, 24576
  s_add_u32 s55, s58, 2121728
  buffer_load_dwordx4 v213, s[28:31], s55 offen sc1 lds
  buffer_load_dwordx4 v213, s[28:31], s55 offen offset:1024 sc1 lds
  buffer_load_dwordx4 v213, s[28:31], s55 offen offset:2048 sc1 lds
  buffer_load_dwordx4 v213, s[28:31], s55 offen offset:3072 sc1 lds
  ds_read_b64_tr_b16 a[80:81], v221 offset:4096
  ds_read_b64_tr_b16 a[82:83], v221 offset:5120
  s_waitcnt vmcnt(12)
  ds_read_b32 v164, v3 offset:0
  ds_read_b32 v165, v3 offset:1024
  ds_read_b32 v166, v3 offset:2048
  ds_read_b64_tr_b16 a[84:85], v222 offset:4096
  ds_read_b64_tr_b16 a[86:87], v222 offset:5120
  ds_read_b32 v167, v3 offset:3072
  s_waitcnt lgkmcnt(0)
  s_add_u32 s61, s98, 688128
  s_cmp_ge_u32 s61, s99
  s_cselect_b32 s94, 1835008, 0
  s_sub_u32 s61, s61, s94
  s_add_u32 m0, s56, 0
  s_nop 0
  buffer_load_dwordx4 v217, s[80:83], s61 offen lds
  v_max3_u32 v7, v164, v165, v166
  ds_read_b64_tr_b16 a[88:89], v221 offset:6144
  ds_read_b64_tr_b16 a[90:91], v221 offset:7168
  v_max_u32 v7, v7, v167
  v_cmp_eq_u32 vcc, -1, v7
  s_cbranch_vccnz L_tag_72005_r
L_tag_72005:
  s_barrier
  ds_read_b64_tr_b16 a[92:93], v222 offset:6144
  ds_read_b64_tr_b16 a[94:95], v222 offset:7168
  ds_read_b128 v[152:155], v2 offset:0
  s_add_u32 s61, s61, 28672
  s_add_u32 m0, s56, 1024
  s_nop 0
  buffer_load_dwordx4 v217, s[80:83], s61 offen lds
  ds_read_b128 v[156:159], v2 offset:1024
  ds_read_b128 v[160:163], v2 offset:2048
  s_waitcnt lgkmcnt(2)
  s_add_u32 s61, s61, 28672
  s_add_u32 m0, s56, 2048
  s_nop 0
  buffer_load_dwordx4 v217, s[80:83], s61 offen lds
  v_mfma_f32_32x32x16_bf16 v[136:151], v[8:11], v[152:155], v[172:187]
  ds_read_b128 v[152:155], v2 offset:3072
  s_waitcnt lgkmcnt(2)
  v_mfma_f32_32x32x16_bf16 v[136:151], v[12:15], v[156:159], v[136:151]
  s_waitcnt vmcnt(11)
  ds_read_b32 v164, v3 offset:8192
  ds_read_b32 v165, v3 offset:9216
  ds_read_b32 v166, v3 offset:10240
  ds_read_b32 v167, v3 offset:11264
  ds_read_b128 v[156:159], v2 offset:4096
  s_waitcnt lgkmcnt(6)
  v_mfma_f32_32x32x16_bf16 v[136:151], v[16:19], v[160:163], v[136:151]
  s_add_u32 s61, s61, 28672
  s_add_u32 m0, s56, 3072
  s_nop 0
  buffer_load_dwordx4 v217, s[80:83], s61 offen lds
  ds_read_b128 v[160:163], v2 offset:5120
  s_waitcnt lgkmcnt(6)
  v_mfma_f32_32x32x16_bf16 v[136:151], v[20:23], v[152:155], v[136:151]
  ds_read_b128 v[152:155], v2 offset:6144
  s_waitcnt lgkmcnt(2)
  v_mfma_f32_32x32x16_bf16 v[136:151], v[24:27], v[156:159], v[136:151]
  v_max3_u32 v7, v164, v165, v166
  v_max_u32 v7, v7, v167
  v_cmp_eq_u32 vcc, -1, v7
  s_cbranch_vccnz L_tag_74006_r
L_tag_74006:
  s_barrier
  ds_read_b128 v[156:159], v2 offset:7168
  s_waitcnt lgkmcnt(2)
  v_mfma_f32_32x32x16_bf16 v[136:151], v[28:31], v[160:163], v[136:151]
  s_add_u32 s61, s61, 28672
  s_add_u32 m0, s56, 4096
  s_nop 0
  buffer_load_dwordx4 v217, s[80:83], s61 offen lds
  ds_read_b128 v[160:163], v2 offset:8192
  s_waitcnt lgkmcnt(2)
  v_mfma_f32_32x32x16_bf16 v[136:151], v[32:35], v[152:155], v[136:151]
  ds_read_b128 v[152:155], v2 offset:9216
  s_waitcnt lgkmcnt(2)
  s_add_u32 s61, s61, 28672
  s_add_u32 m0, s56, 5120
  s_nop 0
  buffer_load_dwordx4 v217, s[80:83], s61 offen lds
  v_mfma_f32_32x32x16_bf16 v[136:151], v[36:39], v[156:159], v[136:151]
  ds_read_b128 v[156:159], v2 offset:10240
  s_waitcnt lgkmcnt(2)
  v_mfma_f32_32x32x16_bf16 v[136:151], v[40:43], v[160:163], v[136:151]
  ds_read_b128 v[160:163], v2 offset:11264
  s_waitcnt lgkmcnt(2)
  v_mfma_f32_32x32x16_bf16 v[136:151], v[44:47], v[152:155], v[136:151]
  s_add_u32 s61, s61, 28672
  s_add_u32 m0, s56, 6144
  s_nop 0
  buffer_load_dwordx4 v217, s[80:83], s61 offen lds
  s_waitcnt vmcnt(11)
  ds_read_b32 v164, v3 offset:16384
  ds_read_b32 v165, v3 offset:17408
  ds_read_b32 v166, v3 offset:18432
  ds_read_b32 v167, v3 offset:19456
  ds_read_b128 v[152:155], v2 offset:12288
  s_waitcnt lgkmcnt(6)
  v_mfma_f32_32x32x16_bf16 v[136:151], v[48:51], v[156:159], v[136:151]
  ds_read_b128 v[156:159], v2 offset:13312
  s_waitcnt lgkmcnt(6)
  v_mfma_f32_32x32x16_bf16 v[136:151], v[52:55], v[160:163], v[136:151]
  s_add_u32 s61, s61, 28672
  s_add_u32 m0, s56, 7168
  s_nop 0
  buffer_load_dwordx4 v217, s[80:83], s61 offen lds
  ds_read_b128 v[160:163], v2 offset:14336
  s_waitcnt lgkmcnt(2)
  s_waitcnt vmcnt(6)
  ds_read_b64_tr_b16 a[96:97], v221 offset:0
  ds_read_b64_tr_b16 a[98:99], v221 offset:1024
  v_mfma_f32_32x32x16_bf16 v[136:151], v[56:59], v[152:155], v[136:151]
  v_max3_u32 v7, v164, v165, v166
  ds_read_b64_tr_b16 a[100:101], v222 offset:0
  ds_read_b64_tr_b16 a[102:103], v222 offset:1024
  v_max_u32 v7, v7, v167
  v_cmp_eq_u32 vcc, -1, v7
  s_cbranch_vccnz L_tag_76007_r
L_tag_76007:
  s_barrier
  ds_read_b128 v[152:155], v2 offset:15360
  s_waitcnt lgkmcnt(6)
  v_mfma_f32_32x32x16_bf16 v[136:151], v[60:63], v[156:159], v[136:151]
  ds_read_b128 v[156:159], v2 offset:16384
  s_waitcnt lgkmcnt(6)
  v_mfma_f32_32x32x16_bf16 v[136:151], v[64:67], v[160:163], v[136:151]
  ds_read_b128 v[160:163], v2 offset:17408
  s_waitcnt lgkmcnt(2)
  s_add_u32 s61, s98, 917504
  s_cmp_ge_u32 s61, s99
  s_cselect_b32 s94, 1835008, 0
  s_sub_u32 s61, s61, s94
  s_add_u32 m0, s56, 0
  s_nop 0
  buffer_load_dwordx4 v217, s[80:83], s61 offen lds
  v_mfma_f32_32x32x16_bf16 v[136:151], v[68:71], v[152:155], v[136:151]
  s_waitcnt vmcnt(5)
  ds_read_b64_tr_b16 a[104:105], v221 offset:2048
  ds_read_b64_tr_b16 a[106:107], v221 offset:3072
  ds_read_b128 v[152:155], v2 offset:18432
  s_waitcnt lgkmcnt(4)
  v_mfma_f32_32x32x16_bf16 v[136:151], v[72:75], v[156:159], v[136:151]
  ds_read_b64_tr_b16 a[108:109], v222 offset:2048
  ds_read_b64_tr_b16 a[110:111], v222 offset:3072
  ds_read_b128 v[156:159], v2 offset:19456
  s_waitcnt lgkmcnt(6)
  v_mfma_f32_32x32x16_bf16 v[136:151], v[76:79], v[160:163], v[136:151]
  s_add_u32 s61, s61, 28672
  s_add_u32 m0, s56, 1024
  s_nop 0
  buffer_load_dwordx4 v217, s[80:83], s61 offen lds
  ds_read_b32 v164, v3 offset:24576
  ds_read_b32 v165, v3 offset:25600
  ds_read_b32 v166, v3 offset:26624
  ds_read_b32 v167, v3 offset:27648
  ds_read_b128 v[160:163], v2 offset:20480
  s_waitcnt lgkmcnt(8)
  v_mfma_f32_32x32x16_bf16 v[136:151], v[80:83], v[152:155], v[136:151]
  ds_read_b128 v[152:155], v2 offset:21504
  s_waitcnt lgkmcnt(6)
  v_mfma_f32_32x32x16_bf16 v[136:151], v[84:87], v[156:159], v[136:151]
  s_add_u32 s61, s61, 28672
  s_add_u32 m0, s56, 2048
  s_nop 0
  buffer_load_dwordx4 v217, s[80:83], s61 offen lds
  ds_read_b128 v[156:159], v2 offset:22528
  s_waitcnt lgkmcnt(2)
  v_mfma_f32_32x32x16_bf16 v[136:151], v[88:91], v[160:163], v[136:151]
  s_waitcnt vmcnt(5)
  ds_read_b64_tr_b16 a[112:113], v221 offset:4096
  ds_read_b64_tr_b16 a[114:115], v221 offset:5120
  v_max3_u32 v7, v164, v165, v166
  v_max_u32 v7, v7, v167
  v_cmp_eq_u32 vcc, -1, v7
  s_cbranch_vccnz L_tag_78008_r
L_tag_78008:
  s_barrier
  s_add_u32 s61, s61, 28672
  s_add_u32 m0, s56, 3072
  s_nop 0
  buffer_load_dwordx4 v217, s[80:83], s61 offen lds
  ds_read_b128 v[160:163], v2 offset:23552
  ds_read_b64_tr_b16 a[116:117], v222 offset:4096
  ds_read_b64_tr_b16 a[118:119], v222 offset:5120
  s_waitcnt lgkmcnt(6)
  v_mfma_f32_32x32x16_bf16 v[136:151], v[92:95], v[152:155], v[136:151]
  ds_read_b128 v[152:155], v2 offset:24576
  s_waitcnt lgkmcnt(6)
  v_mfma_f32_32x32x16_bf16 v[136:151], v[96:99], v[156:159], v[136:151]
  ds_read_b128 v[156:159], v2 offset:25600
  s_waitcnt lgkmcnt(4)
  s_waitcnt vmcnt(4)
  ds_read_b64_tr_b16 a[120:121], v221 offset:6144
  ds_read_b64_tr_b16 a[122:123], v221 offset:7168
  v_mfma_f32_32x32x16_bf16 v[136:151], v[100:103], v[160:163], v[136:151]
  ds_read_b128 v[160:163], v2 offset:26624
  s_waitcnt lgkmcnt(5)
  s_add_u32 s61, s61, 28672
  s_add_u32 m0, s56, 4096
  s_nop 0
  buffer_load_dwordx4 v217, s[80:83], s61 offen lds
  s_waitcnt lgkmcnt(4)
  v_mfma_f32_32x32x16_bf16 v[136:151], v[104:107], v[152:155], v[136:151]
  ds_read_b64_tr_b16 a[124:125], v222 offset:6144
  ds_read_b64_tr_b16 a[126:127], v222 offset:7168
  ds_read_b128 v[152:155], v2 offset:27648
  s_waitcnt lgkmcnt(6)
  v_mfma_f32_32x32x16_bf16 v[136:151], v[108:111], v[156:159], v[136:151]
  ds_read_b128 v[156:159], v2 offset:28672
  s_waitcnt lgkmcnt(4)
  v_mfma_f32_32x32x16_bf16 v[136:151], v[112:115], v[160:163], v[136:151]
  ds_read_b128 v[160:163], v2 offset:29696
  s_waitcnt lgkmcnt(2)
  v_mfma_f32_32x32x16_bf16 v[136:151], v[116:119], v[152:155], v[136:151]
  ds_read_b128 v[152:155], v2 offset:30720
  s_waitcnt lgkmcnt(2)
  v_mfma_f32_32x32x16_bf16 v[136:151], v[120:123], v[156:159], v[136:151]
  s_add_u32 s61, s61, 28672
  s_add_u32 m0, s56, 5120
  s_nop 0
  buffer_load_dwordx4 v217, s[80:83], s61 offen lds
  ds_read_b128 v[156:159], v2 offset:31744
  s_waitcnt lgkmcnt(2)
  v_mfma_f32_32x32x16_bf16 v[136:151], v[124:127], v[160:163], v[136:151]
  s_waitcnt lgkmcnt(1)
  v_mfma_f32_32x32x16_bf16 v[136:151], v[128:131], v[152:155], v[136:151]
  s_add_u32 s61, s61, 28672
  s_add_u32 m0, s56, 6144
  s_nop 0
  buffer_load_dwordx4 v217, s[80:83], s61 offen lds
  s_waitcnt lgkmcnt(0)
  v_mfma_f32_32x32x16_bf16 v[136:151], v[132:135], v[156:159], v[136:151]
  s_waitcnt vmcnt(5)
  ds_read_b64_tr_b16 a[128:129], v221 offset:0
  ds_read_b64_tr_b16 a[130:131], v221 offset:1024
  s_nop 8
  v_cvt_pk_bf16_f32 v164, v136, v137
  v_cvt_pk_bf16_f32 v165, v138, v139
  v_cvt_pk_bf16_f32 v166, v140, v141
  v_cvt_pk_bf16_f32 v167, v142, v143
  v_cvt_pk_bf16_f32 v168, v144, v145
  v_cvt_pk_bf16_f32 v169, v146, v147
  v_cvt_pk_bf16_f32 v170, v148, v149
  v_cvt_pk_bf16_f32 v171, v150, v151
  v_lshlrev_b32 v172, 16, v164
  v_and_b32 v173, 0xffff0000, v164
  v_lshlrev_b32 v174, 16, v165
  v_and_b32 v175, 0xffff0000, v165
  s_add_u32 s61, s61, 28672
  s_add_u32 m0, s56, 7168
  s_nop 0
  buffer_load_dwordx4 v217, s[80:83], s61 offen lds
  v_lshlrev_b32 v176, 16, v166
  ds_read_b64_tr_b16 a[132:133], v222 offset:0
  ds_read_b64_tr_b16 a[134:135], v222 offset:1024
  v_and_b32 v177, 0xffff0000, v166
  v_lshlrev_b32 v178, 16, v167
  v_and_b32 v179, 0xffff0000, v167
  v_lshlrev_b32 v180, 16, v168
  v_and_b32 v181, 0xffff0000, v168
  v_lshlrev_b32 v182, 16, v169
  v_and_b32 v183, 0xffff0000, v169
  v_lshlrev_b32 v184, 16, v170
  v_and_b32 v185, 0xffff0000, v170
  v_lshlrev_b32 v186, 16, v171
  v_and_b32 v187, 0xffff0000, v171
  v_pk_add_f32 v[4:5], v[172:173], v[174:175]
  v_pk_mul_f32 v[6:7], v[172:173], v[172:173]
  v_pk_add_f32 v[152:153], v[176:177], v[178:179]
  v_pk_mul_f32 v[154:155], v[174:175], v[174:175]
  v_pk_fma_f32 v[6:7], v[176:177], v[176:177], v[6:7]
  v_pk_fma_f32 v[154:155], v[178:179], v[178:179], v[154:155]
  v_pk_add_f32 v[4:5], v[4:5], v[180:181]
  v_pk_fma_f32 v[6:7], v[180:181], v[180:181], v[6:7]
  v_pk_add_f32 v[152:153], v[152:153], v[182:183]
  v_pk_fma_f32 v[154:155], v[182:183], v[182:183], v[154:155]
  v_pk_add_f32 v[4:5], v[4:5], v[184:185]
  v_pk_fma_f32 v[6:7], v[184:185], v[184:185], v[6:7]
  v_pk_add_f32 v[152:153], v[152:153], v[186:187]
  v_pk_fma_f32 v[154:155], v[186:187], v[186:187], v[154:155]
  s_waitcnt vmcnt(4)
  ds_read_b64_tr_b16 a[136:137], v221 offset:2048
  ds_read_b64_tr_b16 a[138:139], v221 offset:3072
  v_pk_add_f32 v[4:5], v[4:5], v[152:153]
  v_pk_add_f32 v[6:7], v[6:7], v[154:155]
  v_add_f32 v4, v4, v5
  s_waitcnt lgkmcnt(2)
  s_add_u32 s61, s98, 1146880
  s_cmp_ge_u32 s61, s99
  s_cselect_b32 s94, 1835008, 0
  s_sub_u32 s61, s61, s94
  s_add_u32 m0, s56, 0
  s_nop 0
  buffer_load_dwordx4 v217, s[80:83], s61 offen lds
  v_add_f32 v5, v6, v7
  ds_read_b64_tr_b16 a[140:141], v222 offset:2048
  ds_read_b64_tr_b16 a[142:143], v222 offset:3072
  v_mov_b32 v6, v4
  v_mov_b32 v7, v5
  s_nop 0
  v_permlane32_swap_b32 v4, v6
  v_permlane32_swap_b32 v5, v7
  v_pk_add_f32 v[4:5], v[4:5], v[6:7]
  v_and_b32 v5, 0x7fffffff, v5
  s_mov_b32 exec_hi, 0
  buffer_store_dwordx2 v[4:5], v190, s[28:31], s50 offen sc1
  s_mov_b32 exec_hi, -1
  buffer_store_dwordx4 v[164:167], v227, s[28:31], s52 offen offset:0 sc1
  buffer_store_dwordx4 v[168:171], v227, s[28:31], s52 offen offset:512 sc1
  v_mov_b32 v136, -1
  v_mov_b32 v137, -1
  v_mov_b32 v138, -1
  v_mov_b32 v139, -1
  s_add_u32 s48, s1, 0
  buffer_store_dwordx4 v[136:139], v213, s[28:31], s48 offen offset:0 sc1
  buffer_store_dwordx4 v[136:139], v213, s[28:31], s48 offen offset:1024 sc1
  s_add_u32 s49, s62, 0
  buffer_store_dwordx4 v[136:139], v232, s[28:31], s49 offen sc1
  s_add_u32 s49, s49, s65
  buffer_store_dwordx4 v[136:139], v232, s[28:31], s49 offen sc1
  s_add_u32 s49, s49, s65
  buffer_store_dwordx4 v[136:139], v232, s[28:31], s49 offen sc1
  s_add_u32 s49, s49, s65
  buffer_store_dwordx4 v[136:139], v232, s[28:31], s49 offen sc1
  s_lshl_b32 s48, s75, 1
  s_add_u32 s48, s48, s78
  s_lshl_b32 s48, s48, 2
  s_add_u32 s48, s48, s74
  s_lshl_b32 s48, s48, 1
  s_add_u32 s48, s48, s79
  s_lshl_b32 s48, s48, 8
  s_lshl_b32 s3, s76, 17
  s_add_u32 s48, s48, s3
  s_add_u32 s48, s48, 262144
  v_lshrrev_b32 v140, 2, v213
  buffer_store_dword v136, v140, s[28:31], s48 offen sc1
  s_waitcnt vmcnt(13)
  ds_read_b64_tr_b16 a[144:145], v221 offset:4096
  ds_read_b64_tr_b16 a[146:147], v221 offset:5120
  ds_read_b64_tr_b16 a[148:149], v222 offset:4096
  ds_read_b64_tr_b16 a[150:151], v222 offset:5120
  s_waitcnt vmcnt(11)
  ds_read_b64_tr_b16 a[152:153], v221 offset:6144
  ds_read_b64_tr_b16 a[154:155], v221 offset:7168
  ds_read_b64_tr_b16 a[156:157], v222 offset:6144
  ds_read_b64_tr_b16 a[158:159], v222 offset:7168
  s_add_u32 s61, s61, 28672
  s_add_u32 m0, s56, 1024
  s_nop 0
  buffer_load_dwordx4 v217, s[80:83], s61 offen lds
  s_waitcnt lgkmcnt(8)
  s_add_u32 s61, s61, 28672
  s_add_u32 m0, s56, 2048
  s_nop 0
  buffer_load_dwordx4 v217, s[80:83], s61 offen lds
  s_add_u32 s61, s61, 28672
  s_add_u32 m0, s56, 3072
  s_nop 0
  buffer_load_dwordx4 v217, s[80:83], s61 offen lds
  s_waitcnt lgkmcnt(4)
  s_add_u32 s61, s61, 28672
  s_add_u32 m0, s56, 4096
  s_nop 0
  buffer_load_dwordx4 v217, s[80:83], s61 offen lds
  s_add_u32 s61, s61, 28672
  s_add_u32 m0, s56, 5120
  s_nop 0
  buffer_load_dwordx4 v217, s[80:83], s61 offen lds
  s_waitcnt lgkmcnt(0)
  s_add_u32 s61, s61, 28672
  s_add_u32 m0, s56, 6144
  s_nop 0
  buffer_load_dwordx4 v217, s[80:83], s61 offen lds
  s_lshl_b32 s48, s75, 7
  s_lshl_b32 s49, s77, 5
  s_add_u32 s49, s48, s49
  v_lshrrev_b32 v2, 5, v228
  v_lshlrev_b32 v1, 3, v2
  buffer_load_dwordx2 v[24:25], v1, s[36:39], s49 offen offset:0
  buffer_load_dwordx2 v[26:27], v1, s[36:39], s49 offen offset:16
  s_lshl_b32 s49, s78, 6
  s_add_u32 s48, s48, s49
  v_and_b32 v3, 31, v228
  v_lshlrev_b32 v1, 1, v3
  buffer_load_ushort v32, v1, s[40:43], s48 offen
  v_mov_b32 v28, 0xbdd2d3e8
  v_mov_b32 v29, 0xc0135761
  v_mov_b32 v30, 1.0
  v_lshrrev_b32 v1, 4, v228
  v_bfe_u32 v2, v228, 2, 2
  v_and_b32 v3, 3, v228
  v_lshrrev_b32 v4, 1, v1
  v_lshlrev_b32 v4, 4, v4
  v_and_b32 v5, 1, v1
  v_lshl_add_u32 v4, v5, 2, v4
  v_add_u32 v4, v4, v2
  v_add_u32 v4, 0, v4
  v_lshrrev_b32 v5, 2, v4
  v_lshrrev_b32 v6, 3, v4
  v_xor_b32 v5, v5, v6
  v_and_b32 v5, 1, v5
  v_lshlrev_b32 v5, 1, v5
  v_bfe_u32 v6, v4, 1, 1
  v_or_b32 v5, v5, v6
  v_xor_b32 v5, s77, v5
  v_lshlrev_b32 v5, 5, v5
  v_lshl_add_u32 v5, v4, 7, v5
  v_lshl_add_u32 v5, v3, 3, v5
  v_lshrrev_b32 v4, 3, v4
  v_lshl_add_u32 v5, v4, 11, v5
  v_add_u32 v234, 65536, v5
  v_add_u32 v235, 114688, v5
  v_lshrrev_b32 v4, 1, v1
  v_lshlrev_b32 v4, 4, v4
  v_and_b32 v5, 1, v1
  v_lshl_add_u32 v4, v5, 2, v4
  v_add_u32 v4, v4, v2
  v_add_u32 v4, 8, v4
  v_lshrrev_b32 v5, 2, v4
  v_lshrrev_b32 v6, 3, v4
  v_xor_b32 v5, v5, v6
  v_and_b32 v5, 1, v5
  v_lshlrev_b32 v5, 1, v5
  v_bfe_u32 v6, v4, 1, 1
  v_or_b32 v5, v5, v6
  v_xor_b32 v5, s77, v5
  v_lshlrev_b32 v5, 5, v5
  v_lshl_add_u32 v5, v4, 7, v5
  v_lshl_add_u32 v5, v3, 3, v5
  v_lshrrev_b32 v4, 3, v4
  v_lshl_add_u32 v5, v4, 11, v5
  v_add_u32 v236, 65536, v5
  v_add_u32 v237, 114688, v5
  s_lshl_b32 s4, s77, 12
  v_add_u32 v215, s60, v213
  s_lshl_b32 s3, s72, 16
  s_add_u32 s7, s3, s4
  s_sub_u32 s3, s3, 16384
  s_max_i32 s3, s3, 0
  s_add_u32 s6, s3, s4
  buffer_load_dwordx2 v[8:9], v191, s[28:31], s51 offen offset:0 sc1
  buffer_load_dwordx2 v[10:11], v191, s[28:31], s51 offen offset:256 sc1
  buffer_load_dwordx2 v[12:13], v191, s[28:31], s51 offen offset:512 sc1
  buffer_load_dwordx2 v[14:15], v191, s[28:31], s51 offen offset:768 sc1
  buffer_load_dwordx2 v[16:17], v191, s[28:31], s51 offen offset:1024 sc1
  buffer_load_dwordx2 v[18:19], v191, s[28:31], s51 offen offset:1280 sc1
  buffer_load_dwordx2 v[20:21], v191, s[28:31], s51 offen offset:1536 sc1
  buffer_load_dwordx2 v[22:23], v191, s[28:31], s51 offen offset:1792 sc1
  s_getpc_b64 s[4:5]
L_pc_80009:
  s_lshl_b32 s3, s71, 2
  s_add_u32 s3, s3, s77
  s_lshl_b32 s3, s3, 2
  v_and_b32 v4, 3, v228
  v_add_u32 v4, s3, v4
  v_lshlrev_b32 v4, 7, v4
  v_min_u32 v4, L_end-L_pc_80009, v4
  v_mov_b32 v5, s5
  v_add_co_u32 v4, vcc, s4, v4
  v_addc_co_u32 v5, vcc, 0, v5, vcc
  global_load_dword v212, v[4:5], off
  s_waitcnt vmcnt(17)
  ds_read_b64_tr_b16 a[160:161], v221 offset:0
  ds_read_b64_tr_b16 a[162:163], v221 offset:1024
  ds_read_b64_tr_b16 a[164:165], v222 offset:0
  ds_read_b64_tr_b16 a[166:167], v222 offset:1024
  s_waitcnt vmcnt(15)
  ds_read_b64_tr_b16 a[168:169], v221 offset:2048
  ds_read_b64_tr_b16 a[170:171], v221 offset:3072
  ds_read_b64_tr_b16 a[172:173], v222 offset:2048
  ds_read_b64_tr_b16 a[174:175], v222 offset:3072
  s_waitcnt vmcnt(13)
  ds_read_b64_tr_b16 a[176:177], v221 offset:4096
  ds_read_b64_tr_b16 a[178:179], v221 offset:5120
  ds_read_b64_tr_b16 a[180:181], v222 offset:4096
  ds_read_b64_tr_b16 a[182:183], v222 offset:5120
  s_add_u32 s61, s61, 28672
  s_add_u32 m0, s56, 7168
  s_nop 0
  buffer_load_dwordx4 v217, s[80:83], s61 offen lds
  s_waitcnt lgkmcnt(8)
  s_add_u32 s61, s98, 1376256
  s_cmp_ge_u32 s61, s99
  s_cselect_b32 s94, 1835008, 0
  s_sub_u32 s61, s61, s94
  s_add_u32 m0, s56, 0
  s_nop 0
  buffer_load_dwordx4 v217, s[80:83], s61 offen lds
  s_add_u32 s61, s61, 28672
  s_add_u32 m0, s56, 1024
  s_nop 0
  buffer_load_dwordx4 v217, s[80:83], s61 offen lds
  s_waitcnt lgkmcnt(4)
  s_add_u32 s61, s61, 28672
  s_add_u32 m0, s56, 2048
  s_nop 0
  buffer_load_dwordx4 v217, s[80:83], s61 offen lds
  s_add_u32 s61, s61, 28672
  s_add_u32 m0, s56, 3072
  s_nop 0
  buffer_load_dwordx4 v217, s[80:83], s61 offen lds
  s_waitcnt lgkmcnt(0)
  s_add_u32 s61, s61, 28672
  s_add_u32 m0, s56, 4096
  s_nop 0
  buffer_load_dwordx4 v217, s[80:83], s61 offen lds
  s_add_u32 s61, s61, 28672
  s_add_u32 m0, s56, 5120
  s_nop 0
  buffer_load_dwordx4 v217, s[80:83], s61 offen lds
  s_waitcnt vmcnt(8)
  v_max3_u32 v7, v9, v11, v13
  v_max3_u32 v7, v7, v15, v17
  v_max3_u32 v7, v7, v19, v21
  v_max_u32 v7, v7, v23
  v_cmp_eq_u32 vcc, -1, v7
  s_cbranch_vccnz L_tag_80010_r
L_tag_80010:
  v_pk_add_f32 v[8:9], v[8:9], v[16:17]
  v_pk_add_f32 v[10:11], v[10:11], v[18:19]
  v_pk_add_f32 v[12:13], v[12:13], v[20:21]
  v_pk_add_f32 v[14:15], v[14:15], v[22:23]
  v_pk_add_f32 v[8:9], v[8:9], v[12:13]
  v_pk_add_f32 v[10:11], v[10:11], v[14:15]
  v_pk_add_f32 v[8:9], v[8:9], v[10:11]
  v_mov_b32 v6, v8
  v_mov_b32 v7, v9
  s_nop 0
  v_permlane32_swap_b32 v8, v6
  v_permlane32_swap_b32 v9, v7
  v_pk_add_f32 v[4:5], v[8:9], v[6:7]
  v_mul_f32 v4, 0xbb000000, v4
  v_mul_f32 v5, 0x3b000000, v5
  v_fma_f32 v5, -v4, v4, v5
  v_max_f32 v5, 0, v5
  v_mov_b32 v6, 0x2edbe6ff
  v_fmac_f32 v6, 0x3f800054, v5
  v_rsq_f32 v6, v6
  s_nop 0
  v_mul_f32 v7, v4, v6
  v_pk_fma_f32 v[172:173], v[172:173], v[6:7], v[6:7] op_sel:[0,0,1] op_sel_hi:[1,0,1]
  v_pk_fma_f32 v[174:175], v[174:175], v[6:7], v[6:7] op_sel:[0,0,1] op_sel_hi:[1,0,1]
  v_pk_fma_f32 v[176:177], v[176:177], v[6:7], v[6:7] op_sel:[0,0,1] op_sel_hi:[1,0,1]
  v_pk_fma_f32 v[178:179], v[178:179], v[6:7], v[6:7] op_sel:[0,0,1] op_sel_hi:[1,0,1]
  v_pk_fma_f32 v[180:181], v[180:181], v[6:7], v[6:7] op_sel:[0,0,1] op_sel_hi:[1,0,1]
  v_pk_fma_f32 v[182:183], v[182:183], v[6:7], v[6:7] op_sel:[0,0,1] op_sel_hi:[1,0,1]
  v_pk_fma_f32 v[184:185], v[184:185], v[6:7], v[6:7] op_sel:[0,0,1] op_sel_hi:[1,0,1]
  v_pk_fma_f32 v[186:187], v[186:187], v[6:7], v[6:7] op_sel:[0,0,1] op_sel_hi:[1,0,1]
  v_cvt_pk_bf16_f32 v164, v172, v173
  v_cvt_pk_bf16_f32 v165, v174, v175
  v_cvt_pk_bf16_f32 v166, v176, v177
  v_cvt_pk_bf16_f32 v167, v178, v179
  v_cvt_pk_bf16_f32 v168, v180, v181
  v_cvt_pk_bf16_f32 v169, v182, v183
  v_cvt_pk_bf16_f32 v170, v184, v185
  v_cvt_pk_bf16_f32 v171, v186, v187
  ds_write_b64 v188, v[164:165] offset:0
  ds_write_b64 v188, v[166:167] offset:16
  ds_write_b64 v188, v[168:169] offset:32
  ds_write_b64 v188, v[170:171] offset:48
  s_waitcnt lgkmcnt(0)
  ds_read_b64_tr_b16 v[172:173], v189 offset:0
  ds_read_b64_tr_b16 v[174:175], v189 offset:576
  ds_read_b64_tr_b16 v[176:177], v189 offset:1152
  ds_read_b64_tr_b16 v[178:179], v189 offset:1728
  s_waitcnt lgkmcnt(2)
  buffer_store_dwordx4 v[172:175], v213, s[28:31], s54 offen offset:0 sc1
  s_waitcnt lgkmcnt(0)
  buffer_store_dwordx4 v[176:179], v213, s[28:31], s54 offen offset:1024 sc1
  s_barrier
  s_cmp_lg_u32 s77, 0
  s_cbranch_scc1 L_sig_82011
  s_mov_b32 exec_lo, 15
  s_mov_b32 exec_hi, 0
  buffer_atomic_add v251, v224, s[28:31], 0 offen offset:4 sc1
  s_mov_b64 exec, -1
L_sig_82011:
  s_mul_i32 s3, s76, 36
  v_add_u32 v224, s3, v224
  s_cmp_eq_u32 s76, 0
  s_cbranch_scc1 L_role4_82012
  s_mul_i32 s58, s74, 524288
  s_mul_i32 s66, s77, 32768
  s_add_u32 s58, s58, s66
  s_add_u32 s58, s58, 6291456
  s_mov_b64 exec, 1
  v_mov_b32 v233, 0
  buffer_atomic_add v233, v210, s[28:31], 0 offen offset:4 sc0 sc1
  s_mov_b64 exec, -1
  s_waitcnt vmcnt(9)
  ds_read_b64_tr_b16 a[184:185], v221 offset:6144
  ds_read_b64_tr_b16 a[186:187], v221 offset:7168
  ds_read_b64_tr_b16 a[188:189], v222 offset:6144
  ds_read_b64_tr_b16 a[190:191], v222 offset:7168
  s_waitcnt vmcnt(7)
  ds_read_b64_tr_b16 a[192:193], v221 offset:0
  ds_read_b64_tr_b16 a[194:195], v221 offset:1024
  ds_read_b64_tr_b16 a[196:197], v222 offset:0
  ds_read_b64_tr_b16 a[198:199], v222 offset:1024
  s_waitcnt vmcnt(5)
  ds_read_b64_tr_b16 a[200:201], v221 offset:2048
  ds_read_b64_tr_b16 a[202:203], v221 offset:3072
  ds_read_b64_tr_b16 a[204:205], v222 offset:2048
  ds_read_b64_tr_b16 a[206:207], v222 offset:3072
  s_waitcnt vmcnt(3)
  ds_read_b64_tr_b16 a[208:209], v221 offset:4096
  ds_read_b64_tr_b16 a[210:211], v221 offset:5120
  ds_read_b64_tr_b16 a[212:213], v222 offset:4096
  ds_read_b64_tr_b16 a[214:215], v222 offset:5120
  s_waitcnt lgkmcnt(12)
  s_add_u32 s61, s61, 28672
  s_add_u32 m0, s56, 6144
  s_nop 0
  buffer_load_dwordx4 v217, s[80:83], s61 offen lds
  s_add_u32 s61, s61, 28672
  s_add_u32 m0, s56, 7168
  s_nop 0
  buffer_load_dwordx4 v217, s[80:83], s61 offen lds
  s_waitcnt lgkmcnt(8)
  s_add_u32 s61, s98, 1605632
  s_cmp_ge_u32 s61, s99
  s_cselect_b32 s94, 1835008, 0
  s_sub_u32 s61, s61, s94
  s_add_u32 m0, s56, 0
  s_nop 0
  buffer_load_dwordx4 v217, s[80:83], s61 offen lds
  s_add_u32 s61, s61, 28672
  s_add_u32 m0, s56, 1024
  s_nop 0
  buffer_load_dwordx4 v217, s[80:83], s61 offen lds
  s_waitcnt lgkmcnt(4)
  s_add_u32 s61, s61, 28672
  s_add_u32 m0, s56, 2048
  s_nop 0
  buffer_load_dwordx4 v217, s[80:83], s61 offen lds
  s_add_u32 s61, s61, 28672
  s_add_u32 m0, s56, 3072
  s_nop 0
  buffer_load_dwordx4 v217, s[80:83], s61 offen lds
  s_waitcnt lgkmcnt(0)
  s_add_u32 s61, s61, 28672
  s_add_u32 m0, s56, 4096
  s_nop 0
  buffer_load_dwordx4 v217, s[80:83], s61 offen lds
  s_add_u32 s61, s61, 28672
  s_add_u32 m0, s56, 5120
  s_nop 0
  buffer_load_dwordx4 v217, s[80:83], s61 offen lds
  v_lshlrev_b32 v16, 16, v24
  v_and_b32 v17, 0xffff0000, v24
  v_lshlrev_b32 v18, 16, v25
  v_and_b32 v19, 0xffff0000, v25
  v_lshlrev_b32 v20, 16, v26
  v_and_b32 v21, 0xffff0000, v26
  v_lshlrev_b32 v22, 16, v27
  v_and_b32 v23, 0xffff0000, v27
  s_add_u32 s66, s58, 0
  s_waitcnt vmcnt(8)
  v_readfirstlane_b32 s3, v233
  s_cmp_lt_u32 s3, 16
  s_cbranch_scc1 L_poll_84014_r
L_poll_84014:
  buffer_load_dwordx4 v[156:159], v213, s[28:31], s66 offen offset:0 sc1
  buffer_load_dwordx4 v[160:163], v213, s[28:31], s66 offen offset:1024 sc1
  buffer_load_dwordx4 v[164:167], v213, s[28:31], s66 offen offset:2048 sc1
  buffer_load_dwordx4 v[168:171], v213, s[28:31], s66 offen offset:3072 sc1
  s_add_u32 s66, s58, 4096
  buffer_load_dwordx4 v[172:175], v213, s[28:31], s66 offen offset:0 sc1
  buffer_load_dwordx4 v[176:179], v213, s[28:31], s66 offen offset:1024 sc1
  buffer_load_dwordx4 v[180:183], v213, s[28:31], s66 offen offset:2048 sc1
  buffer_load_dwordx4 v[184:187], v213, s[28:31], s66 offen offset:3072 sc1
  s_add_u32 s66, s58, 8192
  buffer_load_dwordx4 v[108:111], v213, s[28:31], s66 offen offset:0 sc1
  buffer_load_dwordx4 v[112:115], v213, s[28:31], s66 offen offset:1024 sc1
  buffer_load_dwordx4 v[116:119], v213, s[28:31], s66 offen offset:2048 sc1
  s_waitcnt vmcnt(17)
  ds_read_b64_tr_b16 a[216:217], v221 offset:6144
  ds_read_b64_tr_b16 a[218:219], v221 offset:7168
  ds_read_b64_tr_b16 a[220:221], v222 offset:6144
  ds_read_b64_tr_b16 a[222:223], v222 offset:7168
  s_waitcnt vmcnt(15)
  ds_read_b64_tr_b16 a[224:225], v221 offset:0
  ds_read_b64_tr_b16 a[226:227], v221 offset:1024
  ds_read_b64_tr_b16 a[228:229], v222 offset:0
  ds_read_b64_tr_b16 a[230:231], v222 offset:1024
  s_waitcnt vmcnt(13)
  ds_read_b64_tr_b16 a[232:233], v221 offset:2048
  ds_read_b64_tr_b16 a[234:235], v221 offset:3072
  ds_read_b64_tr_b16 a[236:237], v222 offset:2048
  ds_read_b64_tr_b16 a[238:239], v222 offset:3072
  s_waitcnt vmcnt(11)
  ds_read_b64_tr_b16 a[240:241], v221 offset:4096
  ds_read_b64_tr_b16 a[242:243], v221 offset:5120
  ds_read_b64_tr_b16 a[244:245], v222 offset:4096
  ds_read_b64_tr_b16 a[246:247], v222 offset:5120
  s_barrier
  s_waitcnt vmcnt(10)
  v_cmp_eq_u32 vcc, -1, v156
  s_cbranch_vccnz L_tag_86015_r
L_tag_86015:
  v_mfma_f32_32x32x16_bf16 v[36:51], a[0:3], v[156:159], 0
  s_waitcnt vmcnt(9)
  v_cmp_eq_u32 vcc, -1, v160
  v_mfma_f32_32x32x16_bf16 v[52:67], a[4:7], v[156:159], 0
  s_cbranch_vccnz L_tag_90016_r
L_tag_90016:
  buffer_load_dwordx4 v[156:159], v213, s[28:31], s66 offen offset:3072 sc1
  s_waitcnt lgkmcnt(12)
  s_add_u32 s61, s61, 28672
  s_add_u32 m0, s56, 6144
  s_nop 0
  buffer_load_dwordx4 v217, s[80:83], s61 offen lds
  v_mfma_f32_32x32x16_bf16 v[36:51], a[8:11], v[160:163], v[36:51]
  s_waitcnt vmcnt(10)
  v_cmp_eq_u32 vcc, -1, v164
  v_mfma_f32_32x32x16_bf16 v[52:67], a[12:15], v[160:163], v[52:67]
  s_cbranch_vccnz L_tag_92017_r
L_tag_92017:
  s_add_u32 s66, s58, 12288
  buffer_load_dwordx4 v[160:163], v213, s[28:31], s66 offen offset:0 sc1
  s_add_u32 s61, s61, 28672
  s_add_u32 m0, s56, 7168
  s_nop 0
  buffer_load_dwordx4 v217, s[80:83], s61 offen lds
  v_mfma_f32_32x32x16_bf16 v[36:51], a[16:19], v[164:167], v[36:51]
  s_waitcnt vmcnt(11)
  v_cmp_eq_u32 vcc, -1, v168
  v_mfma_f32_32x32x16_bf16 v[52:67], a[20:23], v[164:167], v[52:67]
  s_cbranch_vccnz L_tag_94018_r
L_tag_94018:
  buffer_load_dwordx4 v[164:167], v213, s[28:31], s66 offen offset:1024 sc1
  v_mfma_f32_32x32x16_bf16 v[36:51], a[24:27], v[168:171], v[36:51]
  s_waitcnt vmcnt(11)
  v_cmp_eq_u32 vcc, -1, v172
  v_mfma_f32_32x32x16_bf16 v[52:67], a[28:31], v[168:171], v[52:67]
  s_cbranch_vccnz L_tag_96019_r
L_tag_96019:
  buffer_load_dwordx4 v[168:171], v213, s[28:31], s66 offen offset:2048 sc1
  v_mfma_f32_32x32x16_bf16 v[36:51], a[32:35], v[172:175], v[36:51]
  s_waitcnt vmcnt(11)
  v_cmp_eq_u32 vcc, -1, v176
  v_mfma_f32_32x32x16_bf16 v[52:67], a[36:39], v[172:175], v[52:67]
  s_cbranch_vccnz L_tag_98020_r
L_tag_98020:
  buffer_load_dwordx4 v[172:175], v213, s[28:31], s66 offen offset:3072 sc1
  v_mfma_f32_32x32x16_bf16 v[36:51], a[40:43], v[176:179], v[36:51]
  s_waitcnt vmcnt(11)
  v_cmp_eq_u32 vcc, -1, v180
  v_mfma_f32_32x32x16_bf16 v[52:67], a[44:47], v[176:179], v[52:67]
  s_cbranch_vccnz L_tag_100021_r
L_tag_100021:
  s_add_u32 s66, s58, 16384
  buffer_load_dwordx4 v[176:179], v213, s[28:31], s66 offen offset:0 sc1
  v_mfma_f32_32x32x16_bf16 v[36:51], a[48:51], v[180:183], v[36:51]
  s_waitcnt vmcnt(11)
  v_cmp_eq_u32 vcc, -1, v184
  v_mfma_f32_32x32x16_bf16 v[52:67], a[52:55], v[180:183], v[52:67]
  s_cbranch_vccnz L_tag_102022_r
L_tag_102022:
  buffer_load_dwordx4 v[180:183], v213, s[28:31], s66 offen offset:1024 sc1
  v_mfma_f32_32x32x16_bf16 v[36:51], a[56:59], v[184:187], v[36:51]
  s_waitcnt vmcnt(11)
  v_cmp_eq_u32 vcc, -1, v108
  v_mfma_f32_32x32x16_bf16 v[52:67], a[60:63], v[184:187], v[52:67]
  s_cbranch_vccnz L_tag_104023_r
L_tag_104023:
  buffer_load_dwordx4 v[184:187], v213, s[28:31], s66 offen offset:2048 sc1
  v_mfma_f32_32x32x16_bf16 v[36:51], a[64:67], v[108:111], v[36:51]
  s_waitcnt vmcnt(11)
  v_cmp_eq_u32 vcc, -1, v112
  v_mfma_f32_32x32x16_bf16 v[52:67], a[68:71], v[108:111], v[52:67]
  s_cbranch_vccnz L_tag_106024_r
L_tag_106024:
  buffer_load_dwordx4 v[108:111], v213, s[28:31], s66 offen offset:3072 sc1
  v_mfma_f32_32x32x16_bf16 v[36:51], a[72:75], v[112:115], v[36:51]
  s_waitcnt vmcnt(11)
  v_cmp_eq_u32 vcc, -1, v116
  v_mfma_f32_32x32x16_bf16 v[52:67], a[76:79], v[112:115], v[52:67]
  s_cbranch_vccnz L_tag_108025_r
L_tag_108025:
  s_add_u32 s66, s58, 20480
  buffer_load_dwordx4 v[112:115], v213, s[28:31], s66 offen offset:0 sc1
  v_mfma_f32_32x32x16_bf16 v[36:51], a[80:83], v[116:119], v[36:51]
  s_waitcnt vmcnt(11)
  v_cmp_eq_u32 vcc, -1, v156
  v_mfma_f32_32x32x16_bf16 v[52:67], a[84:87], v[116:119], v[52:67]
  s_cbranch_vccnz L_tag_110026_r
L_tag_110026:
  buffer_load_dwordx4 v[116:119], v213, s[28:31], s66 offen offset:1024 sc1
  v_mfma_f32_32x32x16_bf16 v[36:51], a[88:91], v[156:159], v[36:51]
  s_waitcnt vmcnt(10)
  v_cmp_eq_u32 vcc, -1, v160
  v_mfma_f32_32x32x16_bf16 v[52:67], a[92:95], v[156:159], v[52:67]
  s_cbranch_vccnz L_tag_112027_r
L_tag_112027:
  buffer_load_dwordx4 v[156:159], v213, s[28:31], s66 offen offset:2048 sc1
  v_mfma_f32_32x32x16_bf16 v[36:51], a[96:99], v[160:163], v[36:51]
  s_waitcnt vmcnt(9)
  v_cmp_eq_u32 vcc, -1, v164
  v_mfma_f32_32x32x16_bf16 v[52:67], a[100:103], v[160:163], v[52:67]
  s_cbranch_vccnz L_tag_114028_r
L_tag_114028:
  buffer_load_dwordx4 v[160:163], v213, s[28:31], s66 offen offset:3072 sc1
  ds_read_b64_tr_b16 a[248:249], v221 offset:6144
  ds_read_b64_tr_b16 a[250:251], v221 offset:7168
  ds_read_b64_tr_b16 a[252:253], v222 offset:6144
  ds_read_b64_tr_b16 a[254:255], v222 offset:7168
  v_mfma_f32_32x32x16_bf16 v[36:51], a[104:107], v[164:167], v[36:51]
  s_waitcnt vmcnt(9)
  v_cmp_eq_u32 vcc, -1, v168
  v_mfma_f32_32x32x16_bf16 v[52:67], a[108:111], v[164:167], v[52:67]
  s_cbranch_vccnz L_tag_116029_r
L_tag_116029:
  s_add_u32 s66, s58, 24576
  buffer_load_dwordx4 v[164:167], v213, s[28:31], s66 offen offset:0 sc1
  v_mfma_f32_32x32x16_bf16 v[36:51], a[112:115], v[168:171], v[36:51]
  s_waitcnt vmcnt(9)
  v_cmp_eq_u32 vcc, -1, v172
  v_mfma_f32_32x32x16_bf16 v[52:67], a[116:119], v[168:171], v[52:67]
  s_cbranch_vccnz L_tag_118030_r
L_tag_118030:
  buffer_load_dwordx4 v[168:171], v213, s[28:31], s66 offen offset:1024 sc1
  v_mfma_f32_32x32x16_bf16 v[36:51], a[120:123], v[172:175], v[36:51]
  s_waitcnt vmcnt(9)
  v_cmp_eq_u32 vcc, -1, v176
  v_mfma_f32_32x32x16_bf16 v[52:67], a[124:127], v[172:175], v[52:67]
  s_cbranch_vccnz L_tag_120031_r
L_tag_120031:
  buffer_load_dwordx4 v[172:175], v213, s[28:31], s66 offen offset:2048 sc1
  v_mfma_f32_32x32x16_bf16 v[36:51], a[128:131], v[176:179], v[36:51]
  s_waitcnt vmcnt(9)
  v_cmp_eq_u32 vcc, -1, v180
  v_mfma_f32_32x32x16_bf16 v[52:67], a[132:135], v[176:179], v[52:67]
  s_cbranch_vccnz L_tag_122032_r
L_tag_122032:
  buffer_load_dwordx4 v[176:179], v213, s[28:31], s66 offen offset:3072 sc1
  v_mfma_f32_32x32x16_bf16 v[36:51], a[136:139], v[180:183], v[36:51]
  s_waitcnt vmcnt(9)
  v_cmp_eq_u32 vcc, -1, v184
  v_mfma_f32_32x32x16_bf16 v[52:67], a[140:143], v[180:183], v[52:67]
  s_cbranch_vccnz L_tag_124033_r
L_tag_124033:
  s_add_u32 s66, s58, 28672
  buffer_load_dwordx4 v[180:183], v213, s[28:31], s66 offen offset:0 sc1
  v_mfma_f32_32x32x16_bf16 v[36:51], a[144:147], v[184:187], v[36:51]
  s_waitcnt vmcnt(9)
  v_cmp_eq_u32 vcc, -1, v108
  v_mfma_f32_32x32x16_bf16 v[52:67], a[148:151], v[184:187], v[52:67]
  s_cbranch_vccnz L_tag_126034_r
L_tag_126034:
  buffer_load_dwordx4 v[184:187], v213, s[28:31], s66 offen offset:1024 sc1
  v_mfma_f32_32x32x16_bf16 v[36:51], a[152:155], v[108:111], v[36:51]
  s_waitcnt vmcnt(9)
  v_cmp_eq_u32 vcc, -1, v112
  v_mfma_f32_32x32x16_bf16 v[52:67], a[156:159], v[108:111], v[52:67]
  s_cbranch_vccnz L_tag_128035_r
L_tag_128035:
  buffer_load_dwordx4 v[108:111], v213, s[28:31], s66 offen offset:2048 sc1
  v_mfma_f32_32x32x16_bf16 v[36:51], a[160:163], v[112:115], v[36:51]
  s_waitcnt vmcnt(9)
  v_cmp_eq_u32 vcc, -1, v116
  v_mfma_f32_32x32x16_bf16 v[52:67], a[164:167], v[112:115], v[52:67]
  s_cbranch_vccnz L_tag_130036_r
L_tag_130036:
  buffer_load_dwordx4 v[112:115], v213, s[28:31], s66 offen offset:3072 sc1
  v_mfma_f32_32x32x16_bf16 v[36:51], a[168:171], v[116:119], v[36:51]
  s_waitcnt vmcnt(9)
  v_cmp_eq_u32 vcc, -1, v156
  v_mfma_f32_32x32x16_bf16 v[52:67], a[172:175], v[116:119], v[52:67]
  s_cbranch_vccnz L_tag_132037_r
L_tag_132037:
  s_add_u32 s66, s58, 131072
  buffer_load_dwordx4 v[116:119], v213, s[28:31], s66 offen offset:0 sc1
  v_mfma_f32_32x32x16_bf16 v[36:51], a[176:179], v[156:159], v[36:51]
  s_waitcnt vmcnt(9)
  v_cmp_eq_u32 vcc, -1, v160
  v_mfma_f32_32x32x16_bf16 v[52:67], a[180:183], v[156:159], v[52:67]
  s_cbranch_vccnz L_tag_134038_r
L_tag_134038:
  buffer_load_dwordx4 v[156:159], v213, s[28:31], s66 offen offset:1024 sc1
  v_mfma_f32_32x32x16_bf16 v[36:51], a[184:187], v[160:163], v[36:51]
  s_waitcnt vmcnt(9)
  v_cmp_eq_u32 vcc, -1, v164
  v_mfma_f32_32x32x16_bf16 v[52:67], a[188:191], v[160:163], v[52:67]
  s_cbranch_vccnz L_tag_136039_r
L_tag_136039:
  buffer_load_dwordx4 v[160:163], v213, s[28:31], s66 offen offset:2048 sc1
  v_mfma_f32_32x32x16_bf16 v[36:51], a[192:195], v[164:167], v[36:51]
  s_waitcnt vmcnt(9)
  v_cmp_eq_u32 vcc, -1, v168
  v_mfma_f32_32x32x16_bf16 v[52:67], a[196:199], v[164:167], v[52:67]
  s_cbranch_vccnz L_tag_138040_r
L_tag_138040:
  buffer_load_dwordx4 v[164:167], v213, s[28:31], s66 offen offset:3072 sc1
  v_mfma_f32_32x32x16_bf16 v[36:51], a[200:203], v[168:171], v[36:51]
  s_waitcnt vmcnt(9)
  v_cmp_eq_u32 vcc, -1, v172
  v_mfma_f32_32x32x16_bf16 v[52:67], a[204:207], v[168:171], v[52:67]
  s_cbranch_vccnz L_tag_140041_r
L_tag_140041:
  s_add_u32 s66, s58, 135168
  buffer_load_dwordx4 v[168:171], v213, s[28:31], s66 offen offset:0 sc1
  v_mfma_f32_32x32x16_bf16 v[36:51], a[208:211], v[172:175], v[36:51]
  s_waitcnt vmcnt(9)
  v_cmp_eq_u32 vcc, -1, v176
  v_mfma_f32_32x32x16_bf16 v[52:67], a[212:215], v[172:175], v[52:67]
  s_cbranch_vccnz L_tag_142042_r
L_tag_142042:
  buffer_load_dwordx4 v[172:175], v213, s[28:31], s66 offen offset:1024 sc1
  v_mfma_f32_32x32x16_bf16 v[36:51], a[216:219], v[176:179], v[36:51]
  s_waitcnt vmcnt(9)
  v_cmp_eq_u32 vcc, -1, v180
  v_mfma_f32_32x32x16_bf16 v[52:67], a[220:223], v[176:179], v[52:67]
  s_cbranch_vccnz L_tag_144043_r
L_tag_144043:
  buffer_load_dwordx4 v[176:179], v213, s[28:31], s66 offen offset:2048 sc1
  s_waitcnt lgkmcnt(12)
  v_mfma_f32_32x32x16_bf16 v[36:51], a[224:227], v[180:183], v[36:51]
  s_waitcnt vmcnt(9)
  v_cmp_eq_u32 vcc, -1, v184
  v_mfma_f32_32x32x16_bf16 v[52:67], a[228:231], v[180:183], v[52:67]
  s_cbranch_vccnz L_tag_146044_r
L_tag_146044:
  buffer_load_dwordx4 v[180:183], v213, s[28:31], s66 offen offset:3072 sc1
  s_waitcnt lgkmcnt(8)
  v_mfma_f32_32x32x16_bf16 v[36:51], a[232:235], v[184:187], v[36:51]
  s_waitcnt vmcnt(9)
  v_cmp_eq_u32 vcc, -1, v108
  v_mfma_f32_32x32x16_bf16 v[52:67], a[236:239], v[184:187], v[52:67]
  s_cbranch_vccnz L_tag_148045_r
L_tag_148045:
  s_add_u32 s66, s58, 139264
  buffer_load_dwordx4 v[184:187], v213, s[28:31], s66 offen offset:0 sc1
  s_waitcnt lgkmcnt(4)
  v_mfma_f32_32x32x16_bf16 v[36:51], a[240:243], v[108:111], v[36:51]
  s_waitcnt vmcnt(9)
  v_cmp_eq_u32 vcc, -1, v112
  v_mfma_f32_32x32x16_bf16 v[52:67], a[244:247], v[108:111], v[52:67]
  s_cbranch_vccnz L_tag_150046_r
L_tag_150046:
  buffer_load_dwordx4 v[108:111], v213, s[28:31], s66 offen offset:1024 sc1
  s_waitcnt lgkmcnt(0)
  v_mfma_f32_32x32x16_bf16 v[36:51], a[248:251], v[112:115], v[36:51]
  s_waitcnt vmcnt(9)
  v_cmp_eq_u32 vcc, -1, v116
  v_mfma_f32_32x32x16_bf16 v[52:67], a[252:255], v[112:115], v[52:67]
  s_cbranch_vccnz L_tag_152047_r
L_tag_152047:
  buffer_load_dwordx4 v[112:115], v213, s[28:31], s66 offen offset:2048 sc1
  v_mfma_f32_32x32x16_bf16 v[68:83], a[0:3], v[116:119], 0
  s_nop 5
  ds_write_b128 v253, v[44:47] offset:0
  ds_write_b128 v253, v[48:51] offset:1024
  s_nop 0
  ds_write_b128 v254, v[52:55] offset:0
  s_waitcnt vmcnt(9)
  v_cmp_eq_u32 vcc, -1, v156
  v_mfma_f32_32x32x16_bf16 v[84:99], a[4:7], v[116:119], 0
  s_cbranch_vccnz L_tag_284049_r
L_tag_284049:
  buffer_load_dwordx4 v[116:119], v213, s[28:31], s66 offen offset:3072 sc1
  ds_write_b128 v254, v[56:59] offset:1024
  ds_write_b128 v255, v[60:63] offset:0
  ds_write_b128 v255, v[64:67] offset:1024
  v_mfma_f32_32x32x16_bf16 v[68:83], a[8:11], v[156:159], v[68:83]
  v_pk_add_f32 v[36:37], v[36:37], v[16:17]
  v_pk_add_f32 v[38:39], v[38:39], v[18:19]
  v_pk_add_f32 v[40:41], v[40:41], v[20:21]
  v_pk_add_f32 v[42:43], v[42:43], v[22:23]
  s_waitcnt lgkmcnt(0)
  s_barrier
  ds_read_b128 v[132:135], v230 offset:0
  ds_read_b128 v[136:139], v230 offset:1024
  ds_read_b128 v[140:143], v230 offset:2048
  ds_read_b128 v[144:147], v230 offset:3072
  ds_read_b128 v[148:151], v230 offset:4096
  ds_read_b128 v[152:155], v230 offset:5120
  s_waitcnt vmcnt(9)
  v_cmp_eq_u32 vcc, -1, v160
  v_mfma_f32_32x32x16_bf16 v[84:99], a[12:15], v[156:159], v[84:99]
  s_cbranch_vccnz L_tag_286050_r
L_tag_286050:
  s_add_u32 s66, s58, 143360
  buffer_load_dwordx4 v[156:159], v213, s[28:31], s66 offen offset:0 sc1
  v_mfma_f32_32x32x16_bf16 v[68:83], a[16:19], v[160:163], v[68:83]
  s_waitcnt lgkmcnt(5)
  v_pk_add_f32 v[36:37], v[36:37], v[132:133]
  v_pk_add_f32 v[38:39], v[38:39], v[134:135]
  s_waitcnt lgkmcnt(4)
  v_pk_add_f32 v[40:41], v[40:41], v[136:137]
  v_pk_add_f32 v[42:43], v[42:43], v[138:139]
  s_waitcnt lgkmcnt(3)
  v_pk_add_f32 v[36:37], v[36:37], v[140:141]
  v_pk_add_f32 v[38:39], v[38:39], v[142:143]
  s_waitcnt vmcnt(9)
  v_cmp_eq_u32 vcc, -1, v164
  v_mfma_f32_32x32x16_bf16 v[84:99], a[20:23], v[160:163], v[84:99]
  s_cbranch_vccnz L_tag_288051_r
L_tag_288051:
  buffer_load_dwordx4 v[160:163], v213, s[28:31], s66 offen offset:1024 sc1
  s_waitcnt lgkmcnt(2)
  v_pk_add_f32 v[40:41], v[40:41], v[144:145]
  v_pk_add_f32 v[42:43], v[42:43], v[146:147]
  s_waitcnt lgkmcnt(1)
  v_pk_add_f32 v[36:37], v[36:37], v[148:149]
  v_pk_add_f32 v[38:39], v[38:39], v[150:151]
  s_waitcnt lgkmcnt(0)
  v_pk_add_f32 v[40:41], v[40:41], v[152:153]
  v_pk_add_f32 v[42:43], v[42:43], v[154:155]
  v_mfma_f32_32x32x16_bf16 v[68:83], a[24:27], v[164:167], v[68:83]
  v_pk_mul_f32 v[8:9], v[36:37], v[36:37]
  v_pk_mul_f32 v[10:11], v[38:39], v[38:39]
  v_pk_mul_f32 v[12:13], v[40:41], v[40:41]
  v_pk_mul_f32 v[14:15], v[42:43], v[42:43]
  v_pk_fma_f32 v[8:9], v[8:9], v[28:29], v[28:29] op_sel:[0,0,1] op_sel_hi:[1,0,1]
  v_pk_fma_f32 v[10:11], v[10:11], v[28:29], v[28:29] op_sel:[0,0,1] op_sel_hi:[1,0,1]
  s_waitcnt vmcnt(9)
  v_cmp_eq_u32 vcc, -1, v168
  v_mfma_f32_32x32x16_bf16 v[84:99], a[28:31], v[164:167], v[84:99]
  s_cbranch_vccnz L_tag_290052_r
L_tag_290052:
  buffer_load_dwordx4 v[164:167], v213, s[28:31], s66 offen offset:2048 sc1
  v_pk_fma_f32 v[12:13], v[12:13], v[28:29], v[28:29] op_sel:[0,0,1] op_sel_hi:[1,0,1]
  v_pk_fma_f32 v[14:15], v[14:15], v[28:29], v[28:29] op_sel:[0,0,1] op_sel_hi:[1,0,1]
  v_pk_mul_f32 v[8:9], v[8:9], v[36:37]
  v_pk_mul_f32 v[10:11], v[10:11], v[38:39]
  v_pk_mul_f32 v[12:13], v[12:13], v[40:41]
  v_pk_mul_f32 v[14:15], v[14:15], v[42:43]
  v_mfma_f32_32x32x16_bf16 v[68:83], a[32:35], v[168:171], v[68:83]
  v_exp_f32 v8, v8
  v_exp_f32 v9, v9
  v_exp_f32 v10, v10
  v_exp_f32 v11, v11
  v_exp_f32 v12, v12
  v_exp_f32 v13, v13
  s_waitcnt vmcnt(9)
  v_cmp_eq_u32 vcc, -1, v172
  v_mfma_f32_32x32x16_bf16 v[84:99], a[36:39], v[168:171], v[84:99]
  s_cbranch_vccnz L_tag_292053_r
L_tag_292053:
  buffer_load_dwordx4 v[168:171], v213, s[28:31], s66 offen offset:3072 sc1
  v_exp_f32 v14, v14
  v_exp_f32 v15, v15
  v_pk_add_f32 v[8:9], v[8:9], v[30:31] op_sel_hi:[1,0]
  v_pk_add_f32 v[10:11], v[10:11], v[30:31] op_sel_hi:[1,0]
  v_pk_add_f32 v[12:13], v[12:13], v[30:31] op_sel_hi:[1,0]
  v_pk_add_f32 v[14:15], v[14:15], v[30:31] op_sel_hi:[1,0]
  v_mfma_f32_32x32x16_bf16 v[68:83], a[40:43], v[172:175], v[68:83]
  v_rcp_f32 v8, v8
  v_rcp_f32 v9, v9
  v_rcp_f32 v10, v10
  v_rcp_f32 v11, v11
  v_rcp_f32 v12, v12
  v_rcp_f32 v13, v13
  s_waitcnt vmcnt(9)
  v_cmp_eq_u32 vcc, -1, v176
  v_mfma_f32_32x32x16_bf16 v[84:99], a[44:47], v[172:175], v[84:99]
  s_cbranch_vccnz L_tag_294054_r
L_tag_294054:
  s_add_u32 s66, s58, 147456
  buffer_load_dwordx4 v[172:175], v213, s[28:31], s66 offen offset:0 sc1
  v_rcp_f32 v14, v14
  v_rcp_f32 v15, v15
  v_pk_mul_f32 v[8:9], v[8:9], v[36:37]
  v_pk_mul_f32 v[10:11], v[10:11], v[38:39]
  v_pk_mul_f32 v[12:13], v[12:13], v[40:41]
  v_pk_mul_f32 v[14:15], v[14:15], v[42:43]
  v_mfma_f32_32x32x16_bf16 v[68:83], a[48:51], v[176:179], v[68:83]
  v_cvt_pk_bf16_f32 v24, v8, v9
  v_cvt_pk_bf16_f32 v25, v10, v11
  v_cvt_pk_bf16_f32 v26, v12, v13
  v_cvt_pk_bf16_f32 v27, v14, v15
  s_add_u32 s52, s62, 0
  buffer_store_dwordx4 v[24:27], v232, s[28:31], s52 offen sc1
  s_cmp_lg_u32 s77, 0
  s_cbranch_scc1 L_sig_282048
  s_cmp_eq_u32 s95, 0
  s_cbranch_scc1 L_sig_282048
  s_mov_b32 exec_lo, s95
  s_mov_b32 exec_hi, 0
  buffer_atomic_add v251, v225, s[28:31], 0 offen offset:8 sc1
  s_mov_b64 exec, -1
L_sig_282048:
  s_waitcnt vmcnt(10)
  v_cmp_eq_u32 vcc, -1, v180
  v_mfma_f32_32x32x16_bf16 v[84:99], a[52:55], v[176:179], v[84:99]
  s_cbranch_vccnz L_tag_296055_r
L_tag_296055:
  buffer_load_dwordx4 v[176:179], v213, s[28:31], s66 offen offset:1024 sc1
  v_mfma_f32_32x32x16_bf16 v[68:83], a[56:59], v[180:183], v[68:83]
  s_waitcnt vmcnt(10)
  v_cmp_eq_u32 vcc, -1, v184
  v_mfma_f32_32x32x16_bf16 v[84:99], a[60:63], v[180:183], v[84:99]
  s_cbranch_vccnz L_tag_298056_r
L_tag_298056:
  buffer_load_dwordx4 v[180:183], v213, s[28:31], s66 offen offset:2048 sc1
  v_mfma_f32_32x32x16_bf16 v[68:83], a[64:67], v[184:187], v[68:83]
  s_waitcnt vmcnt(10)
  v_cmp_eq_u32 vcc, -1, v108
  v_mfma_f32_32x32x16_bf16 v[84:99], a[68:71], v[184:187], v[84:99]
  s_cbranch_vccnz L_tag_300057_r
L_tag_300057:
  buffer_load_dwordx4 v[184:187], v213, s[28:31], s66 offen offset:3072 sc1
  v_mfma_f32_32x32x16_bf16 v[68:83], a[72:75], v[108:111], v[68:83]
  s_waitcnt vmcnt(10)
  v_cmp_eq_u32 vcc, -1, v112
  v_mfma_f32_32x32x16_bf16 v[84:99], a[76:79], v[108:111], v[84:99]
  s_cbranch_vccnz L_tag_302058_r
L_tag_302058:
  s_add_u32 s66, s58, 151552
  buffer_load_dwordx4 v[108:111], v213, s[28:31], s66 offen offset:0 sc1
  v_mfma_f32_32x32x16_bf16 v[68:83], a[80:83], v[112:115], v[68:83]
  s_waitcnt vmcnt(10)
  v_cmp_eq_u32 vcc, -1, v116
  v_mfma_f32_32x32x16_bf16 v[84:99], a[84:87], v[112:115], v[84:99]
  s_cbranch_vccnz L_tag_304059_r
L_tag_304059:
  buffer_load_dwordx4 v[112:115], v213, s[28:31], s66 offen offset:1024 sc1
  v_mfma_f32_32x32x16_bf16 v[68:83], a[88:91], v[116:119], v[68:83]
  s_waitcnt vmcnt(10)
  v_cmp_eq_u32 vcc, -1, v156
  v_mfma_f32_32x32x16_bf16 v[84:99], a[92:95], v[116:119], v[84:99]
  s_cbranch_vccnz L_tag_306060_r
L_tag_306060:
  buffer_load_dwordx4 v[116:119], v213, s[28:31], s66 offen offset:2048 sc1
  v_mfma_f32_32x32x16_bf16 v[68:83], a[96:99], v[156:159], v[68:83]
  s_waitcnt vmcnt(10)
  v_cmp_eq_u32 vcc, -1, v160
  v_mfma_f32_32x32x16_bf16 v[84:99], a[100:103], v[156:159], v[84:99]
  s_cbranch_vccnz L_tag_308061_r
L_tag_308061:
  buffer_load_dwordx4 v[156:159], v213, s[28:31], s66 offen offset:3072 sc1
  v_mov_b32 v190, -1
  v_mov_b32 v191, -1
  v_mov_b32 v192, -1
  v_mov_b32 v193, -1
  v_mfma_f32_32x32x16_bf16 v[68:83], a[104:107], v[160:163], v[68:83]
  s_waitcnt vmcnt(10)
  v_cmp_eq_u32 vcc, -1, v164
  v_mfma_f32_32x32x16_bf16 v[84:99], a[108:111], v[160:163], v[84:99]
  s_cbranch_vccnz L_tag_310062_r
L_tag_310062:
  s_add_u32 s66, s58, 155648
  buffer_load_dwordx4 v[160:163], v213, s[28:31], s66 offen offset:0 sc1
  s_lshl_b32 s94, s72, 1
  s_add_u32 s94, s94, s79
  s_lshl_b32 s94, s94, 3
  s_add_u32 s94, s94, s73
  s_lshl_b32 s94, s94, 1
  s_add_u32 s94, s94, s78
  s_lshl_b32 s94, s94, 8
  s_add_u32 s94, s94, 1310720
  v_lshlrev_b32 v252, 2, v228
  buffer_store_dword v190, v252, s[28:31], s94 offen sc1
  v_mfma_f32_32x32x16_bf16 v[68:83], a[112:115], v[164:167], v[68:83]
  s_waitcnt vmcnt(11)
  v_cmp_eq_u32 vcc, -1, v168
  v_mfma_f32_32x32x16_bf16 v[84:99], a[116:119], v[164:167], v[84:99]
  s_cbranch_vccnz L_tag_312063_r
L_tag_312063:
  buffer_load_dwordx4 v[164:167], v213, s[28:31], s66 offen offset:1024 sc1
  v_mfma_f32_32x32x16_bf16 v[68:83], a[120:123], v[168:171], v[68:83]
  s_waitcnt vmcnt(11)
  v_cmp_eq_u32 vcc, -1, v172
  v_mfma_f32_32x32x16_bf16 v[84:99], a[124:127], v[168:171], v[84:99]
  s_cbranch_vccnz L_tag_314064_r
L_tag_314064:
  buffer_load_dwordx4 v[168:171], v213, s[28:31], s66 offen offset:2048 sc1
  v_mfma_f32_32x32x16_bf16 v[68:83], a[128:131], v[172:175], v[68:83]
  s_waitcnt vmcnt(10)
  v_cmp_eq_u32 vcc, -1, v176
  v_mfma_f32_32x32x16_bf16 v[84:99], a[132:135], v[172:175], v[84:99]
  s_cbranch_vccnz L_tag_316065_r
L_tag_316065:
  buffer_load_dwordx4 v[172:175], v213, s[28:31], s66 offen offset:3072 sc1
  s_add_u32 s94, s0, 10485760
  buffer_store_dwordx4 v[190:193], v213, s[28:31], s94 offen sc1
  v_mfma_f32_32x32x16_bf16 v[68:83], a[136:139], v[176:179], v[68:83]
  s_waitcnt vmcnt(11)
  v_cmp_eq_u32 vcc, -1, v180
  v_mfma_f32_32x32x16_bf16 v[84:99], a[140:143], v[176:179], v[84:99]
  s_cbranch_vccnz L_tag_318066_r
L_tag_318066:
  s_add_u32 s66, s58, 159744
  buffer_load_dwordx4 v[176:179], v213, s[28:31], s66 offen offset:0 sc1
  v_mfma_f32_32x32x16_bf16 v[68:83], a[144:147], v[180:183], v[68:83]
  s_waitcnt vmcnt(11)
  v_cmp_eq_u32 vcc, -1, v184
  v_mfma_f32_32x32x16_bf16 v[84:99], a[148:151], v[180:183], v[84:99]
  s_cbranch_vccnz L_tag_320067_r
L_tag_320067:
  buffer_load_dwordx4 v[180:183], v213, s[28:31], s66 offen offset:1024 sc1
  v_mfma_f32_32x32x16_bf16 v[68:83], a[152:155], v[184:187], v[68:83]
  s_waitcnt vmcnt(11)
  v_cmp_eq_u32 vcc, -1, v108
  v_mfma_f32_32x32x16_bf16 v[84:99], a[156:159], v[184:187], v[84:99]
  s_cbranch_vccnz L_tag_322068_r
L_tag_322068:
  buffer_load_dwordx4 v[184:187], v213, s[28:31], s66 offen offset:2048 sc1
  s_add_u32 s94, s0, 10518528
  buffer_store_dwordx4 v[190:193], v213, s[28:31], s94 offen sc1
  v_mfma_f32_32x32x16_bf16 v[68:83], a[160:163], v[108:111], v[68:83]
  s_waitcnt vmcnt(12)
  v_cmp_eq_u32 vcc, -1, v112
  v_mfma_f32_32x32x16_bf16 v[84:99], a[164:167], v[108:111], v[84:99]
  s_cbranch_vccnz L_tag_324069_r
L_tag_324069:
  buffer_load_dwordx4 v[108:111], v213, s[28:31], s66 offen offset:3072 sc1
  v_mfma_f32_32x32x16_bf16 v[68:83], a[168:171], v[112:115], v[68:83]
  s_waitcnt vmcnt(12)
  v_cmp_eq_u32 vcc, -1, v116
  v_mfma_f32_32x32x16_bf16 v[84:99], a[172:175], v[112:115], v[84:99]
  s_cbranch_vccnz L_tag_326070_r
L_tag_326070:
  s_add_u32 s66, s58, 262144
  buffer_load_dwordx4 v[112:115], v213, s[28:31], s66 offen offset:0 sc1
  v_mfma_f32_32x32x16_bf16 v[68:83], a[176:179], v[116:119], v[68:83]
  s_waitcnt vmcnt(12)
  v_cmp_eq_u32 vcc, -1, v156
  v_mfma_f32_32x32x16_bf16 v[84:99], a[180:183], v[116:119], v[84:99]
  s_cbranch_vccnz L_tag_328071_r
L_tag_328071:
  buffer_load_dwordx4 v[116:119], v213, s[28:31], s66 offen offset:1024 sc1
  v_mfma_f32_32x32x16_bf16 v[68:83], a[184:187], v[156:159], v[68:83]
  s_waitcnt vmcnt(12)
  v_cmp_eq_u32 vcc, -1, v160
  v_mfma_f32_32x32x16_bf16 v[84:99], a[188:191], v[156:159], v[84:99]
  s_cbranch_vccnz L_tag_330072_r
L_tag_330072:
  buffer_load_dwordx4 v[156:159], v213, s[28:31], s66 offen offset:2048 sc1
  v_mfma_f32_32x32x16_bf16 v[68:83], a[192:195], v[160:163], v[68:83]
  s_waitcnt vmcnt(11)
  v_cmp_eq_u32 vcc, -1, v164
  v_mfma_f32_32x32x16_bf16 v[84:99], a[196:199], v[160:163], v[84:99]
  s_cbranch_vccnz L_tag_332073_r
L_tag_332073:
  buffer_load_dwordx4 v[160:163], v213, s[28:31], s66 offen offset:3072 sc1
  v_mfma_f32_32x32x16_bf16 v[68:83], a[200:203], v[164:167], v[68:83]
  s_waitcnt vmcnt(11)
  v_cmp_eq_u32 vcc, -1, v168
  v_mfma_f32_32x32x16_bf16 v[84:99], a[204:207], v[164:167], v[84:99]
  s_cbranch_vccnz L_tag_334074_r
L_tag_334074:
  s_add_u32 s66, s58, 266240
  buffer_load_dwordx4 v[164:167], v213, s[28:31], s66 offen offset:0 sc1
  v_mfma_f32_32x32x16_bf16 v[68:83], a[208:211], v[168:171], v[68:83]
  s_waitcnt vmcnt(11)
  v_cmp_eq_u32 vcc, -1, v172
  v_mfma_f32_32x32x16_bf16 v[84:99], a[212:215], v[168:171], v[84:99]
  s_cbranch_vccnz L_tag_336075_r
L_tag_336075:
  buffer_load_dwordx4 v[168:171], v213, s[28:31], s66 offen offset:1024 sc1
  v_mfma_f32_32x32x16_bf16 v[68:83], a[216:219], v[172:175], v[68:83]
  s_waitcnt vmcnt(10)
  v_cmp_eq_u32 vcc, -1, v176
  v_mfma_f32_32x32x16_bf16 v[84:99], a[220:223], v[172:175], v[84:99]
  s_cbranch_vccnz L_tag_338076_r
L_tag_338076:
  buffer_load_dwordx4 v[172:175], v213, s[28:31], s66 offen offset:2048 sc1
  v_mfma_f32_32x32x16_bf16 v[68:83], a[224:227], v[176:179], v[68:83]
  s_waitcnt vmcnt(10)
  v_cmp_eq_u32 vcc, -1, v180
  v_mfma_f32_32x32x16_bf16 v[84:99], a[228:231], v[176:179], v[84:99]
  s_cbranch_vccnz L_tag_340077_r
L_tag_340077:
  buffer_load_dwordx4 v[176:179], v213, s[28:31], s66 offen offset:3072 sc1
  v_mfma_f32_32x32x16_bf16 v[68:83], a[232:235], v[180:183], v[68:83]
  s_waitcnt vmcnt(10)
  v_cmp_eq_u32 vcc, -1, v184
  v_mfma_f32_32x32x16_bf16 v[84:99], a[236:239], v[180:183], v[84:99]
  s_cbranch_vccnz L_tag_342078_r
L_tag_342078:
  s_add_u32 s66, s58, 270336
  buffer_load_dwordx4 v[180:183], v213, s[28:31], s66 offen offset:0 sc1
  v_mfma_f32_32x32x16_bf16 v[68:83], a[240:243], v[184:187], v[68:83]
  s_waitcnt vmcnt(9)
  v_cmp_eq_u32 vcc, -1, v108
  v_mfma_f32_32x32x16_bf16 v[84:99], a[244:247], v[184:187], v[84:99]
  s_cbranch_vccnz L_tag_344079_r
L_tag_344079:
  buffer_load_dwordx4 v[184:187], v213, s[28:31], s66 offen offset:1024 sc1
  v_mfma_f32_32x32x16_bf16 v[68:83], a[248:251], v[108:111], v[68:83]
  s_waitcnt vmcnt(9)
  v_cmp_eq_u32 vcc, -1, v112
  v_mfma_f32_32x32x16_bf16 v[84:99], a[252:255], v[108:111], v[84:99]
  s_cbranch_vccnz L_tag_346080_r
L_tag_346080:
  buffer_load_dwordx4 v[108:111], v213, s[28:31], s66 offen offset:2048 sc1
  v_mfma_f32_32x32x16_bf16 v[36:51], a[0:3], v[112:115], 0
  s_nop 5
  ds_write_b128 v253, v[76:79] offset:0
  ds_write_b128 v253, v[80:83] offset:1024
  s_nop 0
  ds_write_b128 v254, v[84:87] offset:0
  s_waitcnt vmcnt(9)
  v_cmp_eq_u32 vcc, -1, v116
  v_mfma_f32_32x32x16_bf16 v[52:67], a[4:7], v[112:115], 0
  s_cbranch_vccnz L_tag_478082_r
L_tag_478082:
  buffer_load_dwordx4 v[112:115], v213, s[28:31], s66 offen offset:3072 sc1
  ds_write_b128 v254, v[88:91] offset:1024
  ds_write_b128 v255, v[92:95] offset:0
  ds_write_b128 v255, v[96:99] offset:1024
  v_mfma_f32_32x32x16_bf16 v[36:51], a[8:11], v[116:119], v[36:51]
  v_pk_add_f32 v[68:69], v[68:69], v[16:17]
  v_pk_add_f32 v[70:71], v[70:71], v[18:19]
  v_pk_add_f32 v[72:73], v[72:73], v[20:21]
  v_pk_add_f32 v[74:75], v[74:75], v[22:23]
  s_waitcnt lgkmcnt(0)
  s_barrier
  ds_read_b128 v[132:135], v230 offset:0
  ds_read_b128 v[136:139], v230 offset:1024
  ds_read_b128 v[140:143], v230 offset:2048
  ds_read_b128 v[144:147], v230 offset:3072
  ds_read_b128 v[148:151], v230 offset:4096
  ds_read_b128 v[152:155], v230 offset:5120
  s_waitcnt vmcnt(9)
  v_cmp_eq_u32 vcc, -1, v156
  v_mfma_f32_32x32x16_bf16 v[52:67], a[12:15], v[116:119], v[52:67]
  s_cbranch_vccnz L_tag_480083_r
L_tag_480083:
  s_add_u32 s66, s58, 274432
  buffer_load_dwordx4 v[116:119], v213, s[28:31], s66 offen offset:0 sc1
  v_mfma_f32_32x32x16_bf16 v[36:51], a[16:19], v[156:159], v[36:51]
  s_waitcnt lgkmcnt(5)
  v_pk_add_f32 v[68:69], v[68:69], v[132:133]
  v_pk_add_f32 v[70:71], v[70:71], v[134:135]
  s_waitcnt lgkmcnt(4)
  v_pk_add_f32 v[72:73], v[72:73], v[136:137]
  v_pk_add_f32 v[74:75], v[74:75], v[138:139]
  s_waitcnt lgkmcnt(3)
  v_pk_add_f32 v[68:69], v[68:69], v[140:141]
  v_pk_add_f32 v[70:71], v[70:71], v[142:143]
  s_waitcnt vmcnt(9)
  v_cmp_eq_u32 vcc, -1, v160
  v_mfma_f32_32x32x16_bf16 v[52:67], a[20:23], v[156:159], v[52:67]
  s_cbranch_vccnz L_tag_482084_r
L_tag_482084:
  buffer_load_dwordx4 v[156:159], v213, s[28:31], s66 offen offset:1024 sc1
  s_waitcnt lgkmcnt(2)
  v_pk_add_f32 v[72:73], v[72:73], v[144:145]
  v_pk_add_f32 v[74:75], v[74:75], v[146:147]
  s_waitcnt lgkmcnt(1)
  v_pk_add_f32 v[68:69], v[68:69], v[148:149]
  v_pk_add_f32 v[70:71], v[70:71], v[150:151]
  s_waitcnt lgkmcnt(0)
  v_pk_add_f32 v[72:73], v[72:73], v[152:153]
  v_pk_add_f32 v[74:75], v[74:75], v[154:155]
  v_mfma_f32_32x32x16_bf16 v[36:51], a[24:27], v[160:163], v[36:51]
  v_pk_mul_f32 v[8:9], v[68:69], v[68:69]
  v_pk_mul_f32 v[10:11], v[70:71], v[70:71]
  v_pk_mul_f32 v[12:13], v[72:73], v[72:73]
  v_pk_mul_f32 v[14:15], v[74:75], v[74:75]
  v_pk_fma_f32 v[8:9], v[8:9], v[28:29], v[28:29] op_sel:[0,0,1] op_sel_hi:[1,0,1]
  v_pk_fma_f32 v[10:11], v[10:11], v[28:29], v[28:29] op_sel:[0,0,1] op_sel_hi:[1,0,1]
  s_waitcnt vmcnt(9)
  v_cmp_eq_u32 vcc, -1, v164
  v_mfma_f32_32x32x16_bf16 v[52:67], a[28:31], v[160:163], v[52:67]
  s_cbranch_vccnz L_tag_484085_r
L_tag_484085:
  buffer_load_dwordx4 v[160:163], v213, s[28:31], s66 offen offset:2048 sc1
  v_pk_fma_f32 v[12:13], v[12:13], v[28:29], v[28:29] op_sel:[0,0,1] op_sel_hi:[1,0,1]
  v_pk_fma_f32 v[14:15], v[14:15], v[28:29], v[28:29] op_sel:[0,0,1] op_sel_hi:[1,0,1]
  v_pk_mul_f32 v[8:9], v[8:9], v[68:69]
  v_pk_mul_f32 v[10:11], v[10:11], v[70:71]
  v_pk_mul_f32 v[12:13], v[12:13], v[72:73]
  v_pk_mul_f32 v[14:15], v[14:15], v[74:75]
  v_mfma_f32_32x32x16_bf16 v[36:51], a[32:35], v[164:167], v[36:51]
  v_exp_f32 v8, v8
  v_exp_f32 v9, v9
  v_exp_f32 v10, v10
  v_exp_f32 v11, v11
  v_exp_f32 v12, v12
  v_exp_f32 v13, v13
  s_waitcnt vmcnt(9)
  v_cmp_eq_u32 vcc, -1, v168
  v_mfma_f32_32x32x16_bf16 v[52:67], a[36:39], v[164:167], v[52:67]
  s_cbranch_vccnz L_tag_486086_r
L_tag_486086:
  buffer_load_dwordx4 v[164:167], v213, s[28:31], s66 offen offset:3072 sc1
  v_exp_f32 v14, v14
  v_exp_f32 v15, v15
  v_pk_add_f32 v[8:9], v[8:9], v[30:31] op_sel_hi:[1,0]
  v_pk_add_f32 v[10:11], v[10:11], v[30:31] op_sel_hi:[1,0]
  v_pk_add_f32 v[12:13], v[12:13], v[30:31] op_sel_hi:[1,0]
  v_pk_add_f32 v[14:15], v[14:15], v[30:31] op_sel_hi:[1,0]
  v_mfma_f32_32x32x16_bf16 v[36:51], a[40:43], v[168:171], v[36:51]
  v_rcp_f32 v8, v8
  v_rcp_f32 v9, v9
  v_rcp_f32 v10, v10
  v_rcp_f32 v11, v11
  v_rcp_f32 v12, v12
  v_rcp_f32 v13, v13
  s_waitcnt vmcnt(9)
  v_cmp_eq_u32 vcc, -1, v172
  v_mfma_f32_32x32x16_bf16 v[52:67], a[44:47], v[168:171], v[52:67]
  s_cbranch_vccnz L_tag_488087_r
L_tag_488087:
  s_add_u32 s66, s58, 278528
  buffer_load_dwordx4 v[168:171], v213, s[28:31], s66 offen offset:0 sc1
  v_rcp_f32 v14, v14
  v_rcp_f32 v15, v15
  v_pk_mul_f32 v[8:9], v[8:9], v[68:69]
  v_pk_mul_f32 v[10:11], v[10:11], v[70:71]
  v_pk_mul_f32 v[12:13], v[12:13], v[72:73]
  v_pk_mul_f32 v[14:15], v[14:15], v[74:75]
  v_mfma_f32_32x32x16_bf16 v[36:51], a[48:51], v[172:175], v[36:51]
  v_cvt_pk_bf16_f32 v24, v8, v9
  v_cvt_pk_bf16_f32 v25, v10, v11
  v_cvt_pk_bf16_f32 v26, v12, v13
  v_cvt_pk_bf16_f32 v27, v14, v15
  s_add_u32 s52, s62, 114688
  buffer_store_dwordx4 v[24:27], v232, s[28:31], s52 offen sc1
  s_cmp_lg_u32 s77, 0
  s_cbranch_scc1 L_sig_476081
  s_cmp_eq_u32 s95, 0
  s_cbranch_scc1 L_sig_476081
  s_mov_b32 exec_lo, s95
  s_mov_b32 exec_hi, 0
  buffer_atomic_add v251, v225, s[28:31], 0 offen offset:12 sc1
  s_mov_b64 exec, -1
L_sig_476081:
  s_waitcnt vmcnt(10)
  v_cmp_eq_u32 vcc, -1, v176
  v_mfma_f32_32x32x16_bf16 v[52:67], a[52:55], v[172:175], v[52:67]
  s_cbranch_vccnz L_tag_490088_r
L_tag_490088:
  buffer_load_dwordx4 v[172:175], v213, s[28:31], s66 offen offset:1024 sc1
  v_mfma_f32_32x32x16_bf16 v[36:51], a[56:59], v[176:179], v[36:51]
  s_waitcnt vmcnt(10)
  v_cmp_eq_u32 vcc, -1, v180
  v_mfma_f32_32x32x16_bf16 v[52:67], a[60:63], v[176:179], v[52:67]
  s_cbranch_vccnz L_tag_492089_r
L_tag_492089:
  buffer_load_dwordx4 v[176:179], v213, s[28:31], s66 offen offset:2048 sc1
  v_mfma_f32_32x32x16_bf16 v[36:51], a[64:67], v[180:183], v[36:51]
  s_waitcnt vmcnt(10)
  v_cmp_eq_u32 vcc, -1, v184
  v_mfma_f32_32x32x16_bf16 v[52:67], a[68:71], v[180:183], v[52:67]
  s_cbranch_vccnz L_tag_494090_r
L_tag_494090:
  buffer_load_dwordx4 v[180:183], v213, s[28:31], s66 offen offset:3072 sc1
  v_mfma_f32_32x32x16_bf16 v[36:51], a[72:75], v[184:187], v[36:51]
  s_waitcnt vmcnt(10)
  v_cmp_eq_u32 vcc, -1, v108
  v_mfma_f32_32x32x16_bf16 v[52:67], a[76:79], v[184:187], v[52:67]
  s_cbranch_vccnz L_tag_496091_r
L_tag_496091:
  s_add_u32 s66, s58, 282624
  buffer_load_dwordx4 v[184:187], v213, s[28:31], s66 offen offset:0 sc1
  v_mfma_f32_32x32x16_bf16 v[36:51], a[80:83], v[108:111], v[36:51]
  s_waitcnt vmcnt(10)
  v_cmp_eq_u32 vcc, -1, v112
  v_mfma_f32_32x32x16_bf16 v[52:67], a[84:87], v[108:111], v[52:67]
  s_cbranch_vccnz L_tag_498092_r
L_tag_498092:
  buffer_load_dwordx4 v[108:111], v213, s[28:31], s66 offen offset:1024 sc1
  v_mfma_f32_32x32x16_bf16 v[36:51], a[88:91], v[112:115], v[36:51]
  s_waitcnt vmcnt(10)
  v_cmp_eq_u32 vcc, -1, v116
  v_mfma_f32_32x32x16_bf16 v[52:67], a[92:95], v[112:115], v[52:67]
  s_cbranch_vccnz L_tag_500093_r
L_tag_500093:
  buffer_load_dwordx4 v[112:115], v213, s[28:31], s66 offen offset:2048 sc1
  v_mfma_f32_32x32x16_bf16 v[36:51], a[96:99], v[116:119], v[36:51]
  s_waitcnt vmcnt(10)
  v_cmp_eq_u32 vcc, -1, v156
  v_mfma_f32_32x32x16_bf16 v[52:67], a[100:103], v[116:119], v[52:67]
  s_cbranch_vccnz L_tag_502094_r
L_tag_502094:
  buffer_load_dwordx4 v[116:119], v213, s[28:31], s66 offen offset:3072 sc1
  v_mfma_f32_32x32x16_bf16 v[36:51], a[104:107], v[156:159], v[36:51]
  s_waitcnt vmcnt(10)
  v_cmp_eq_u32 vcc, -1, v160
  v_mfma_f32_32x32x16_bf16 v[52:67], a[108:111], v[156:159], v[52:67]
  s_cbranch_vccnz L_tag_504095_r
L_tag_504095:
  s_add_u32 s66, s58, 286720
  buffer_load_dwordx4 v[156:159], v213, s[28:31], s66 offen offset:0 sc1
  v_mfma_f32_32x32x16_bf16 v[36:51], a[112:115], v[160:163], v[36:51]
  s_waitcnt vmcnt(10)
  v_cmp_eq_u32 vcc, -1, v164
  v_mfma_f32_32x32x16_bf16 v[52:67], a[116:119], v[160:163], v[52:67]
  s_cbranch_vccnz L_tag_506096_r
L_tag_506096:
  buffer_load_dwordx4 v[160:163], v213, s[28:31], s66 offen offset:1024 sc1
  v_mfma_f32_32x32x16_bf16 v[36:51], a[120:123], v[164:167], v[36:51]
  s_waitcnt vmcnt(10)
  v_cmp_eq_u32 vcc, -1, v168
  v_mfma_f32_32x32x16_bf16 v[52:67], a[124:127], v[164:167], v[52:67]
  s_cbranch_vccnz L_tag_508097_r
L_tag_508097:
  buffer_load_dwordx4 v[164:167], v213, s[28:31], s66 offen offset:2048 sc1
  v_mfma_f32_32x32x16_bf16 v[36:51], a[128:131], v[168:171], v[36:51]
  s_waitcnt vmcnt(9)
  v_cmp_eq_u32 vcc, -1, v172
  v_mfma_f32_32x32x16_bf16 v[52:67], a[132:135], v[168:171], v[52:67]
  s_cbranch_vccnz L_tag_510098_r
L_tag_510098:
  buffer_load_dwordx4 v[168:171], v213, s[28:31], s66 offen offset:3072 sc1
  v_mfma_f32_32x32x16_bf16 v[36:51], a[136:139], v[172:175], v[36:51]
  s_waitcnt vmcnt(9)
  v_cmp_eq_u32 vcc, -1, v176
  v_mfma_f32_32x32x16_bf16 v[52:67], a[140:143], v[172:175], v[52:67]
  s_cbranch_vccnz L_tag_512099_r
L_tag_512099:
  s_add_u32 s66, s58, 290816
  buffer_load_dwordx4 v[172:175], v213, s[28:31], s66 offen offset:0 sc1
  v_mfma_f32_32x32x16_bf16 v[36:51], a[144:147], v[176:179], v[36:51]
  s_waitcnt vmcnt(9)
  v_cmp_eq_u32 vcc, -1, v180
  v_mfma_f32_32x32x16_bf16 v[52:67], a[148:151], v[176:179], v[52:67]
  s_cbranch_vccnz L_tag_514100_r
L_tag_514100:
  buffer_load_dwordx4 v[176:179], v213, s[28:31], s66 offen offset:1024 sc1
  v_mfma_f32_32x32x16_bf16 v[36:51], a[152:155], v[180:183], v[36:51]
  s_waitcnt vmcnt(9)
  v_cmp_eq_u32 vcc, -1, v184
  v_mfma_f32_32x32x16_bf16 v[52:67], a[156:159], v[180:183], v[52:67]
  s_cbranch_vccnz L_tag_516101_r
L_tag_516101:
  buffer_load_dwordx4 v[180:183], v213, s[28:31], s66 offen offset:2048 sc1
  v_mfma_f32_32x32x16_bf16 v[36:51], a[160:163], v[184:187], v[36:51]
  s_waitcnt vmcnt(9)
  v_cmp_eq_u32 vcc, -1, v108
  v_mfma_f32_32x32x16_bf16 v[52:67], a[164:167], v[184:187], v[52:67]
  s_cbranch_vccnz L_tag_518102_r
L_tag_518102:
  buffer_load_dwordx4 v[184:187], v213, s[28:31], s66 offen offset:3072 sc1
  v_mfma_f32_32x32x16_bf16 v[36:51], a[168:171], v[108:111], v[36:51]
  s_waitcnt vmcnt(9)
  v_cmp_eq_u32 vcc, -1, v112
  v_mfma_f32_32x32x16_bf16 v[52:67], a[172:175], v[108:111], v[52:67]
  s_cbranch_vccnz L_tag_520103_r
L_tag_520103:
  s_add_u32 s66, s58, 393216
  buffer_load_dwordx4 v[108:111], v213, s[28:31], s66 offen offset:0 sc1
  v_mfma_f32_32x32x16_bf16 v[36:51], a[176:179], v[112:115], v[36:51]
  s_waitcnt vmcnt(9)
  v_cmp_eq_u32 vcc, -1, v116
  v_mfma_f32_32x32x16_bf16 v[52:67], a[180:183], v[112:115], v[52:67]
  s_cbranch_vccnz L_tag_522104_r
L_tag_522104:
  buffer_load_dwordx4 v[112:115], v213, s[28:31], s66 offen offset:1024 sc1
  v_mfma_f32_32x32x16_bf16 v[36:51], a[184:187], v[116:119], v[36:51]
  s_waitcnt vmcnt(9)
  v_cmp_eq_u32 vcc, -1, v156
  v_mfma_f32_32x32x16_bf16 v[52:67], a[188:191], v[116:119], v[52:67]
  s_cbranch_vccnz L_tag_524105_r
L_tag_524105:
  buffer_load_dwordx4 v[116:119], v213, s[28:31], s66 offen offset:2048 sc1
  v_mfma_f32_32x32x16_bf16 v[36:51], a[192:195], v[156:159], v[36:51]
  s_waitcnt vmcnt(9)
  v_cmp_eq_u32 vcc, -1, v160
  v_mfma_f32_32x32x16_bf16 v[52:67], a[196:199], v[156:159], v[52:67]
  s_cbranch_vccnz L_tag_526106_r
L_tag_526106:
  buffer_load_dwordx4 v[156:159], v213, s[28:31], s66 offen offset:3072 sc1
  v_mfma_f32_32x32x16_bf16 v[36:51], a[200:203], v[160:163], v[36:51]
  s_waitcnt vmcnt(9)
  v_cmp_eq_u32 vcc, -1, v164
  v_mfma_f32_32x32x16_bf16 v[52:67], a[204:207], v[160:163], v[52:67]
  s_cbranch_vccnz L_tag_528107_r
L_tag_528107:
  s_add_u32 s66, s58, 397312
  buffer_load_dwordx4 v[160:163], v213, s[28:31], s66 offen offset:0 sc1
  v_mfma_f32_32x32x16_bf16 v[36:51], a[208:211], v[164:167], v[36:51]
  s_waitcnt vmcnt(9)
  v_cmp_eq_u32 vcc, -1, v168
  v_mfma_f32_32x32x16_bf16 v[52:67], a[212:215], v[164:167], v[52:67]
  s_cbranch_vccnz L_tag_530108_r
L_tag_530108:
  buffer_load_dwordx4 v[164:167], v213, s[28:31], s66 offen offset:1024 sc1
  v_mfma_f32_32x32x16_bf16 v[36:51], a[216:219], v[168:171], v[36:51]
  s_waitcnt vmcnt(9)
  v_cmp_eq_u32 vcc, -1, v172
  v_mfma_f32_32x32x16_bf16 v[52:67], a[220:223], v[168:171], v[52:67]
  s_cbranch_vccnz L_tag_532109_r
L_tag_532109:
  buffer_load_dwordx4 v[168:171], v213, s[28:31], s66 offen offset:2048 sc1
  v_mfma_f32_32x32x16_bf16 v[36:51], a[224:227], v[172:175], v[36:51]
  s_waitcnt vmcnt(9)
  v_cmp_eq_u32 vcc, -1, v176
  v_mfma_f32_32x32x16_bf16 v[52:67], a[228:231], v[172:175], v[52:67]
  s_cbranch_vccnz L_tag_534110_r
L_tag_534110:
  buffer_load_dwordx4 v[172:175], v213, s[28:31], s66 offen offset:3072 sc1
  v_mfma_f32_32x32x16_bf16 v[36:51], a[232:235], v[176:179], v[36:51]
  s_waitcnt vmcnt(9)
  v_cmp_eq_u32 vcc, -1, v180
  v_mfma_f32_32x32x16_bf16 v[52:67], a[236:239], v[176:179], v[52:67]
  s_cbranch_vccnz L_tag_536111_r
L_tag_536111:
  s_add_u32 s66, s58, 401408
  buffer_load_dwordx4 v[176:179], v213, s[28:31], s66 offen offset:0 sc1
  v_mfma_f32_32x32x16_bf16 v[36:51], a[240:243], v[180:183], v[36:51]
  s_waitcnt vmcnt(9)
  v_cmp_eq_u32 vcc, -1, v184
  v_mfma_f32_32x32x16_bf16 v[52:67], a[244:247], v[180:183], v[52:67]
  s_cbranch_vccnz L_tag_538112_r
L_tag_538112:
  buffer_load_dwordx4 v[180:183], v213, s[28:31], s66 offen offset:1024 sc1
  v_mfma_f32_32x32x16_bf16 v[36:51], a[248:251], v[184:187], v[36:51]
  s_waitcnt vmcnt(9)
  v_cmp_eq_u32 vcc, -1, v108
  v_mfma_f32_32x32x16_bf16 v[52:67], a[252:255], v[184:187], v[52:67]
  s_cbranch_vccnz L_tag_540113_r
L_tag_540113:
  buffer_load_dwordx4 v[184:187], v213, s[28:31], s66 offen offset:2048 sc1
  v_mfma_f32_32x32x16_bf16 v[68:83], a[0:3], v[108:111], 0
  s_nop 5
  ds_write_b128 v253, v[44:47] offset:0
  ds_write_b128 v253, v[48:51] offset:1024
  s_nop 0
  ds_write_b128 v254, v[52:55] offset:0
  s_waitcnt vmcnt(9)
  v_cmp_eq_u32 vcc, -1, v112
  v_mfma_f32_32x32x16_bf16 v[84:99], a[4:7], v[108:111], 0
  s_cbranch_vccnz L_tag_672115_r
L_tag_672115:
  buffer_load_dwordx4 v[108:111], v213, s[28:31], s66 offen offset:3072 sc1
  ds_write_b128 v254, v[56:59] offset:1024
  ds_write_b128 v255, v[60:63] offset:0
  ds_write_b128 v255, v[64:67] offset:1024
  v_mfma_f32_32x32x16_bf16 v[68:83], a[8:11], v[112:115], v[68:83]
  v_pk_add_f32 v[36:37], v[36:37], v[16:17]
  v_pk_add_f32 v[38:39], v[38:39], v[18:19]
  v_pk_add_f32 v[40:41], v[40:41], v[20:21]
  v_pk_add_f32 v[42:43], v[42:43], v[22:23]
  s_waitcnt lgkmcnt(0)
  s_barrier
  ds_read_b128 v[132:135], v230 offset:0
  ds_read_b128 v[136:139], v230 offset:1024
  ds_read_b128 v[140:143], v230 offset:2048
  ds_read_b128 v[144:147], v230 offset:3072
  ds_read_b128 v[148:151], v230 offset:4096
  ds_read_b128 v[152:155], v230 offset:5120
  s_waitcnt vmcnt(9)
  v_cmp_eq_u32 vcc, -1, v116
  v_mfma_f32_32x32x16_bf16 v[84:99], a[12:15], v[112:115], v[84:99]
  s_cbranch_vccnz L_tag_674116_r
L_tag_674116:
  s_add_u32 s66, s58, 405504
  buffer_load_dwordx4 v[112:115], v213, s[28:31], s66 offen offset:0 sc1
  v_mfma_f32_32x32x16_bf16 v[68:83], a[16:19], v[116:119], v[68:83]
  s_waitcnt lgkmcnt(5)
  v_pk_add_f32 v[36:37], v[36:37], v[132:133]
  v_pk_add_f32 v[38:39], v[38:39], v[134:135]
  s_waitcnt lgkmcnt(4)
  v_pk_add_f32 v[40:41], v[40:41], v[136:137]
  v_pk_add_f32 v[42:43], v[42:43], v[138:139]
  s_waitcnt lgkmcnt(3)
  v_pk_add_f32 v[36:37], v[36:37], v[140:141]
  v_pk_add_f32 v[38:39], v[38:39], v[142:143]
  s_waitcnt vmcnt(9)
  v_cmp_eq_u32 vcc, -1, v156
  v_mfma_f32_32x32x16_bf16 v[84:99], a[20:23], v[116:119], v[84:99]
  s_cbranch_vccnz L_tag_676117_r
L_tag_676117:
  buffer_load_dwordx4 v[116:119], v213, s[28:31], s66 offen offset:1024 sc1
  s_waitcnt lgkmcnt(2)
  v_pk_add_f32 v[40:41], v[40:41], v[144:145]
  v_pk_add_f32 v[42:43], v[42:43], v[146:147]
  s_waitcnt lgkmcnt(1)
  v_pk_add_f32 v[36:37], v[36:37], v[148:149]
  v_pk_add_f32 v[38:39], v[38:39], v[150:151]
  s_waitcnt lgkmcnt(0)
  v_pk_add_f32 v[40:41], v[40:41], v[152:153]
  v_pk_add_f32 v[42:43], v[42:43], v[154:155]
  v_mfma_f32_32x32x16_bf16 v[68:83], a[24:27], v[156:159], v[68:83]
  v_pk_mul_f32 v[8:9], v[36:37], v[36:37]
  v_pk_mul_f32 v[10:11], v[38:39], v[38:39]
  v_pk_mul_f32 v[12:13], v[40:41], v[40:41]
  v_pk_mul_f32 v[14:15], v[42:43], v[42:43]
  v_pk_fma_f32 v[8:9], v[8:9], v[28:29], v[28:29] op_sel:[0,0,1] op_sel_hi:[1,0,1]
  v_pk_fma_f32 v[10:11], v[10:11], v[28:29], v[28:29] op_sel:[0,0,1] op_sel_hi:[1,0,1]
  s_waitcnt vmcnt(9)
  v_cmp_eq_u32 vcc, -1, v160
  v_mfma_f32_32x32x16_bf16 v[84:99], a[28:31], v[156:159], v[84:99]
  s_cbranch_vccnz L_tag_678118_r
L_tag_678118:
  buffer_load_dwordx4 v[156:159], v213, s[28:31], s66 offen offset:2048 sc1
  v_pk_fma_f32 v[12:13], v[12:13], v[28:29], v[28:29] op_sel:[0,0,1] op_sel_hi:[1,0,1]
  v_pk_fma_f32 v[14:15], v[14:15], v[28:29], v[28:29] op_sel:[0,0,1] op_sel_hi:[1,0,1]
  v_pk_mul_f32 v[8:9], v[8:9], v[36:37]
  v_pk_mul_f32 v[10:11], v[10:11], v[38:39]
  v_pk_mul_f32 v[12:13], v[12:13], v[40:41]
  v_pk_mul_f32 v[14:15], v[14:15], v[42:43]
  v_mfma_f32_32x32x16_bf16 v[68:83], a[32:35], v[160:163], v[68:83]
  v_exp_f32 v8, v8
  v_exp_f32 v9, v9
  v_exp_f32 v10, v10
  v_exp_f32 v11, v11
  v_exp_f32 v12, v12
  v_exp_f32 v13, v13
  s_waitcnt vmcnt(9)
  v_cmp_eq_u32 vcc, -1, v164
  v_mfma_f32_32x32x16_bf16 v[84:99], a[36:39], v[160:163], v[84:99]
  s_cbranch_vccnz L_tag_680119_r
L_tag_680119:
  buffer_load_dwordx4 v[160:163], v213, s[28:31], s66 offen offset:3072 sc1
  v_exp_f32 v14, v14
  v_exp_f32 v15, v15
  v_pk_add_f32 v[8:9], v[8:9], v[30:31] op_sel_hi:[1,0]
  v_pk_add_f32 v[10:11], v[10:11], v[30:31] op_sel_hi:[1,0]
  v_pk_add_f32 v[12:13], v[12:13], v[30:31] op_sel_hi:[1,0]
  v_pk_add_f32 v[14:15], v[14:15], v[30:31] op_sel_hi:[1,0]
  v_mfma_f32_32x32x16_bf16 v[68:83], a[40:43], v[164:167], v[68:83]
  v_rcp_f32 v8, v8
  v_rcp_f32 v9, v9
  v_rcp_f32 v10, v10
  v_rcp_f32 v11, v11
  v_rcp_f32 v12, v12
  v_rcp_f32 v13, v13
  s_waitcnt vmcnt(9)
  v_cmp_eq_u32 vcc, -1, v168
  v_mfma_f32_32x32x16_bf16 v[84:99], a[44:47], v[164:167], v[84:99]
  s_cbranch_vccnz L_tag_682120_r
L_tag_682120:
  s_add_u32 s66, s58, 409600
  buffer_load_dwordx4 v[164:167], v213, s[28:31], s66 offen offset:0 sc1
  v_rcp_f32 v14, v14
  v_rcp_f32 v15, v15
  v_pk_mul_f32 v[8:9], v[8:9], v[36:37]
  v_pk_mul_f32 v[10:11], v[10:11], v[38:39]
  v_pk_mul_f32 v[12:13], v[12:13], v[40:41]
  v_pk_mul_f32 v[14:15], v[14:15], v[42:43]
  v_mfma_f32_32x32x16_bf16 v[68:83], a[48:51], v[168:171], v[68:83]
  v_cvt_pk_bf16_f32 v24, v8, v9
  v_cvt_pk_bf16_f32 v25, v10, v11
  v_cvt_pk_bf16_f32 v26, v12, v13
  v_cvt_pk_bf16_f32 v27, v14, v15
  s_add_u32 s52, s62, 229376
  buffer_store_dwordx4 v[24:27], v232, s[28:31], s52 offen sc1
  s_cmp_lg_u32 s77, 0
  s_cbranch_scc1 L_sig_670114
  s_cmp_eq_u32 s95, 0
  s_cbranch_scc1 L_sig_670114
  s_mov_b32 exec_lo, s95
  s_mov_b32 exec_hi, 0
  buffer_atomic_add v251, v225, s[28:31], 0 offen offset:16 sc1
  s_mov_b64 exec, -1
L_sig_670114:
  s_waitcnt vmcnt(10)
  v_cmp_eq_u32 vcc, -1, v172
  v_mfma_f32_32x32x16_bf16 v[84:99], a[52:55], v[168:171], v[84:99]
  s_cbranch_vccnz L_tag_684121_r
L_tag_684121:
  buffer_load_dwordx4 v[168:171], v213, s[28:31], s66 offen offset:1024 sc1
  v_mfma_f32_32x32x16_bf16 v[68:83], a[56:59], v[172:175], v[68:83]
  s_waitcnt vmcnt(10)
  v_cmp_eq_u32 vcc, -1, v176
  v_mfma_f32_32x32x16_bf16 v[84:99], a[60:63], v[172:175], v[84:99]
  s_cbranch_vccnz L_tag_686122_r
L_tag_686122:
  buffer_load_dwordx4 v[172:175], v213, s[28:31], s66 offen offset:2048 sc1
  v_mfma_f32_32x32x16_bf16 v[68:83], a[64:67], v[176:179], v[68:83]
  s_waitcnt vmcnt(10)
  v_cmp_eq_u32 vcc, -1, v180
  v_mfma_f32_32x32x16_bf16 v[84:99], a[68:71], v[176:179], v[84:99]
  s_cbranch_vccnz L_tag_688123_r
L_tag_688123:
  buffer_load_dwordx4 v[176:179], v213, s[28:31], s66 offen offset:3072 sc1
  v_mfma_f32_32x32x16_bf16 v[68:83], a[72:75], v[180:183], v[68:83]
  s_waitcnt vmcnt(10)
  v_cmp_eq_u32 vcc, -1, v184
  v_mfma_f32_32x32x16_bf16 v[84:99], a[76:79], v[180:183], v[84:99]
  s_cbranch_vccnz L_tag_690124_r
L_tag_690124:
  s_add_u32 s66, s58, 413696
  buffer_load_dwordx4 v[180:183], v213, s[28:31], s66 offen offset:0 sc1
  v_mfma_f32_32x32x16_bf16 v[68:83], a[80:83], v[184:187], v[68:83]
  s_waitcnt vmcnt(10)
  v_cmp_eq_u32 vcc, -1, v108
  v_mfma_f32_32x32x16_bf16 v[84:99], a[84:87], v[184:187], v[84:99]
  s_cbranch_vccnz L_tag_692125_r
L_tag_692125:
  buffer_load_dwordx4 v[184:187], v213, s[28:31], s66 offen offset:1024 sc1
  v_mfma_f32_32x32x16_bf16 v[68:83], a[88:91], v[108:111], v[68:83]
  s_waitcnt vmcnt(10)
  v_cmp_eq_u32 vcc, -1, v112
  v_mfma_f32_32x32x16_bf16 v[84:99], a[92:95], v[108:111], v[84:99]
  s_cbranch_vccnz L_tag_694126_r
L_tag_694126:
  buffer_load_dwordx4 v[108:111], v213, s[28:31], s66 offen offset:2048 sc1
  v_mfma_f32_32x32x16_bf16 v[68:83], a[96:99], v[112:115], v[68:83]
  s_waitcnt vmcnt(10)
  v_cmp_eq_u32 vcc, -1, v116
  v_mfma_f32_32x32x16_bf16 v[84:99], a[100:103], v[112:115], v[84:99]
  s_cbranch_vccnz L_tag_696127_r
L_tag_696127:
  buffer_load_dwordx4 v[112:115], v213, s[28:31], s66 offen offset:3072 sc1
  v_mfma_f32_32x32x16_bf16 v[68:83], a[104:107], v[116:119], v[68:83]
  s_waitcnt vmcnt(10)
  v_cmp_eq_u32 vcc, -1, v156
  v_mfma_f32_32x32x16_bf16 v[84:99], a[108:111], v[116:119], v[84:99]
  s_cbranch_vccnz L_tag_698128_r
L_tag_698128:
  s_add_u32 s66, s58, 417792
  buffer_load_dwordx4 v[116:119], v213, s[28:31], s66 offen offset:0 sc1
  v_mfma_f32_32x32x16_bf16 v[68:83], a[112:115], v[156:159], v[68:83]
  s_waitcnt vmcnt(10)
  v_cmp_eq_u32 vcc, -1, v160
  v_mfma_f32_32x32x16_bf16 v[84:99], a[116:119], v[156:159], v[84:99]
  s_cbranch_vccnz L_tag_700129_r
L_tag_700129:
  buffer_load_dwordx4 v[156:159], v213, s[28:31], s66 offen offset:1024 sc1
  v_mfma_f32_32x32x16_bf16 v[68:83], a[120:123], v[160:163], v[68:83]
  s_waitcnt vmcnt(10)
  v_cmp_eq_u32 vcc, -1, v164
  v_mfma_f32_32x32x16_bf16 v[84:99], a[124:127], v[160:163], v[84:99]
  s_cbranch_vccnz L_tag_702130_r
L_tag_702130:
  buffer_load_dwordx4 v[160:163], v213, s[28:31], s66 offen offset:2048 sc1
  v_mfma_f32_32x32x16_bf16 v[68:83], a[128:131], v[164:167], v[68:83]
  s_waitcnt vmcnt(9)
  v_cmp_eq_u32 vcc, -1, v168
  v_mfma_f32_32x32x16_bf16 v[84:99], a[132:135], v[164:167], v[84:99]
  s_cbranch_vccnz L_tag_704131_r
L_tag_704131:
  buffer_load_dwordx4 v[164:167], v213, s[28:31], s66 offen offset:3072 sc1
  v_mfma_f32_32x32x16_bf16 v[68:83], a[136:139], v[168:171], v[68:83]
  s_waitcnt vmcnt(9)
  v_cmp_eq_u32 vcc, -1, v172
  v_mfma_f32_32x32x16_bf16 v[84:99], a[140:143], v[168:171], v[84:99]
  s_cbranch_vccnz L_tag_706132_r
L_tag_706132:
  s_add_u32 s66, s58, 421888
  buffer_load_dwordx4 v[168:171], v213, s[28:31], s66 offen offset:0 sc1
  v_mfma_f32_32x32x16_bf16 v[68:83], a[144:147], v[172:175], v[68:83]
  s_waitcnt vmcnt(9)
  v_cmp_eq_u32 vcc, -1, v176
  v_mfma_f32_32x32x16_bf16 v[84:99], a[148:151], v[172:175], v[84:99]
  s_cbranch_vccnz L_tag_708133_r
L_tag_708133:
  buffer_load_dwordx4 v[172:175], v213, s[28:31], s66 offen offset:1024 sc1
  v_mfma_f32_32x32x16_bf16 v[68:83], a[152:155], v[176:179], v[68:83]
  s_waitcnt vmcnt(9)
  v_cmp_eq_u32 vcc, -1, v180
  v_mfma_f32_32x32x16_bf16 v[84:99], a[156:159], v[176:179], v[84:99]
  s_cbranch_vccnz L_tag_710134_r
L_tag_710134:
  buffer_load_dwordx4 v[176:179], v213, s[28:31], s66 offen offset:2048 sc1
  v_mfma_f32_32x32x16_bf16 v[68:83], a[160:163], v[180:183], v[68:83]
  s_waitcnt vmcnt(9)
  v_cmp_eq_u32 vcc, -1, v184
  v_mfma_f32_32x32x16_bf16 v[84:99], a[164:167], v[180:183], v[84:99]
  s_cbranch_vccnz L_tag_712135_r
L_tag_712135:
  buffer_load_dwordx4 v[180:183], v213, s[28:31], s66 offen offset:3072 sc1
  v_mfma_f32_32x32x16_bf16 v[68:83], a[168:171], v[184:187], v[68:83]
  s_waitcnt vmcnt(9)
  v_cmp_eq_u32 vcc, -1, v108
  v_mfma_f32_32x32x16_bf16 v[84:99], a[172:175], v[184:187], v[84:99]
  s_cbranch_vccnz L_tag_714136_r
L_tag_714136:
  v_mfma_f32_32x32x16_bf16 v[68:83], a[176:179], v[108:111], v[68:83]
  s_waitcnt vmcnt(8)
  v_cmp_eq_u32 vcc, -1, v112
  v_mfma_f32_32x32x16_bf16 v[84:99], a[180:183], v[108:111], v[84:99]
  s_cbranch_vccnz L_tag_716137_r
L_tag_716137:
  v_mfma_f32_32x32x16_bf16 v[68:83], a[184:187], v[112:115], v[68:83]
  s_waitcnt vmcnt(7)
  v_cmp_eq_u32 vcc, -1, v116
  v_mfma_f32_32x32x16_bf16 v[84:99], a[188:191], v[112:115], v[84:99]
  s_cbranch_vccnz L_tag_718138_r
L_tag_718138:
  s_add_u32 m0, s68, 0
  s_nop 0
  buffer_load_dwordx4 v219, s[12:15], s67 offen lds
  v_mfma_f32_32x32x16_bf16 v[68:83], a[192:195], v[116:119], v[68:83]
  s_waitcnt vmcnt(7)
  v_cmp_eq_u32 vcc, -1, v156
  v_mfma_f32_32x32x16_bf16 v[84:99], a[196:199], v[116:119], v[84:99]
  s_cbranch_vccnz L_tag_720139_r
L_tag_720139:
  s_add_u32 m0, s68, 1024
  s_add_u32 s94, s67, 1024
  buffer_load_dwordx4 v219, s[12:15], s94 offen lds
  v_mfma_f32_32x32x16_bf16 v[68:83], a[200:203], v[156:159], v[68:83]
  s_waitcnt vmcnt(7)
  v_cmp_eq_u32 vcc, -1, v160
  v_mfma_f32_32x32x16_bf16 v[84:99], a[204:207], v[156:159], v[84:99]
  s_cbranch_vccnz L_tag_722140_r
L_tag_722140:
  s_add_u32 m0, s68, 2048
  s_add_u32 s94, s67, 2048
  buffer_load_dwordx4 v219, s[12:15], s94 offen lds
  v_mfma_f32_32x32x16_bf16 v[68:83], a[208:211], v[160:163], v[68:83]
  s_waitcnt vmcnt(7)
  v_cmp_eq_u32 vcc, -1, v164
  v_mfma_f32_32x32x16_bf16 v[84:99], a[212:215], v[160:163], v[84:99]
  s_cbranch_vccnz L_tag_724141_r
L_tag_724141:
  s_add_u32 m0, s68, 12288
  s_add_u32 s94, s67, 393216
  buffer_load_dwordx4 v219, s[12:15], s94 offen lds
  v_mfma_f32_32x32x16_bf16 v[68:83], a[216:219], v[164:167], v[68:83]
  s_waitcnt vmcnt(7)
  v_cmp_eq_u32 vcc, -1, v168
  v_mfma_f32_32x32x16_bf16 v[84:99], a[220:223], v[164:167], v[84:99]
  s_cbranch_vccnz L_tag_726142_r
L_tag_726142:
  s_add_u32 m0, s68, 13312
  s_add_u32 s94, s67, 394240
  buffer_load_dwordx4 v219, s[12:15], s94 offen lds
  v_mfma_f32_32x32x16_bf16 v[68:83], a[224:227], v[168:171], v[68:83]
  s_waitcnt vmcnt(7)
  v_cmp_eq_u32 vcc, -1, v172
  v_mfma_f32_32x32x16_bf16 v[84:99], a[228:231], v[168:171], v[84:99]
  s_cbranch_vccnz L_tag_728143_r
L_tag_728143:
  s_add_u32 m0, s68, 14336
  s_add_u32 s94, s67, 395264
  buffer_load_dwordx4 v219, s[12:15], s94 offen lds
  v_mfma_f32_32x32x16_bf16 v[68:83], a[232:235], v[172:175], v[68:83]
  s_waitcnt vmcnt(7)
  v_cmp_eq_u32 vcc, -1, v176
  v_mfma_f32_32x32x16_bf16 v[84:99], a[236:239], v[172:175], v[84:99]
  s_cbranch_vccnz L_tag_730144_r
L_tag_730144:
  v_mfma_f32_32x32x16_bf16 v[68:83], a[240:243], v[176:179], v[68:83]
  s_waitcnt vmcnt(6)
  v_cmp_eq_u32 vcc, -1, v180
  v_mfma_f32_32x32x16_bf16 v[84:99], a[244:247], v[176:179], v[84:99]
  s_cbranch_vccnz L_tag_732145_r
L_tag_732145:
  v_mfma_f32_32x32x16_bf16 v[68:83], a[248:251], v[180:183], v[68:83]
  v_mfma_f32_32x32x16_bf16 v[84:99], a[252:255], v[180:183], v[84:99]
  s_nop 10
  ds_write_b128 v253, v[76:79] offset:0
  ds_write_b128 v253, v[80:83] offset:1024
  ds_write_b128 v254, v[84:87] offset:0
  ds_write_b128 v254, v[88:91] offset:1024
  ds_write_b128 v255, v[92:95] offset:0
  ds_write_b128 v255, v[96:99] offset:1024
  v_pk_add_f32 v[68:69], v[68:69], v[16:17]
  v_pk_add_f32 v[70:71], v[70:71], v[18:19]
  v_pk_add_f32 v[72:73], v[72:73], v[20:21]
  v_pk_add_f32 v[74:75], v[74:75], v[22:23]
  s_waitcnt lgkmcnt(0)
  s_barrier
  ds_read_b128 v[132:135], v230 offset:0
  ds_read_b128 v[136:139], v230 offset:1024
  ds_read_b128 v[140:143], v230 offset:2048
  ds_read_b128 v[144:147], v230 offset:3072
  ds_read_b128 v[148:151], v230 offset:4096
  ds_read_b128 v[152:155], v230 offset:5120
  s_waitcnt lgkmcnt(5)
  v_pk_add_f32 v[68:69], v[68:69], v[132:133]
  v_pk_add_f32 v[70:71], v[70:71], v[134:135]
  s_waitcnt lgkmcnt(4)
  v_pk_add_f32 v[72:73], v[72:73], v[136:137]
  v_pk_add_f32 v[74:75], v[74:75], v[138:139]
  s_waitcnt lgkmcnt(3)
  v_pk_add_f32 v[68:69], v[68:69], v[140:141]
  v_pk_add_f32 v[70:71], v[70:71], v[142:143]
  s_waitcnt lgkmcnt(2)
  v_pk_add_f32 v[72:73], v[72:73], v[144:145]
  v_pk_add_f32 v[74:75], v[74:75], v[146:147]
  s_waitcnt lgkmcnt(1)
  v_pk_add_f32 v[68:69], v[68:69], v[148:149]
  v_pk_add_f32 v[70:71], v[70:71], v[150:151]
  s_waitcnt lgkmcnt(0)
  v_pk_add_f32 v[72:73], v[72:73], v[152:153]
  v_pk_add_f32 v[74:75], v[74:75], v[154:155]
  v_pk_mul_f32 v[8:9], v[68:69], v[68:69]
  v_pk_mul_f32 v[10:11], v[70:71], v[70:71]
  v_pk_mul_f32 v[12:13], v[72:73], v[72:73]
  v_pk_mul_f32 v[14:15], v[74:75], v[74:75]
  v_pk_fma_f32 v[8:9], v[8:9], v[28:29], v[28:29] op_sel:[0,0,1] op_sel_hi:[1,0,1]
  v_pk_fma_f32 v[10:11], v[10:11], v[28:29], v[28:29] op_sel:[0,0,1] op_sel_hi:[1,0,1]
  v_pk_fma_f32 v[12:13], v[12:13], v[28:29], v[28:29] op_sel:[0,0,1] op_sel_hi:[1,0,1]
  v_pk_fma_f32 v[14:15], v[14:15], v[28:29], v[28:29] op_sel:[0,0,1] op_sel_hi:[1,0,1]
  v_pk_mul_f32 v[8:9], v[8:9], v[68:69]
  v_pk_mul_f32 v[10:11], v[10:11], v[70:71]
  v_pk_mul_f32 v[12:13], v[12:13], v[72:73]
  v_pk_mul_f32 v[14:15], v[14:15], v[74:75]
  v_exp_f32 v8, v8
  v_exp_f32 v9, v9
  v_exp_f32 v10, v10
  v_exp_f32 v11, v11
  v_exp_f32 v12, v12
  v_exp_f32 v13, v13
  v_exp_f32 v14, v14
  v_exp_f32 v15, v15
  v_pk_add_f32 v[8:9], v[8:9], v[30:31] op_sel_hi:[1,0]
  v_pk_add_f32 v[10:11], v[10:11], v[30:31] op_sel_hi:[1,0]
  v_pk_add_f32 v[12:13], v[12:13], v[30:31] op_sel_hi:[1,0]
  v_pk_add_f32 v[14:15], v[14:15], v[30:31] op_sel_hi:[1,0]
  v_rcp_f32 v8, v8
  v_rcp_f32 v9, v9
  v_rcp_f32 v10, v10
  v_rcp_f32 v11, v11
  v_rcp_f32 v12, v12
  v_rcp_f32 v13, v13
  v_rcp_f32 v14, v14
  v_rcp_f32 v15, v15
  v_pk_mul_f32 v[8:9], v[8:9], v[68:69]
  v_pk_mul_f32 v[10:11], v[10:11], v[70:71]
  v_pk_mul_f32 v[12:13], v[12:13], v[72:73]
  v_pk_mul_f32 v[14:15], v[14:15], v[74:75]
  v_cvt_pk_bf16_f32 v24, v8, v9
  v_cvt_pk_bf16_f32 v25, v10, v11
  v_cvt_pk_bf16_f32 v26, v12, v13
  v_cvt_pk_bf16_f32 v27, v14, v15
  s_add_u32 s52, s62, 344064
  buffer_store_dwordx4 v[24:27], v232, s[28:31], s52 offen sc1
  s_cmp_lg_u32 s77, 0
  s_cbranch_scc1 L_sig_864146
  s_cmp_eq_u32 s95, 0
  s_cbranch_scc1 L_sig_864146
  s_mov_b32 exec_lo, s95
  s_mov_b32 exec_hi, 0
  buffer_atomic_add v251, v225, s[28:31], 0 offen offset:20 sc1
  s_mov_b64 exec, -1
L_sig_864146:
  s_getpc_b64 s[4:5]
L_pc_864147:
  s_lshl_b32 s3, s71, 2
  s_add_u32 s3, s3, s77
  s_lshl_b32 s3, s3, 2
  v_and_b32 v4, 3, v228
  v_add_u32 v4, s3, v4
  v_lshlrev_b32 v4, 7, v4
  v_min_u32 v4, L_end-L_pc_864147, v4
  v_mov_b32 v5, s5
  v_add_co_u32 v4, vcc, s4, v4
  v_addc_co_u32 v5, vcc, 0, v5, vcc
  global_load_dword v212, v[4:5], off
  s_mov_b64 exec, 1
  v_mov_b32 v233, 0
  buffer_atomic_add v233, v226, s[28:31], 0 offen offset:24 sc0 sc1
  s_mov_b64 exec, -1
  s_add_u32 m0, s68, 24576
  s_add_u32 s94, s67, 786432
  buffer_load_dwordx4 v219, s[12:15], s94 offen lds
  s_add_u32 m0, s68, 25600
  s_add_u32 s94, s67, 787456
  buffer_load_dwordx4 v219, s[12:15], s94 offen lds
  s_add_u32 m0, s68, 26624
  s_add_u32 s94, s67, 788480
  buffer_load_dwordx4 v219, s[12:15], s94 offen lds
  s_add_u32 m0, s68, 36864
  s_add_u32 s94, s67, 1179648
  buffer_load_dwordx4 v219, s[12:15], s94 offen lds
  s_add_u32 m0, s68, 37888
  s_add_u32 s94, s67, 1180672
  buffer_load_dwordx4 v219, s[12:15], s94 offen lds
  s_add_u32 m0, s68, 38912
  s_add_u32 s94, s67, 1181696
  buffer_load_dwordx4 v219, s[12:15], s94 offen lds
  s_waitcnt vmcnt(6)
  v_readfirstlane_b32 s3, v233
  s_cmp_lt_u32 s3, s97
  s_cbranch_scc1 L_poll_866148_r
L_poll_866148:
  s_add_u32 m0, s60, 24576
  s_add_u32 s94, s6, 10485760
  buffer_load_dwordx4 v213, s[28:31], s94 offen sc1 lds
  s_add_u32 m0, s60, 28672
  s_add_u32 s94, s7, 10485760
  buffer_load_dwordx4 v213, s[28:31], s94 offen sc1 lds
  s_add_u32 m0, s60, 32768
  s_add_u32 s94, s7, 10502144
  buffer_load_dwordx4 v213, s[28:31], s94 offen sc1 lds
  s_add_u32 m0, s60, 36864
  s_add_u32 s94, s7, 10518528
  buffer_load_dwordx4 v213, s[28:31], s94 offen sc1 lds
  s_add_u32 m0, s60, 40960
  s_add_u32 s94, s7, 10534912
  buffer_load_dwordx4 v213, s[28:31], s94 offen sc1 lds
  s_mov_b64 exec, 1
  v_mov_b32 v233, 0
  buffer_atomic_add v233, v226, s[28:31], 0 offen offset:28 sc0 sc1
  s_mov_b64 exec, -1
  s_waitcnt vmcnt(0)
  v_readfirstlane_b32 s3, v233
  s_cmp_lt_u32 s3, s97
  s_cbranch_scc1 L_poll_870149_r
L_poll_870149:
  s_add_u32 m0, s60, 45056
  s_add_u32 s94, s6, 10486784
  buffer_load_dwordx4 v213, s[28:31], s94 offen sc1 lds
  s_add_u32 m0, s60, 49152
  s_add_u32 s94, s7, 10486784
  buffer_load_dwordx4 v213, s[28:31], s94 offen sc1 lds
  s_add_u32 m0, s60, 53248
  s_add_u32 s94, s7, 10503168
  buffer_load_dwordx4 v213, s[28:31], s94 offen sc1 lds
  s_add_u32 m0, s60, 57344
  s_add_u32 s94, s7, 10519552
  buffer_load_dwordx4 v213, s[28:31], s94 offen sc1 lds
  s_add_u32 m0, s60, 61440
  s_add_u32 s94, s7, 10535936
  buffer_load_dwordx4 v213, s[28:31], s94 offen sc1 lds
  s_waitcnt vmcnt(0)
  s_branch L_join_82013
L_role4_82012:
  s_mul_i32 s58, s74, 458752
  s_mul_i32 s66, s77, 28672
  s_add_u32 s58, s58, s66
  s_add_u32 s58, s58, 8388608
  v_lshlrev_b32 v32, 16, v32
  s_lshl_b32 s53, s75, 1
  s_add_u32 s53, s53, s78
  s_lshl_b32 s53, s53, 2
  s_add_u32 s53, s53, s74
  s_lshl_b32 s53, s53, 1
  s_add_u32 s53, s53, s79
  s_lshl_b32 s53, s53, 8
  s_lshl_b32 s3, s76, 17
  s_add_u32 s53, s53, s3
  s_add_u32 s53, s53, 262144
  v_lshrrev_b32 v20, 1, v213
  s_waitcnt vmcnt(0) lgkmcnt(0)
  s_barrier
  s_mul_i32 s48, s77, 28672
  s_add_u32 s48, s48, 32768
  v_add_u32 v8, s48, v220
  v_xor_b32 v9, 64, v8
  s_add_u32 s61, s98, 262144
  s_cmp_ge_u32 s61, s99
  s_cselect_b32 s3, 1835008, 0
  s_sub_u32 s61, s61, s3
  s_add_u32 m0, s48, 8192
  s_nop 0
  buffer_load_dwordx4 v217, s[24:27], s61 offen lds
  s_add_u32 s61, s61, 32768
  s_add_u32 m0, s48, 9216
  s_nop 0
  buffer_load_dwordx4 v217, s[24:27], s61 offen lds
  s_add_u32 s61, s61, 32768
  s_add_u32 m0, s48, 10240
  s_nop 0
  buffer_load_dwordx4 v217, s[24:27], s61 offen lds
  s_add_u32 s61, s61, 32768
  s_add_u32 m0, s48, 11264
  s_nop 0
  buffer_load_dwordx4 v217, s[24:27], s61 offen lds
  s_add_u32 s61, s61, 32768
  s_add_u32 m0, s48, 12288
  s_nop 0
  buffer_load_dwordx4 v217, s[24:27], s61 offen lds
  s_add_u32 s61, s61, 32768
  s_add_u32 m0, s48, 13312
  s_nop 0
  buffer_load_dwordx4 v217, s[24:27], s61 offen lds
  s_add_u32 s61, s61, 32768
  s_add_u32 m0, s48, 14336
  s_nop 0
  buffer_load_dwordx4 v217, s[24:27], s61 offen lds
  s_add_u32 s61, s61, 32768
  s_add_u32 m0, s48, 15360
  s_nop 0
  buffer_load_dwordx4 v217, s[24:27], s61 offen lds
  s_add_u32 s61, s98, 524288
  s_cmp_ge_u32 s61, s99
  s_cselect_b32 s3, 1835008, 0
  s_sub_u32 s61, s61, s3
  s_add_u32 m0, s48, 16384
  s_nop 0
  buffer_load_dwordx4 v217, s[24:27], s61 offen lds
  s_add_u32 s61, s61, 32768
  s_add_u32 m0, s48, 17408
  s_nop 0
  buffer_load_dwordx4 v217, s[24:27], s61 offen lds
  s_add_u32 s61, s61, 32768
  s_add_u32 m0, s48, 18432
  s_nop 0
  buffer_load_dwordx4 v217, s[24:27], s61 offen lds
  s_add_u32 s61, s61, 32768
  s_add_u32 m0, s48, 19456
  s_nop 0
  buffer_load_dwordx4 v217, s[24:27], s61 offen lds
  s_add_u32 s61, s61, 32768
  s_add_u32 m0, s48, 20480
  s_nop 0
  buffer_load_dwordx4 v217, s[24:27], s61 offen lds
  s_add_u32 s61, s61, 32768
  s_add_u32 m0, s48, 21504
  s_nop 0
  buffer_load_dwordx4 v217, s[24:27], s61 offen lds
  s_waitcnt vmcnt(12)
  ds_read_b64_tr_b16 a[32:33], v8 offset:8192
  ds_read_b64_tr_b16 a[34:35], v8 offset:9216
  ds_read_b64_tr_b16 a[36:37], v9 offset:8192
  ds_read_b64_tr_b16 a[38:39], v9 offset:9216
  s_add_u32 s61, s61, 32768
  s_add_u32 m0, s48, 22528
  s_nop 0
  buffer_load_dwordx4 v217, s[24:27], s61 offen lds
  s_add_u32 s61, s61, 32768
  s_add_u32 m0, s48, 23552
  s_nop 0
  buffer_load_dwordx4 v217, s[24:27], s61 offen lds
  s_waitcnt vmcnt(12)
  ds_read_b64_tr_b16 a[40:41], v8 offset:10240
  ds_read_b64_tr_b16 a[42:43], v8 offset:11264
  ds_read_b64_tr_b16 a[44:45], v9 offset:10240
  ds_read_b64_tr_b16 a[46:47], v9 offset:11264
  s_add_u32 s61, s98, 786432
  s_cmp_ge_u32 s61, s99
  s_cselect_b32 s3, 1835008, 0
  s_sub_u32 s61, s61, s3
  s_add_u32 m0, s48, 24576
  s_nop 0
  buffer_load_dwordx4 v217, s[24:27], s61 offen lds
  s_add_u32 s61, s61, 32768
  s_add_u32 m0, s48, 25600
  s_nop 0
  buffer_load_dwordx4 v217, s[24:27], s61 offen lds
  s_waitcnt vmcnt(12)
  ds_read_b64_tr_b16 a[48:49], v8 offset:12288
  ds_read_b64_tr_b16 a[50:51], v8 offset:13312
  ds_read_b64_tr_b16 a[52:53], v9 offset:12288
  ds_read_b64_tr_b16 a[54:55], v9 offset:13312
  s_add_u32 s61, s61, 32768
  s_add_u32 m0, s48, 26624
  s_nop 0
  buffer_load_dwordx4 v217, s[24:27], s61 offen lds
  s_add_u32 s61, s61, 32768
  s_add_u32 m0, s48, 27648
  s_nop 0
  buffer_load_dwordx4 v217, s[24:27], s61 offen lds
  s_waitcnt vmcnt(12)
  ds_read_b64_tr_b16 a[56:57], v8 offset:14336
  ds_read_b64_tr_b16 a[58:59], v8 offset:15360
  ds_read_b64_tr_b16 a[60:61], v9 offset:14336
  ds_read_b64_tr_b16 a[62:63], v9 offset:15360
  s_add_u32 s61, s61, 32768
  s_add_u32 m0, s48, 0
  s_nop 0
  buffer_load_dwordx4 v217, s[24:27], s61 offen lds
  s_add_u32 s61, s61, 32768
  s_add_u32 m0, s48, 1024
  s_nop 0
  buffer_load_dwordx4 v217, s[24:27], s61 offen lds
  s_waitcnt vmcnt(12)
  ds_read_b64_tr_b16 a[64:65], v8 offset:16384
  ds_read_b64_tr_b16 a[66:67], v8 offset:17408
  ds_read_b64_tr_b16 a[68:69], v9 offset:16384
  ds_read_b64_tr_b16 a[70:71], v9 offset:17408
  s_add_u32 s61, s61, 32768
  s_add_u32 m0, s48, 2048
  s_nop 0
  buffer_load_dwordx4 v217, s[24:27], s61 offen lds
  s_add_u32 s61, s61, 32768
  s_add_u32 m0, s48, 3072
  s_nop 0
  buffer_load_dwordx4 v217, s[24:27], s61 offen lds
  s_waitcnt vmcnt(12)
  ds_read_b64_tr_b16 a[72:73], v8 offset:18432
  ds_read_b64_tr_b16 a[74:75], v8 offset:19456
  ds_read_b64_tr_b16 a[76:77], v9 offset:18432
  ds_read_b64_tr_b16 a[78:79], v9 offset:19456
  s_add_u32 s61, s98, 1048576
  s_cmp_ge_u32 s61, s99
  s_cselect_b32 s3, 1835008, 0
  s_sub_u32 s61, s61, s3
  s_add_u32 m0, s48, 4096
  s_nop 0
  buffer_load_dwordx4 v217, s[24:27], s61 offen lds
  s_add_u32 s61, s61, 32768
  s_add_u32 m0, s48, 5120
  s_nop 0
  buffer_load_dwordx4 v217, s[24:27], s61 offen lds
  s_waitcnt vmcnt(12)
  ds_read_b64_tr_b16 a[80:81], v8 offset:20480
  ds_read_b64_tr_b16 a[82:83], v8 offset:21504
  ds_read_b64_tr_b16 a[84:85], v9 offset:20480
  ds_read_b64_tr_b16 a[86:87], v9 offset:21504
  s_add_u32 s61, s61, 32768
  s_add_u32 m0, s48, 6144
  s_nop 0
  buffer_load_dwordx4 v217, s[24:27], s61 offen lds
  s_add_u32 s61, s61, 32768
  s_add_u32 m0, s48, 7168
  s_nop 0
  buffer_load_dwordx4 v217, s[24:27], s61 offen lds
  s_waitcnt vmcnt(12)
  ds_read_b64_tr_b16 a[88:89], v8 offset:22528
  ds_read_b64_tr_b16 a[90:91], v8 offset:23552
  ds_read_b64_tr_b16 a[92:93], v9 offset:22528
  ds_read_b64_tr_b16 a[94:95], v9 offset:23552
  s_waitcnt lgkmcnt(14)
  s_add_u32 s61, s61, 32768
  s_add_u32 m0, s48, 8192
  s_nop 0
  buffer_load_dwordx4 v217, s[24:27], s61 offen lds
  s_add_u32 s61, s61, 32768
  s_add_u32 m0, s48, 9216
  s_nop 0
  buffer_load_dwordx4 v217, s[24:27], s61 offen lds
  s_waitcnt vmcnt(12)
  ds_read_b64_tr_b16 a[96:97], v8 offset:24576
  ds_read_b64_tr_b16 a[98:99], v8 offset:25600
  ds_read_b64_tr_b16 a[100:101], v9 offset:24576
  ds_read_b64_tr_b16 a[102:103], v9 offset:25600
  s_add_u32 s61, s61, 32768
  s_add_u32 m0, s48, 10240
  s_nop 0
  buffer_load_dwordx4 v217, s[24:27], s61 offen lds
  s_add_u32 s61, s61, 32768
  s_add_u32 m0, s48, 11264
  s_nop 0
  buffer_load_dwordx4 v217, s[24:27], s61 offen lds
  s_waitcnt vmcnt(12)
  ds_read_b64_tr_b16 a[104:105], v8 offset:26624
  ds_read_b64_tr_b16 a[106:107], v8 offset:27648
  ds_read_b64_tr_b16 a[108:109], v9 offset:26624
  ds_read_b64_tr_b16 a[110:111], v9 offset:27648
  s_add_u32 s61, s98, 1310720
  s_cmp_ge_u32 s61, s99
  s_cselect_b32 s3, 1835008, 0
  s_sub_u32 s61, s61, s3
  s_add_u32 m0, s48, 12288
  s_nop 0
  buffer_load_dwordx4 v217, s[24:27], s61 offen lds
  s_add_u32 s61, s61, 32768
  s_add_u32 m0, s48, 13312
  s_nop 0
  buffer_load_dwordx4 v217, s[24:27], s61 offen lds
  s_waitcnt vmcnt(12)
  ds_read_b64_tr_b16 a[112:113], v8 offset:0
  ds_read_b64_tr_b16 a[114:115], v8 offset:1024
  ds_read_b64_tr_b16 a[116:117], v9 offset:0
  ds_read_b64_tr_b16 a[118:119], v9 offset:1024
  s_add_u32 s61, s61, 32768
  s_add_u32 m0, s48, 14336
  s_nop 0
  buffer_load_dwordx4 v217, s[24:27], s61 offen lds
  s_add_u32 s61, s61, 32768
  s_add_u32 m0, s48, 15360
  s_nop 0
  buffer_load_dwordx4 v217, s[24:27], s61 offen lds
  s_waitcnt vmcnt(12)
  ds_read_b64_tr_b16 a[120:121], v8 offset:2048
  ds_read_b64_tr_b16 a[122:123], v8 offset:3072
  ds_read_b64_tr_b16 a[124:125], v9 offset:2048
  ds_read_b64_tr_b16 a[126:127], v9 offset:3072
  s_waitcnt lgkmcnt(14)
  s_add_u32 s61, s61, 32768
  s_add_u32 m0, s48, 16384
  s_nop 0
  buffer_load_dwordx4 v217, s[24:27], s61 offen lds
  s_add_u32 s61, s61, 32768
  s_add_u32 m0, s48, 17408
  s_nop 0
  buffer_load_dwordx4 v217, s[24:27], s61 offen lds
  s_waitcnt vmcnt(12)
  ds_read_b64_tr_b16 a[128:129], v8 offset:4096
  ds_read_b64_tr_b16 a[130:131], v8 offset:5120
  ds_read_b64_tr_b16 a[132:133], v9 offset:4096
  ds_read_b64_tr_b16 a[134:135], v9 offset:5120
  s_add_u32 s61, s61, 32768
  s_add_u32 m0, s48, 18432
  s_nop 0
  buffer_load_dwordx4 v217, s[24:27], s61 offen lds
  s_add_u32 s61, s61, 32768
  s_add_u32 m0, s48, 19456
  s_nop 0
  buffer_load_dwordx4 v217, s[24:27], s61 offen lds
  s_waitcnt vmcnt(12)
  ds_read_b64_tr_b16 a[136:137], v8 offset:6144
  ds_read_b64_tr_b16 a[138:139], v8 offset:7168
  ds_read_b64_tr_b16 a[140:141], v9 offset:6144
  ds_read_b64_tr_b16 a[142:143], v9 offset:7168
  s_add_u32 s61, s98, 1572864
  s_cmp_ge_u32 s61, s99
  s_cselect_b32 s3, 1835008, 0
  s_sub_u32 s61, s61, s3
  s_add_u32 m0, s48, 20480
  s_nop 0
  buffer_load_dwordx4 v217, s[24:27], s61 offen lds
  s_add_u32 s61, s61, 32768
  s_add_u32 m0, s48, 21504
  s_nop 0
  buffer_load_dwordx4 v217, s[24:27], s61 offen lds
  s_waitcnt vmcnt(12)
  ds_read_b64_tr_b16 a[144:145], v8 offset:8192
  ds_read_b64_tr_b16 a[146:147], v8 offset:9216
  ds_read_b64_tr_b16 a[148:149], v9 offset:8192
  ds_read_b64_tr_b16 a[150:151], v9 offset:9216
  s_add_u32 s61, s61, 32768
  s_add_u32 m0, s48, 22528
  s_nop 0
  buffer_load_dwordx4 v217, s[24:27], s61 offen lds
  s_add_u32 s61, s61, 32768
  s_add_u32 m0, s48, 23552
  s_nop 0
  buffer_load_dwordx4 v217, s[24:27], s61 offen lds
  s_waitcnt vmcnt(12)
  ds_read_b64_tr_b16 a[152:153], v8 offset:10240
  ds_read_b64_tr_b16 a[154:155], v8 offset:11264
  ds_read_b64_tr_b16 a[156:157], v9 offset:10240
  ds_read_b64_tr_b16 a[158:159], v9 offset:11264
  s_waitcnt lgkmcnt(14)
  s_add_u32 s61, s61, 32768
  s_add_u32 m0, s48, 24576
  s_nop 0
  buffer_load_dwordx4 v217, s[24:27], s61 offen lds
  s_add_u32 s61, s61, 32768
  s_add_u32 m0, s48, 25600
  s_nop 0
  buffer_load_dwordx4 v217, s[24:27], s61 offen lds
  s_waitcnt vmcnt(12)
  ds_read_b64_tr_b16 a[160:161], v8 offset:12288
  ds_read_b64_tr_b16 a[162:163], v8 offset:13312
  ds_read_b64_tr_b16 a[164:165], v9 offset:12288
  ds_read_b64_tr_b16 a[166:167], v9 offset:13312
  s_add_u32 s61, s61, 32768
  s_add_u32 m0, s48, 26624
  s_nop 0
  buffer_load_dwordx4 v217, s[24:27], s61 offen lds
  s_add_u32 s61, s61, 32768
  s_add_u32 m0, s48, 27648
  s_nop 0
  buffer_load_dwordx4 v217, s[24:27], s61 offen lds
  s_waitcnt vmcnt(12)
  ds_read_b64_tr_b16 a[168:169], v8 offset:14336
  ds_read_b64_tr_b16 a[170:171], v8 offset:15360
  ds_read_b64_tr_b16 a[172:173], v9 offset:14336
  ds_read_b64_tr_b16 a[174:175], v9 offset:15360
  s_waitcnt vmcnt(10)
  ds_read_b64_tr_b16 a[176:177], v8 offset:16384
  ds_read_b64_tr_b16 a[178:179], v8 offset:17408
  ds_read_b64_tr_b16 a[180:181], v9 offset:16384
  ds_read_b64_tr_b16 a[182:183], v9 offset:17408
  s_waitcnt vmcnt(8)
  ds_read_b64_tr_b16 a[184:185], v8 offset:18432
  ds_read_b64_tr_b16 a[186:187], v8 offset:19456
  ds_read_b64_tr_b16 a[188:189], v9 offset:18432
  ds_read_b64_tr_b16 a[190:191], v9 offset:19456
  s_waitcnt vmcnt(6)
  ds_read_b64_tr_b16 a[192:193], v8 offset:20480
  ds_read_b64_tr_b16 a[194:195], v8 offset:21504
  ds_read_b64_tr_b16 a[196:197], v9 offset:20480
  ds_read_b64_tr_b16 a[198:199], v9 offset:21504
  s_waitcnt vmcnt(4)
  ds_read_b64_tr_b16 a[200:201], v8 offset:22528
  ds_read_b64_tr_b16 a[202:203], v8 offset:23552
  ds_read_b64_tr_b16 a[204:205], v9 offset:22528
  ds_read_b64_tr_b16 a[206:207], v9 offset:23552
  s_waitcnt vmcnt(2)
  ds_read_b64_tr_b16 a[208:209], v8 offset:24576
  ds_read_b64_tr_b16 a[210:211], v8 offset:25600
  ds_read_b64_tr_b16 a[212:213], v9 offset:24576
  ds_read_b64_tr_b16 a[214:215], v9 offset:25600
  s_waitcnt vmcnt(0)
  ds_read_b64_tr_b16 a[216:217], v8 offset:26624
  ds_read_b64_tr_b16 a[218:219], v8 offset:27648
  ds_read_b64_tr_b16 a[220:221], v9 offset:26624
  ds_read_b64_tr_b16 a[222:223], v9 offset:27648
  s_waitcnt lgkmcnt(0)
  s_barrier
  v_mov_b32 v190, -1
  v_mov_b32 v191, -1
  v_mov_b32 v192, -1
  v_mov_b32 v193, -1
  s_add_u32 m0, s68, 0
  s_nop 0
  buffer_load_dwordx4 v219, s[12:15], s67 offen lds
  s_add_u32 m0, s68, 1024
  s_add_u32 s94, s67, 1024
  buffer_load_dwordx4 v219, s[12:15], s94 offen lds
  s_add_u32 m0, s68, 2048
  s_add_u32 s94, s67, 2048
  buffer_load_dwordx4 v219, s[12:15], s94 offen lds
  s_add_u32 m0, s68, 12288
  s_add_u32 s94, s67, 393216
  buffer_load_dwordx4 v219, s[12:15], s94 offen lds
  s_add_u32 m0, s68, 13312
  s_add_u32 s94, s67, 394240
  buffer_load_dwordx4 v219, s[12:15], s94 offen lds
  s_add_u32 m0, s68, 14336
  s_add_u32 s94, s67, 395264
  buffer_load_dwordx4 v219, s[12:15], s94 offen lds
  s_add_u32 m0, s68, 24576
  s_add_u32 s94, s67, 786432
  buffer_load_dwordx4 v219, s[12:15], s94 offen lds
  s_add_u32 m0, s68, 25600
  s_add_u32 s94, s67, 787456
  buffer_load_dwordx4 v219, s[12:15], s94 offen lds
  s_add_u32 m0, s68, 26624
  s_add_u32 s94, s67, 788480
  buffer_load_dwordx4 v219, s[12:15], s94 offen lds
  s_add_u32 m0, s68, 36864
  s_add_u32 s94, s67, 1179648
  buffer_load_dwordx4 v219, s[12:15], s94 offen lds
  s_add_u32 m0, s68, 37888
  s_add_u32 s94, s67, 1180672
  buffer_load_dwordx4 v219, s[12:15], s94 offen lds
  s_add_u32 m0, s68, 38912
  s_add_u32 s94, s67, 1181696
  buffer_load_dwordx4 v219, s[12:15], s94 offen lds
  s_lshl_b32 s94, s72, 1
  s_add_u32 s94, s94, s79
  s_lshl_b32 s94, s94, 3
  s_add_u32 s94, s94, s73
  s_lshl_b32 s94, s94, 1
  s_add_u32 s94, s94, s78
  s_lshl_b32 s94, s94, 8
  s_add_u32 s94, s94, 1310720
  v_lshlrev_b32 v252, 2, v228
  buffer_store_dword v190, v252, s[28:31], s94 offen sc1
  s_add_u32 s94, s0, 10485760
  buffer_store_dwordx4 v[190:193], v213, s[28:31], s94 offen sc1
  s_add_u32 s94, s0, 10518528
  buffer_store_dwordx4 v[190:193], v213, s[28:31], s94 offen sc1
  s_mov_b64 exec, 1
  v_mov_b32 v233, 0
  buffer_atomic_add v233, v210, s[28:31], 0 offen offset:8 sc0 sc1
  s_mov_b64 exec, -1
  s_add_u32 s66, s58, 0
  s_waitcnt vmcnt(0)
  v_readfirstlane_b32 s3, v233
  s_cmp_lt_u32 s3, 7
  s_cbranch_scc1 L_poll_874150_r
L_poll_874150:
  buffer_load_dwordx4 v[156:159], v231, s[28:31], s66 offen offset:0 sc1
  buffer_load_dwordx4 v[160:163], v231, s[28:31], s66 offen offset:1024 sc1
  buffer_load_dwordx4 v[164:167], v231, s[28:31], s66 offen offset:2048 sc1
  buffer_load_dwordx4 v[168:171], v231, s[28:31], s66 offen offset:3072 sc1
  s_add_u32 s66, s58, 4096
  buffer_load_dwordx4 v[172:175], v231, s[28:31], s66 offen offset:0 sc1
  buffer_load_dwordx4 v[176:179], v231, s[28:31], s66 offen offset:1024 sc1
  buffer_load_dwordx4 v[180:183], v231, s[28:31], s66 offen offset:2048 sc1
  buffer_load_dwordx4 v[184:187], v231, s[28:31], s66 offen offset:3072 sc1
  s_add_u32 s66, s58, 8192
  buffer_load_dwordx4 v[108:111], v231, s[28:31], s66 offen offset:0 sc1
  buffer_load_dwordx4 v[112:115], v231, s[28:31], s66 offen offset:1024 sc1
  buffer_load_dwordx4 v[116:119], v231, s[28:31], s66 offen offset:2048 sc1
  s_waitcnt vmcnt(10)
  v_cmp_eq_u32 vcc, -1, v156
  s_cbranch_vccnz L_tag_876151_r
L_tag_876151:
  v_mfma_f32_32x32x16_bf16 v[36:51], v[156:159], a[0:3], 0
  s_waitcnt vmcnt(9)
  v_cmp_eq_u32 vcc, -1, v160
  v_mfma_f32_32x32x16_bf16 v[52:67], v[156:159], a[4:7], 0
  s_cbranch_vccnz L_tag_880152_r
L_tag_880152:
  buffer_load_dwordx4 v[156:159], v231, s[28:31], s66 offen offset:3072 sc1
  v_mfma_f32_32x32x16_bf16 v[36:51], v[160:163], a[8:11], v[36:51]
  s_waitcnt vmcnt(9)
  v_cmp_eq_u32 vcc, -1, v164
  v_mfma_f32_32x32x16_bf16 v[52:67], v[160:163], a[12:15], v[52:67]
  s_cbranch_vccnz L_tag_882153_r
L_tag_882153:
  s_add_u32 s66, s58, 12288
  buffer_load_dwordx4 v[160:163], v231, s[28:31], s66 offen offset:0 sc1
  v_mfma_f32_32x32x16_bf16 v[36:51], v[164:167], a[16:19], v[36:51]
  s_waitcnt vmcnt(9)
  v_cmp_eq_u32 vcc, -1, v168
  v_mfma_f32_32x32x16_bf16 v[52:67], v[164:167], a[20:23], v[52:67]
  s_cbranch_vccnz L_tag_884154_r
L_tag_884154:
  buffer_load_dwordx4 v[164:167], v231, s[28:31], s66 offen offset:1024 sc1
  v_mfma_f32_32x32x16_bf16 v[36:51], v[168:171], a[24:27], v[36:51]
  s_waitcnt vmcnt(9)
  v_cmp_eq_u32 vcc, -1, v172
  v_mfma_f32_32x32x16_bf16 v[52:67], v[168:171], a[28:31], v[52:67]
  s_cbranch_vccnz L_tag_886155_r
L_tag_886155:
  buffer_load_dwordx4 v[168:171], v231, s[28:31], s66 offen offset:2048 sc1
  v_mfma_f32_32x32x16_bf16 v[36:51], v[172:175], a[32:35], v[36:51]
  s_waitcnt vmcnt(9)
  v_cmp_eq_u32 vcc, -1, v176
  v_mfma_f32_32x32x16_bf16 v[52:67], v[172:175], a[36:39], v[52:67]
  s_cbranch_vccnz L_tag_888156_r
L_tag_888156:
  buffer_load_dwordx4 v[172:175], v231, s[28:31], s66 offen offset:3072 sc1
  v_mfma_f32_32x32x16_bf16 v[36:51], v[176:179], a[40:43], v[36:51]
  s_waitcnt vmcnt(9)
  v_cmp_eq_u32 vcc, -1, v180
  v_mfma_f32_32x32x16_bf16 v[52:67], v[176:179], a[44:47], v[52:67]
  s_cbranch_vccnz L_tag_890157_r
L_tag_890157:
  s_add_u32 s66, s58, 16384
  buffer_load_dwordx4 v[176:179], v231, s[28:31], s66 offen offset:0 sc1
  v_mfma_f32_32x32x16_bf16 v[36:51], v[180:183], a[48:51], v[36:51]
  s_waitcnt vmcnt(9)
  v_cmp_eq_u32 vcc, -1, v184
  v_mfma_f32_32x32x16_bf16 v[52:67], v[180:183], a[52:55], v[52:67]
  s_cbranch_vccnz L_tag_892158_r
L_tag_892158:
  buffer_load_dwordx4 v[180:183], v231, s[28:31], s66 offen offset:1024 sc1
  v_mfma_f32_32x32x16_bf16 v[36:51], v[184:187], a[56:59], v[36:51]
  s_waitcnt vmcnt(9)
  v_cmp_eq_u32 vcc, -1, v108
  v_mfma_f32_32x32x16_bf16 v[52:67], v[184:187], a[60:63], v[52:67]
  s_cbranch_vccnz L_tag_894159_r
L_tag_894159:
  buffer_load_dwordx4 v[184:187], v231, s[28:31], s66 offen offset:2048 sc1
  v_mfma_f32_32x32x16_bf16 v[36:51], v[108:111], a[64:67], v[36:51]
  s_waitcnt vmcnt(9)
  v_cmp_eq_u32 vcc, -1, v112
  v_mfma_f32_32x32x16_bf16 v[52:67], v[108:111], a[68:71], v[52:67]
  s_cbranch_vccnz L_tag_896160_r
L_tag_896160:
  buffer_load_dwordx4 v[108:111], v231, s[28:31], s66 offen offset:3072 sc1
  v_mfma_f32_32x32x16_bf16 v[36:51], v[112:115], a[72:75], v[36:51]
  s_waitcnt vmcnt(9)
  v_cmp_eq_u32 vcc, -1, v116
  v_mfma_f32_32x32x16_bf16 v[52:67], v[112:115], a[76:79], v[52:67]
  s_cbranch_vccnz L_tag_898161_r
L_tag_898161:
  s_add_u32 s66, s58, 20480
  buffer_load_dwordx4 v[112:115], v231, s[28:31], s66 offen offset:0 sc1
  v_mfma_f32_32x32x16_bf16 v[36:51], v[116:119], a[80:83], v[36:51]
  s_waitcnt vmcnt(9)
  v_cmp_eq_u32 vcc, -1, v156
  v_mfma_f32_32x32x16_bf16 v[52:67], v[116:119], a[84:87], v[52:67]
  s_cbranch_vccnz L_tag_900162_r
L_tag_900162:
  buffer_load_dwordx4 v[116:119], v231, s[28:31], s66 offen offset:1024 sc1
  v_mfma_f32_32x32x16_bf16 v[36:51], v[156:159], a[88:91], v[36:51]
  s_waitcnt vmcnt(9)
  v_cmp_eq_u32 vcc, -1, v160
  v_mfma_f32_32x32x16_bf16 v[52:67], v[156:159], a[92:95], v[52:67]
  s_cbranch_vccnz L_tag_902163_r
L_tag_902163:
  buffer_load_dwordx4 v[156:159], v231, s[28:31], s66 offen offset:2048 sc1
  v_mfma_f32_32x32x16_bf16 v[36:51], v[160:163], a[96:99], v[36:51]
  s_waitcnt vmcnt(9)
  v_cmp_eq_u32 vcc, -1, v164
  v_mfma_f32_32x32x16_bf16 v[52:67], v[160:163], a[100:103], v[52:67]
  s_cbranch_vccnz L_tag_904164_r
L_tag_904164:
  buffer_load_dwordx4 v[160:163], v231, s[28:31], s66 offen offset:3072 sc1
  v_mfma_f32_32x32x16_bf16 v[36:51], v[164:167], a[104:107], v[36:51]
  s_waitcnt vmcnt(9)
  v_cmp_eq_u32 vcc, -1, v168
  v_mfma_f32_32x32x16_bf16 v[52:67], v[164:167], a[108:111], v[52:67]
  s_cbranch_vccnz L_tag_906165_r
L_tag_906165:
  s_add_u32 s66, s58, 24576
  buffer_load_dwordx4 v[164:167], v231, s[28:31], s66 offen offset:0 sc1
  v_mfma_f32_32x32x16_bf16 v[36:51], v[168:171], a[112:115], v[36:51]
  s_waitcnt vmcnt(9)
  v_cmp_eq_u32 vcc, -1, v172
  v_mfma_f32_32x32x16_bf16 v[52:67], v[168:171], a[116:119], v[52:67]
  s_cbranch_vccnz L_tag_908166_r
L_tag_908166:
  buffer_load_dwordx4 v[168:171], v231, s[28:31], s66 offen offset:1024 sc1
  s_mov_b64 exec, 1
  v_mov_b32 v233, 0
  buffer_atomic_add v233, v210, s[28:31], 0 offen offset:12 sc0 sc1
  s_mov_b64 exec, -1
  s_add_u32 s52, s63, 4194304
  buffer_load_dwordx4 v[100:103], v227, s[28:31], s52 offen sc1
  v_mfma_f32_32x32x16_bf16 v[36:51], v[172:175], a[120:123], v[36:51]
  s_waitcnt vmcnt(11)
  v_cmp_eq_u32 vcc, -1, v176
  v_mfma_f32_32x32x16_bf16 v[52:67], v[172:175], a[124:127], v[52:67]
  s_cbranch_vccnz L_tag_912167_r
L_tag_912167:
  buffer_load_dwordx4 v[172:175], v231, s[28:31], s66 offen offset:2048 sc1
  v_mfma_f32_32x32x16_bf16 v[36:51], v[176:179], a[128:131], v[36:51]
  s_waitcnt vmcnt(11)
  v_cmp_eq_u32 vcc, -1, v180
  v_mfma_f32_32x32x16_bf16 v[52:67], v[176:179], a[132:135], v[52:67]
  s_cbranch_vccnz L_tag_914168_r
L_tag_914168:
  buffer_load_dwordx4 v[176:179], v231, s[28:31], s66 offen offset:3072 sc1
  v_mfma_f32_32x32x16_bf16 v[36:51], v[180:183], a[136:139], v[36:51]
  s_waitcnt vmcnt(11)
  v_cmp_eq_u32 vcc, -1, v184
  v_mfma_f32_32x32x16_bf16 v[52:67], v[180:183], a[140:143], v[52:67]
  s_cbranch_vccnz L_tag_916169_r
L_tag_916169:
  v_mfma_f32_32x32x16_bf16 v[36:51], v[184:187], a[144:147], v[36:51]
  s_waitcnt vmcnt(10)
  v_cmp_eq_u32 vcc, -1, v108
  v_mfma_f32_32x32x16_bf16 v[52:67], v[184:187], a[148:151], v[52:67]
  s_cbranch_vccnz L_tag_918170_r
L_tag_918170:
  v_mfma_f32_32x32x16_bf16 v[36:51], v[108:111], a[152:155], v[36:51]
  s_waitcnt vmcnt(9)
  v_cmp_eq_u32 vcc, -1, v112
  v_mfma_f32_32x32x16_bf16 v[52:67], v[108:111], a[156:159], v[52:67]
  s_cbranch_vccnz L_tag_920171_r
L_tag_920171:
  v_mfma_f32_32x32x16_bf16 v[36:51], v[112:115], a[160:163], v[36:51]
  s_waitcnt vmcnt(8)
  v_cmp_eq_u32 vcc, -1, v116
  v_mfma_f32_32x32x16_bf16 v[52:67], v[112:115], a[164:167], v[52:67]
  s_cbranch_vccnz L_tag_922172_r
L_tag_922172:
  v_mfma_f32_32x32x16_bf16 v[36:51], v[116:119], a[168:171], v[36:51]
  s_waitcnt vmcnt(7)
  v_cmp_eq_u32 vcc, -1, v156
  v_mfma_f32_32x32x16_bf16 v[52:67], v[116:119], a[172:175], v[52:67]
  s_cbranch_vccnz L_tag_924173_r
L_tag_924173:
  v_mfma_f32_32x32x16_bf16 v[36:51], v[156:159], a[176:179], v[36:51]
  s_waitcnt vmcnt(6)
  v_cmp_eq_u32 vcc, -1, v160
  v_mfma_f32_32x32x16_bf16 v[52:67], v[156:159], a[180:183], v[52:67]
  s_cbranch_vccnz L_tag_926174_r
L_tag_926174:
  s_add_u32 s66, s58, 114688
  s_waitcnt vmcnt(3)
  v_readfirstlane_b32 s3, v233
  s_cmp_lt_u32 s3, 7
  s_cbranch_scc1 L_poll_926175_r
L_poll_926175:
  buffer_load_dwordx4 v[180:183], v231, s[28:31], s66 offen offset:0 sc1
  buffer_load_dwordx4 v[184:187], v231, s[28:31], s66 offen offset:1024 sc1
  buffer_load_dwordx4 v[108:111], v231, s[28:31], s66 offen offset:2048 sc1
  buffer_load_dwordx4 v[112:115], v231, s[28:31], s66 offen offset:3072 sc1
  s_add_u32 s66, s58, 118784
  buffer_load_dwordx4 v[116:119], v231, s[28:31], s66 offen offset:0 sc1
  buffer_load_dwordx4 v[156:159], v231, s[28:31], s66 offen offset:1024 sc1
  v_mfma_f32_32x32x16_bf16 v[36:51], v[160:163], a[184:187], v[36:51]
  v_cmp_eq_u32 vcc, -1, v164
  v_mfma_f32_32x32x16_bf16 v[52:67], v[160:163], a[188:191], v[52:67]
  s_cbranch_vccnz L_tag_930176_r
L_tag_930176:
  buffer_load_dwordx4 v[160:163], v231, s[28:31], s66 offen offset:2048 sc1
  v_mfma_f32_32x32x16_bf16 v[36:51], v[164:167], a[192:195], v[36:51]
  v_cmp_eq_u32 vcc, -1, v168
  v_mfma_f32_32x32x16_bf16 v[52:67], v[164:167], a[196:199], v[52:67]
  s_cbranch_vccnz L_tag_932177_r
L_tag_932177:
  buffer_load_dwordx4 v[164:167], v231, s[28:31], s66 offen offset:3072 sc1
  v_mfma_f32_32x32x16_bf16 v[36:51], v[168:171], a[200:203], v[36:51]
  s_waitcnt vmcnt(9)
  v_cmp_eq_u32 vcc, -1, v172
  v_mfma_f32_32x32x16_bf16 v[52:67], v[168:171], a[204:207], v[52:67]
  s_cbranch_vccnz L_tag_934178_r
L_tag_934178:
  s_add_u32 s66, s58, 122880
  buffer_load_dwordx4 v[168:171], v231, s[28:31], s66 offen offset:0 sc1
  v_mfma_f32_32x32x16_bf16 v[36:51], v[172:175], a[208:211], v[36:51]
  s_waitcnt vmcnt(9)
  v_cmp_eq_u32 vcc, -1, v176
  v_mfma_f32_32x32x16_bf16 v[52:67], v[172:175], a[212:215], v[52:67]
  s_cbranch_vccnz L_tag_936179_r
L_tag_936179:
  buffer_load_dwordx4 v[172:175], v231, s[28:31], s66 offen offset:1024 sc1
  v_mfma_f32_32x32x16_bf16 v[36:51], v[176:179], a[216:219], v[36:51]
  s_waitcnt vmcnt(9)
  v_cmp_eq_u32 vcc, -1, v180
  v_mfma_f32_32x32x16_bf16 v[52:67], v[176:179], a[220:223], v[52:67]
  s_cbranch_vccnz L_tag_938180_r
L_tag_938180:
  buffer_load_dwordx4 v[176:179], v231, s[28:31], s66 offen offset:2048 sc1
  v_mfma_f32_32x32x16_bf16 v[68:83], v[180:183], a[0:3], 0
  s_nop 5
  ds_write_b128 v253, v[44:47] offset:0
  s_waitcnt vmcnt(9)
  v_cmp_eq_u32 vcc, -1, v184
  v_mfma_f32_32x32x16_bf16 v[84:99], v[180:183], a[4:7], 0
  s_cbranch_vccnz L_tag_1108182_r
L_tag_1108182:
  buffer_load_dwordx4 v[180:183], v231, s[28:31], s66 offen offset:3072 sc1
  ds_write_b128 v253, v[48:51] offset:1024
  v_mfma_f32_32x32x16_bf16 v[68:83], v[184:187], a[8:11], v[68:83]
  ds_write_b128 v254, v[52:55] offset:0
  s_waitcnt vmcnt(9)
  v_cmp_eq_u32 vcc, -1, v108
  v_mfma_f32_32x32x16_bf16 v[84:99], v[184:187], a[12:15], v[84:99]
  s_cbranch_vccnz L_tag_1110183_r
L_tag_1110183:
  s_add_u32 s66, s58, 126976
  buffer_load_dwordx4 v[184:187], v231, s[28:31], s66 offen offset:0 sc1
  ds_write_b128 v254, v[56:59] offset:1024
  v_mfma_f32_32x32x16_bf16 v[68:83], v[108:111], a[16:19], v[68:83]
  ds_write_b128 v255, v[60:63] offset:0
  s_waitcnt vmcnt(9)
  v_cmp_eq_u32 vcc, -1, v112
  v_mfma_f32_32x32x16_bf16 v[84:99], v[108:111], a[20:23], v[84:99]
  s_cbranch_vccnz L_tag_1112184_r
L_tag_1112184:
  buffer_load_dwordx4 v[108:111], v231, s[28:31], s66 offen offset:1024 sc1
  ds_write_b128 v255, v[64:67] offset:1024
  v_mfma_f32_32x32x16_bf16 v[68:83], v[112:115], a[24:27], v[68:83]
  v_lshlrev_b32 v8, 16, v100
  v_and_b32 v9, 0xffff0000, v100
  v_lshlrev_b32 v10, 16, v101
  v_and_b32 v11, 0xffff0000, v101
  s_waitcnt vmcnt(9)
  v_cmp_eq_u32 vcc, -1, v116
  v_mfma_f32_32x32x16_bf16 v[84:99], v[112:115], a[28:31], v[84:99]
  s_cbranch_vccnz L_tag_1114185_r
L_tag_1114185:
  buffer_load_dwordx4 v[112:115], v231, s[28:31], s66 offen offset:2048 sc1
  v_lshlrev_b32 v12, 16, v102
  v_and_b32 v13, 0xffff0000, v102
  v_lshlrev_b32 v14, 16, v103
  v_and_b32 v15, 0xffff0000, v103
  v_mfma_f32_32x32x16_bf16 v[68:83], v[116:119], a[32:35], v[68:83]
  v_add_f32 v8, v8, v32
  v_add_f32 v9, v9, v32
  v_add_f32 v10, v10, v32
  v_add_f32 v11, v11, v32
  s_waitcnt vmcnt(9)
  v_cmp_eq_u32 vcc, -1, v156
  v_mfma_f32_32x32x16_bf16 v[84:99], v[116:119], a[36:39], v[84:99]
  s_cbranch_vccnz L_tag_1116186_r
L_tag_1116186:
  buffer_load_dwordx4 v[116:119], v231, s[28:31], s66 offen offset:3072 sc1
  v_add_f32 v12, v12, v32
  v_add_f32 v13, v13, v32
  v_add_f32 v14, v14, v32
  v_add_f32 v15, v15, v32
  v_mfma_f32_32x32x16_bf16 v[68:83], v[156:159], a[40:43], v[68:83]
  v_add_f32 v36, v36, v8
  v_add_f32 v37, v37, v9
  v_add_f32 v38, v38, v10
  v_add_f32 v39, v39, v11
  s_waitcnt vmcnt(9)
  v_cmp_eq_u32 vcc, -1, v160
  v_mfma_f32_32x32x16_bf16 v[84:99], v[156:159], a[44:47], v[84:99]
  s_cbranch_vccnz L_tag_1118187_r
L_tag_1118187:
  s_add_u32 s66, s58, 131072
  buffer_load_dwordx4 v[156:159], v231, s[28:31], s66 offen offset:0 sc1
  v_add_f32 v40, v40, v12
  v_add_f32 v41, v41, v13
  v_add_f32 v42, v42, v14
  v_add_f32 v43, v43, v15
  v_mfma_f32_32x32x16_bf16 v[68:83], v[160:163], a[48:51], v[68:83]
  s_waitcnt lgkmcnt(0)
  s_barrier
  ds_read_b128 v[132:135], v230 offset:0
  ds_read_b128 v[136:139], v230 offset:1024
  ds_read_b128 v[140:143], v230 offset:2048
  ds_read_b128 v[144:147], v230 offset:3072
  ds_read_b128 v[148:151], v230 offset:4096
  ds_read_b128 v[152:155], v230 offset:5120
  s_waitcnt vmcnt(9)
  v_cmp_eq_u32 vcc, -1, v164
  v_mfma_f32_32x32x16_bf16 v[84:99], v[160:163], a[52:55], v[84:99]
  s_cbranch_vccnz L_tag_1120188_r
L_tag_1120188:
  buffer_load_dwordx4 v[160:163], v231, s[28:31], s66 offen offset:1024 sc1
  v_mfma_f32_32x32x16_bf16 v[68:83], v[164:167], a[56:59], v[68:83]
  s_waitcnt lgkmcnt(5)
  v_add_f32 v36, v36, v132
  v_add_f32 v37, v37, v133
  v_add_f32 v38, v38, v134
  v_add_f32 v39, v39, v135
  s_waitcnt vmcnt(9)
  v_cmp_eq_u32 vcc, -1, v168
  v_mfma_f32_32x32x16_bf16 v[84:99], v[164:167], a[60:63], v[84:99]
  s_cbranch_vccnz L_tag_1122189_r
L_tag_1122189:
  buffer_load_dwordx4 v[164:167], v231, s[28:31], s66 offen offset:2048 sc1
  s_waitcnt lgkmcnt(4)
  v_add_f32 v40, v40, v136
  v_add_f32 v41, v41, v137
  v_add_f32 v42, v42, v138
  v_add_f32 v43, v43, v139
  v_mfma_f32_32x32x16_bf16 v[68:83], v[168:171], a[64:67], v[68:83]
  s_waitcnt lgkmcnt(3)
  v_add_f32 v36, v36, v140
  v_add_f32 v37, v37, v141
  v_add_f32 v38, v38, v142
  v_add_f32 v39, v39, v143
  s_waitcnt vmcnt(9)
  v_cmp_eq_u32 vcc, -1, v172
  v_mfma_f32_32x32x16_bf16 v[84:99], v[168:171], a[68:71], v[84:99]
  s_cbranch_vccnz L_tag_1124190_r
L_tag_1124190:
  buffer_load_dwordx4 v[168:171], v231, s[28:31], s66 offen offset:3072 sc1
  s_waitcnt lgkmcnt(2)
  v_add_f32 v40, v40, v144
  v_add_f32 v41, v41, v145
  v_add_f32 v42, v42, v146
  v_add_f32 v43, v43, v147
  v_mfma_f32_32x32x16_bf16 v[68:83], v[172:175], a[72:75], v[68:83]
  s_waitcnt lgkmcnt(1)
  v_add_f32 v36, v36, v148
  v_add_f32 v37, v37, v149
  v_add_f32 v38, v38, v150
  v_add_f32 v39, v39, v151
  s_waitcnt vmcnt(9)
  v_cmp_eq_u32 vcc, -1, v176
  v_mfma_f32_32x32x16_bf16 v[84:99], v[172:175], a[76:79], v[84:99]
  s_cbranch_vccnz L_tag_1126191_r
L_tag_1126191:
  s_add_u32 s66, s58, 135168
  buffer_load_dwordx4 v[172:175], v231, s[28:31], s66 offen offset:0 sc1
  s_waitcnt lgkmcnt(0)
  v_add_f32 v40, v40, v152
  v_add_f32 v41, v41, v153
  v_add_f32 v42, v42, v154
  v_add_f32 v43, v43, v155
  v_mfma_f32_32x32x16_bf16 v[68:83], v[176:179], a[80:83], v[68:83]
  v_cvt_pk_bf16_f32 v24, v36, v37
  v_cvt_pk_bf16_f32 v25, v38, v39
  v_cvt_pk_bf16_f32 v26, v40, v41
  v_cvt_pk_bf16_f32 v27, v42, v43
  s_waitcnt vmcnt(9)
  v_cmp_eq_u32 vcc, -1, v180
  v_mfma_f32_32x32x16_bf16 v[84:99], v[176:179], a[84:87], v[84:99]
  s_cbranch_vccnz L_tag_1128192_r
L_tag_1128192:
  buffer_load_dwordx4 v[176:179], v231, s[28:31], s66 offen offset:1024 sc1
  s_add_u32 s52, s62, 0
  buffer_store_dwordx4 v[24:27], v232, s[28:31], s52 offen sc1
  s_cmp_lg_u32 s77, 0
  s_cbranch_scc1 L_sig_1060181
  s_cmp_eq_u32 s95, 0
  s_cbranch_scc1 L_sig_1060181
  s_mov_b32 exec_lo, s95
  s_mov_b32 exec_hi, 0
  buffer_atomic_add v251, v225, s[28:31], 0 offen offset:24 sc1
  s_mov_b64 exec, -1
L_sig_1060181:
  v_mfma_f32_32x32x16_bf16 v[68:83], v[180:183], a[88:91], v[68:83]
  v_lshlrev_b32 v8, 16, v24
  v_and_b32 v9, 0xffff0000, v24
  v_lshlrev_b32 v10, 16, v25
  v_and_b32 v11, 0xffff0000, v25
  s_waitcnt vmcnt(10)
  v_cmp_eq_u32 vcc, -1, v184
  v_mfma_f32_32x32x16_bf16 v[84:99], v[180:183], a[92:95], v[84:99]
  s_cbranch_vccnz L_tag_1130193_r
L_tag_1130193:
  buffer_load_dwordx4 v[180:183], v231, s[28:31], s66 offen offset:2048 sc1
  s_mov_b64 exec, 1
  v_mov_b32 v233, 0
  buffer_atomic_add v233, v210, s[28:31], 0 offen offset:16 sc0 sc1
  s_mov_b64 exec, -1
  v_lshlrev_b32 v12, 16, v26
  v_and_b32 v13, 0xffff0000, v26
  v_lshlrev_b32 v14, 16, v27
  v_and_b32 v15, 0xffff0000, v27
  v_mfma_f32_32x32x16_bf16 v[68:83], v[184:187], a[96:99], v[68:83]
  v_mov_b32 v16, v8
  v_mov_b32 v17, v9
  v_mul_f32 v18, v8, v8
  v_mul_f32 v19, v9, v9
  s_waitcnt vmcnt(11)
  v_cmp_eq_u32 vcc, -1, v108
  v_mfma_f32_32x32x16_bf16 v[84:99], v[184:187], a[100:103], v[84:99]
  s_cbranch_vccnz L_tag_1134194_r
L_tag_1134194:
  buffer_load_dwordx4 v[184:187], v231, s[28:31], s66 offen offset:3072 sc1
  v_add_f32 v16, v16, v10
  v_add_f32 v17, v17, v11
  v_fma_f32 v18, v10, v10, v18
  v_fma_f32 v19, v11, v11, v19
  v_mfma_f32_32x32x16_bf16 v[68:83], v[108:111], a[104:107], v[68:83]
  v_add_f32 v16, v16, v12
  v_add_f32 v17, v17, v13
  v_fma_f32 v18, v12, v12, v18
  v_fma_f32 v19, v13, v13, v19
  s_waitcnt vmcnt(11)
  v_cmp_eq_u32 vcc, -1, v112
  v_mfma_f32_32x32x16_bf16 v[84:99], v[108:111], a[108:111], v[84:99]
  s_cbranch_vccnz L_tag_1136195_r
L_tag_1136195:
  s_add_u32 s66, s58, 139264
  buffer_load_dwordx4 v[108:111], v231, s[28:31], s66 offen offset:0 sc1
  v_add_f32 v16, v16, v14
  v_add_f32 v17, v17, v15
  v_fma_f32 v18, v14, v14, v18
  v_fma_f32 v19, v15, v15, v19
  v_mfma_f32_32x32x16_bf16 v[68:83], v[112:115], a[112:115], v[68:83]
  s_waitcnt vmcnt(11)
  v_cmp_eq_u32 vcc, -1, v116
  v_mfma_f32_32x32x16_bf16 v[84:99], v[112:115], a[116:119], v[84:99]
  s_cbranch_vccnz L_tag_1138196_r
L_tag_1138196:
  buffer_load_dwordx4 v[112:115], v231, s[28:31], s66 offen offset:1024 sc1
  s_add_u32 s52, s63, 4195328
  buffer_load_dwordx4 v[104:107], v227, s[28:31], s52 offen sc1
  v_mfma_f32_32x32x16_bf16 v[68:83], v[116:119], a[120:123], v[68:83]
  s_waitcnt vmcnt(12)
  v_cmp_eq_u32 vcc, -1, v156
  v_mfma_f32_32x32x16_bf16 v[84:99], v[116:119], a[124:127], v[84:99]
  s_cbranch_vccnz L_tag_1140197_r
L_tag_1140197:
  buffer_load_dwordx4 v[116:119], v231, s[28:31], s66 offen offset:2048 sc1
  v_mfma_f32_32x32x16_bf16 v[68:83], v[156:159], a[128:131], v[68:83]
  s_waitcnt vmcnt(12)
  v_cmp_eq_u32 vcc, -1, v160
  v_mfma_f32_32x32x16_bf16 v[84:99], v[156:159], a[132:135], v[84:99]
  s_cbranch_vccnz L_tag_1142198_r
L_tag_1142198:
  buffer_load_dwordx4 v[156:159], v231, s[28:31], s66 offen offset:3072 sc1
  v_mfma_f32_32x32x16_bf16 v[68:83], v[160:163], a[136:139], v[68:83]
  s_waitcnt vmcnt(12)
  v_cmp_eq_u32 vcc, -1, v164
  v_mfma_f32_32x32x16_bf16 v[84:99], v[160:163], a[140:143], v[84:99]
  s_cbranch_vccnz L_tag_1144199_r
L_tag_1144199:
  v_mfma_f32_32x32x16_bf16 v[68:83], v[164:167], a[144:147], v[68:83]
  s_waitcnt vmcnt(11)
  v_cmp_eq_u32 vcc, -1, v168
  v_mfma_f32_32x32x16_bf16 v[84:99], v[164:167], a[148:151], v[84:99]
  s_cbranch_vccnz L_tag_1146200_r
L_tag_1146200:
  v_mfma_f32_32x32x16_bf16 v[68:83], v[168:171], a[152:155], v[68:83]
  s_waitcnt vmcnt(10)
  v_cmp_eq_u32 vcc, -1, v172
  v_mfma_f32_32x32x16_bf16 v[84:99], v[168:171], a[156:159], v[84:99]
  s_cbranch_vccnz L_tag_1148201_r
L_tag_1148201:
  s_add_u32 s66, s58, 229376
  s_waitcnt vmcnt(6)
  v_readfirstlane_b32 s3, v233
  s_cmp_lt_u32 s3, 7
  s_cbranch_scc1 L_poll_1148202_r
L_poll_1148202:
  buffer_load_dwordx4 v[160:163], v231, s[28:31], s66 offen offset:0 sc1
  buffer_load_dwordx4 v[164:167], v231, s[28:31], s66 offen offset:1024 sc1
  buffer_load_dwordx4 v[168:171], v231, s[28:31], s66 offen offset:2048 sc1
  v_mfma_f32_32x32x16_bf16 v[68:83], v[172:175], a[160:163], v[68:83]
  v_cmp_eq_u32 vcc, -1, v176
  v_mfma_f32_32x32x16_bf16 v[84:99], v[172:175], a[164:167], v[84:99]
  s_cbranch_vccnz L_tag_1152203_r
L_tag_1152203:
  buffer_load_dwordx4 v[172:175], v231, s[28:31], s66 offen offset:3072 sc1
  v_mfma_f32_32x32x16_bf16 v[68:83], v[176:179], a[168:171], v[68:83]
  v_cmp_eq_u32 vcc, -1, v180
  v_mfma_f32_32x32x16_bf16 v[84:99], v[176:179], a[172:175], v[84:99]
  s_cbranch_vccnz L_tag_1154204_r
L_tag_1154204:
  s_add_u32 s66, s58, 233472
  buffer_load_dwordx4 v[176:179], v231, s[28:31], s66 offen offset:0 sc1
  v_mfma_f32_32x32x16_bf16 v[68:83], v[180:183], a[176:179], v[68:83]
  s_waitcnt vmcnt(10)
  v_cmp_eq_u32 vcc, -1, v184
  v_mfma_f32_32x32x16_bf16 v[84:99], v[180:183], a[180:183], v[84:99]
  s_cbranch_vccnz L_tag_1156205_r
L_tag_1156205:
  buffer_load_dwordx4 v[180:183], v231, s[28:31], s66 offen offset:1024 sc1
  v_mfma_f32_32x32x16_bf16 v[68:83], v[184:187], a[184:187], v[68:83]
  s_waitcnt vmcnt(10)
  v_cmp_eq_u32 vcc, -1, v108
  v_mfma_f32_32x32x16_bf16 v[84:99], v[184:187], a[188:191], v[84:99]
  s_cbranch_vccnz L_tag_1158206_r
L_tag_1158206:
  buffer_load_dwordx4 v[184:187], v231, s[28:31], s66 offen offset:2048 sc1
  v_mfma_f32_32x32x16_bf16 v[68:83], v[108:111], a[192:195], v[68:83]
  s_waitcnt vmcnt(10)
  v_cmp_eq_u32 vcc, -1, v112
  v_mfma_f32_32x32x16_bf16 v[84:99], v[108:111], a[196:199], v[84:99]
  s_cbranch_vccnz L_tag_1160207_r
L_tag_1160207:
  buffer_load_dwordx4 v[108:111], v231, s[28:31], s66 offen offset:3072 sc1
  v_mfma_f32_32x32x16_bf16 v[68:83], v[112:115], a[200:203], v[68:83]
  s_waitcnt vmcnt(9)
  v_cmp_eq_u32 vcc, -1, v116
  v_mfma_f32_32x32x16_bf16 v[84:99], v[112:115], a[204:207], v[84:99]
  s_cbranch_vccnz L_tag_1162208_r
L_tag_1162208:
  s_add_u32 s66, s58, 237568
  buffer_load_dwordx4 v[112:115], v231, s[28:31], s66 offen offset:0 sc1
  v_mfma_f32_32x32x16_bf16 v[68:83], v[116:119], a[208:211], v[68:83]
  s_waitcnt vmcnt(9)
  v_cmp_eq_u32 vcc, -1, v156
  v_mfma_f32_32x32x16_bf16 v[84:99], v[116:119], a[212:215], v[84:99]
  s_cbranch_vccnz L_tag_1164209_r
L_tag_1164209:
  buffer_load_dwordx4 v[116:119], v231, s[28:31], s66 offen offset:1024 sc1
  v_mfma_f32_32x32x16_bf16 v[68:83], v[156:159], a[216:219], v[68:83]
  s_waitcnt vmcnt(9)
  v_cmp_eq_u32 vcc, -1, v160
  v_mfma_f32_32x32x16_bf16 v[84:99], v[156:159], a[220:223], v[84:99]
  s_cbranch_vccnz L_tag_1166210_r
L_tag_1166210:
  buffer_load_dwordx4 v[156:159], v231, s[28:31], s66 offen offset:2048 sc1
  v_mfma_f32_32x32x16_bf16 v[36:51], v[160:163], a[0:3], 0
  s_nop 5
  ds_write_b128 v253, v[76:79] offset:0
  s_waitcnt vmcnt(9)
  v_cmp_eq_u32 vcc, -1, v164
  v_mfma_f32_32x32x16_bf16 v[52:67], v[160:163], a[4:7], 0
  s_cbranch_vccnz L_tag_1338212_r
L_tag_1338212:
  buffer_load_dwordx4 v[160:163], v231, s[28:31], s66 offen offset:3072 sc1
  ds_write_b128 v253, v[80:83] offset:1024
  v_mfma_f32_32x32x16_bf16 v[36:51], v[164:167], a[8:11], v[36:51]
  ds_write_b128 v254, v[84:87] offset:0
  s_waitcnt vmcnt(9)
  v_cmp_eq_u32 vcc, -1, v168
  v_mfma_f32_32x32x16_bf16 v[52:67], v[164:167], a[12:15], v[52:67]
  s_cbranch_vccnz L_tag_1340213_r
L_tag_1340213:
  s_add_u32 s66, s58, 241664
  buffer_load_dwordx4 v[164:167], v231, s[28:31], s66 offen offset:0 sc1
  ds_write_b128 v254, v[88:91] offset:1024
  v_mfma_f32_32x32x16_bf16 v[36:51], v[168:171], a[16:19], v[36:51]
  ds_write_b128 v255, v[92:95] offset:0
  s_waitcnt vmcnt(9)
  v_cmp_eq_u32 vcc, -1, v172
  v_mfma_f32_32x32x16_bf16 v[52:67], v[168:171], a[20:23], v[52:67]
  s_cbranch_vccnz L_tag_1342214_r
L_tag_1342214:
  buffer_load_dwordx4 v[168:171], v231, s[28:31], s66 offen offset:1024 sc1
  ds_write_b128 v255, v[96:99] offset:1024
  v_mfma_f32_32x32x16_bf16 v[36:51], v[172:175], a[24:27], v[36:51]
  v_lshlrev_b32 v8, 16, v104
  v_and_b32 v9, 0xffff0000, v104
  v_lshlrev_b32 v10, 16, v105
  v_and_b32 v11, 0xffff0000, v105
  s_waitcnt vmcnt(9)
  v_cmp_eq_u32 vcc, -1, v176
  v_mfma_f32_32x32x16_bf16 v[52:67], v[172:175], a[28:31], v[52:67]
  s_cbranch_vccnz L_tag_1344215_r
L_tag_1344215:
  buffer_load_dwordx4 v[172:175], v231, s[28:31], s66 offen offset:2048 sc1
  v_lshlrev_b32 v12, 16, v106
  v_and_b32 v13, 0xffff0000, v106
  v_lshlrev_b32 v14, 16, v107
  v_and_b32 v15, 0xffff0000, v107
  v_mfma_f32_32x32x16_bf16 v[36:51], v[176:179], a[32:35], v[36:51]
  v_add_f32 v8, v8, v32
  v_add_f32 v9, v9, v32
  v_add_f32 v10, v10, v32
  v_add_f32 v11, v11, v32
  s_waitcnt vmcnt(9)
  v_cmp_eq_u32 vcc, -1, v180
  v_mfma_f32_32x32x16_bf16 v[52:67], v[176:179], a[36:39], v[52:67]
  s_cbranch_vccnz L_tag_1346216_r
L_tag_1346216:
  buffer_load_dwordx4 v[176:179], v231, s[28:31], s66 offen offset:3072 sc1
  v_add_f32 v12, v12, v32
  v_add_f32 v13, v13, v32
  v_add_f32 v14, v14, v32
  v_add_f32 v15, v15, v32
  v_mfma_f32_32x32x16_bf16 v[36:51], v[180:183], a[40:43], v[36:51]
  v_add_f32 v68, v68, v8
  v_add_f32 v69, v69, v9
  v_add_f32 v70, v70, v10
  v_add_f32 v71, v71, v11
  s_waitcnt vmcnt(9)
  v_cmp_eq_u32 vcc, -1, v184
  v_mfma_f32_32x32x16_bf16 v[52:67], v[180:183], a[44:47], v[52:67]
  s_cbranch_vccnz L_tag_1348217_r
L_tag_1348217:
  s_add_u32 s66, s58, 245760
  buffer_load_dwordx4 v[180:183], v231, s[28:31], s66 offen offset:0 sc1
  v_add_f32 v72, v72, v12
  v_add_f32 v73, v73, v13
  v_add_f32 v74, v74, v14
  v_add_f32 v75, v75, v15
  v_mfma_f32_32x32x16_bf16 v[36:51], v[184:187], a[48:51], v[36:51]
  s_waitcnt lgkmcnt(0)
  s_barrier
  ds_read_b128 v[132:135], v230 offset:0
  ds_read_b128 v[136:139], v230 offset:1024
  ds_read_b128 v[140:143], v230 offset:2048
  ds_read_b128 v[144:147], v230 offset:3072
  ds_read_b128 v[148:151], v230 offset:4096
  ds_read_b128 v[152:155], v230 offset:5120
  s_waitcnt vmcnt(9)
  v_cmp_eq_u32 vcc, -1, v108
  v_mfma_f32_32x32x16_bf16 v[52:67], v[184:187], a[52:55], v[52:67]
  s_cbranch_vccnz L_tag_1350218_r
L_tag_1350218:
  buffer_load_dwordx4 v[184:187], v231, s[28:31], s66 offen offset:1024 sc1
  v_mfma_f32_32x32x16_bf16 v[36:51], v[108:111], a[56:59], v[36:51]
  s_waitcnt lgkmcnt(5)
  v_add_f32 v68, v68, v132
  v_add_f32 v69, v69, v133
  v_add_f32 v70, v70, v134
  v_add_f32 v71, v71, v135
  s_waitcnt vmcnt(9)
  v_cmp_eq_u32 vcc, -1, v112
  v_mfma_f32_32x32x16_bf16 v[52:67], v[108:111], a[60:63], v[52:67]
  s_cbranch_vccnz L_tag_1352219_r
L_tag_1352219:
  buffer_load_dwordx4 v[108:111], v231, s[28:31], s66 offen offset:2048 sc1
  s_waitcnt lgkmcnt(4)
  v_add_f32 v72, v72, v136
  v_add_f32 v73, v73, v137
  v_add_f32 v74, v74, v138
  v_add_f32 v75, v75, v139
  v_mfma_f32_32x32x16_bf16 v[36:51], v[112:115], a[64:67], v[36:51]
  s_waitcnt lgkmcnt(3)
  v_add_f32 v68, v68, v140
  v_add_f32 v69, v69, v141
  v_add_f32 v70, v70, v142
  v_add_f32 v71, v71, v143
  s_waitcnt vmcnt(9)
  v_cmp_eq_u32 vcc, -1, v116
  v_mfma_f32_32x32x16_bf16 v[52:67], v[112:115], a[68:71], v[52:67]
  s_cbranch_vccnz L_tag_1354220_r
L_tag_1354220:
  buffer_load_dwordx4 v[112:115], v231, s[28:31], s66 offen offset:3072 sc1
  s_waitcnt lgkmcnt(2)
  v_add_f32 v72, v72, v144
  v_add_f32 v73, v73, v145
  v_add_f32 v74, v74, v146
  v_add_f32 v75, v75, v147
  v_mfma_f32_32x32x16_bf16 v[36:51], v[116:119], a[72:75], v[36:51]
  s_waitcnt lgkmcnt(1)
  v_add_f32 v68, v68, v148
  v_add_f32 v69, v69, v149
  v_add_f32 v70, v70, v150
  v_add_f32 v71, v71, v151
  s_waitcnt vmcnt(9)
  v_cmp_eq_u32 vcc, -1, v156
  v_mfma_f32_32x32x16_bf16 v[52:67], v[116:119], a[76:79], v[52:67]
  s_cbranch_vccnz L_tag_1356221_r
L_tag_1356221:
  s_add_u32 s66, s58, 249856
  buffer_load_dwordx4 v[116:119], v231, s[28:31], s66 offen offset:0 sc1
  s_mov_b64 exec, 1
  v_mov_b32 v233, 0
  buffer_atomic_add v233, v210, s[28:31], 0 offen offset:20 sc0 sc1
  s_mov_b64 exec, -1
  s_waitcnt lgkmcnt(0)
  v_add_f32 v72, v72, v152
  v_add_f32 v73, v73, v153
  v_add_f32 v74, v74, v154
  v_add_f32 v75, v75, v155
  v_mfma_f32_32x32x16_bf16 v[36:51], v[156:159], a[80:83], v[36:51]
  v_cvt_pk_bf16_f32 v24, v68, v69
  v_cvt_pk_bf16_f32 v25, v70, v71
  v_cvt_pk_bf16_f32 v26, v72, v73
  v_cvt_pk_bf16_f32 v27, v74, v75
  s_waitcnt vmcnt(10)
  v_cmp_eq_u32 vcc, -1, v160
  v_mfma_f32_32x32x16_bf16 v[52:67], v[156:159], a[84:87], v[52:67]
  s_cbranch_vccnz L_tag_1360222_r
L_tag_1360222:
  buffer_load_dwordx4 v[156:159], v231, s[28:31], s66 offen offset:1024 sc1
  s_add_u32 s52, s62, 1024
  buffer_store_dwordx4 v[24:27], v232, s[28:31], s52 offen sc1
  s_cmp_lg_u32 s77, 0
  s_cbranch_scc1 L_sig_1288211
  s_cmp_eq_u32 s95, 0
  s_cbranch_scc1 L_sig_1288211
  s_mov_b32 exec_lo, s95
  s_mov_b32 exec_hi, 0
  buffer_atomic_add v251, v225, s[28:31], 0 offen offset:28 sc1
  s_mov_b64 exec, -1
L_sig_1288211:
  v_mfma_f32_32x32x16_bf16 v[36:51], v[160:163], a[88:91], v[36:51]
  v_lshlrev_b32 v8, 16, v24
  v_and_b32 v9, 0xffff0000, v24
  v_lshlrev_b32 v10, 16, v25
  v_and_b32 v11, 0xffff0000, v25
  s_waitcnt vmcnt(11)
  v_cmp_eq_u32 vcc, -1, v164
  v_mfma_f32_32x32x16_bf16 v[52:67], v[160:163], a[92:95], v[52:67]
  s_cbranch_vccnz L_tag_1362223_r
L_tag_1362223:
  buffer_load_dwordx4 v[160:163], v231, s[28:31], s66 offen offset:2048 sc1
  v_lshlrev_b32 v12, 16, v26
  v_and_b32 v13, 0xffff0000, v26
  v_lshlrev_b32 v14, 16, v27
  v_and_b32 v15, 0xffff0000, v27
  v_mfma_f32_32x32x16_bf16 v[36:51], v[164:167], a[96:99], v[36:51]
  v_add_f32 v16, v16, v8
  v_add_f32 v17, v17, v9
  v_fma_f32 v18, v8, v8, v18
  v_fma_f32 v19, v9, v9, v19
  s_waitcnt vmcnt(11)
  v_cmp_eq_u32 vcc, -1, v168
  v_mfma_f32_32x32x16_bf16 v[52:67], v[164:167], a[100:103], v[52:67]
  s_cbranch_vccnz L_tag_1364224_r
L_tag_1364224:
  buffer_load_dwordx4 v[164:167], v231, s[28:31], s66 offen offset:3072 sc1
  v_add_f32 v16, v16, v10
  v_add_f32 v17, v17, v11
  v_fma_f32 v18, v10, v10, v18
  v_fma_f32 v19, v11, v11, v19
  v_mfma_f32_32x32x16_bf16 v[36:51], v[168:171], a[104:107], v[36:51]
  v_add_f32 v16, v16, v12
  v_add_f32 v17, v17, v13
  v_fma_f32 v18, v12, v12, v18
  v_fma_f32 v19, v13, v13, v19
  s_waitcnt vmcnt(11)
  v_cmp_eq_u32 vcc, -1, v172
  v_mfma_f32_32x32x16_bf16 v[52:67], v[168:171], a[108:111], v[52:67]
  s_cbranch_vccnz L_tag_1366225_r
L_tag_1366225:
  s_add_u32 s66, s58, 253952
  buffer_load_dwordx4 v[168:171], v231, s[28:31], s66 offen offset:0 sc1
  v_add_f32 v16, v16, v14
  v_add_f32 v17, v17, v15
  v_fma_f32 v18, v14, v14, v18
  v_fma_f32 v19, v15, v15, v19
  v_mfma_f32_32x32x16_bf16 v[36:51], v[172:175], a[112:115], v[36:51]
  s_waitcnt vmcnt(11)
  v_cmp_eq_u32 vcc, -1, v176
  v_mfma_f32_32x32x16_bf16 v[52:67], v[172:175], a[116:119], v[52:67]
  s_cbranch_vccnz L_tag_1368226_r
L_tag_1368226:
  buffer_load_dwordx4 v[172:175], v231, s[28:31], s66 offen offset:1024 sc1
  s_add_u32 s52, s63, 4196352
  buffer_load_dwordx4 v[100:103], v227, s[28:31], s52 offen sc1
  v_mfma_f32_32x32x16_bf16 v[36:51], v[176:179], a[120:123], v[36:51]
  s_waitcnt vmcnt(12)
  v_cmp_eq_u32 vcc, -1, v180
  v_mfma_f32_32x32x16_bf16 v[52:67], v[176:179], a[124:127], v[52:67]
  s_cbranch_vccnz L_tag_1370227_r
L_tag_1370227:
  buffer_load_dwordx4 v[176:179], v231, s[28:31], s66 offen offset:2048 sc1
  v_mfma_f32_32x32x16_bf16 v[36:51], v[180:183], a[128:131], v[36:51]
  s_waitcnt vmcnt(12)
  v_cmp_eq_u32 vcc, -1, v184
  v_mfma_f32_32x32x16_bf16 v[52:67], v[180:183], a[132:135], v[52:67]
  s_cbranch_vccnz L_tag_1372228_r
L_tag_1372228:
  buffer_load_dwordx4 v[180:183], v231, s[28:31], s66 offen offset:3072 sc1
  v_mfma_f32_32x32x16_bf16 v[36:51], v[184:187], a[136:139], v[36:51]
  s_waitcnt vmcnt(12)
  v_cmp_eq_u32 vcc, -1, v108
  v_mfma_f32_32x32x16_bf16 v[52:67], v[184:187], a[140:143], v[52:67]
  s_cbranch_vccnz L_tag_1374229_r
L_tag_1374229:
  s_add_u32 s66, s58, 344064
  s_waitcnt vmcnt(9)
  v_readfirstlane_b32 s3, v233
  s_cmp_lt_u32 s3, 7
  s_cbranch_scc1 L_poll_1374230_r
L_poll_1374230:
  buffer_load_dwordx4 v[184:187], v231, s[28:31], s66 offen offset:0 sc1
  v_mfma_f32_32x32x16_bf16 v[36:51], v[108:111], a[144:147], v[36:51]
  v_cmp_eq_u32 vcc, -1, v112
  v_mfma_f32_32x32x16_bf16 v[52:67], v[108:111], a[148:151], v[52:67]
  s_cbranch_vccnz L_tag_1378231_r
L_tag_1378231:
  buffer_load_dwordx4 v[108:111], v231, s[28:31], s66 offen offset:1024 sc1
  v_mfma_f32_32x32x16_bf16 v[36:51], v[112:115], a[152:155], v[36:51]
  v_cmp_eq_u32 vcc, -1, v116
  v_mfma_f32_32x32x16_bf16 v[52:67], v[112:115], a[156:159], v[52:67]
  s_cbranch_vccnz L_tag_1380232_r
L_tag_1380232:
  buffer_load_dwordx4 v[112:115], v231, s[28:31], s66 offen offset:2048 sc1
  v_mfma_f32_32x32x16_bf16 v[36:51], v[116:119], a[160:163], v[36:51]
  s_waitcnt vmcnt(11)
  v_cmp_eq_u32 vcc, -1, v156
  v_mfma_f32_32x32x16_bf16 v[52:67], v[116:119], a[164:167], v[52:67]
  s_cbranch_vccnz L_tag_1382233_r
L_tag_1382233:
  buffer_load_dwordx4 v[116:119], v231, s[28:31], s66 offen offset:3072 sc1
  v_mfma_f32_32x32x16_bf16 v[36:51], v[156:159], a[168:171], v[36:51]
  s_waitcnt vmcnt(10)
  v_cmp_eq_u32 vcc, -1, v160
  v_mfma_f32_32x32x16_bf16 v[52:67], v[156:159], a[172:175], v[52:67]
  s_cbranch_vccnz L_tag_1384234_r
L_tag_1384234:
  s_add_u32 s66, s58, 348160
  buffer_load_dwordx4 v[156:159], v231, s[28:31], s66 offen offset:0 sc1
  v_mfma_f32_32x32x16_bf16 v[36:51], v[160:163], a[176:179], v[36:51]
  s_waitcnt vmcnt(10)
  v_cmp_eq_u32 vcc, -1, v164
  v_mfma_f32_32x32x16_bf16 v[52:67], v[160:163], a[180:183], v[52:67]
  s_cbranch_vccnz L_tag_1386235_r
L_tag_1386235:
  buffer_load_dwordx4 v[160:163], v231, s[28:31], s66 offen offset:1024 sc1
  v_mfma_f32_32x32x16_bf16 v[36:51], v[164:167], a[184:187], v[36:51]
  s_waitcnt vmcnt(10)
  v_cmp_eq_u32 vcc, -1, v168
  v_mfma_f32_32x32x16_bf16 v[52:67], v[164:167], a[188:191], v[52:67]
  s_cbranch_vccnz L_tag_1388236_r
L_tag_1388236:
  buffer_load_dwordx4 v[164:167], v231, s[28:31], s66 offen offset:2048 sc1
  v_mfma_f32_32x32x16_bf16 v[36:51], v[168:171], a[192:195], v[36:51]
  s_waitcnt vmcnt(10)
  v_cmp_eq_u32 vcc, -1, v172
  v_mfma_f32_32x32x16_bf16 v[52:67], v[168:171], a[196:199], v[52:67]
  s_cbranch_vccnz L_tag_1390237_r
L_tag_1390237:
  buffer_load_dwordx4 v[168:171], v231, s[28:31], s66 offen offset:3072 sc1
  v_mfma_f32_32x32x16_bf16 v[36:51], v[172:175], a[200:203], v[36:51]
  s_waitcnt vmcnt(9)
  v_cmp_eq_u32 vcc, -1, v176
  v_mfma_f32_32x32x16_bf16 v[52:67], v[172:175], a[204:207], v[52:67]
  s_cbranch_vccnz L_tag_1392238_r
L_tag_1392238:
  s_add_u32 s66, s58, 352256
  buffer_load_dwordx4 v[172:175], v231, s[28:31], s66 offen offset:0 sc1
  v_mfma_f32_32x32x16_bf16 v[36:51], v[176:179], a[208:211], v[36:51]
  s_waitcnt vmcnt(9)
  v_cmp_eq_u32 vcc, -1, v180
  v_mfma_f32_32x32x16_bf16 v[52:67], v[176:179], a[212:215], v[52:67]
  s_cbranch_vccnz L_tag_1394239_r
L_tag_1394239:
  buffer_load_dwordx4 v[176:179], v231, s[28:31], s66 offen offset:1024 sc1
  v_mfma_f32_32x32x16_bf16 v[36:51], v[180:183], a[216:219], v[36:51]
  s_waitcnt vmcnt(9)
  v_cmp_eq_u32 vcc, -1, v184
  v_mfma_f32_32x32x16_bf16 v[52:67], v[180:183], a[220:223], v[52:67]
  s_cbranch_vccnz L_tag_1396240_r
L_tag_1396240:
  buffer_load_dwordx4 v[180:183], v231, s[28:31], s66 offen offset:2048 sc1
  v_mfma_f32_32x32x16_bf16 v[68:83], v[184:187], a[0:3], 0
  s_nop 5
  ds_write_b128 v253, v[44:47] offset:0
  s_waitcnt vmcnt(9)
  v_cmp_eq_u32 vcc, -1, v108
  v_mfma_f32_32x32x16_bf16 v[84:99], v[184:187], a[4:7], 0
  s_cbranch_vccnz L_tag_1568242_r
L_tag_1568242:
  buffer_load_dwordx4 v[184:187], v231, s[28:31], s66 offen offset:3072 sc1
  ds_write_b128 v253, v[48:51] offset:1024
  v_mfma_f32_32x32x16_bf16 v[68:83], v[108:111], a[8:11], v[68:83]
  ds_write_b128 v254, v[52:55] offset:0
  s_waitcnt vmcnt(9)
  v_cmp_eq_u32 vcc, -1, v112
  v_mfma_f32_32x32x16_bf16 v[84:99], v[108:111], a[12:15], v[84:99]
  s_cbranch_vccnz L_tag_1570243_r
L_tag_1570243:
  s_add_u32 s66, s58, 356352
  buffer_load_dwordx4 v[108:111], v231, s[28:31], s66 offen offset:0 sc1
  ds_write_b128 v254, v[56:59] offset:1024
  v_mfma_f32_32x32x16_bf16 v[68:83], v[112:115], a[16:19], v[68:83]
  ds_write_b128 v255, v[60:63] offset:0
  s_waitcnt vmcnt(9)
  v_cmp_eq_u32 vcc, -1, v116
  v_mfma_f32_32x32x16_bf16 v[84:99], v[112:115], a[20:23], v[84:99]
  s_cbranch_vccnz L_tag_1572244_r
L_tag_1572244:
  buffer_load_dwordx4 v[112:115], v231, s[28:31], s66 offen offset:1024 sc1
  ds_write_b128 v255, v[64:67] offset:1024
  v_mfma_f32_32x32x16_bf16 v[68:83], v[116:119], a[24:27], v[68:83]
  v_lshlrev_b32 v8, 16, v100
  v_and_b32 v9, 0xffff0000, v100
  v_lshlrev_b32 v10, 16, v101
  v_and_b32 v11, 0xffff0000, v101
  s_waitcnt vmcnt(9)
  v_cmp_eq_u32 vcc, -1, v156
  v_mfma_f32_32x32x16_bf16 v[84:99], v[116:119], a[28:31], v[84:99]
  s_cbranch_vccnz L_tag_1574245_r
L_tag_1574245:
  buffer_load_dwordx4 v[116:119], v231, s[28:31], s66 offen offset:2048 sc1
  v_lshlrev_b32 v12, 16, v102
  v_and_b32 v13, 0xffff0000, v102
  v_lshlrev_b32 v14, 16, v103
  v_and_b32 v15, 0xffff0000, v103
  v_mfma_f32_32x32x16_bf16 v[68:83], v[156:159], a[32:35], v[68:83]
  v_add_f32 v8, v8, v32
  v_add_f32 v9, v9, v32
  v_add_f32 v10, v10, v32
  v_add_f32 v11, v11, v32
  s_waitcnt vmcnt(9)
  v_cmp_eq_u32 vcc, -1, v160
  v_mfma_f32_32x32x16_bf16 v[84:99], v[156:159], a[36:39], v[84:99]
  s_cbranch_vccnz L_tag_1576246_r
L_tag_1576246:
  buffer_load_dwordx4 v[156:159], v231, s[28:31], s66 offen offset:3072 sc1
  v_add_f32 v12, v12, v32
  v_add_f32 v13, v13, v32
  v_add_f32 v14, v14, v32
  v_add_f32 v15, v15, v32
  v_mfma_f32_32x32x16_bf16 v[68:83], v[160:163], a[40:43], v[68:83]
  v_add_f32 v36, v36, v8
  v_add_f32 v37, v37, v9
  v_add_f32 v38, v38, v10
  v_add_f32 v39, v39, v11
  s_waitcnt vmcnt(9)
  v_cmp_eq_u32 vcc, -1, v164
  v_mfma_f32_32x32x16_bf16 v[84:99], v[160:163], a[44:47], v[84:99]
  s_cbranch_vccnz L_tag_1578247_r
L_tag_1578247:
  s_add_u32 s66, s58, 360448
  buffer_load_dwordx4 v[160:163], v231, s[28:31], s66 offen offset:0 sc1
  v_add_f32 v40, v40, v12
  v_add_f32 v41, v41, v13
  v_add_f32 v42, v42, v14
  v_add_f32 v43, v43, v15
  v_mfma_f32_32x32x16_bf16 v[68:83], v[164:167], a[48:51], v[68:83]
  s_waitcnt lgkmcnt(0)
  s_barrier
  ds_read_b128 v[132:135], v230 offset:0
  ds_read_b128 v[136:139], v230 offset:1024
  ds_read_b128 v[140:143], v230 offset:2048
  ds_read_b128 v[144:147], v230 offset:3072
  ds_read_b128 v[148:151], v230 offset:4096
  ds_read_b128 v[152:155], v230 offset:5120
  s_waitcnt vmcnt(9)
  v_cmp_eq_u32 vcc, -1, v168
  v_mfma_f32_32x32x16_bf16 v[84:99], v[164:167], a[52:55], v[84:99]
  s_cbranch_vccnz L_tag_1580248_r
L_tag_1580248:
  buffer_load_dwordx4 v[164:167], v231, s[28:31], s66 offen offset:1024 sc1
  v_mfma_f32_32x32x16_bf16 v[68:83], v[168:171], a[56:59], v[68:83]
  s_waitcnt lgkmcnt(5)
  v_add_f32 v36, v36, v132
  v_add_f32 v37, v37, v133
  v_add_f32 v38, v38, v134
  v_add_f32 v39, v39, v135
  s_waitcnt vmcnt(9)
  v_cmp_eq_u32 vcc, -1, v172
  v_mfma_f32_32x32x16_bf16 v[84:99], v[168:171], a[60:63], v[84:99]
  s_cbranch_vccnz L_tag_1582249_r
L_tag_1582249:
  buffer_load_dwordx4 v[168:171], v231, s[28:31], s66 offen offset:2048 sc1
  s_waitcnt lgkmcnt(4)
  v_add_f32 v40, v40, v136
  v_add_f32 v41, v41, v137
  v_add_f32 v42, v42, v138
  v_add_f32 v43, v43, v139
  v_mfma_f32_32x32x16_bf16 v[68:83], v[172:175], a[64:67], v[68:83]
  s_waitcnt lgkmcnt(3)
  v_add_f32 v36, v36, v140
  v_add_f32 v37, v37, v141
  v_add_f32 v38, v38, v142
  v_add_f32 v39, v39, v143
  s_waitcnt vmcnt(9)
  v_cmp_eq_u32 vcc, -1, v176
  v_mfma_f32_32x32x16_bf16 v[84:99], v[172:175], a[68:71], v[84:99]
  s_cbranch_vccnz L_tag_1584250_r
L_tag_1584250:
  buffer_load_dwordx4 v[172:175], v231, s[28:31], s66 offen offset:3072 sc1
  s_mov_b64 exec, 1
  v_mov_b32 v233, 0
  buffer_atomic_add v233, v226, s[28:31], 0 offen offset:24 sc0 sc1
  s_mov_b64 exec, -1
  s_waitcnt lgkmcnt(2)
  v_add_f32 v40, v40, v144
  v_add_f32 v41, v41, v145
  v_add_f32 v42, v42, v146
  v_add_f32 v43, v43, v147
  v_mfma_f32_32x32x16_bf16 v[68:83], v[176:179], a[72:75], v[68:83]
  s_waitcnt lgkmcnt(1)
  v_add_f32 v36, v36, v148
  v_add_f32 v37, v37, v149
  v_add_f32 v38, v38, v150
  v_add_f32 v39, v39, v151
  s_waitcnt vmcnt(10)
  v_cmp_eq_u32 vcc, -1, v180
  v_mfma_f32_32x32x16_bf16 v[84:99], v[176:179], a[76:79], v[84:99]
  s_cbranch_vccnz L_tag_1588251_r
L_tag_1588251:
  s_add_u32 s66, s58, 364544
  buffer_load_dwordx4 v[176:179], v231, s[28:31], s66 offen offset:0 sc1
  s_waitcnt lgkmcnt(0)
  v_add_f32 v40, v40, v152
  v_add_f32 v41, v41, v153
  v_add_f32 v42, v42, v154
  v_add_f32 v43, v43, v155
  v_mfma_f32_32x32x16_bf16 v[68:83], v[180:183], a[80:83], v[68:83]
  v_cvt_pk_bf16_f32 v24, v36, v37
  v_cvt_pk_bf16_f32 v25, v38, v39
  v_cvt_pk_bf16_f32 v26, v40, v41
  v_cvt_pk_bf16_f32 v27, v42, v43
  s_waitcnt vmcnt(10)
  v_cmp_eq_u32 vcc, -1, v184
  v_mfma_f32_32x32x16_bf16 v[84:99], v[180:183], a[84:87], v[84:99]
  s_cbranch_vccnz L_tag_1590252_r
L_tag_1590252:
  buffer_load_dwordx4 v[180:183], v231, s[28:31], s66 offen offset:1024 sc1
  s_add_u32 s52, s62, 2048
  buffer_store_dwordx4 v[24:27], v232, s[28:31], s52 offen sc1
  s_cmp_lg_u32 s77, 0
  s_cbranch_scc1 L_sig_1518241
  s_cmp_eq_u32 s95, 0
  s_cbranch_scc1 L_sig_1518241
  s_mov_b32 exec_lo, s95
  s_mov_b32 exec_hi, 0
  buffer_atomic_add v251, v225, s[28:31], 0 offen offset:32 sc1
  s_mov_b64 exec, -1
L_sig_1518241:
  v_mfma_f32_32x32x16_bf16 v[68:83], v[184:187], a[88:91], v[68:83]
  v_lshlrev_b32 v8, 16, v24
  v_and_b32 v9, 0xffff0000, v24
  v_lshlrev_b32 v10, 16, v25
  v_and_b32 v11, 0xffff0000, v25
  s_waitcnt vmcnt(11)
  v_cmp_eq_u32 vcc, -1, v108
  v_mfma_f32_32x32x16_bf16 v[84:99], v[184:187], a[92:95], v[84:99]
  s_cbranch_vccnz L_tag_1592253_r
L_tag_1592253:
  buffer_load_dwordx4 v[184:187], v231, s[28:31], s66 offen offset:2048 sc1
  v_lshlrev_b32 v12, 16, v26
  v_and_b32 v13, 0xffff0000, v26
  v_lshlrev_b32 v14, 16, v27
  v_and_b32 v15, 0xffff0000, v27
  v_mfma_f32_32x32x16_bf16 v[68:83], v[108:111], a[96:99], v[68:83]
  v_add_f32 v16, v16, v8
  v_add_f32 v17, v17, v9
  v_fma_f32 v18, v8, v8, v18
  v_fma_f32 v19, v9, v9, v19
  s_waitcnt vmcnt(11)
  v_cmp_eq_u32 vcc, -1, v112
  v_mfma_f32_32x32x16_bf16 v[84:99], v[108:111], a[100:103], v[84:99]
  s_cbranch_vccnz L_tag_1594254_r
L_tag_1594254:
  buffer_load_dwordx4 v[108:111], v231, s[28:31], s66 offen offset:3072 sc1
  v_add_f32 v16, v16, v10
  v_add_f32 v17, v17, v11
  v_fma_f32 v18, v10, v10, v18
  v_fma_f32 v19, v11, v11, v19
  v_mfma_f32_32x32x16_bf16 v[68:83], v[112:115], a[104:107], v[68:83]
  v_add_f32 v16, v16, v12
  v_add_f32 v17, v17, v13
  v_fma_f32 v18, v12, v12, v18
  v_fma_f32 v19, v13, v13, v19
  s_waitcnt vmcnt(11)
  v_cmp_eq_u32 vcc, -1, v116
  v_mfma_f32_32x32x16_bf16 v[84:99], v[112:115], a[108:111], v[84:99]
  s_cbranch_vccnz L_tag_1596255_r
L_tag_1596255:
  s_add_u32 s66, s58, 368640
  buffer_load_dwordx4 v[112:115], v231, s[28:31], s66 offen offset:0 sc1
  v_add_f32 v16, v16, v14
  v_add_f32 v17, v17, v15
  v_fma_f32 v18, v14, v14, v18
  v_fma_f32 v19, v15, v15, v19
  v_mfma_f32_32x32x16_bf16 v[68:83], v[116:119], a[112:115], v[68:83]
  s_waitcnt vmcnt(11)
  v_cmp_eq_u32 vcc, -1, v156
  v_mfma_f32_32x32x16_bf16 v[84:99], v[116:119], a[116:119], v[84:99]
  s_cbranch_vccnz L_tag_1598256_r
L_tag_1598256:
  buffer_load_dwordx4 v[116:119], v231, s[28:31], s66 offen offset:1024 sc1
  s_add_u32 s52, s63, 4197376
  buffer_load_dwordx4 v[104:107], v227, s[28:31], s52 offen sc1
  v_mfma_f32_32x32x16_bf16 v[68:83], v[156:159], a[120:123], v[68:83]
  s_waitcnt vmcnt(12)
  v_cmp_eq_u32 vcc, -1, v160
  v_mfma_f32_32x32x16_bf16 v[84:99], v[156:159], a[124:127], v[84:99]
  s_cbranch_vccnz L_tag_1600257_r
L_tag_1600257:
  buffer_load_dwordx4 v[156:159], v231, s[28:31], s66 offen offset:2048 sc1
  v_mfma_f32_32x32x16_bf16 v[68:83], v[160:163], a[128:131], v[68:83]
  s_waitcnt vmcnt(12)
  v_cmp_eq_u32 vcc, -1, v164
  v_mfma_f32_32x32x16_bf16 v[84:99], v[160:163], a[132:135], v[84:99]
  s_cbranch_vccnz L_tag_1602258_r
L_tag_1602258:
  buffer_load_dwordx4 v[160:163], v231, s[28:31], s66 offen offset:3072 sc1
  v_mfma_f32_32x32x16_bf16 v[68:83], v[164:167], a[136:139], v[68:83]
  s_waitcnt vmcnt(12)
  v_cmp_eq_u32 vcc, -1, v168
  v_mfma_f32_32x32x16_bf16 v[84:99], v[164:167], a[140:143], v[84:99]
  s_cbranch_vccnz L_tag_1604259_r
L_tag_1604259:
  v_mfma_f32_32x32x16_bf16 v[68:83], v[168:171], a[144:147], v[68:83]
  s_waitcnt vmcnt(11)
  v_cmp_eq_u32 vcc, -1, v172
  v_mfma_f32_32x32x16_bf16 v[84:99], v[168:171], a[148:151], v[84:99]
  s_cbranch_vccnz L_tag_1606260_r
L_tag_1606260:
  s_waitcnt vmcnt(10)
  v_readfirstlane_b32 s3, v233
  s_cmp_lt_u32 s3, s97
  s_cbranch_scc1 L_poll_1606261_r
L_poll_1606261:
  s_add_u32 m0, s60, 24576
  s_add_u32 s94, s6, 10485760
  buffer_load_dwordx4 v213, s[28:31], s94 offen sc1 lds
  v_mfma_f32_32x32x16_bf16 v[68:83], v[172:175], a[152:155], v[68:83]
  s_waitcnt vmcnt(10)
  v_cmp_eq_u32 vcc, -1, v176
  v_mfma_f32_32x32x16_bf16 v[84:99], v[172:175], a[156:159], v[84:99]
  s_cbranch_vccnz L_tag_1610262_r
L_tag_1610262:
  s_mov_b64 exec, 1
  v_mov_b32 v233, 0
  buffer_atomic_add v233, v226, s[28:31], 0 offen offset:28 sc0 sc1
  s_mov_b64 exec, -1
  s_add_u32 m0, s60, 28672
  s_add_u32 s94, s7, 10485760
  buffer_load_dwordx4 v213, s[28:31], s94 offen sc1 lds
  v_mfma_f32_32x32x16_bf16 v[68:83], v[176:179], a[160:163], v[68:83]
  s_waitcnt vmcnt(11)
  v_cmp_eq_u32 vcc, -1, v180
  v_mfma_f32_32x32x16_bf16 v[84:99], v[176:179], a[164:167], v[84:99]
  s_cbranch_vccnz L_tag_1614263_r
L_tag_1614263:
  s_add_u32 m0, s60, 32768
  s_add_u32 s94, s7, 10502144
  buffer_load_dwordx4 v213, s[28:31], s94 offen sc1 lds
  v_mfma_f32_32x32x16_bf16 v[68:83], v[180:183], a[168:171], v[68:83]
  s_waitcnt vmcnt(10)
  v_cmp_eq_u32 vcc, -1, v184
  v_mfma_f32_32x32x16_bf16 v[84:99], v[180:183], a[172:175], v[84:99]
  s_cbranch_vccnz L_tag_1616264_r
L_tag_1616264:
  s_add_u32 m0, s60, 36864
  s_add_u32 s94, s7, 10518528
  buffer_load_dwordx4 v213, s[28:31], s94 offen sc1 lds
  v_mfma_f32_32x32x16_bf16 v[68:83], v[184:187], a[176:179], v[68:83]
  s_waitcnt vmcnt(10)
  v_cmp_eq_u32 vcc, -1, v108
  v_mfma_f32_32x32x16_bf16 v[84:99], v[184:187], a[180:183], v[84:99]
  s_cbranch_vccnz L_tag_1618265_r
L_tag_1618265:
  s_add_u32 m0, s60, 40960
  s_add_u32 s94, s7, 10534912
  buffer_load_dwordx4 v213, s[28:31], s94 offen sc1 lds
  v_mfma_f32_32x32x16_bf16 v[68:83], v[108:111], a[184:187], v[68:83]
  s_waitcnt vmcnt(10)
  v_cmp_eq_u32 vcc, -1, v112
  v_mfma_f32_32x32x16_bf16 v[84:99], v[108:111], a[188:191], v[84:99]
  s_cbranch_vccnz L_tag_1620266_r
L_tag_1620266:
  s_waitcnt vmcnt(4)
  v_readfirstlane_b32 s3, v233
  s_cmp_lt_u32 s3, s97
  s_cbranch_scc1 L_poll_1620267_r
L_poll_1620267:
  s_add_u32 m0, s60, 45056
  s_add_u32 s94, s6, 10486784
  buffer_load_dwordx4 v213, s[28:31], s94 offen sc1 lds
  v_mfma_f32_32x32x16_bf16 v[68:83], v[112:115], a[192:195], v[68:83]
  v_cmp_eq_u32 vcc, -1, v116
  v_mfma_f32_32x32x16_bf16 v[84:99], v[112:115], a[196:199], v[84:99]
  s_cbranch_vccnz L_tag_1624268_r
L_tag_1624268:
  s_add_u32 m0, s60, 49152
  s_add_u32 s94, s7, 10486784
  buffer_load_dwordx4 v213, s[28:31], s94 offen sc1 lds
  v_mfma_f32_32x32x16_bf16 v[68:83], v[116:119], a[200:203], v[68:83]
  v_cmp_eq_u32 vcc, -1, v156
  v_mfma_f32_32x32x16_bf16 v[84:99], v[116:119], a[204:207], v[84:99]
  s_cbranch_vccnz L_tag_1626269_r
L_tag_1626269:
  s_add_u32 m0, s60, 53248
  s_add_u32 s94, s7, 10503168
  buffer_load_dwordx4 v213, s[28:31], s94 offen sc1 lds
  v_mfma_f32_32x32x16_bf16 v[68:83], v[156:159], a[208:211], v[68:83]
  v_cmp_eq_u32 vcc, -1, v160
  v_mfma_f32_32x32x16_bf16 v[84:99], v[156:159], a[212:215], v[84:99]
  s_cbranch_vccnz L_tag_1628270_r
L_tag_1628270:
  s_add_u32 m0, s60, 57344
  s_add_u32 s94, s7, 10519552
  buffer_load_dwordx4 v213, s[28:31], s94 offen sc1 lds
  v_mfma_f32_32x32x16_bf16 v[68:83], v[160:163], a[216:219], v[68:83]
  v_mfma_f32_32x32x16_bf16 v[84:99], v[160:163], a[220:223], v[84:99]
  s_add_u32 m0, s60, 61440
  s_add_u32 s94, s7, 10535936
  buffer_load_dwordx4 v213, s[28:31], s94 offen sc1 lds
  s_nop 7
  ds_write_b128 v253, v[76:79] offset:0
  ds_write_b128 v253, v[80:83] offset:1024
  ds_write_b128 v254, v[84:87] offset:0
  ds_write_b128 v254, v[88:91] offset:1024
  ds_write_b128 v255, v[92:95] offset:0
  ds_write_b128 v255, v[96:99] offset:1024
  v_lshlrev_b32 v8, 16, v104
  v_and_b32 v9, 0xffff0000, v104
  v_lshlrev_b32 v10, 16, v105
  v_and_b32 v11, 0xffff0000, v105
  v_lshlrev_b32 v12, 16, v106
  v_and_b32 v13, 0xffff0000, v106
  v_lshlrev_b32 v14, 16, v107
  v_and_b32 v15, 0xffff0000, v107
  v_pk_add_f32 v[8:9], v[8:9], v[32:33] op_sel_hi:[1,0]
  v_pk_add_f32 v[10:11], v[10:11], v[32:33] op_sel_hi:[1,0]
  v_pk_add_f32 v[12:13], v[12:13], v[32:33] op_sel_hi:[1,0]
  v_pk_add_f32 v[14:15], v[14:15], v[32:33] op_sel_hi:[1,0]
  v_pk_add_f32 v[68:69], v[68:69], v[8:9]
  v_pk_add_f32 v[70:71], v[70:71], v[10:11]
  v_pk_add_f32 v[72:73], v[72:73], v[12:13]
  v_pk_add_f32 v[74:75], v[74:75], v[14:15]
  s_waitcnt lgkmcnt(0)
  s_barrier
  ds_read_b128 v[132:135], v230 offset:0
  ds_read_b128 v[136:139], v230 offset:1024
  ds_read_b128 v[140:143], v230 offset:2048
  ds_read_b128 v[144:147], v230 offset:3072
  ds_read_b128 v[148:151], v230 offset:4096
  ds_read_b128 v[152:155], v230 offset:5120
  s_waitcnt lgkmcnt(5)
  v_pk_add_f32 v[68:69], v[68:69], v[132:133]
  v_pk_add_f32 v[70:71], v[70:71], v[134:135]
  s_waitcnt lgkmcnt(4)
  v_pk_add_f32 v[72:73], v[72:73], v[136:137]
  v_pk_add_f32 v[74:75], v[74:75], v[138:139]
  s_waitcnt lgkmcnt(3)
  v_pk_add_f32 v[68:69], v[68:69], v[140:141]
  v_pk_add_f32 v[70:71], v[70:71], v[142:143]
  s_waitcnt lgkmcnt(2)
  v_pk_add_f32 v[72:73], v[72:73], v[144:145]
  v_pk_add_f32 v[74:75], v[74:75], v[146:147]
  s_waitcnt lgkmcnt(1)
  v_pk_add_f32 v[68:69], v[68:69], v[148:149]
  v_pk_add_f32 v[70:71], v[70:71], v[150:151]
  s_waitcnt lgkmcnt(0)
  v_pk_add_f32 v[72:73], v[72:73], v[152:153]
  v_pk_add_f32 v[74:75], v[74:75], v[154:155]
  v_cvt_pk_bf16_f32 v24, v68, v69
  v_cvt_pk_bf16_f32 v25, v70, v71
  v_cvt_pk_bf16_f32 v26, v72, v73
  v_cvt_pk_bf16_f32 v27, v74, v75
  s_add_u32 s52, s62, 3072
  buffer_store_dwordx4 v[24:27], v232, s[28:31], s52 offen sc1
  v_lshlrev_b32 v8, 16, v24
  v_and_b32 v9, 0xffff0000, v24
  v_lshlrev_b32 v10, 16, v25
  v_and_b32 v11, 0xffff0000, v25
  v_lshlrev_b32 v12, 16, v26
  v_and_b32 v13, 0xffff0000, v26
  v_lshlrev_b32 v14, 16, v27
  v_and_b32 v15, 0xffff0000, v27
  v_pk_add_f32 v[16:17], v[16:17], v[8:9]
  v_pk_fma_f32 v[18:19], v[8:9], v[8:9], v[18:19]
  v_pk_add_f32 v[16:17], v[16:17], v[10:11]
  v_pk_fma_f32 v[18:19], v[10:11], v[10:11], v[18:19]
  v_pk_add_f32 v[16:17], v[16:17], v[12:13]
  v_pk_fma_f32 v[18:19], v[12:13], v[12:13], v[18:19]
  v_pk_add_f32 v[16:17], v[16:17], v[14:15]
  v_pk_fma_f32 v[18:19], v[14:15], v[14:15], v[18:19]
  v_add_f32 v16, v16, v17
  v_add_f32 v17, v18, v19
  v_mov_b32 v18, v16
  v_mov_b32 v19, v17
  s_nop 0
  v_permlane32_swap_b32 v16, v18
  v_permlane32_swap_b32 v17, v19
  v_pk_add_f32 v[16:17], v[16:17], v[18:19]
  v_and_b32 v17, 0x7fffffff, v17
  s_mov_b32 exec_hi, 0
  buffer_store_dwordx2 v[16:17], v20, s[28:31], s53 offen sc1
  s_mov_b32 exec_hi, -1
  s_cmp_lg_u32 s77, 0
  s_cbranch_scc1 L_sig_1746271
  s_cmp_eq_u32 s95, 0
  s_cbranch_scc1 L_sig_1746271
  s_mov_b32 exec_lo, s95
  s_mov_b32 exec_hi, 0
  buffer_atomic_add v251, v225, s[28:31], 0 offen offset:36 sc1
  s_mov_b64 exec, -1
L_sig_1746271:
  s_waitcnt vmcnt(2)
L_join_82013:
  s_nop 0
  ds_read_b32 v160, v215 offset:24576
  ds_read_b32 v161, v215 offset:28672
  ds_read_b32 v162, v215 offset:32768
  ds_read_b32 v163, v215 offset:36864
  ds_read_b32 v156, v215 offset:40960
  s_waitcnt lgkmcnt(0)
  v_max3_u32 v7, v160, v161, v162
  v_max3_u32 v7, v7, v163, v156
  v_cmp_eq_u32 vcc, -1, v7
  s_cbranch_vccnz L_tag_1746272_r
L_tag_1746272:
  s_barrier
  ds_read_b64_tr_b16 v[164:165], v234 offset:0
  ds_read_b64_tr_b16 v[166:167], v236 offset:0
  ds_read_b64_tr_b16 v[168:169], v234 offset:1024
  ds_read_b64_tr_b16 v[170:171], v236 offset:1024
  ds_read_b64_tr_b16 v[172:173], v234 offset:2048
  ds_read_b64_tr_b16 v[174:175], v236 offset:2048
  s_add_u32 m0, s68, 49152
  s_add_u32 s94, s67, 98304
  buffer_load_dwordx4 v219, s[12:15], s94 offen lds
  ds_read_b128 v[8:11], v213 offset:24576
  ds_read_b128 v[12:15], v213 offset:28672
  ds_read_b128 v[16:19], v213 offset:32768
  ds_read_b128 v[20:23], v213 offset:36864
  ds_read_b128 v[24:27], v213 offset:40960
  s_waitcnt lgkmcnt(5)
  s_add_u32 m0, s68, 50176
  s_add_u32 s94, s67, 99328
  buffer_load_dwordx4 v219, s[12:15], s94 offen lds
  s_waitcnt lgkmcnt(3)
  v_mfma_f32_16x16x32_bf16 v[84:87], v[168:171], v[8:11], 0
  ds_read_b64_tr_b16 v[176:177], v234 offset:12288
  ds_read_b64_tr_b16 v[178:179], v236 offset:12288
  v_mfma_f32_16x16x32_bf16 v[104:107], v[8:11], v[172:175], 0
  ds_read_b64_tr_b16 v[180:181], v234 offset:13312
  v_mfma_f32_16x16x32_bf16 v[68:71], v[164:167], v[12:15], 0
  ds_read_b64_tr_b16 v[182:183], v236 offset:13312
  s_add_u32 m0, s68, 51200
  s_add_u32 s94, s67, 100352
  buffer_load_dwordx4 v219, s[12:15], s94 offen lds
  ds_read_b64_tr_b16 v[184:185], v234 offset:14336
  v_mfma_f32_16x16x32_bf16 v[88:91], v[168:171], v[12:15], 0
  ds_read_b64_tr_b16 v[186:187], v236 offset:14336
  v_mfma_f32_16x16x32_bf16 v[108:111], v[12:15], v[172:175], 0
  ds_read_b128 v[28:31], v213 offset:25600
  s_waitcnt lgkmcnt(7)
  v_mfma_f32_16x16x32_bf16 v[72:75], v[164:167], v[16:19], 0
  ds_read_b128 v[32:35], v213 offset:29696
  ds_read_b128 v[36:39], v213 offset:33792
  v_mfma_f32_16x16x32_bf16 v[92:95], v[168:171], v[16:19], 0
  s_add_u32 m0, s68, 61440
  s_add_u32 s94, s67, 491520
  buffer_load_dwordx4 v219, s[12:15], s94 offen lds
  ds_read_b128 v[40:43], v213 offset:37888
  v_mfma_f32_16x16x32_bf16 v[112:115], v[16:19], v[172:175], 0
  ds_read_b128 v[44:47], v213 offset:41984
  v_mfma_f32_16x16x32_bf16 v[76:79], v[164:167], v[20:23], 0
  v_mfma_f32_16x16x32_bf16 v[96:99], v[168:171], v[20:23], 0
  v_mfma_f32_16x16x32_bf16 v[116:119], v[20:23], v[172:175], 0
  s_add_u32 m0, s68, 62464
  s_add_u32 s94, s67, 492544
  buffer_load_dwordx4 v219, s[12:15], s94 offen lds
  v_mfma_f32_16x16x32_bf16 v[80:83], v[164:167], v[24:27], 0
  v_mfma_f32_16x16x32_bf16 v[100:103], v[168:171], v[24:27], 0
  v_mfma_f32_16x16x32_bf16 v[120:123], v[24:27], v[172:175], 0
  s_waitcnt lgkmcnt(5)
  s_waitcnt lgkmcnt(3)
  v_mfma_f32_16x16x32_bf16 v[84:87], v[180:183], v[28:31], v[84:87]
  s_add_u32 m0, s68, 63488
  s_add_u32 s94, s67, 493568
  buffer_load_dwordx4 v219, s[12:15], s94 offen lds
  s_barrier
  ds_read_b64_tr_b16 v[164:165], v234 offset:24576
  ds_read_b64_tr_b16 v[166:167], v236 offset:24576
  v_mfma_f32_16x16x32_bf16 v[104:107], v[28:31], v[184:187], v[104:107]
  s_add_u32 m0, s68, 73728
  s_add_u32 s94, s67, 884736
  buffer_load_dwordx4 v219, s[12:15], s94 offen lds
  ds_read_b64_tr_b16 v[168:169], v234 offset:25600
  ds_read_b64_tr_b16 v[170:171], v236 offset:25600
  v_mfma_f32_16x16x32_bf16 v[68:71], v[176:179], v[32:35], v[68:71]
  ds_read_b64_tr_b16 v[172:173], v234 offset:26624
  ds_read_b64_tr_b16 v[174:175], v236 offset:26624
  v_mfma_f32_16x16x32_bf16 v[88:91], v[180:183], v[32:35], v[88:91]
  ds_read_b128 v[8:11], v213 offset:26624
  ds_read_b128 v[12:15], v213 offset:30720
  v_mfma_f32_16x16x32_bf16 v[108:111], v[32:35], v[184:187], v[108:111]
  ds_read_b128 v[16:19], v213 offset:34816
  s_add_u32 m0, s68, 74752
  s_add_u32 s94, s67, 885760
  buffer_load_dwordx4 v219, s[12:15], s94 offen lds
  ds_read_b128 v[20:23], v213 offset:38912
  s_waitcnt lgkmcnt(10)
  v_mfma_f32_16x16x32_bf16 v[72:75], v[176:179], v[36:39], v[72:75]
  ds_read_b128 v[24:27], v213 offset:43008
  v_lshrrev_b32 v2, 5, v228
  v_mfma_f32_16x16x32_bf16 v[92:95], v[180:183], v[36:39], v[92:95]
  v_lshlrev_b32 v2, 11, v2
  v_and_b32 v3, 31, v228
  v_lshl_add_u32 v2, v3, 3, v2
  v_mfma_f32_16x16x32_bf16 v[112:115], v[36:39], v[184:187], v[112:115]
  s_add_u32 m0, s68, 75776
  s_add_u32 s94, s67, 886784
  buffer_load_dwordx4 v219, s[12:15], s94 offen lds
  v_and_b32 v3, 15, v228
  v_lshlrev_b32 v3, 3, v3
  v_mfma_f32_16x16x32_bf16 v[76:79], v[176:179], v[40:43], v[76:79]
  s_lshl_b32 s50, s72, 12
  s_lshl_b32 s3, s77, 9
  v_mfma_f32_16x16x32_bf16 v[96:99], v[180:183], v[40:43], v[96:99]
  s_add_u32 s3, s3, 262144
  s_sub_u32 s51, s50, 2048
  v_mfma_f32_16x16x32_bf16 v[116:119], v[40:43], v[184:187], v[116:119]
  s_max_i32 s51, s51, 0
  s_add_u32 s50, s50, s3
  v_mfma_f32_16x16x32_bf16 v[80:83], v[176:179], v[44:47], v[80:83]
  s_add_u32 m0, s68, 86016
  s_add_u32 s94, s67, 1277952
  buffer_load_dwordx4 v219, s[12:15], s94 offen lds
  s_add_u32 s51, s51, s3
  s_mov_b64 exec, 1
  v_mov_b32 v233, 0
  buffer_atomic_add v233, v226, s[28:31], 0 offen offset:32 sc0 sc1
  s_mov_b64 exec, -1
  v_mfma_f32_16x16x32_bf16 v[100:103], v[180:183], v[44:47], v[100:103]
  v_mfma_f32_16x16x32_bf16 v[120:123], v[44:47], v[184:187], v[120:123]
  s_waitcnt lgkmcnt(5)
  s_waitcnt lgkmcnt(3)
  v_mfma_f32_16x16x32_bf16 v[84:87], v[168:171], v[8:11], v[84:87]
  ds_read_b64_tr_b16 v[176:177], v234 offset:36864
  ds_read_b64_tr_b16 v[178:179], v236 offset:36864
  v_mfma_f32_16x16x32_bf16 v[104:107], v[8:11], v[172:175], v[104:107]
  ds_read_b64_tr_b16 v[180:181], v234 offset:37888
  ds_read_b64_tr_b16 v[182:183], v236 offset:37888
  v_mfma_f32_16x16x32_bf16 v[68:71], v[164:167], v[12:15], v[68:71]
  ds_read_b64_tr_b16 v[184:185], v234 offset:38912
  s_add_u32 m0, s68, 87040
  s_add_u32 s94, s67, 1278976
  buffer_load_dwordx4 v219, s[12:15], s94 offen lds
  ds_read_b64_tr_b16 v[186:187], v236 offset:38912
  v_mfma_f32_16x16x32_bf16 v[88:91], v[168:171], v[12:15], v[88:91]
  ds_read_b128 v[28:31], v213 offset:27648
  ds_read_b128 v[32:35], v213 offset:31744
  v_mfma_f32_16x16x32_bf16 v[108:111], v[12:15], v[172:175], v[108:111]
  ds_read_b128 v[36:39], v213 offset:35840
  ds_read_b128 v[40:43], v213 offset:39936
  s_waitcnt lgkmcnt(10)
  v_mfma_f32_16x16x32_bf16 v[72:75], v[164:167], v[16:19], v[72:75]
  ds_read_b128 v[44:47], v213 offset:44032
  ds_read_b32 v160, v215 offset:45056
  v_mfma_f32_16x16x32_bf16 v[92:95], v[168:171], v[16:19], v[92:95]
  s_add_u32 m0, s68, 88064
  s_add_u32 s94, s67, 1280000
  buffer_load_dwordx4 v219, s[12:15], s94 offen lds
  ds_read_b32 v161, v215 offset:49152
  ds_read_b32 v162, v215 offset:53248
  v_mfma_f32_16x16x32_bf16 v[112:115], v[16:19], v[172:175], v[112:115]
  ds_read_b32 v163, v215 offset:57344
  ds_read_b32 v156, v215 offset:61440
  v_mfma_f32_16x16x32_bf16 v[76:79], v[164:167], v[20:23], v[76:79]
  v_mfma_f32_16x16x32_bf16 v[96:99], v[168:171], v[20:23], v[96:99]
  v_mfma_f32_16x16x32_bf16 v[116:119], v[20:23], v[172:175], v[116:119]
  s_add_u32 m0, s68, 0
  s_add_u32 s94, s67, 196608
  buffer_load_dwordx4 v219, s[12:15], s94 offen lds
  v_mfma_f32_16x16x32_bf16 v[80:83], v[164:167], v[24:27], v[80:83]
  v_mfma_f32_16x16x32_bf16 v[100:103], v[168:171], v[24:27], v[100:103]
  v_mfma_f32_16x16x32_bf16 v[120:123], v[24:27], v[172:175], v[120:123]
  s_waitcnt lgkmcnt(10)
  s_waitcnt lgkmcnt(8)
  v_mfma_f32_16x16x32_bf16 v[84:87], v[180:183], v[28:31], v[84:87]
  s_add_u32 m0, s68, 1024
  s_add_u32 s94, s67, 197632
  buffer_load_dwordx4 v219, s[12:15], s94 offen lds
  s_waitcnt vmcnt(9)
  s_waitcnt lgkmcnt(0)
  v_max3_u32 v7, v160, v161, v162
  v_max3_u32 v7, v7, v163, v156
  s_add_u32 m0, s68, 2048
  s_add_u32 s94, s67, 198656
  buffer_load_dwordx4 v219, s[12:15], s94 offen lds
  v_mfma_f32_16x16x32_bf16 v[104:107], v[28:31], v[184:187], v[104:107]
  v_cmp_eq_u32 vcc, -1, v7
  s_cbranch_vccnz L_tag_1764273_r
L_tag_1764273:
  v_mfma_f32_16x16x32_bf16 v[68:71], v[176:179], v[32:35], v[68:71]
  s_barrier
  ds_read_b64_tr_b16 v[164:165], v235 offset:0
  v_mfma_f32_16x16x32_bf16 v[88:91], v[180:183], v[32:35], v[88:91]
  s_add_u32 m0, s68, 12288
  s_add_u32 s94, s67, 589824
  buffer_load_dwordx4 v219, s[12:15], s94 offen lds
  ds_read_b64_tr_b16 v[166:167], v237 offset:0
  ds_read_b64_tr_b16 v[168:169], v235 offset:1024
  v_mfma_f32_16x16x32_bf16 v[108:111], v[32:35], v[184:187], v[108:111]
  ds_read_b64_tr_b16 v[170:171], v237 offset:1024
  ds_read_b64_tr_b16 v[172:173], v235 offset:2048
  v_mfma_f32_16x16x32_bf16 v[72:75], v[176:179], v[36:39], v[72:75]
  ds_read_b64_tr_b16 v[174:175], v237 offset:2048
  ds_read_b128 v[8:11], v213 offset:45056
  v_mfma_f32_16x16x32_bf16 v[92:95], v[180:183], v[36:39], v[92:95]
  s_add_u32 m0, s68, 13312
  s_add_u32 s94, s67, 590848
  buffer_load_dwordx4 v219, s[12:15], s94 offen lds
  ds_read_b128 v[12:15], v213 offset:49152
  ds_read_b128 v[16:19], v213 offset:53248
  v_mfma_f32_16x16x32_bf16 v[112:115], v[36:39], v[184:187], v[112:115]
  ds_read_b128 v[20:23], v213 offset:57344
  ds_read_b128 v[24:27], v213 offset:61440
  v_mfma_f32_16x16x32_bf16 v[76:79], v[176:179], v[40:43], v[76:79]
  v_mfma_f32_16x16x32_bf16 v[96:99], v[180:183], v[40:43], v[96:99]
  v_mfma_f32_16x16x32_bf16 v[116:119], v[40:43], v[184:187], v[116:119]
  s_add_u32 m0, s68, 14336
  s_add_u32 s94, s67, 591872
  buffer_load_dwordx4 v219, s[12:15], s94 offen lds
  v_mfma_f32_16x16x32_bf16 v[80:83], v[176:179], v[44:47], v[80:83]
  v_mfma_f32_16x16x32_bf16 v[100:103], v[180:183], v[44:47], v[100:103]
  v_mfma_f32_16x16x32_bf16 v[120:123], v[44:47], v[184:187], v[120:123]
  s_waitcnt vmcnt(8)
  s_add_u32 m0, s68, 24576
  s_add_u32 s94, s67, 983040
  buffer_load_dwordx4 v219, s[12:15], s94 offen lds
  v_readfirstlane_b32 s3, v233
  s_cmp_lt_u32 s3, s97
  s_cbranch_scc1 L_poll_1764274_r
L_poll_1764274:
  s_waitcnt lgkmcnt(5)
  s_waitcnt lgkmcnt(3)
  v_mfma_f32_16x16x32_bf16 v[84:87], v[168:171], v[8:11], v[84:87]
  ds_read_b64_tr_b16 v[176:177], v235 offset:12288
  ds_read_b64_tr_b16 v[178:179], v237 offset:12288
  v_mfma_f32_16x16x32_bf16 v[104:107], v[8:11], v[172:175], v[104:107]
  ds_read_b64_tr_b16 v[180:181], v235 offset:13312
  v_mfma_f32_16x16x32_bf16 v[68:71], v[164:167], v[12:15], v[68:71]
  s_add_u32 m0, s60, 0
  s_add_u32 s94, s6, 10487808
  buffer_load_dwordx4 v213, s[28:31], s94 offen sc1 lds
  ds_read_b64_tr_b16 v[182:183], v237 offset:13312
  ds_read_b64_tr_b16 v[184:185], v235 offset:14336
  v_mfma_f32_16x16x32_bf16 v[88:91], v[168:171], v[12:15], v[88:91]
  ds_read_b64_tr_b16 v[186:187], v237 offset:14336
  v_mfma_f32_16x16x32_bf16 v[108:111], v[12:15], v[172:175], v[108:111]
  ds_read_b128 v[28:31], v213 offset:46080
  s_waitcnt lgkmcnt(7)
  v_mfma_f32_16x16x32_bf16 v[72:75], v[164:167], v[16:19], v[72:75]
  ds_read_b128 v[32:35], v213 offset:50176
  s_add_u32 m0, s60, 4096
  s_add_u32 s94, s7, 10487808
  buffer_load_dwordx4 v213, s[28:31], s94 offen sc1 lds
  ds_read_b128 v[36:39], v213 offset:54272
  v_mfma_f32_16x16x32_bf16 v[92:95], v[168:171], v[16:19], v[92:95]
  ds_read_b128 v[40:43], v213 offset:58368
  v_mfma_f32_16x16x32_bf16 v[112:115], v[16:19], v[172:175], v[112:115]
  ds_read_b128 v[44:47], v213 offset:62464
  v_mfma_f32_16x16x32_bf16 v[76:79], v[164:167], v[20:23], v[76:79]
  v_mfma_f32_16x16x32_bf16 v[96:99], v[168:171], v[20:23], v[96:99]
  s_add_u32 m0, s60, 8192
  s_add_u32 s94, s7, 10504192
  buffer_load_dwordx4 v213, s[28:31], s94 offen sc1 lds
  v_mfma_f32_16x16x32_bf16 v[116:119], v[20:23], v[172:175], v[116:119]
  v_mfma_f32_16x16x32_bf16 v[80:83], v[164:167], v[24:27], v[80:83]
  v_mfma_f32_16x16x32_bf16 v[100:103], v[168:171], v[24:27], v[100:103]
  v_mfma_f32_16x16x32_bf16 v[120:123], v[24:27], v[172:175], v[120:123]
  s_add_u32 m0, s60, 12288
  s_add_u32 s94, s7, 10520576
  buffer_load_dwordx4 v213, s[28:31], s94 offen sc1 lds
  s_waitcnt lgkmcnt(5)
  s_waitcnt lgkmcnt(3)
  v_mfma_f32_16x16x32_bf16 v[84:87], v[180:183], v[28:31], v[84:87]
  s_waitcnt vmcnt(11)
  s_barrier
  ds_read_b64_tr_b16 v[164:165], v235 offset:24576
  v_mfma_f32_16x16x32_bf16 v[104:107], v[28:31], v[184:187], v[104:107]
  s_add_u32 m0, s60, 16384
  s_add_u32 s94, s7, 10536960
  buffer_load_dwordx4 v213, s[28:31], s94 offen sc1 lds
  ds_read_b64_tr_b16 v[166:167], v237 offset:24576
  v_mfma_f32_16x16x32_bf16 v[68:71], v[176:179], v[32:35], v[68:71]
  ds_read_b64_tr_b16 v[168:169], v235 offset:25600
  ds_read_b64_tr_b16 v[170:171], v237 offset:25600
  v_mfma_f32_16x16x32_bf16 v[88:91], v[180:183], v[32:35], v[88:91]
  ds_read_b64_tr_b16 v[172:173], v235 offset:26624
  v_mfma_f32_16x16x32_bf16 v[108:111], v[32:35], v[184:187], v[108:111]
  ds_read_b64_tr_b16 v[174:175], v237 offset:26624
  ds_read_b128 v[8:11], v213 offset:47104
  s_waitcnt lgkmcnt(7)
  v_mfma_f32_16x16x32_bf16 v[72:75], v[176:179], v[36:39], v[72:75]
  s_add_u32 m0, s68, 25600
  s_add_u32 s94, s67, 984064
  buffer_load_dwordx4 v219, s[12:15], s94 offen lds
  ds_read_b128 v[12:15], v213 offset:51200
  v_mfma_f32_16x16x32_bf16 v[92:95], v[180:183], v[36:39], v[92:95]
  ds_read_b128 v[16:19], v213 offset:55296
  ds_read_b128 v[20:23], v213 offset:59392
  v_mfma_f32_16x16x32_bf16 v[112:115], v[36:39], v[184:187], v[112:115]
  ds_read_b128 v[24:27], v213 offset:63488
  v_mfma_f32_16x16x32_bf16 v[76:79], v[176:179], v[40:43], v[76:79]
  v_mfma_f32_16x16x32_bf16 v[96:99], v[180:183], v[40:43], v[96:99]
  s_add_u32 m0, s68, 26624
  s_add_u32 s94, s67, 985088
  buffer_load_dwordx4 v219, s[12:15], s94 offen lds
  v_mfma_f32_16x16x32_bf16 v[116:119], v[40:43], v[184:187], v[116:119]
  v_mfma_f32_16x16x32_bf16 v[80:83], v[176:179], v[44:47], v[80:83]
  v_mfma_f32_16x16x32_bf16 v[100:103], v[180:183], v[44:47], v[100:103]
  v_mfma_f32_16x16x32_bf16 v[120:123], v[44:47], v[184:187], v[120:123]
  s_add_u32 m0, s68, 36864
  s_add_u32 s94, s67, 1376256
  buffer_load_dwordx4 v219, s[12:15], s94 offen lds
  s_waitcnt lgkmcnt(5)
  s_waitcnt lgkmcnt(3)
  v_mfma_f32_16x16x32_bf16 v[84:87], v[168:171], v[8:11], v[84:87]
  ds_read_b64_tr_b16 v[176:177], v235 offset:36864
  ds_read_b64_tr_b16 v[178:179], v237 offset:36864
  v_mfma_f32_16x16x32_bf16 v[104:107], v[8:11], v[172:175], v[104:107]
  ds_read_b64_tr_b16 v[180:181], v235 offset:37888
  v_mfma_f32_16x16x32_bf16 v[68:71], v[164:167], v[12:15], v[68:71]
  ds_read_b64_tr_b16 v[182:183], v237 offset:37888
  s_add_u32 m0, s68, 37888
  s_add_u32 s94, s67, 1377280
  buffer_load_dwordx4 v219, s[12:15], s94 offen lds
  ds_read_b64_tr_b16 v[184:185], v235 offset:38912
  v_mfma_f32_16x16x32_bf16 v[88:91], v[168:171], v[12:15], v[88:91]
  ds_read_b64_tr_b16 v[186:187], v237 offset:38912
  v_mfma_f32_16x16x32_bf16 v[108:111], v[12:15], v[172:175], v[108:111]
  ds_read_b128 v[28:31], v213 offset:48128
  ds_read_b128 v[32:35], v213 offset:52224
  s_waitcnt lgkmcnt(8)
  v_mfma_f32_16x16x32_bf16 v[72:75], v[164:167], v[16:19], v[72:75]
  ds_read_b128 v[36:39], v213 offset:56320
  s_add_u32 m0, s68, 38912
  s_add_u32 s94, s67, 1378304
  buffer_load_dwordx4 v219, s[12:15], s94 offen lds
  v_mfma_f32_16x16x32_bf16 v[92:95], v[168:171], v[16:19], v[92:95]
  ds_read_b128 v[40:43], v213 offset:60416
  v_mfma_f32_16x16x32_bf16 v[112:115], v[16:19], v[172:175], v[112:115]
  ds_read_b128 v[44:47], v213 offset:64512
  s_waitcnt vmcnt(5)
  s_add_u32 m0, s68, 49152
  s_add_u32 s94, s67, 294912
  buffer_load_dwordx4 v219, s[12:15], s94 offen lds
  ds_read_b32 v160, v215 offset:0
  v_mfma_f32_16x16x32_bf16 v[76:79], v[164:167], v[20:23], v[76:79]
  ds_read_b32 v161, v215 offset:4096
  v_mfma_f32_16x16x32_bf16 v[96:99], v[168:171], v[20:23], v[96:99]
  ds_read_b32 v162, v215 offset:8192
  ds_read_b32 v163, v215 offset:12288
  v_mfma_f32_16x16x32_bf16 v[116:119], v[20:23], v[172:175], v[116:119]
  ds_read_b32 v156, v215 offset:16384
  v_mfma_f32_16x16x32_bf16 v[80:83], v[164:167], v[24:27], v[80:83]
  s_add_u32 m0, s68, 50176
  s_add_u32 s94, s67, 295936
  buffer_load_dwordx4 v219, s[12:15], s94 offen lds
  s_mov_b64 exec, 1
  v_mov_b32 v233, 0
  buffer_atomic_add v233, v226, s[28:31], 0 offen offset:36 sc0 sc1
  s_mov_b64 exec, -1
  v_mfma_f32_16x16x32_bf16 v[100:103], v[168:171], v[24:27], v[100:103]
  v_mfma_f32_16x16x32_bf16 v[120:123], v[24:27], v[172:175], v[120:123]
  s_waitcnt lgkmcnt(10)
  s_waitcnt lgkmcnt(8)
  v_mfma_f32_16x16x32_bf16 v[84:87], v[180:183], v[28:31], v[84:87]
  s_waitcnt lgkmcnt(0)
  v_max3_u32 v7, v160, v161, v162
  v_max3_u32 v7, v7, v163, v156
  v_mfma_f32_16x16x32_bf16 v[104:107], v[28:31], v[184:187], v[104:107]
  s_add_u32 m0, s68, 51200
  s_add_u32 s94, s67, 296960
  buffer_load_dwordx4 v219, s[12:15], s94 offen lds
  v_cmp_eq_u32 vcc, -1, v7
  s_cbranch_vccnz L_tag_1782275_r
L_tag_1782275:
  v_mfma_f32_16x16x32_bf16 v[68:71], v[176:179], v[32:35], v[68:71]
  s_barrier
  ds_read_b64_tr_b16 v[164:165], v234 offset:0
  v_mfma_f32_16x16x32_bf16 v[88:91], v[180:183], v[32:35], v[88:91]
  s_add_u32 m0, s68, 61440
  s_add_u32 s94, s67, 688128
  buffer_load_dwordx4 v219, s[12:15], s94 offen lds
  ds_read_b64_tr_b16 v[166:167], v236 offset:0
  ds_read_b64_tr_b16 v[168:169], v234 offset:1024
  v_mfma_f32_16x16x32_bf16 v[108:111], v[32:35], v[184:187], v[108:111]
  ds_read_b64_tr_b16 v[170:171], v236 offset:1024
  ds_read_b64_tr_b16 v[172:173], v234 offset:2048
  v_mfma_f32_16x16x32_bf16 v[72:75], v[176:179], v[36:39], v[72:75]
  ds_read_b64_tr_b16 v[174:175], v236 offset:2048
  ds_read_b128 v[8:11], v213 offset:0
  v_mfma_f32_16x16x32_bf16 v[92:95], v[180:183], v[36:39], v[92:95]
  s_add_u32 m0, s68, 62464
  s_add_u32 s94, s67, 689152
  buffer_load_dwordx4 v219, s[12:15], s94 offen lds
  ds_read_b128 v[12:15], v213 offset:4096
  ds_read_b128 v[16:19], v213 offset:8192
  v_mfma_f32_16x16x32_bf16 v[112:115], v[36:39], v[184:187], v[112:115]
  ds_read_b128 v[20:23], v213 offset:12288
  ds_read_b128 v[24:27], v213 offset:16384
  v_mfma_f32_16x16x32_bf16 v[76:79], v[176:179], v[40:43], v[76:79]
  v_mfma_f32_16x16x32_bf16 v[96:99], v[180:183], v[40:43], v[96:99]
  v_mfma_f32_16x16x32_bf16 v[116:119], v[40:43], v[184:187], v[116:119]
  s_add_u32 m0, s68, 63488
  s_add_u32 s94, s67, 690176
  buffer_load_dwordx4 v219, s[12:15], s94 offen lds
  v_mfma_f32_16x16x32_bf16 v[80:83], v[176:179], v[44:47], v[80:83]
  v_mfma_f32_16x16x32_bf16 v[100:103], v[180:183], v[44:47], v[100:103]
  v_mfma_f32_16x16x32_bf16 v[120:123], v[44:47], v[184:187], v[120:123]
  s_waitcnt lgkmcnt(5)
  s_waitcnt lgkmcnt(3)
  v_mfma_f32_16x16x32_bf16 v[84:87], v[168:171], v[8:11], v[84:87]
  s_add_u32 m0, s68, 73728
  s_add_u32 s94, s67, 1081344
  buffer_load_dwordx4 v219, s[12:15], s94 offen lds
  ds_read_b64_tr_b16 v[176:177], v234 offset:12288
  ds_read_b64_tr_b16 v[178:179], v236 offset:12288
  v_mfma_f32_16x16x32_bf16 v[104:107], v[8:11], v[172:175], v[104:107]
  ds_read_b64_tr_b16 v[180:181], v234 offset:13312
  v_mfma_f32_16x16x32_bf16 v[68:71], v[164:167], v[12:15], v[68:71]
  ds_read_b64_tr_b16 v[182:183], v236 offset:13312
  ds_read_b64_tr_b16 v[184:185], v234 offset:14336
  v_mfma_f32_16x16x32_bf16 v[88:91], v[168:171], v[12:15], v[88:91]
  ds_read_b64_tr_b16 v[186:187], v236 offset:14336
  s_add_u32 m0, s68, 74752
  s_add_u32 s94, s67, 1082368
  buffer_load_dwordx4 v219, s[12:15], s94 offen lds
  v_mfma_f32_16x16x32_bf16 v[108:111], v[12:15], v[172:175], v[108:111]
  ds_read_b128 v[28:31], v213 offset:1024
  s_waitcnt lgkmcnt(7)
  v_mfma_f32_16x16x32_bf16 v[72:75], v[164:167], v[16:19], v[72:75]
  ds_read_b128 v[32:35], v213 offset:5120
  ds_read_b128 v[36:39], v213 offset:9216
  v_mfma_f32_16x16x32_bf16 v[92:95], v[168:171], v[16:19], v[92:95]
  ds_read_b128 v[40:43], v213 offset:13312
  v_mfma_f32_16x16x32_bf16 v[112:115], v[16:19], v[172:175], v[112:115]
  s_add_u32 m0, s68, 75776
  s_add_u32 s94, s67, 1083392
  buffer_load_dwordx4 v219, s[12:15], s94 offen lds
  ds_read_b128 v[44:47], v213 offset:17408
  v_mfma_f32_16x16x32_bf16 v[76:79], v[164:167], v[20:23], v[76:79]
  v_mfma_f32_16x16x32_bf16 v[96:99], v[168:171], v[20:23], v[96:99]
  v_mfma_f32_16x16x32_bf16 v[116:119], v[20:23], v[172:175], v[116:119]
  v_mfma_f32_16x16x32_bf16 v[80:83], v[164:167], v[24:27], v[80:83]
  s_add_u32 m0, s68, 86016
  s_add_u32 s94, s67, 1474560
  buffer_load_dwordx4 v219, s[12:15], s94 offen lds
  v_mfma_f32_16x16x32_bf16 v[100:103], v[168:171], v[24:27], v[100:103]
  v_mfma_f32_16x16x32_bf16 v[120:123], v[24:27], v[172:175], v[120:123]
  s_waitcnt vmcnt(8)
  s_add_u32 m0, s68, 87040
  s_add_u32 s94, s67, 1475584
  buffer_load_dwordx4 v219, s[12:15], s94 offen lds
  v_readfirstlane_b32 s3, v233
  s_cmp_lt_u32 s3, s97
  s_cbranch_scc1 L_poll_1786276_r
L_poll_1786276:
  s_waitcnt lgkmcnt(5)
  s_waitcnt lgkmcnt(3)
  v_mfma_f32_16x16x32_bf16 v[84:87], v[180:183], v[28:31], v[84:87]
  s_barrier
  ds_read_b64_tr_b16 v[164:165], v234 offset:24576
  v_mfma_f32_16x16x32_bf16 v[104:107], v[28:31], v[184:187], v[104:107]
  s_add_u32 m0, s60, 24576
  s_add_u32 s94, s6, 10488832
  buffer_load_dwordx4 v213, s[28:31], s94 offen sc1 lds
  ds_read_b64_tr_b16 v[166:167], v236 offset:24576
  v_mfma_f32_16x16x32_bf16 v[68:71], v[176:179], v[32:35], v[68:71]
  ds_read_b64_tr_b16 v[168:169], v234 offset:25600
  ds_read_b64_tr_b16 v[170:171], v236 offset:25600
  v_mfma_f32_16x16x32_bf16 v[88:91], v[180:183], v[32:35], v[88:91]
  ds_read_b64_tr_b16 v[172:173], v234 offset:26624
  v_mfma_f32_16x16x32_bf16 v[108:111], v[32:35], v[184:187], v[108:111]
  ds_read_b64_tr_b16 v[174:175], v236 offset:26624
  ds_read_b128 v[8:11], v213 offset:2048
  s_waitcnt lgkmcnt(7)
  v_mfma_f32_16x16x32_bf16 v[72:75], v[176:179], v[36:39], v[72:75]
  s_add_u32 m0, s60, 28672
  s_add_u32 s94, s7, 10488832
  buffer_load_dwordx4 v213, s[28:31], s94 offen sc1 lds
  ds_read_b128 v[12:15], v213 offset:6144
  v_mfma_f32_16x16x32_bf16 v[92:95], v[180:183], v[36:39], v[92:95]
  ds_read_b128 v[16:19], v213 offset:10240
  ds_read_b128 v[20:23], v213 offset:14336
  v_mfma_f32_16x16x32_bf16 v[112:115], v[36:39], v[184:187], v[112:115]
  ds_read_b128 v[24:27], v213 offset:18432
  v_mfma_f32_16x16x32_bf16 v[76:79], v[176:179], v[40:43], v[76:79]
  v_mfma_f32_16x16x32_bf16 v[96:99], v[180:183], v[40:43], v[96:99]
  s_add_u32 m0, s60, 32768
  s_add_u32 s94, s7, 10505216
  buffer_load_dwordx4 v213, s[28:31], s94 offen sc1 lds
  v_mfma_f32_16x16x32_bf16 v[116:119], v[40:43], v[184:187], v[116:119]
  v_mfma_f32_16x16x32_bf16 v[80:83], v[176:179], v[44:47], v[80:83]
  v_mfma_f32_16x16x32_bf16 v[100:103], v[180:183], v[44:47], v[100:103]
  v_mfma_f32_16x16x32_bf16 v[120:123], v[44:47], v[184:187], v[120:123]
  s_add_u32 m0, s60, 36864
  s_add_u32 s94, s7, 10521600
  buffer_load_dwordx4 v213, s[28:31], s94 offen sc1 lds
  s_waitcnt lgkmcnt(5)
  s_waitcnt lgkmcnt(3)
  v_mfma_f32_16x16x32_bf16 v[84:87], v[168:171], v[8:11], v[84:87]
  ds_read_b64_tr_b16 v[176:177], v234 offset:36864
  ds_read_b64_tr_b16 v[178:179], v236 offset:36864
  v_mfma_f32_16x16x32_bf16 v[104:107], v[8:11], v[172:175], v[104:107]
  ds_read_b64_tr_b16 v[180:181], v234 offset:37888
  ds_read_b64_tr_b16 v[182:183], v236 offset:37888
  v_mfma_f32_16x16x32_bf16 v[68:71], v[164:167], v[12:15], v[68:71]
  ds_read_b64_tr_b16 v[184:185], v234 offset:38912
  s_add_u32 m0, s60, 40960
  s_add_u32 s94, s7, 10537984
  buffer_load_dwordx4 v213, s[28:31], s94 offen sc1 lds
  ds_read_b64_tr_b16 v[186:187], v236 offset:38912
  v_mfma_f32_16x16x32_bf16 v[88:91], v[168:171], v[12:15], v[88:91]
  ds_read_b128 v[28:31], v213 offset:3072
  ds_read_b128 v[32:35], v213 offset:7168
  v_mfma_f32_16x16x32_bf16 v[108:111], v[12:15], v[172:175], v[108:111]
  ds_read_b128 v[36:39], v213 offset:11264
  ds_read_b128 v[40:43], v213 offset:15360
  s_waitcnt lgkmcnt(10)
  v_mfma_f32_16x16x32_bf16 v[72:75], v[164:167], v[16:19], v[72:75]
  ds_read_b128 v[44:47], v213 offset:19456
  s_add_u32 m0, s68, 88064
  s_add_u32 s94, s67, 1476608
  buffer_load_dwordx4 v219, s[12:15], s94 offen lds
  buffer_load_dwordx2 v[144:145], v2, s[28:31], s50 offen offset:0 sc1
  v_mfma_f32_16x16x32_bf16 v[92:95], v[168:171], v[16:19], v[92:95]
  buffer_load_dwordx2 v[146:147], v2, s[28:31], s50 offen offset:256 sc1
  buffer_load_dwordx2 v[148:149], v3, s[28:31], s51 offen offset:128 sc1
  v_mfma_f32_16x16x32_bf16 v[112:115], v[16:19], v[172:175], v[112:115]
  buffer_load_dwordx2 v[150:151], v3, s[28:31], s51 offen offset:384 sc1
  v_mfma_f32_16x16x32_bf16 v[76:79], v[164:167], v[20:23], v[76:79]
  v_mfma_f32_16x16x32_bf16 v[96:99], v[168:171], v[20:23], v[96:99]
  v_mfma_f32_16x16x32_bf16 v[116:119], v[20:23], v[172:175], v[116:119]
  v_mfma_f32_16x16x32_bf16 v[80:83], v[164:167], v[24:27], v[80:83]
  v_mfma_f32_16x16x32_bf16 v[100:103], v[168:171], v[24:27], v[100:103]
  v_mfma_f32_16x16x32_bf16 v[120:123], v[24:27], v[172:175], v[120:123]
  s_waitcnt lgkmcnt(5)
  s_add_u32 m0, s60, 65536
  s_nop 0
  buffer_load_dwordx4 v218, s[16:19], s69 offen lds
  s_waitcnt lgkmcnt(3)
  v_mfma_f32_16x16x32_bf16 v[84:87], v[180:183], v[28:31], v[84:87]
  s_waitcnt vmcnt(6)
  s_add_u32 m0, s60, 69632
  s_add_u32 s94, s69, 32768
  buffer_load_dwordx4 v218, s[16:19], s94 offen lds
  ds_read_b32 v160, v215 offset:24576
  ds_read_b32 v161, v215 offset:28672
  v_mfma_f32_16x16x32_bf16 v[104:107], v[28:31], v[184:187], v[104:107]
  ds_read_b32 v162, v215 offset:32768
  ds_read_b32 v163, v215 offset:36864
  v_mfma_f32_16x16x32_bf16 v[68:71], v[176:179], v[32:35], v[68:71]
  ds_read_b32 v156, v215 offset:40960
  s_waitcnt lgkmcnt(0)
  s_add_u32 m0, s60, 73728
  s_add_u32 s94, s69, 65536
  buffer_load_dwordx4 v218, s[16:19], s94 offen lds
  v_max3_u32 v7, v160, v161, v162
  v_mfma_f32_16x16x32_bf16 v[88:91], v[180:183], v[32:35], v[88:91]
  v_max3_u32 v7, v7, v163, v156
  v_mfma_f32_16x16x32_bf16 v[108:111], v[32:35], v[184:187], v[108:111]
  v_cmp_eq_u32 vcc, -1, v7
  s_cbranch_vccnz L_tag_1800277_r
L_tag_1800277:
  v_mfma_f32_16x16x32_bf16 v[72:75], v[176:179], v[36:39], v[72:75]
  s_barrier
  ds_read_b64_tr_b16 v[164:165], v235 offset:0
  v_mfma_f32_16x16x32_bf16 v[92:95], v[180:183], v[36:39], v[92:95]
  s_add_u32 m0, s60, 77824
  s_add_u32 s94, s69, 98304
  buffer_load_dwordx4 v218, s[16:19], s94 offen lds
  ds_read_b64_tr_b16 v[166:167], v237 offset:0
  ds_read_b64_tr_b16 v[168:169], v235 offset:1024
  v_mfma_f32_16x16x32_bf16 v[112:115], v[36:39], v[184:187], v[112:115]
  ds_read_b64_tr_b16 v[170:171], v237 offset:1024
  v_mfma_f32_16x16x32_bf16 v[76:79], v[176:179], v[40:43], v[76:79]
  ds_read_b64_tr_b16 v[172:173], v235 offset:2048
  ds_read_b64_tr_b16 v[174:175], v237 offset:2048
  v_mfma_f32_16x16x32_bf16 v[96:99], v[180:183], v[40:43], v[96:99]
  ds_read_b128 v[8:11], v213 offset:24576
  s_add_u32 m0, s60, 81920
  s_add_u32 s94, s69, 131072
  buffer_load_dwordx4 v218, s[16:19], s94 offen lds
  ds_read_b128 v[12:15], v213 offset:28672
  v_mfma_f32_16x16x32_bf16 v[116:119], v[40:43], v[184:187], v[116:119]
  ds_read_b128 v[16:19], v213 offset:32768
  ds_read_b128 v[20:23], v213 offset:36864
  v_mfma_f32_16x16x32_bf16 v[80:83], v[176:179], v[44:47], v[80:83]
  ds_read_b128 v[24:27], v213 offset:40960
  v_mfma_f32_16x16x32_bf16 v[100:103], v[180:183], v[44:47], v[100:103]
  v_mfma_f32_16x16x32_bf16 v[120:123], v[44:47], v[184:187], v[120:123]
  s_add_u32 m0, s60, 86016
  s_add_u32 s94, s69, 163840
  buffer_load_dwordx4 v218, s[16:19], s94 offen lds
  s_waitcnt lgkmcnt(5)
  s_waitcnt lgkmcnt(3)
  s_add_u32 m0, s60, 90112
  s_add_u32 s94, s69, 196608
  buffer_load_dwordx4 v218, s[16:19], s94 offen lds
  v_mfma_f32_16x16x32_bf16 v[84:87], v[168:171], v[8:11], v[84:87]
  ds_read_b64_tr_b16 v[176:177], v235 offset:12288
  ds_read_b64_tr_b16 v[178:179], v237 offset:12288
  v_mfma_f32_16x16x32_bf16 v[104:107], v[8:11], v[172:175], v[104:107]
  ds_read_b64_tr_b16 v[180:181], v235 offset:13312
  ds_read_b64_tr_b16 v[182:183], v237 offset:13312
  v_mfma_f32_16x16x32_bf16 v[68:71], v[164:167], v[12:15], v[68:71]
  ds_read_b64_tr_b16 v[184:185], v235 offset:14336
  ds_read_b64_tr_b16 v[186:187], v237 offset:14336
  v_mfma_f32_16x16x32_bf16 v[88:91], v[168:171], v[12:15], v[88:91]
  s_add_u32 m0, s60, 94208
  s_add_u32 s94, s69, 229376
  buffer_load_dwordx4 v218, s[16:19], s94 offen lds
  ds_read_b128 v[28:31], v213 offset:25600
  ds_read_b128 v[32:35], v213 offset:29696
  v_mfma_f32_16x16x32_bf16 v[108:111], v[12:15], v[172:175], v[108:111]
  ds_read_b128 v[36:39], v213 offset:33792
  ds_read_b128 v[40:43], v213 offset:37888
  s_waitcnt lgkmcnt(10)
  v_mfma_f32_16x16x32_bf16 v[72:75], v[164:167], v[16:19], v[72:75]
  ds_read_b128 v[44:47], v213 offset:41984
  s_waitcnt vmcnt(8)
  v_max3_u32 v7, v145, v147, v149
  v_mfma_f32_16x16x32_bf16 v[92:95], v[168:171], v[16:19], v[92:95]
  s_add_u32 m0, s60, 98304
  s_add_u32 s94, s69, 262144
  buffer_load_dwordx4 v218, s[16:19], s94 offen lds
  v_max_u32 v7, v7, v151
  v_cmp_eq_u32 vcc, -1, v7
  v_mfma_f32_16x16x32_bf16 v[112:115], v[16:19], v[172:175], v[112:115]
  s_cbranch_vccnz L_tag_1804278_r
L_tag_1804278:
  v_add_f32 v144, v144, v146
  v_mfma_f32_16x16x32_bf16 v[76:79], v[164:167], v[20:23], v[76:79]
  v_add_f32 v145, v145, v147
  v_add_f32 v148, v148, v150
  v_mfma_f32_16x16x32_bf16 v[96:99], v[168:171], v[20:23], v[96:99]
  v_add_f32 v149, v149, v151
  s_mul_i32 s3, s77, 640
  v_mfma_f32_16x16x32_bf16 v[116:119], v[20:23], v[172:175], v[116:119]
  s_add_u32 m0, s60, 102400
  s_add_u32 s94, s69, 294912
  buffer_load_dwordx4 v218, s[16:19], s94 offen lds
  v_add_u32 v2, s3, v207
  ds_write_b64 v2, v[144:145] offset:128
  v_mfma_f32_16x16x32_bf16 v[80:83], v[164:167], v[24:27], v[80:83]
  ds_write_b64 v206, v[148:149]
  v_mfma_f32_16x16x32_bf16 v[100:103], v[168:171], v[24:27], v[100:103]
  v_mfma_f32_16x16x32_bf16 v[120:123], v[24:27], v[172:175], v[120:123]
  s_add_u32 m0, s60, 106496
  s_add_u32 s94, s69, 327680
  buffer_load_dwordx4 v218, s[16:19], s94 offen lds
  s_waitcnt lgkmcnt(7)
  s_waitcnt lgkmcnt(5)
  v_mfma_f32_16x16x32_bf16 v[84:87], v[180:183], v[28:31], v[84:87]
  s_barrier
  ds_read_b64_tr_b16 v[164:165], v235 offset:24576
  v_mfma_f32_16x16x32_bf16 v[104:107], v[28:31], v[184:187], v[104:107]
  s_add_u32 m0, s60, 110592
  s_add_u32 s94, s69, 360448
  buffer_load_dwordx4 v218, s[16:19], s94 offen lds
  ds_read_b64_tr_b16 v[166:167], v237 offset:24576
  ds_read_b64_tr_b16 v[168:169], v235 offset:25600
  v_mfma_f32_16x16x32_bf16 v[68:71], v[176:179], v[32:35], v[68:71]
  ds_read_b64_tr_b16 v[170:171], v237 offset:25600
  ds_read_b64_tr_b16 v[172:173], v235 offset:26624
  v_mfma_f32_16x16x32_bf16 v[88:91], v[180:183], v[32:35], v[88:91]
  ds_read_b64_tr_b16 v[174:175], v237 offset:26624
  ds_read_b128 v[8:11], v213 offset:26624
  v_mfma_f32_16x16x32_bf16 v[108:111], v[32:35], v[184:187], v[108:111]
  ds_read_b128 v[12:15], v213 offset:30720
  s_add_u32 m0, s60, 114688
  s_add_u32 s94, s69, 393216
  buffer_load_dwordx4 v218, s[16:19], s94 offen lds
  ds_read_b128 v[16:19], v213 offset:34816
  s_waitcnt lgkmcnt(11)
  v_mfma_f32_16x16x32_bf16 v[72:75], v[176:179], v[36:39], v[72:75]
  ds_read_b128 v[20:23], v213 offset:38912
  ds_read_b128 v[24:27], v213 offset:43008
  v_mfma_f32_16x16x32_bf16 v[92:95], v[180:183], v[36:39], v[92:95]
  v_and_b32 v1, 15, v228
  v_lshlrev_b32 v1, 3, v1
  v_mfma_f32_16x16x32_bf16 v[112:115], v[36:39], v[184:187], v[112:115]
  v_add_u32 v1, 45568, v1
  s_waitcnt lgkmcnt(11)
  s_barrier
  v_mfma_f32_16x16x32_bf16 v[76:79], v[176:179], v[40:43], v[76:79]
  s_add_u32 m0, s60, 118784
  s_add_u32 s94, s69, 425984
  buffer_load_dwordx4 v218, s[16:19], s94 offen lds
  ds_read_b64 v[48:49], v207 offset:0
  ds_read_b64 v[50:51], v207 offset:640
  v_mfma_f32_16x16x32_bf16 v[96:99], v[180:183], v[40:43], v[96:99]
  ds_read_b64 v[52:53], v207 offset:1280
  ds_read_b64 v[54:55], v207 offset:1920
  v_mfma_f32_16x16x32_bf16 v[116:119], v[40:43], v[184:187], v[116:119]
  ds_read_b64 v[56:57], v1 offset:0
  ds_read_b64 v[58:59], v1 offset:640
  v_mfma_f32_16x16x32_bf16 v[80:83], v[176:179], v[44:47], v[80:83]
  ds_read_b64 v[60:61], v1 offset:1280
  s_add_u32 m0, s60, 122880
  s_add_u32 s94, s69, 458752
  buffer_load_dwordx4 v218, s[16:19], s94 offen lds
  ds_read_b64 v[62:63], v1 offset:1920
  v_mfma_f32_16x16x32_bf16 v[100:103], v[180:183], v[44:47], v[100:103]
  v_mfma_f32_16x16x32_bf16 v[120:123], v[44:47], v[184:187], v[120:123]
  s_waitcnt lgkmcnt(13)
  s_waitcnt lgkmcnt(11)
  v_mfma_f32_16x16x32_bf16 v[84:87], v[168:171], v[8:11], v[84:87]
  ds_read_b64_tr_b16 v[176:177], v235 offset:36864
  ds_read_b64_tr_b16 v[178:179], v237 offset:36864
  ds_read_b64_tr_b16 v[180:181], v235 offset:37888
  v_mfma_f32_16x16x32_bf16 v[104:107], v[8:11], v[172:175], v[104:107]
  s_add_u32 m0, s60, 126976
  s_add_u32 s94, s69, 491520
  buffer_load_dwordx4 v218, s[16:19], s94 offen lds
  ds_read_b64_tr_b16 v[182:183], v237 offset:37888
  ds_read_b64_tr_b16 v[184:185], v235 offset:38912
  ds_read_b64_tr_b16 v[186:187], v237 offset:38912
  v_mfma_f32_16x16x32_bf16 v[68:71], v[164:167], v[12:15], v[68:71]
  ds_read_b128 v[28:31], v213 offset:27648
  ds_read_b128 v[32:35], v213 offset:31744
  ds_read_b128 v[36:39], v213 offset:35840
  v_mfma_f32_16x16x32_bf16 v[88:91], v[168:171], v[12:15], v[88:91]
  ds_read_b128 v[40:43], v213 offset:39936
  ds_read_b128 v[44:47], v213 offset:44032
  v_mfma_f32_16x16x32_bf16 v[108:111], v[12:15], v[172:175], v[108:111]
  s_waitcnt lgkmcnt(11)
  v_pk_add_f32 v[48:49], v[48:49], v[50:51]
  v_pk_add_f32 v[52:53], v[52:53], v[54:55]
  v_pk_add_f32 v[56:57], v[56:57], v[58:59]
  v_mfma_f32_16x16x32_bf16 v[72:75], v[164:167], v[16:19], v[72:75]
  v_pk_add_f32 v[60:61], v[60:61], v[62:63]
  v_pk_add_f32 v[48:49], v[48:49], v[52:53]
  v_pk_add_f32 v[56:57], v[56:57], v[60:61]
  v_mfma_f32_16x16x32_bf16 v[92:95], v[168:171], v[16:19], v[92:95]
  v_mul_f32 v48, 0xbb000000, v48
  v_mul_f32 v49, 0x3b000000, v49
  v_mul_f32 v56, 0xbb000000, v56
  v_mfma_f32_16x16x32_bf16 v[112:115], v[16:19], v[172:175], v[112:115]
  v_mul_f32 v57, 0x3b000000, v57
  v_fma_f32 v49, -v48, v48, v49
  v_mfma_f32_16x16x32_bf16 v[76:79], v[164:167], v[20:23], v[76:79]
  v_fma_f32 v57, -v56, v56, v57
  v_max_f32 v49, 0, v49
  v_max_f32 v57, 0, v57
  v_mfma_f32_16x16x32_bf16 v[96:99], v[168:171], v[20:23], v[96:99]
  v_add_f32 v49, 0x3727c5ac, v49
  v_add_f32 v57, 0x3727c5ac, v57
  v_rsq_f32 v49, v49
  v_mfma_f32_16x16x32_bf16 v[116:119], v[20:23], v[172:175], v[116:119]
  v_rsq_f32 v57, v57
  v_lshrrev_b32 v2, 4, v228
  v_lshl_add_u32 v2, v2, 6, v208
  v_mfma_f32_16x16x32_bf16 v[80:83], v[164:167], v[24:27], v[80:83]
  ds_write2_b32 v2, v49, v48 offset0:0 offset1:80
  ds_write2_b32 v208, v57, v56 offset0:64 offset1:144
  v_mfma_f32_16x16x32_bf16 v[100:103], v[168:171], v[24:27], v[100:103]
  v_mfma_f32_16x16x32_bf16 v[120:123], v[24:27], v[172:175], v[120:123]
  s_waitcnt lgkmcnt(7)
  s_waitcnt lgkmcnt(5)
  v_mfma_f32_16x16x32_bf16 v[84:87], v[180:183], v[28:31], v[84:87]
  s_waitcnt lgkmcnt(0)
  ds_read2_b32 v[124:125], v208 offset0:0 offset1:80
  ds_read2_b32 v[128:129], v208 offset0:16 offset1:96
  v_mfma_f32_16x16x32_bf16 v[104:107], v[28:31], v[184:187], v[104:107]
  ds_read2_b32 v[132:133], v208 offset0:32 offset1:112
  ds_read2_b32 v[136:137], v208 offset0:48 offset1:128
  v_mfma_f32_16x16x32_bf16 v[68:71], v[176:179], v[32:35], v[68:71]
  ds_read2_b32 v[140:141], v208 offset0:64 offset1:144
  ds_read_b128 v[144:147], v209 offset:0
  v_mfma_f32_16x16x32_bf16 v[88:91], v[180:183], v[32:35], v[88:91]
  ds_read_b128 v[48:51], v209 offset:320
  ds_read_b128 v[148:151], v209 offset:64
  v_mfma_f32_16x16x32_bf16 v[108:111], v[32:35], v[184:187], v[108:111]
  ds_read_b128 v[52:55], v209 offset:384
  ds_read_b128 v[152:155], v209 offset:128
  v_mfma_f32_16x16x32_bf16 v[72:75], v[176:179], v[36:39], v[72:75]
  ds_read_b128 v[56:59], v209 offset:448
  ds_read_b128 v[156:159], v209 offset:192
  v_mfma_f32_16x16x32_bf16 v[92:95], v[180:183], v[36:39], v[92:95]
  ds_read_b128 v[60:63], v209 offset:512
  ds_read_b128 v[160:163], v209 offset:256
  v_mfma_f32_16x16x32_bf16 v[112:115], v[36:39], v[184:187], v[112:115]
  ds_read_b128 v[64:67], v209 offset:576
  v_mfma_f32_16x16x32_bf16 v[76:79], v[176:179], v[40:43], v[76:79]
  v_mfma_f32_16x16x32_bf16 v[96:99], v[180:183], v[40:43], v[96:99]
  v_mfma_f32_16x16x32_bf16 v[116:119], v[40:43], v[184:187], v[116:119]
  v_mfma_f32_16x16x32_bf16 v[80:83], v[176:179], v[44:47], v[80:83]
  v_mfma_f32_16x16x32_bf16 v[100:103], v[180:183], v[44:47], v[100:103]
  v_mfma_f32_16x16x32_bf16 v[120:123], v[44:47], v[184:187], v[120:123]
  s_waitcnt lgkmcnt(0)
  s_barrier
  s_cmp_eq_u32 s72, 0
  s_cselect_b32 s48, 0xff61b1e6, 0
  v_min_f32 v176, s48, v198
  v_min_f32 v177, s48, v199
  v_min_f32 v178, s48, v200
  v_min_f32 v179, s48, v201
  v_pk_fma_f32 v[84:85], v[246:247], v[124:125], v[84:85] op_sel:[0,1,0]
  v_pk_fma_f32 v[86:87], v[248:249], v[124:125], v[86:87] op_sel:[0,1,0]
  v_pk_mul_f32 v[84:85], v[84:85], v[124:125] op_sel_hi:[1,0]
  v_pk_mul_f32 v[86:87], v[86:87], v[124:125] op_sel_hi:[1,0]
  v_cvt_pk_bf16_f32 v10, v84, v85
  v_cvt_pk_bf16_f32 v11, v86, v87
  v_pk_fma_f32 v[88:89], v[246:247], v[128:129], v[88:89] op_sel:[0,1,0]
  v_pk_fma_f32 v[68:69], v[242:243], v[128:129], v[68:69] op_sel:[0,1,0]
  v_pk_fma_f32 v[90:91], v[248:249], v[128:129], v[90:91] op_sel:[0,1,0]
  v_pk_fma_f32 v[70:71], v[244:245], v[128:129], v[70:71] op_sel:[0,1,0]
  v_pk_mul_f32 v[88:89], v[88:89], v[128:129] op_sel_hi:[1,0]
  v_pk_mul_f32 v[90:91], v[90:91], v[128:129] op_sel_hi:[1,0]
  v_cvt_pk_bf16_f32 v12, v68, v69
  v_cvt_pk_bf16_f32 v13, v70, v71
  v_mul_f32 v128, 0x3eb8aa3b, v128
  v_cvt_pk_bf16_f32 v14, v88, v89
  v_cvt_pk_bf16_f32 v15, v90, v91
  v_pk_fma_f32 v[92:93], v[246:247], v[132:133], v[92:93] op_sel:[0,1,0]
  v_pk_fma_f32 v[72:73], v[242:243], v[132:133], v[72:73] op_sel:[0,1,0]
  v_pk_fma_f32 v[94:95], v[248:249], v[132:133], v[94:95] op_sel:[0,1,0]
  v_pk_fma_f32 v[74:75], v[244:245], v[132:133], v[74:75] op_sel:[0,1,0]
  v_pk_mul_f32 v[92:93], v[92:93], v[132:133] op_sel_hi:[1,0]
  v_pk_mul_f32 v[94:95], v[94:95], v[132:133] op_sel_hi:[1,0]
  v_cvt_pk_bf16_f32 v16, v72, v73
  v_cvt_pk_bf16_f32 v17, v74, v75
  v_mul_f32 v132, 0x3eb8aa3b, v132
  v_cvt_pk_bf16_f32 v18, v92, v93
  v_cvt_pk_bf16_f32 v19, v94, v95
  v_pk_fma_f32 v[96:97], v[246:247], v[136:137], v[96:97] op_sel:[0,1,0]
  v_pk_fma_f32 v[76:77], v[242:243], v[136:137], v[76:77] op_sel:[0,1,0]
  v_pk_fma_f32 v[98:99], v[248:249], v[136:137], v[98:99] op_sel:[0,1,0]
  v_pk_fma_f32 v[78:79], v[244:245], v[136:137], v[78:79] op_sel:[0,1,0]
  v_pk_mul_f32 v[96:97], v[96:97], v[136:137] op_sel_hi:[1,0]
  v_pk_mul_f32 v[98:99], v[98:99], v[136:137] op_sel_hi:[1,0]
  v_cvt_pk_bf16_f32 v20, v76, v77
  v_cvt_pk_bf16_f32 v21, v78, v79
  v_mul_f32 v136, 0x3eb8aa3b, v136
  v_cvt_pk_bf16_f32 v22, v96, v97
  v_cvt_pk_bf16_f32 v23, v98, v99
  v_pk_fma_f32 v[100:101], v[246:247], v[140:141], v[100:101] op_sel:[0,1,0]
  v_pk_fma_f32 v[80:81], v[242:243], v[140:141], v[80:81] op_sel:[0,1,0]
  v_pk_fma_f32 v[102:103], v[248:249], v[140:141], v[102:103] op_sel:[0,1,0]
  v_pk_fma_f32 v[82:83], v[244:245], v[140:141], v[82:83] op_sel:[0,1,0]
  v_pk_mul_f32 v[100:101], v[100:101], v[140:141] op_sel_hi:[1,0]
  v_pk_mul_f32 v[102:103], v[102:103], v[140:141] op_sel_hi:[1,0]
  v_cvt_pk_bf16_f32 v24, v80, v81
  v_cvt_pk_bf16_f32 v25, v82, v83
  v_mul_f32 v140, 0x3eb8aa3b, v140
  v_cvt_pk_bf16_f32 v26, v100, v101
  v_cvt_pk_bf16_f32 v27, v102, v103
  v_mfma_f32_16x16x16_bf16 v[68:71], v[10:11], v[12:13], v[176:179]
  v_mfma_f32_16x16x16_bf16 v[88:91], v[14:15], v[12:13], v[194:197]
  v_mfma_f32_16x16x16_bf16 v[72:75], v[14:15], v[16:17], v[198:201]
  v_mfma_f32_16x16x16_bf16 v[92:95], v[18:19], v[16:17], v[194:197]
  v_mfma_f32_16x16x16_bf16 v[76:79], v[18:19], v[20:21], v[198:201]
  v_mfma_f32_16x16x16_bf16 v[96:99], v[22:23], v[20:21], v[194:197]
  v_mfma_f32_16x16x16_bf16 v[80:83], v[22:23], v[24:25], v[198:201]
  v_mfma_f32_16x16x16_bf16 v[100:103], v[26:27], v[24:25], v[194:197]
  v_pk_fma_f32 v[104:105], v[48:49], v[250:251], v[104:105] op_sel_hi:[1,0,1]
  v_pk_fma_f32 v[106:107], v[50:51], v[250:251], v[106:107] op_sel_hi:[1,0,1]
  v_pk_mul_f32 v[104:105], v[104:105], v[144:145]
  v_pk_mul_f32 v[106:107], v[106:107], v[146:147]
  v_cvt_pk_bf16_f32 v164, v104, v105
  v_cvt_pk_bf16_f32 v165, v106, v107
  v_pk_fma_f32 v[108:109], v[52:53], v[250:251], v[108:109] op_sel_hi:[1,0,1]
  v_pk_fma_f32 v[110:111], v[54:55], v[250:251], v[110:111] op_sel_hi:[1,0,1]
  v_pk_mul_f32 v[108:109], v[108:109], v[148:149]
  v_pk_mul_f32 v[110:111], v[110:111], v[150:151]
  v_cvt_pk_bf16_f32 v166, v108, v109
  v_cvt_pk_bf16_f32 v167, v110, v111
  v_pk_fma_f32 v[112:113], v[56:57], v[250:251], v[112:113] op_sel_hi:[1,0,1]
  v_pk_fma_f32 v[114:115], v[58:59], v[250:251], v[114:115] op_sel_hi:[1,0,1]
  v_pk_mul_f32 v[112:113], v[112:113], v[152:153]
  v_pk_mul_f32 v[114:115], v[114:115], v[154:155]
  v_cvt_pk_bf16_f32 v168, v112, v113
  v_cvt_pk_bf16_f32 v169, v114, v115
  s_cmp_lg_u32 s77, 0
  s_cbranch_scc1 L_sig_1820279
  s_mov_b32 exec_lo, 15
  s_mov_b32 exec_hi, 0
  buffer_atomic_add v251, v223, s[28:31], 0 offen offset:64 sc1
  s_mov_b64 exec, -1
L_sig_1820279:
  v_pk_fma_f32 v[116:117], v[60:61], v[250:251], v[116:117] op_sel_hi:[1,0,1]
  v_pk_fma_f32 v[118:119], v[62:63], v[250:251], v[118:119] op_sel_hi:[1,0,1]
  v_pk_mul_f32 v[116:117], v[116:117], v[156:157]
  v_pk_mul_f32 v[118:119], v[118:119], v[158:159]
  v_cvt_pk_bf16_f32 v170, v116, v117
  v_cvt_pk_bf16_f32 v171, v118, v119
  v_pk_fma_f32 v[120:121], v[64:65], v[250:251], v[120:121] op_sel_hi:[1,0,1]
  v_pk_fma_f32 v[122:123], v[66:67], v[250:251], v[122:123] op_sel_hi:[1,0,1]
  v_pk_mul_f32 v[120:121], v[120:121], v[160:161]
  v_pk_mul_f32 v[122:123], v[122:123], v[162:163]
  v_cvt_pk_bf16_f32 v172, v120, v121
  v_cvt_pk_bf16_f32 v173, v122, v123
  v_max3_f32 v32, v68, v69, v88
  v_max3_f32 v33, v70, v71, v90
  v_max3_f32 v36, v72, v73, v92
  v_max3_f32 v37, v74, v75, v94
  v_max3_f32 v40, v76, v77, v96
  v_max3_f32 v41, v78, v79, v98
  v_max3_f32 v44, v80, v81, v100
  v_max3_f32 v45, v82, v83, v102
  v_max_f32 v32, v32, v89
  v_max_f32 v33, v33, v91
  v_max_f32 v36, v36, v93
  v_max_f32 v37, v37, v95
  v_max_f32 v40, v40, v97
  v_max_f32 v41, v41, v99
  v_max_f32 v44, v44, v101
  v_max_f32 v45, v45, v103
  v_max_f32 v34, v32, v33
  v_max_f32 v38, v36, v37
  v_max_f32 v42, v40, v41
  v_max_f32 v46, v44, v45
  v_mov_b32 v35, v34
  v_mov_b32 v39, v38
  v_mov_b32 v43, v42
  v_mov_b32 v47, v46
  v_permlane16_swap_b32 v34, v35
  v_permlane16_swap_b32 v38, v39
  v_permlane16_swap_b32 v42, v43
  v_permlane16_swap_b32 v46, v47
  v_max_f32 v34, v34, v35
  v_max_f32 v38, v38, v39
  v_max_f32 v42, v42, v43
  v_max_f32 v46, v46, v47
  v_mov_b32 v35, v34
  v_mov_b32 v39, v38
  v_mov_b32 v43, v42
  v_mov_b32 v47, v46
  v_permlane32_swap_b32 v34, v35
  v_permlane32_swap_b32 v38, v39
  v_permlane32_swap_b32 v42, v43
  v_permlane32_swap_b32 v46, v47
  v_max_f32 v34, v34, v35
  v_max_f32 v38, v38, v39
  v_max_f32 v42, v42, v43
  v_max_f32 v46, v46, v47
  v_pk_add_f32 v[32:33], v[32:33], v[34:35] op_sel_hi:[1,0] neg_lo:[0,1] neg_hi:[0,1]
  v_pk_add_f32 v[36:37], v[36:37], v[38:39] op_sel_hi:[1,0] neg_lo:[0,1] neg_hi:[0,1]
  v_pk_add_f32 v[40:41], v[40:41], v[42:43] op_sel_hi:[1,0] neg_lo:[0,1] neg_hi:[0,1]
  v_pk_add_f32 v[44:45], v[44:45], v[46:47] op_sel_hi:[1,0] neg_lo:[0,1] neg_hi:[0,1]
  v_pk_mul_f32 v[32:33], v[32:33], v[128:129] op_sel_hi:[1,0]
  v_pk_mul_f32 v[36:37], v[36:37], v[132:133] op_sel_hi:[1,0]
  v_pk_mul_f32 v[40:41], v[40:41], v[136:137] op_sel_hi:[1,0]
  v_pk_mul_f32 v[44:45], v[44:45], v[140:141] op_sel_hi:[1,0]
  v_exp_f32 v32, v32
  v_exp_f32 v33, v33
  v_exp_f32 v36, v36
  v_exp_f32 v37, v37
  v_exp_f32 v40, v40
  v_exp_f32 v41, v41
  v_exp_f32 v44, v44
  v_exp_f32 v45, v45
  v_cvt_pk_bf16_f32 v32, v32, v32
  v_cvt_pk_bf16_f32 v33, v33, v33
  v_cvt_pk_bf16_f32 v36, v36, v36
  v_cvt_pk_bf16_f32 v37, v37, v37
  v_cvt_pk_bf16_f32 v40, v40, v40
  v_cvt_pk_bf16_f32 v41, v41, v41
  v_cvt_pk_bf16_f32 v44, v44, v44
  v_cvt_pk_bf16_f32 v45, v45, v45
  v_and_b32 v108, v32, v202
  v_and_b32 v109, v33, v203
  v_and_b32 v110, v32, v204
  v_and_b32 v111, v33, v205
  v_and_b32 v112, v36, v202
  v_and_b32 v113, v37, v203
  v_and_b32 v114, v36, v204
  v_and_b32 v115, v37, v205
  v_and_b32 v116, v40, v202
  v_and_b32 v117, v41, v203
  v_and_b32 v118, v40, v204
  v_and_b32 v119, v41, v205
  v_and_b32 v120, v44, v202
  v_and_b32 v121, v45, v203
  v_and_b32 v122, v44, v204
  v_and_b32 v123, v45, v205
  v_mfma_f32_16x16x32_bf16 v[68:71], v[238:241], v[108:111], 0
  v_mfma_f32_16x16x32_bf16 v[88:91], v[164:167], v[108:111], 0
  v_mfma_f32_16x16x32_bf16 v[72:75], v[238:241], v[112:115], 0
  v_mfma_f32_16x16x32_bf16 v[92:95], v[166:169], v[112:115], 0
  v_mfma_f32_16x16x32_bf16 v[76:79], v[238:241], v[116:119], 0
  v_mfma_f32_16x16x32_bf16 v[96:99], v[168:171], v[116:119], 0
  v_mfma_f32_16x16x32_bf16 v[80:83], v[238:241], v[120:123], 0
  v_mfma_f32_16x16x32_bf16 v[100:103], v[170:173], v[120:123], 0
  s_add_u32 s48, s0, 10485760
  s_add_u32 s49, s0, 10518528
  v_rcp_f32 v68, v68
  v_rcp_f32 v72, v72
  s_nop 0
  v_rcp_f32 v76, v76
  s_nop 0
  v_rcp_f32 v80, v80
  v_pk_mul_f32 v[88:89], v[88:89], v[68:69] op_sel_hi:[1,0]
  v_pk_mul_f32 v[90:91], v[90:91], v[68:69] op_sel_hi:[1,0]
  v_pk_mul_f32 v[92:93], v[92:93], v[72:73] op_sel_hi:[1,0]
  v_pk_mul_f32 v[94:95], v[94:95], v[72:73] op_sel_hi:[1,0]
  v_pk_mul_f32 v[96:97], v[96:97], v[76:77] op_sel_hi:[1,0]
  v_pk_mul_f32 v[98:99], v[98:99], v[76:77] op_sel_hi:[1,0]
  v_pk_mul_f32 v[100:101], v[100:101], v[80:81] op_sel_hi:[1,0]
  v_pk_mul_f32 v[102:103], v[102:103], v[80:81] op_sel_hi:[1,0]
  v_cvt_pk_bf16_f32 v8, v88, v89
  v_cvt_pk_bf16_f32 v9, v90, v91
  v_cvt_pk_bf16_f32 v10, v92, v93
  v_cvt_pk_bf16_f32 v11, v94, v95
  v_cvt_pk_bf16_f32 v12, v96, v97
  v_cvt_pk_bf16_f32 v13, v98, v99
  v_cvt_pk_bf16_f32 v14, v100, v101
  v_cvt_pk_bf16_f32 v15, v102, v103
  s_mov_b64 exec, 1
  v_mov_b32 v233, 0
  buffer_atomic_add v233, v226, s[28:31], 0 offen offset:64 sc0 sc1
  s_mov_b64 exec, -1
  v_permlane32_swap_b32 v8, v10
  v_permlane32_swap_b32 v9, v11
  buffer_store_dwordx4 v[8:11], v229, s[28:31], s48 offen sc1
  v_permlane32_swap_b32 v12, v14
  v_permlane32_swap_b32 v13, v15
  buffer_store_dwordx4 v[12:15], v229, s[28:31], s49 offen sc1
  s_lshl_b32 s48, s72, 1
  s_add_u32 s48, s48, s79
  s_lshl_b32 s48, s48, 15
  s_lshl_b32 s49, s73, 1
  s_add_u32 s49, s49, s78
  s_lshl_b32 s50, s49, 10
  s_add_u32 s52, s48, s50
  s_add_u32 s50, s52, 10485760
  buffer_load_dwordx4 v[164:167], v227, s[28:31], s50 offen offset:0 sc1
  buffer_load_dwordx4 v[168:171], v227, s[28:31], s50 offen offset:512 sc1
  s_lshl_b32 s48, s79, 15
  s_lshl_b32 s49, s78, 12
  s_add_u32 s53, s48, s49
  s_lshl_b32 s49, s72, 16
  s_add_u32 s58, s49, s53
  s_add_u32 s48, s48, 0
  s_add_u32 s53, s53, 0
  v_add_u32 v2, s48, v213
  v_add_u32 v3, s53, v213
  s_waitcnt vmcnt(5)
  s_barrier
  ds_read_b64_tr_b16 v[8:9], v214 offset:0
  ds_read_b64_tr_b16 v[10:11], v214 offset:1024
  ds_read_b64_tr_b16 v[12:13], v214 offset:2048
  ds_read_b64_tr_b16 v[14:15], v214 offset:3072
  ds_read_b64_tr_b16 v[16:17], v214 offset:4096
  ds_read_b64_tr_b16 v[18:19], v214 offset:5120
  ds_read_b64_tr_b16 v[20:21], v214 offset:6144
  ds_read_b64_tr_b16 v[22:23], v214 offset:7168
  ds_read_b64_tr_b16 v[24:25], v214 offset:8192
  ds_read_b64_tr_b16 v[26:27], v214 offset:9216
  ds_read_b64_tr_b16 v[28:29], v214 offset:10240
  ds_read_b64_tr_b16 v[30:31], v214 offset:11264
  ds_read_b64_tr_b16 v[32:33], v214 offset:12288
  ds_read_b64_tr_b16 v[34:35], v214 offset:13312
  ds_read_b64_tr_b16 v[36:37], v214 offset:14336
  ds_read_b64_tr_b16 v[38:39], v214 offset:15360
  ds_read_b64_tr_b16 v[40:41], v214 offset:16384
  ds_read_b64_tr_b16 v[42:43], v214 offset:17408
  ds_read_b64_tr_b16 v[44:45], v214 offset:18432
  ds_read_b64_tr_b16 v[46:47], v214 offset:19456
  ds_read_b64_tr_b16 v[48:49], v214 offset:20480
  ds_read_b64_tr_b16 v[50:51], v214 offset:21504
  ds_read_b64_tr_b16 v[52:53], v214 offset:22528
  ds_read_b64_tr_b16 v[54:55], v214 offset:23552
  ds_read_b64_tr_b16 v[56:57], v214 offset:24576
  ds_read_b64_tr_b16 v[58:59], v214 offset:25600
  ds_read_b64_tr_b16 v[60:61], v214 offset:26624
  ds_read_b64_tr_b16 v[62:63], v214 offset:27648
  ds_read_b64_tr_b16 v[64:65], v214 offset:28672
  ds_read_b64_tr_b16 v[66:67], v214 offset:29696
  ds_read_b64_tr_b16 v[68:69], v214 offset:30720
  ds_read_b64_tr_b16 v[70:71], v214 offset:31744
  s_waitcnt vmcnt(4)
  v_readfirstlane_b32 s3, v233
  s_cmp_lt_u32 s3, 8
  s_cbranch_scc1 L_poll_1822280_r
L_poll_1822280:
  s_waitcnt vmcnt(2)
  s_add_u32 m0, s53, 0
  s_add_u32 s55, s58, 12582912
  buffer_load_dwordx4 v213, s[28:31], s55 offen sc1 lds
  buffer_load_dwordx4 v213, s[28:31], s55 offen offset:1024 sc1 lds
  buffer_load_dwordx4 v213, s[28:31], s55 offen offset:2048 sc1 lds
  buffer_load_dwordx4 v213, s[28:31], s55 offen offset:3072 sc1 lds
  s_add_u32 m0, s53, 8192
  s_add_u32 s55, s58, 12591104
  buffer_load_dwordx4 v213, s[28:31], s55 offen sc1 lds
  buffer_load_dwordx4 v213, s[28:31], s55 offen offset:1024 sc1 lds
  buffer_load_dwordx4 v213, s[28:31], s55 offen offset:2048 sc1 lds
  buffer_load_dwordx4 v213, s[28:31], s55 offen offset:3072 sc1 lds
  s_add_u32 m0, s53, 16384
  s_add_u32 s55, s58, 12599296
  buffer_load_dwordx4 v213, s[28:31], s55 offen sc1 lds
  buffer_load_dwordx4 v213, s[28:31], s55 offen offset:1024 sc1 lds
  buffer_load_dwordx4 v213, s[28:31], s55 offen offset:2048 sc1 lds
  buffer_load_dwordx4 v213, s[28:31], s55 offen offset:3072 sc1 lds
  ds_read_b64_tr_b16 v[72:73], v214 offset:32768
  ds_read_b64_tr_b16 v[74:75], v214 offset:33792
  ds_read_b64_tr_b16 v[76:77], v214 offset:34816
  ds_read_b64_tr_b16 v[78:79], v214 offset:35840
  ds_read_b64_tr_b16 v[80:81], v214 offset:36864
  ds_read_b64_tr_b16 v[82:83], v214 offset:37888
  ds_read_b64_tr_b16 v[84:85], v214 offset:38912
  ds_read_b64_tr_b16 v[86:87], v214 offset:39936
  ds_read_b64_tr_b16 v[88:89], v214 offset:40960
  ds_read_b64_tr_b16 v[90:91], v214 offset:41984
  ds_read_b64_tr_b16 v[92:93], v214 offset:43008
  ds_read_b64_tr_b16 v[94:95], v214 offset:44032
  ds_read_b64_tr_b16 v[96:97], v214 offset:45056
  ds_read_b64_tr_b16 v[98:99], v214 offset:46080
  ds_read_b64_tr_b16 v[100:101], v214 offset:47104
  ds_read_b64_tr_b16 v[102:103], v214 offset:48128
  ds_read_b64_tr_b16 v[104:105], v214 offset:49152
  ds_read_b64_tr_b16 v[106:107], v214 offset:50176
  ds_read_b64_tr_b16 v[108:109], v214 offset:51200
  ds_read_b64_tr_b16 v[110:111], v214 offset:52224
  ds_read_b64_tr_b16 v[112:113], v214 offset:53248
  ds_read_b64_tr_b16 v[114:115], v214 offset:54272
  ds_read_b64_tr_b16 v[116:117], v214 offset:55296
  ds_read_b64_tr_b16 v[118:119], v214 offset:56320
  ds_read_b64_tr_b16 v[120:121], v214 offset:57344
  ds_read_b64_tr_b16 v[122:123], v214 offset:58368
  ds_read_b64_tr_b16 v[124:125], v214 offset:59392
  ds_read_b64_tr_b16 v[126:127], v214 offset:60416
  ds_read_b64_tr_b16 v[128:129], v214 offset:61440
  ds_read_b64_tr_b16 v[130:131], v214 offset:62464
  ds_read_b64_tr_b16 v[132:133], v214 offset:63488
  ds_read_b64_tr_b16 v[134:135], v214 offset:64512
  s_waitcnt vmcnt(12)
  v_lshlrev_b32 v172, 16, v164
  v_and_b32 v173, 0xffff0000, v164
  v_lshlrev_b32 v174, 16, v165
  v_and_b32 v175, 0xffff0000, v165
  v_lshlrev_b32 v176, 16, v166
  v_and_b32 v177, 0xffff0000, v166
  v_lshlrev_b32 v178, 16, v167
  v_and_b32 v179, 0xffff0000, v167
  v_lshlrev_b32 v180, 16, v168
  v_and_b32 v181, 0xffff0000, v168
  v_lshlrev_b32 v182, 16, v169
  v_and_b32 v183, 0xffff0000, v169
  v_lshlrev_b32 v184, 16, v170
  v_and_b32 v185, 0xffff0000, v170
  v_lshlrev_b32 v186, 16, v171
  v_and_b32 v187, 0xffff0000, v171
  s_mul_i32 s49, s77, 2304
  s_add_u32 s49, s49, 65536
  v_and_b32 v5, 31, v228
  v_lshlrev_b32 v190, 3, v5
  v_mul_u32_u24 v5, 72, v5
  v_lshrrev_b32 v4, 5, v228
  v_lshl_add_u32 v5, v4, 3, v5
  v_add_u32 v188, s49, v5
  v_lshl_add_u32 v191, v4, 11, v190
  v_bfe_u32 v5, v228, 2, 2
  v_lshl_add_u32 v5, v4, 2, v5
  v_mul_u32_u24 v5, 72, v5
  v_bfe_u32 v4, v228, 4, 1
  v_lshl_add_u32 v5, v4, 5, v5
  v_and_b32 v4, 3, v228
  v_lshl_add_u32 v5, v4, 3, v5
  v_add_u32 v189, s49, v5
  s_lshl_b32 s50, s72, 1
  s_add_u32 s50, s50, s79
  s_lshl_b32 s50, s50, 4
  s_lshl_b32 s3, s73, 1
  s_add_u32 s50, s50, s3
  s_add_u32 s50, s50, s78
  s_lshl_b32 s50, s50, 8
  s_add_u32 s50, s50, 1310720
  s_add_u32 s52, s52, 14680064
  s_lshl_b32 s51, s72, 1
  s_add_u32 s51, s51, s79
  s_lshl_b32 s51, s51, 12
  s_add_u32 s51, s51, 1310720
  s_add_u32 s54, s1, 10485760
  s_add_u32 m0, s53, 24576
  s_add_u32 s55, s58, 12607488
  buffer_load_dwordx4 v213, s[28:31], s55 offen sc1 lds
  buffer_load_dwordx4 v213, s[28:31], s55 offen offset:1024 sc1 lds
  buffer_load_dwordx4 v213, s[28:31], s55 offen offset:2048 sc1 lds
  buffer_load_dwordx4 v213, s[28:31], s55 offen offset:3072 sc1 lds
  s_waitcnt vmcnt(12)
  ds_read_b32 v164, v3 offset:0
  ds_read_b32 v165, v3 offset:1024
  ds_read_b32 v166, v3 offset:2048
  ds_read_b32 v167, v3 offset:3072
  s_waitcnt lgkmcnt(0)
  v_max3_u32 v7, v164, v165, v166
  v_max_u32 v7, v7, v167
  v_cmp_eq_u32 vcc, -1, v7
  s_cbranch_vccnz L_tag_1824281_r
L_tag_1824281:
  s_barrier
  ds_read_b128 v[152:155], v2 offset:0
  ds_read_b128 v[156:159], v2 offset:1024
  ds_read_b128 v[160:163], v2 offset:2048
  s_waitcnt lgkmcnt(2)
  v_mfma_f32_32x32x16_bf16 v[136:151], v[8:11], v[152:155], v[172:187]
  ds_read_b128 v[152:155], v2 offset:3072
  s_waitcnt lgkmcnt(2)
  v_mfma_f32_32x32x16_bf16 v[136:151], v[12:15], v[156:159], v[136:151]
  s_waitcnt vmcnt(8)
  ds_read_b32 v164, v3 offset:8192
  ds_read_b32 v165, v3 offset:9216
  ds_read_b32 v166, v3 offset:10240
  ds_read_b32 v167, v3 offset:11264
  ds_read_b128 v[156:159], v2 offset:4096
  s_waitcnt lgkmcnt(6)
  v_mfma_f32_32x32x16_bf16 v[136:151], v[16:19], v[160:163], v[136:151]
  ds_read_b128 v[160:163], v2 offset:5120
  s_waitcnt lgkmcnt(6)
  v_mfma_f32_32x32x16_bf16 v[136:151], v[20:23], v[152:155], v[136:151]
  ds_read_b128 v[152:155], v2 offset:6144
  s_waitcnt lgkmcnt(2)
  v_mfma_f32_32x32x16_bf16 v[136:151], v[24:27], v[156:159], v[136:151]
  v_max3_u32 v7, v164, v165, v166
  v_max_u32 v7, v7, v167
  v_cmp_eq_u32 vcc, -1, v7
  s_cbranch_vccnz L_tag_1826282_r
L_tag_1826282:
  s_barrier
  ds_read_b128 v[156:159], v2 offset:7168
  s_waitcnt lgkmcnt(2)
  v_mfma_f32_32x32x16_bf16 v[136:151], v[28:31], v[160:163], v[136:151]
  ds_read_b128 v[160:163], v2 offset:8192
  s_waitcnt lgkmcnt(2)
  v_mfma_f32_32x32x16_bf16 v[136:151], v[32:35], v[152:155], v[136:151]
  ds_read_b128 v[152:155], v2 offset:9216
  s_waitcnt lgkmcnt(2)
  v_mfma_f32_32x32x16_bf16 v[136:151], v[36:39], v[156:159], v[136:151]
  ds_read_b128 v[156:159], v2 offset:10240
  s_waitcnt lgkmcnt(2)
  v_mfma_f32_32x32x16_bf16 v[136:151], v[40:43], v[160:163], v[136:151]
  ds_read_b128 v[160:163], v2 offset:11264
  s_waitcnt lgkmcnt(2)
  v_mfma_f32_32x32x16_bf16 v[136:151], v[44:47], v[152:155], v[136:151]
  s_waitcnt vmcnt(4)
  ds_read_b32 v164, v3 offset:16384
  ds_read_b32 v165, v3 offset:17408
  ds_read_b32 v166, v3 offset:18432
  ds_read_b32 v167, v3 offset:19456
  ds_read_b128 v[152:155], v2 offset:12288
  s_waitcnt lgkmcnt(6)
  v_mfma_f32_32x32x16_bf16 v[136:151], v[48:51], v[156:159], v[136:151]
  ds_read_b128 v[156:159], v2 offset:13312
  s_waitcnt lgkmcnt(6)
  v_mfma_f32_32x32x16_bf16 v[136:151], v[52:55], v[160:163], v[136:151]
  ds_read_b128 v[160:163], v2 offset:14336
  s_waitcnt lgkmcnt(2)
  v_mfma_f32_32x32x16_bf16 v[136:151], v[56:59], v[152:155], v[136:151]
  v_max3_u32 v7, v164, v165, v166
  v_max_u32 v7, v7, v167
  v_cmp_eq_u32 vcc, -1, v7
  s_cbranch_vccnz L_tag_1828283_r
L_tag_1828283:
  s_barrier
  ds_read_b128 v[152:155], v2 offset:15360
  s_waitcnt lgkmcnt(2)
  v_mfma_f32_32x32x16_bf16 v[136:151], v[60:63], v[156:159], v[136:151]
  ds_read_b128 v[156:159], v2 offset:16384
  s_waitcnt lgkmcnt(2)
  v_mfma_f32_32x32x16_bf16 v[136:151], v[64:67], v[160:163], v[136:151]
  ds_read_b128 v[160:163], v2 offset:17408
  s_waitcnt lgkmcnt(2)
  v_mfma_f32_32x32x16_bf16 v[136:151], v[68:71], v[152:155], v[136:151]
  ds_read_b128 v[152:155], v2 offset:18432
  s_waitcnt lgkmcnt(2)
  v_mfma_f32_32x32x16_bf16 v[136:151], v[72:75], v[156:159], v[136:151]
  ds_read_b128 v[156:159], v2 offset:19456
  s_waitcnt lgkmcnt(2)
  v_mfma_f32_32x32x16_bf16 v[136:151], v[76:79], v[160:163], v[136:151]
  s_waitcnt vmcnt(0)
  ds_read_b32 v164, v3 offset:24576
  ds_read_b32 v165, v3 offset:25600
  ds_read_b32 v166, v3 offset:26624
  ds_read_b32 v167, v3 offset:27648
  ds_read_b128 v[160:163], v2 offset:20480
  s_waitcnt lgkmcnt(6)
  v_mfma_f32_32x32x16_bf16 v[136:151], v[80:83], v[152:155], v[136:151]
  ds_read_b128 v[152:155], v2 offset:21504
  s_waitcnt lgkmcnt(6)
  v_mfma_f32_32x32x16_bf16 v[136:151], v[84:87], v[156:159], v[136:151]
  ds_read_b128 v[156:159], v2 offset:22528
  s_waitcnt lgkmcnt(2)
  v_mfma_f32_32x32x16_bf16 v[136:151], v[88:91], v[160:163], v[136:151]
  v_max3_u32 v7, v164, v165, v166
  v_max_u32 v7, v7, v167
  v_cmp_eq_u32 vcc, -1, v7
  s_cbranch_vccnz L_tag_1830284_r
L_tag_1830284:
  s_barrier
  ds_read_b128 v[160:163], v2 offset:23552
  s_waitcnt lgkmcnt(2)
  v_mfma_f32_32x32x16_bf16 v[136:151], v[92:95], v[152:155], v[136:151]
  ds_read_b128 v[152:155], v2 offset:24576
  s_waitcnt lgkmcnt(2)
  v_mfma_f32_32x32x16_bf16 v[136:151], v[96:99], v[156:159], v[136:151]
  ds_read_b128 v[156:159], v2 offset:25600
  s_waitcnt lgkmcnt(2)
  v_mfma_f32_32x32x16_bf16 v[136:151], v[100:103], v[160:163], v[136:151]
  ds_read_b128 v[160:163], v2 offset:26624
  s_waitcnt lgkmcnt(2)
  v_mfma_f32_32x32x16_bf16 v[136:151], v[104:107], v[152:155], v[136:151]
  ds_read_b128 v[152:155], v2 offset:27648
  s_waitcnt lgkmcnt(2)
  v_mfma_f32_32x32x16_bf16 v[136:151], v[108:111], v[156:159], v[136:151]
  ds_read_b128 v[156:159], v2 offset:28672
  s_waitcnt lgkmcnt(2)
  v_mfma_f32_32x32x16_bf16 v[136:151], v[112:115], v[160:163], v[136:151]
  ds_read_b128 v[160:163], v2 offset:29696
  s_waitcnt lgkmcnt(2)
  v_mfma_f32_32x32x16_bf16 v[136:151], v[116:119], v[152:155], v[136:151]
  ds_read_b128 v[152:155], v2 offset:30720
  s_waitcnt lgkmcnt(2)
  v_mfma_f32_32x32x16_bf16 v[136:151], v[120:123], v[156:159], v[136:151]
  ds_read_b128 v[156:159], v2 offset:31744
  s_waitcnt lgkmcnt(2)
  v_mfma_f32_32x32x16_bf16 v[136:151], v[124:127], v[160:163], v[136:151]
  s_waitcnt lgkmcnt(1)
  v_mfma_f32_32x32x16_bf16 v[136:151], v[128:131], v[152:155], v[136:151]
  s_waitcnt lgkmcnt(0)
  v_mfma_f32_32x32x16_bf16 v[136:151], v[132:135], v[156:159], v[136:151]
  s_nop 11
  v_cvt_pk_bf16_f32 v164, v136, v137
  v_cvt_pk_bf16_f32 v165, v138, v139
  v_cvt_pk_bf16_f32 v166, v140, v141
  v_cvt_pk_bf16_f32 v167, v142, v143
  v_cvt_pk_bf16_f32 v168, v144, v145
  v_cvt_pk_bf16_f32 v169, v146, v147
  v_cvt_pk_bf16_f32 v170, v148, v149
  v_cvt_pk_bf16_f32 v171, v150, v151
  v_lshlrev_b32 v172, 16, v164
  v_and_b32 v173, 0xffff0000, v164
  v_lshlrev_b32 v174, 16, v165
  v_and_b32 v175, 0xffff0000, v165
  v_lshlrev_b32 v176, 16, v166
  v_and_b32 v177, 0xffff0000, v166
  v_lshlrev_b32 v178, 16, v167
  v_and_b32 v179, 0xffff0000, v167
  v_lshlrev_b32 v180, 16, v168
  v_and_b32 v181, 0xffff0000, v168
  v_lshlrev_b32 v182, 16, v169
  v_and_b32 v183, 0xffff0000, v169
  v_lshlrev_b32 v184, 16, v170
  v_and_b32 v185, 0xffff0000, v170
  v_lshlrev_b32 v186, 16, v171
  v_and_b32 v187, 0xffff0000, v171
  v_pk_add_f32 v[4:5], v[172:173], v[174:175]
  v_pk_mul_f32 v[6:7], v[172:173], v[172:173]
  v_pk_add_f32 v[152:153], v[176:177], v[178:179]
  v_pk_mul_f32 v[154:155], v[174:175], v[174:175]
  v_pk_fma_f32 v[6:7], v[176:177], v[176:177], v[6:7]
  v_pk_fma_f32 v[154:155], v[178:179], v[178:179], v[154:155]
  v_pk_add_f32 v[4:5], v[4:5], v[180:181]
  v_pk_fma_f32 v[6:7], v[180:181], v[180:181], v[6:7]
  v_pk_add_f32 v[152:153], v[152:153], v[182:183]
  v_pk_fma_f32 v[154:155], v[182:183], v[182:183], v[154:155]
  v_pk_add_f32 v[4:5], v[4:5], v[184:185]
  v_pk_fma_f32 v[6:7], v[184:185], v[184:185], v[6:7]
  v_pk_add_f32 v[152:153], v[152:153], v[186:187]
  v_pk_fma_f32 v[154:155], v[186:187], v[186:187], v[154:155]
  v_pk_add_f32 v[4:5], v[4:5], v[152:153]
  v_pk_add_f32 v[6:7], v[6:7], v[154:155]
  v_add_f32 v4, v4, v5
  v_add_f32 v5, v6, v7
  v_mov_b32 v6, v4
  v_mov_b32 v7, v5
  s_nop 0
  v_permlane32_swap_b32 v4, v6
  v_permlane32_swap_b32 v5, v7
  v_pk_add_f32 v[4:5], v[4:5], v[6:7]
  v_and_b32 v5, 0x7fffffff, v5
  s_mov_b32 exec_hi, 0
  buffer_store_dwordx2 v[4:5], v190, s[28:31], s50 offen sc1
  s_mov_b32 exec_hi, -1
  buffer_store_dwordx4 v[164:167], v227, s[28:31], s52 offen offset:0 sc1
  buffer_store_dwordx4 v[168:171], v227, s[28:31], s52 offen offset:512 sc1
  v_mov_b32 v136, -1
  v_mov_b32 v137, -1
  v_mov_b32 v138, -1
  v_mov_b32 v139, -1
  s_add_u32 s48, s1, 10485760
  buffer_store_dwordx4 v[136:139], v213, s[28:31], s48 offen offset:0 sc1
  buffer_store_dwordx4 v[136:139], v213, s[28:31], s48 offen offset:1024 sc1
  s_add_u32 s49, s62, 10485760
  buffer_store_dwordx4 v[136:139], v232, s[28:31], s49 offen sc1
  s_add_u32 s49, s49, s65
  buffer_store_dwordx4 v[136:139], v232, s[28:31], s49 offen sc1
  s_add_u32 s49, s49, s65
  buffer_store_dwordx4 v[136:139], v232, s[28:31], s49 offen sc1
  s_add_u32 s49, s49, s65
  buffer_store_dwordx4 v[136:139], v232, s[28:31], s49 offen sc1
  s_lshl_b32 s48, s75, 7
  s_lshl_b32 s49, s77, 5
  s_add_u32 s49, s48, s49
  v_lshrrev_b32 v2, 5, v228
  v_lshlrev_b32 v1, 3, v2
  buffer_load_dwordx2 v[24:25], v1, s[36:39], s49 offen offset:0
  buffer_load_dwordx2 v[26:27], v1, s[36:39], s49 offen offset:16
  s_lshl_b32 s49, s78, 6
  s_add_u32 s48, s48, s49
  v_and_b32 v3, 31, v228
  v_lshlrev_b32 v1, 1, v3
  buffer_load_ushort v32, v1, s[40:43], s48 offen
  v_mov_b32 v28, 0xbdd2d3e8
  v_mov_b32 v29, 0xc0135761
  v_mov_b32 v30, 1.0
  v_lshlrev_b32 v1, 10, v3
  v_lshl_add_u32 v31, v2, 4, v1
  buffer_load_dwordx2 v[8:9], v191, s[28:31], s51 offen offset:0 sc1
  buffer_load_dwordx2 v[10:11], v191, s[28:31], s51 offen offset:256 sc1
  buffer_load_dwordx2 v[12:13], v191, s[28:31], s51 offen offset:512 sc1
  buffer_load_dwordx2 v[14:15], v191, s[28:31], s51 offen offset:768 sc1
  buffer_load_dwordx2 v[16:17], v191, s[28:31], s51 offen offset:1024 sc1
  buffer_load_dwordx2 v[18:19], v191, s[28:31], s51 offen offset:1280 sc1
  buffer_load_dwordx2 v[20:21], v191, s[28:31], s51 offen offset:1536 sc1
  buffer_load_dwordx2 v[22:23], v191, s[28:31], s51 offen offset:1792 sc1
  s_getpc_b64 s[4:5]
L_pc_1832285:
  s_lshl_b32 s3, s71, 2
  s_add_u32 s3, s3, s77
  s_lshl_b32 s3, s3, 2
  v_and_b32 v4, 3, v228
  v_add_u32 v4, s3, v4
  v_lshlrev_b32 v4, 7, v4
  v_min_u32 v4, L_end-L_pc_1832285, v4
  v_mov_b32 v5, s5
  v_add_co_u32 v4, vcc, s4, v4
  v_addc_co_u32 v5, vcc, 0, v5, vcc
  global_load_dword v212, v[4:5], off
  s_waitcnt vmcnt(1)
  v_max3_u32 v7, v9, v11, v13
  v_max3_u32 v7, v7, v15, v17
  v_max3_u32 v7, v7, v19, v21
  v_max_u32 v7, v7, v23
  v_cmp_eq_u32 vcc, -1, v7
  s_cbranch_vccnz L_tag_1832286_r
L_tag_1832286:
  v_pk_add_f32 v[8:9], v[8:9], v[16:17]
  v_pk_add_f32 v[10:11], v[10:11], v[18:19]
  v_pk_add_f32 v[12:13], v[12:13], v[20:21]
  v_pk_add_f32 v[14:15], v[14:15], v[22:23]
  v_pk_add_f32 v[8:9], v[8:9], v[12:13]
  v_pk_add_f32 v[10:11], v[10:11], v[14:15]
  v_pk_add_f32 v[8:9], v[8:9], v[10:11]
  v_mov_b32 v6, v8
  v_mov_b32 v7, v9
  s_nop 0
  v_permlane32_swap_b32 v8, v6
  v_permlane32_swap_b32 v9, v7
  v_pk_add_f32 v[4:5], v[8:9], v[6:7]
  v_mul_f32 v4, 0xbb000000, v4
  v_mul_f32 v5, 0x3b000000, v5
  v_fma_f32 v5, -v4, v4, v5
  v_max_f32 v5, 0, v5
  v_mov_b32 v6, 0x2edbe6ff
  v_fmac_f32 v6, 0x3f800054, v5
  v_rsq_f32 v6, v6
  s_nop 0
  v_mul_f32 v7, v4, v6
  v_pk_fma_f32 v[172:173], v[172:173], v[6:7], v[6:7] op_sel:[0,0,1] op_sel_hi:[1,0,1]
  v_pk_fma_f32 v[174:175], v[174:175], v[6:7], v[6:7] op_sel:[0,0,1] op_sel_hi:[1,0,1]
  v_pk_fma_f32 v[176:177], v[176:177], v[6:7], v[6:7] op_sel:[0,0,1] op_sel_hi:[1,0,1]
  v_pk_fma_f32 v[178:179], v[178:179], v[6:7], v[6:7] op_sel:[0,0,1] op_sel_hi:[1,0,1]
  v_pk_fma_f32 v[180:181], v[180:181], v[6:7], v[6:7] op_sel:[0,0,1] op_sel_hi:[1,0,1]
  v_pk_fma_f32 v[182:183], v[182:183], v[6:7], v[6:7] op_sel:[0,0,1] op_sel_hi:[1,0,1]
  v_pk_fma_f32 v[184:185], v[184:185], v[6:7], v[6:7] op_sel:[0,0,1] op_sel_hi:[1,0,1]
  v_pk_fma_f32 v[186:187], v[186:187], v[6:7], v[6:7] op_sel:[0,0,1] op_sel_hi:[1,0,1]
  v_cvt_pk_bf16_f32 v164, v172, v173
  v_cvt_pk_bf16_f32 v165, v174, v175
  v_cvt_pk_bf16_f32 v166, v176, v177
  v_cvt_pk_bf16_f32 v167, v178, v179
  v_cvt_pk_bf16_f32 v168, v180, v181
  v_cvt_pk_bf16_f32 v169, v182, v183
  v_cvt_pk_bf16_f32 v170, v184, v185
  v_cvt_pk_bf16_f32 v171, v186, v187
  ds_write_b64 v188, v[164:165] offset:0
  ds_write_b64 v188, v[166:167] offset:16
  ds_write_b64 v188, v[168:169] offset:32
  ds_write_b64 v188, v[170:171] offset:48
  s_waitcnt lgkmcnt(0)
  ds_read_b64_tr_b16 v[172:173], v189 offset:0
  ds_read_b64_tr_b16 v[174:175], v189 offset:576
  ds_read_b64_tr_b16 v[176:177], v189 offset:1152
  ds_read_b64_tr_b16 v[178:179], v189 offset:1728
  s_waitcnt lgkmcnt(2)
  buffer_store_dwordx4 v[172:175], v213, s[28:31], s54 offen offset:0 sc1
  s_waitcnt lgkmcnt(0)
  buffer_store_dwordx4 v[176:179], v213, s[28:31], s54 offen offset:1024 sc1
  s_barrier
  s_cmp_lg_u32 s77, 0
  s_cbranch_scc1 L_sig_1834287
  s_mov_b32 exec_lo, 15
  s_mov_b32 exec_hi, 0
  buffer_atomic_add v251, v224, s[28:31], 0 offen offset:68 sc1
  s_mov_b64 exec, -1
L_sig_1834287:
  s_cmp_eq_u32 s76, 0
  s_cbranch_scc1 L_role4_1834288
  s_mul_i32 s58, s74, 524288
  s_mul_i32 s66, s77, 32768
  s_add_u32 s58, s58, s66
  s_add_u32 s58, s58, 16777216
  s_mov_b64 exec, 1
  v_mov_b32 v233, 0
  buffer_atomic_add v233, v210, s[28:31], 0 offen offset:104 sc0 sc1
  s_mov_b64 exec, -1
  v_lshlrev_b32 v16, 16, v24
  v_and_b32 v17, 0xffff0000, v24
  v_lshlrev_b32 v18, 16, v25
  v_and_b32 v19, 0xffff0000, v25
  v_lshlrev_b32 v20, 16, v26
  v_and_b32 v21, 0xffff0000, v26
  v_lshlrev_b32 v22, 16, v27
  v_and_b32 v23, 0xffff0000, v27
  s_add_u32 s66, s58, 4096
  s_waitcnt vmcnt(0)
  v_readfirstlane_b32 s3, v233
  s_cmp_lt_u32 s3, 8
  s_cbranch_scc1 L_poll_1836290_r
L_poll_1836290:
  buffer_load_dwordx4 v[156:159], v213, s[28:31], s66 offen offset:0 sc1
  buffer_load_dwordx4 v[160:163], v213, s[28:31], s66 offen offset:1024 sc1
  buffer_load_dwordx4 v[164:167], v213, s[28:31], s66 offen offset:2048 sc1
  buffer_load_dwordx4 v[168:171], v213, s[28:31], s66 offen offset:3072 sc1
  s_add_u32 s66, s58, 12288
  buffer_load_dwordx4 v[172:175], v213, s[28:31], s66 offen offset:0 sc1
  buffer_load_dwordx4 v[176:179], v213, s[28:31], s66 offen offset:1024 sc1
  buffer_load_dwordx4 v[180:183], v213, s[28:31], s66 offen offset:2048 sc1
  buffer_load_dwordx4 v[184:187], v213, s[28:31], s66 offen offset:3072 sc1
  s_add_u32 s66, s58, 20480
  buffer_load_dwordx4 v[108:111], v213, s[28:31], s66 offen offset:0 sc1
  buffer_load_dwordx4 v[112:115], v213, s[28:31], s66 offen offset:1024 sc1
  buffer_load_dwordx4 v[116:119], v213, s[28:31], s66 offen offset:2048 sc1
  s_barrier
  s_waitcnt vmcnt(10)
  v_cmp_eq_u32 vcc, -1, v156
  s_cbranch_vccnz L_tag_1838291_r
L_tag_1838291:
  v_mfma_f32_32x32x16_bf16 v[36:51], a[32:35], v[156:159], 0
  s_waitcnt vmcnt(9)
  v_cmp_eq_u32 vcc, -1, v160
  v_mfma_f32_32x32x16_bf16 v[52:67], a[36:39], v[156:159], 0
  s_cbranch_vccnz L_tag_1842292_r
L_tag_1842292:
  buffer_load_dwordx4 v[156:159], v213, s[28:31], s66 offen offset:3072 sc1
  v_mfma_f32_32x32x16_bf16 v[36:51], a[40:43], v[160:163], v[36:51]
  s_waitcnt vmcnt(9)
  v_cmp_eq_u32 vcc, -1, v164
  v_mfma_f32_32x32x16_bf16 v[52:67], a[44:47], v[160:163], v[52:67]
  s_cbranch_vccnz L_tag_1844293_r
L_tag_1844293:
  s_add_u32 s66, s58, 28672
  buffer_load_dwordx4 v[160:163], v213, s[28:31], s66 offen offset:0 sc1
  v_mfma_f32_32x32x16_bf16 v[36:51], a[48:51], v[164:167], v[36:51]
  s_waitcnt vmcnt(9)
  v_cmp_eq_u32 vcc, -1, v168
  v_mfma_f32_32x32x16_bf16 v[52:67], a[52:55], v[164:167], v[52:67]
  s_cbranch_vccnz L_tag_1846294_r
L_tag_1846294:
  buffer_load_dwordx4 v[164:167], v213, s[28:31], s66 offen offset:1024 sc1
  v_mfma_f32_32x32x16_bf16 v[36:51], a[56:59], v[168:171], v[36:51]
  s_waitcnt vmcnt(9)
  v_cmp_eq_u32 vcc, -1, v172
  v_mfma_f32_32x32x16_bf16 v[52:67], a[60:63], v[168:171], v[52:67]
  s_cbranch_vccnz L_tag_1848295_r
L_tag_1848295:
  buffer_load_dwordx4 v[168:171], v213, s[28:31], s66 offen offset:2048 sc1
  v_mfma_f32_32x32x16_bf16 v[36:51], a[96:99], v[172:175], v[36:51]
  s_waitcnt vmcnt(9)
  v_cmp_eq_u32 vcc, -1, v176
  v_mfma_f32_32x32x16_bf16 v[52:67], a[100:103], v[172:175], v[52:67]
  s_cbranch_vccnz L_tag_1850296_r
L_tag_1850296:
  buffer_load_dwordx4 v[172:175], v213, s[28:31], s66 offen offset:3072 sc1
  v_mfma_f32_32x32x16_bf16 v[36:51], a[104:107], v[176:179], v[36:51]
  s_waitcnt vmcnt(9)
  v_cmp_eq_u32 vcc, -1, v180
  v_mfma_f32_32x32x16_bf16 v[52:67], a[108:111], v[176:179], v[52:67]
  s_cbranch_vccnz L_tag_1852297_r
L_tag_1852297:
  s_add_u32 s66, s58, 135168
  buffer_load_dwordx4 v[176:179], v213, s[28:31], s66 offen offset:0 sc1
  v_mfma_f32_32x32x16_bf16 v[36:51], a[112:115], v[180:183], v[36:51]
  s_waitcnt vmcnt(9)
  v_cmp_eq_u32 vcc, -1, v184
  v_mfma_f32_32x32x16_bf16 v[52:67], a[116:119], v[180:183], v[52:67]
  s_cbranch_vccnz L_tag_1854298_r
L_tag_1854298:
  buffer_load_dwordx4 v[180:183], v213, s[28:31], s66 offen offset:1024 sc1
  v_mfma_f32_32x32x16_bf16 v[36:51], a[120:123], v[184:187], v[36:51]
  s_waitcnt vmcnt(9)
  v_cmp_eq_u32 vcc, -1, v108
  v_mfma_f32_32x32x16_bf16 v[52:67], a[124:127], v[184:187], v[52:67]
  s_cbranch_vccnz L_tag_1856299_r
L_tag_1856299:
  buffer_load_dwordx4 v[184:187], v213, s[28:31], s66 offen offset:2048 sc1
  v_mfma_f32_32x32x16_bf16 v[36:51], a[160:163], v[108:111], v[36:51]
  s_waitcnt vmcnt(9)
  v_cmp_eq_u32 vcc, -1, v112
  v_mfma_f32_32x32x16_bf16 v[52:67], a[164:167], v[108:111], v[52:67]
  s_cbranch_vccnz L_tag_1858300_r
L_tag_1858300:
  buffer_load_dwordx4 v[108:111], v213, s[28:31], s66 offen offset:3072 sc1
  v_mfma_f32_32x32x16_bf16 v[36:51], a[168:171], v[112:115], v[36:51]
  s_waitcnt vmcnt(9)
  v_cmp_eq_u32 vcc, -1, v116
  v_mfma_f32_32x32x16_bf16 v[52:67], a[172:175], v[112:115], v[52:67]
  s_cbranch_vccnz L_tag_1860301_r
L_tag_1860301:
  s_add_u32 s66, s58, 143360
  buffer_load_dwordx4 v[112:115], v213, s[28:31], s66 offen offset:0 sc1
  v_mfma_f32_32x32x16_bf16 v[36:51], a[176:179], v[116:119], v[36:51]
  s_waitcnt vmcnt(9)
  v_cmp_eq_u32 vcc, -1, v156
  v_mfma_f32_32x32x16_bf16 v[52:67], a[180:183], v[116:119], v[52:67]
  s_cbranch_vccnz L_tag_1862302_r
L_tag_1862302:
  buffer_load_dwordx4 v[116:119], v213, s[28:31], s66 offen offset:1024 sc1
  v_mfma_f32_32x32x16_bf16 v[36:51], a[184:187], v[156:159], v[36:51]
  s_waitcnt vmcnt(9)
  v_cmp_eq_u32 vcc, -1, v160
  v_mfma_f32_32x32x16_bf16 v[52:67], a[188:191], v[156:159], v[52:67]
  s_cbranch_vccnz L_tag_1864303_r
L_tag_1864303:
  buffer_load_dwordx4 v[156:159], v213, s[28:31], s66 offen offset:2048 sc1
  v_mfma_f32_32x32x16_bf16 v[36:51], a[224:227], v[160:163], v[36:51]
  s_waitcnt vmcnt(9)
  v_cmp_eq_u32 vcc, -1, v164
  v_mfma_f32_32x32x16_bf16 v[52:67], a[228:231], v[160:163], v[52:67]
  s_cbranch_vccnz L_tag_1866304_r
L_tag_1866304:
  buffer_load_dwordx4 v[160:163], v213, s[28:31], s66 offen offset:3072 sc1
  s_mov_b64 exec, 1
  v_mov_b32 v233, 0
  buffer_atomic_add v233, v210, s[28:31], 0 offen offset:68 sc0 sc1
  s_mov_b64 exec, -1
  v_mfma_f32_32x32x16_bf16 v[36:51], a[232:235], v[164:167], v[36:51]
  s_waitcnt vmcnt(10)
  v_cmp_eq_u32 vcc, -1, v168
  v_mfma_f32_32x32x16_bf16 v[52:67], a[236:239], v[164:167], v[52:67]
  s_cbranch_vccnz L_tag_1870305_r
L_tag_1870305:
  s_add_u32 s66, s58, 151552
  buffer_load_dwordx4 v[164:167], v213, s[28:31], s66 offen offset:0 sc1
  v_mfma_f32_32x32x16_bf16 v[36:51], a[240:243], v[168:171], v[36:51]
  s_waitcnt vmcnt(10)
  v_cmp_eq_u32 vcc, -1, v172
  v_mfma_f32_32x32x16_bf16 v[52:67], a[244:247], v[168:171], v[52:67]
  s_cbranch_vccnz L_tag_1872306_r
L_tag_1872306:
  buffer_load_dwordx4 v[168:171], v213, s[28:31], s66 offen offset:1024 sc1
  v_mfma_f32_32x32x16_bf16 v[36:51], a[248:251], v[172:175], v[36:51]
  s_waitcnt vmcnt(10)
  v_cmp_eq_u32 vcc, -1, v176
  v_mfma_f32_32x32x16_bf16 v[52:67], a[252:255], v[172:175], v[52:67]
  s_cbranch_vccnz L_tag_1874307_r
L_tag_1874307:
  buffer_load_dwordx4 v[172:175], v213, s[28:31], s66 offen offset:2048 sc1
  v_mfma_f32_32x32x16_bf16 v[68:83], a[32:35], v[176:179], 0
  s_waitcnt vmcnt(10)
  v_cmp_eq_u32 vcc, -1, v180
  v_mfma_f32_32x32x16_bf16 v[84:99], a[36:39], v[176:179], 0
  s_cbranch_vccnz L_tag_1876308_r
L_tag_1876308:
  buffer_load_dwordx4 v[176:179], v213, s[28:31], s66 offen offset:3072 sc1
  v_mfma_f32_32x32x16_bf16 v[68:83], a[40:43], v[180:183], v[68:83]
  s_waitcnt vmcnt(10)
  v_cmp_eq_u32 vcc, -1, v184
  v_mfma_f32_32x32x16_bf16 v[84:99], a[44:47], v[180:183], v[84:99]
  s_cbranch_vccnz L_tag_1878309_r
L_tag_1878309:
  v_mfma_f32_32x32x16_bf16 v[68:83], a[48:51], v[184:187], v[68:83]
  s_waitcnt vmcnt(9)
  v_cmp_eq_u32 vcc, -1, v108
  v_mfma_f32_32x32x16_bf16 v[84:99], a[52:55], v[184:187], v[84:99]
  s_cbranch_vccnz L_tag_1880310_r
L_tag_1880310:
  v_mfma_f32_32x32x16_bf16 v[68:83], a[56:59], v[108:111], v[68:83]
  s_waitcnt vmcnt(8)
  v_cmp_eq_u32 vcc, -1, v112
  v_mfma_f32_32x32x16_bf16 v[84:99], a[60:63], v[108:111], v[84:99]
  s_cbranch_vccnz L_tag_1882311_r
L_tag_1882311:
  v_mfma_f32_32x32x16_bf16 v[68:83], a[96:99], v[112:115], v[68:83]
  s_waitcnt vmcnt(7)
  v_cmp_eq_u32 vcc, -1, v116
  v_mfma_f32_32x32x16_bf16 v[84:99], a[100:103], v[112:115], v[84:99]
  s_cbranch_vccnz L_tag_1884312_r
L_tag_1884312:
  s_add_u32 s66, s58, 0
  s_waitcnt vmcnt(4)
  v_readfirstlane_b32 s3, v233
  s_cmp_lt_u32 s3, 8
  s_cbranch_scc1 L_poll_1884313_r
L_poll_1884313:
  buffer_load_dwordx4 v[180:183], v213, s[28:31], s66 offen offset:0 sc1
  buffer_load_dwordx4 v[184:187], v213, s[28:31], s66 offen offset:1024 sc1
  buffer_load_dwordx4 v[108:111], v213, s[28:31], s66 offen offset:2048 sc1
  buffer_load_dwordx4 v[112:115], v213, s[28:31], s66 offen offset:3072 sc1
  v_mfma_f32_32x32x16_bf16 v[68:83], a[104:107], v[116:119], v[68:83]
  v_cmp_eq_u32 vcc, -1, v156
  v_mfma_f32_32x32x16_bf16 v[84:99], a[108:111], v[116:119], v[84:99]
  s_cbranch_vccnz L_tag_1888314_r
L_tag_1888314:
  s_add_u32 s66, s58, 8192
  buffer_load_dwordx4 v[116:119], v213, s[28:31], s66 offen offset:0 sc1
  v_mfma_f32_32x32x16_bf16 v[68:83], a[112:115], v[156:159], v[68:83]
  v_cmp_eq_u32 vcc, -1, v160
  v_mfma_f32_32x32x16_bf16 v[84:99], a[116:119], v[156:159], v[84:99]
  s_cbranch_vccnz L_tag_1890315_r
L_tag_1890315:
  buffer_load_dwordx4 v[156:159], v213, s[28:31], s66 offen offset:1024 sc1
  v_mfma_f32_32x32x16_bf16 v[68:83], a[120:123], v[160:163], v[68:83]
  s_waitcnt vmcnt(9)
  v_cmp_eq_u32 vcc, -1, v164
  v_mfma_f32_32x32x16_bf16 v[84:99], a[124:127], v[160:163], v[84:99]
  s_cbranch_vccnz L_tag_1892316_r
L_tag_1892316:
  buffer_load_dwordx4 v[160:163], v213, s[28:31], s66 offen offset:2048 sc1
  v_mfma_f32_32x32x16_bf16 v[68:83], a[160:163], v[164:167], v[68:83]
  s_waitcnt vmcnt(9)
  v_cmp_eq_u32 vcc, -1, v168
  v_mfma_f32_32x32x16_bf16 v[84:99], a[164:167], v[164:167], v[84:99]
  s_cbranch_vccnz L_tag_1894317_r
L_tag_1894317:
  buffer_load_dwordx4 v[164:167], v213, s[28:31], s66 offen offset:3072 sc1
  v_mfma_f32_32x32x16_bf16 v[68:83], a[168:171], v[168:171], v[68:83]
  s_waitcnt vmcnt(9)
  v_cmp_eq_u32 vcc, -1, v172
  v_mfma_f32_32x32x16_bf16 v[84:99], a[172:175], v[168:171], v[84:99]
  s_cbranch_vccnz L_tag_1896318_r
L_tag_1896318:
  s_add_u32 s66, s58, 16384
  buffer_load_dwordx4 v[168:171], v213, s[28:31], s66 offen offset:0 sc1
  v_mfma_f32_32x32x16_bf16 v[68:83], a[176:179], v[172:175], v[68:83]
  s_waitcnt vmcnt(9)
  v_cmp_eq_u32 vcc, -1, v176
  v_mfma_f32_32x32x16_bf16 v[84:99], a[180:183], v[172:175], v[84:99]
  s_cbranch_vccnz L_tag_1898319_r
L_tag_1898319:
  buffer_load_dwordx4 v[172:175], v213, s[28:31], s66 offen offset:1024 sc1
  v_mfma_f32_32x32x16_bf16 v[68:83], a[184:187], v[176:179], v[68:83]
  s_waitcnt vmcnt(9)
  v_cmp_eq_u32 vcc, -1, v180
  v_mfma_f32_32x32x16_bf16 v[84:99], a[188:191], v[176:179], v[84:99]
  s_cbranch_vccnz L_tag_1900320_r
L_tag_1900320:
  buffer_load_dwordx4 v[176:179], v213, s[28:31], s66 offen offset:2048 sc1
  v_mfma_f32_32x32x16_bf16 v[36:51], a[0:3], v[180:183], v[36:51]
  s_waitcnt vmcnt(9)
  v_cmp_eq_u32 vcc, -1, v184
  v_mfma_f32_32x32x16_bf16 v[52:67], a[4:7], v[180:183], v[52:67]
  s_cbranch_vccnz L_tag_1902321_r
L_tag_1902321:
  buffer_load_dwordx4 v[180:183], v213, s[28:31], s66 offen offset:3072 sc1
  v_mfma_f32_32x32x16_bf16 v[36:51], a[8:11], v[184:187], v[36:51]
  s_waitcnt vmcnt(9)
  v_cmp_eq_u32 vcc, -1, v108
  v_mfma_f32_32x32x16_bf16 v[52:67], a[12:15], v[184:187], v[52:67]
  s_cbranch_vccnz L_tag_1904322_r
L_tag_1904322:
  s_add_u32 s66, s58, 24576
  buffer_load_dwordx4 v[184:187], v213, s[28:31], s66 offen offset:0 sc1
  v_mfma_f32_32x32x16_bf16 v[36:51], a[16:19], v[108:111], v[36:51]
  s_waitcnt vmcnt(9)
  v_cmp_eq_u32 vcc, -1, v112
  v_mfma_f32_32x32x16_bf16 v[52:67], a[20:23], v[108:111], v[52:67]
  s_cbranch_vccnz L_tag_1906323_r
L_tag_1906323:
  buffer_load_dwordx4 v[108:111], v213, s[28:31], s66 offen offset:1024 sc1
  v_mfma_f32_32x32x16_bf16 v[36:51], a[24:27], v[112:115], v[36:51]
  s_waitcnt vmcnt(9)
  v_cmp_eq_u32 vcc, -1, v116
  v_mfma_f32_32x32x16_bf16 v[52:67], a[28:31], v[112:115], v[52:67]
  s_cbranch_vccnz L_tag_1908324_r
L_tag_1908324:
  buffer_load_dwordx4 v[112:115], v213, s[28:31], s66 offen offset:2048 sc1
  v_mfma_f32_32x32x16_bf16 v[36:51], a[64:67], v[116:119], v[36:51]
  s_waitcnt vmcnt(9)
  v_cmp_eq_u32 vcc, -1, v156
  v_mfma_f32_32x32x16_bf16 v[52:67], a[68:71], v[116:119], v[52:67]
  s_cbranch_vccnz L_tag_1910325_r
L_tag_1910325:
  buffer_load_dwordx4 v[116:119], v213, s[28:31], s66 offen offset:3072 sc1
  v_mfma_f32_32x32x16_bf16 v[36:51], a[72:75], v[156:159], v[36:51]
  s_waitcnt vmcnt(9)
  v_cmp_eq_u32 vcc, -1, v160
  v_mfma_f32_32x32x16_bf16 v[52:67], a[76:79], v[156:159], v[52:67]
  s_cbranch_vccnz L_tag_1912326_r
L_tag_1912326:
  s_add_u32 s66, s58, 159744
  buffer_load_dwordx4 v[156:159], v213, s[28:31], s66 offen offset:0 sc1
  v_mfma_f32_32x32x16_bf16 v[36:51], a[80:83], v[160:163], v[36:51]
  s_waitcnt vmcnt(9)
  v_cmp_eq_u32 vcc, -1, v164
  v_mfma_f32_32x32x16_bf16 v[52:67], a[84:87], v[160:163], v[52:67]
  s_cbranch_vccnz L_tag_1914327_r
L_tag_1914327:
  buffer_load_dwordx4 v[160:163], v213, s[28:31], s66 offen offset:1024 sc1
  v_mfma_f32_32x32x16_bf16 v[36:51], a[88:91], v[164:167], v[36:51]
  s_waitcnt vmcnt(9)
  v_cmp_eq_u32 vcc, -1, v168
  v_mfma_f32_32x32x16_bf16 v[52:67], a[92:95], v[164:167], v[52:67]
  s_cbranch_vccnz L_tag_1916328_r
L_tag_1916328:
  buffer_load_dwordx4 v[164:167], v213, s[28:31], s66 offen offset:2048 sc1
  v_mfma_f32_32x32x16_bf16 v[36:51], a[128:131], v[168:171], v[36:51]
  s_waitcnt vmcnt(9)
  v_cmp_eq_u32 vcc, -1, v172
  v_mfma_f32_32x32x16_bf16 v[52:67], a[132:135], v[168:171], v[52:67]
  s_cbranch_vccnz L_tag_1918329_r
L_tag_1918329:
  buffer_load_dwordx4 v[168:171], v213, s[28:31], s66 offen offset:3072 sc1
  v_mfma_f32_32x32x16_bf16 v[36:51], a[136:139], v[172:175], v[36:51]
  s_waitcnt vmcnt(9)
  v_cmp_eq_u32 vcc, -1, v176
  v_mfma_f32_32x32x16_bf16 v[52:67], a[140:143], v[172:175], v[52:67]
  s_cbranch_vccnz L_tag_1920330_r
L_tag_1920330:
  s_add_u32 s66, s58, 131072
  buffer_load_dwordx4 v[172:175], v213, s[28:31], s66 offen offset:0 sc1
  v_mfma_f32_32x32x16_bf16 v[36:51], a[144:147], v[176:179], v[36:51]
  s_waitcnt vmcnt(9)
  v_cmp_eq_u32 vcc, -1, v180
  v_mfma_f32_32x32x16_bf16 v[52:67], a[148:151], v[176:179], v[52:67]
  s_cbranch_vccnz L_tag_1922331_r
L_tag_1922331:
  buffer_load_dwordx4 v[176:179], v213, s[28:31], s66 offen offset:1024 sc1
  v_mfma_f32_32x32x16_bf16 v[36:51], a[152:155], v[180:183], v[36:51]
  s_waitcnt vmcnt(9)
  v_cmp_eq_u32 vcc, -1, v184
  v_mfma_f32_32x32x16_bf16 v[52:67], a[156:159], v[180:183], v[52:67]
  s_cbranch_vccnz L_tag_1924332_r
L_tag_1924332:
  buffer_load_dwordx4 v[180:183], v213, s[28:31], s66 offen offset:2048 sc1
  v_mfma_f32_32x32x16_bf16 v[36:51], a[192:195], v[184:187], v[36:51]
  s_waitcnt vmcnt(9)
  v_cmp_eq_u32 vcc, -1, v108
  v_mfma_f32_32x32x16_bf16 v[52:67], a[196:199], v[184:187], v[52:67]
  s_cbranch_vccnz L_tag_1926333_r
L_tag_1926333:
  buffer_load_dwordx4 v[184:187], v213, s[28:31], s66 offen offset:3072 sc1
  v_mfma_f32_32x32x16_bf16 v[36:51], a[200:203], v[108:111], v[36:51]
  s_waitcnt vmcnt(9)
  v_cmp_eq_u32 vcc, -1, v112
  v_mfma_f32_32x32x16_bf16 v[52:67], a[204:207], v[108:111], v[52:67]
  s_cbranch_vccnz L_tag_1928334_r
L_tag_1928334:
  s_add_u32 s66, s58, 139264
  buffer_load_dwordx4 v[108:111], v213, s[28:31], s66 offen offset:0 sc1
  v_mfma_f32_32x32x16_bf16 v[36:51], a[208:211], v[112:115], v[36:51]
  s_waitcnt vmcnt(9)
  v_cmp_eq_u32 vcc, -1, v116
  v_mfma_f32_32x32x16_bf16 v[52:67], a[212:215], v[112:115], v[52:67]
  s_cbranch_vccnz L_tag_1930335_r
L_tag_1930335:
  buffer_load_dwordx4 v[112:115], v213, s[28:31], s66 offen offset:1024 sc1
  v_mfma_f32_32x32x16_bf16 v[36:51], a[216:219], v[116:119], v[36:51]
  s_waitcnt vmcnt(9)
  v_cmp_eq_u32 vcc, -1, v156
  v_mfma_f32_32x32x16_bf16 v[52:67], a[220:223], v[116:119], v[52:67]
  s_cbranch_vccnz L_tag_1932336_r
L_tag_1932336:
  buffer_load_dwordx4 v[116:119], v213, s[28:31], s66 offen offset:2048 sc1
  v_mfma_f32_32x32x16_bf16 v[68:83], a[224:227], v[156:159], v[68:83]
  s_nop 5
  ds_write_b128 v253, v[44:47] offset:0
  ds_write_b128 v253, v[48:51] offset:1024
  s_nop 0
  ds_write_b128 v254, v[52:55] offset:0
  s_waitcnt vmcnt(9)
  v_cmp_eq_u32 vcc, -1, v160
  v_mfma_f32_32x32x16_bf16 v[84:99], a[228:231], v[156:159], v[84:99]
  s_cbranch_vccnz L_tag_2064338_r
L_tag_2064338:
  buffer_load_dwordx4 v[156:159], v213, s[28:31], s66 offen offset:3072 sc1
  ds_write_b128 v254, v[56:59] offset:1024
  ds_write_b128 v255, v[60:63] offset:0
  ds_write_b128 v255, v[64:67] offset:1024
  v_mfma_f32_32x32x16_bf16 v[68:83], a[232:235], v[160:163], v[68:83]
  v_pk_add_f32 v[36:37], v[36:37], v[16:17]
  v_pk_add_f32 v[38:39], v[38:39], v[18:19]
  v_pk_add_f32 v[40:41], v[40:41], v[20:21]
  v_pk_add_f32 v[42:43], v[42:43], v[22:23]
  s_waitcnt lgkmcnt(0)
  s_barrier
  ds_read_b128 v[132:135], v230 offset:0
  ds_read_b128 v[136:139], v230 offset:1024
  ds_read_b128 v[140:143], v230 offset:2048
  ds_read_b128 v[144:147], v230 offset:3072
  ds_read_b128 v[148:151], v230 offset:4096
  ds_read_b128 v[152:155], v230 offset:5120
  s_waitcnt vmcnt(9)
  v_cmp_eq_u32 vcc, -1, v164
  v_mfma_f32_32x32x16_bf16 v[84:99], a[236:239], v[160:163], v[84:99]
  s_cbranch_vccnz L_tag_2066339_r
L_tag_2066339:
  s_add_u32 s66, s58, 147456
  buffer_load_dwordx4 v[160:163], v213, s[28:31], s66 offen offset:0 sc1
  v_mfma_f32_32x32x16_bf16 v[68:83], a[240:243], v[164:167], v[68:83]
  s_waitcnt lgkmcnt(5)
  v_pk_add_f32 v[36:37], v[36:37], v[132:133]
  v_pk_add_f32 v[38:39], v[38:39], v[134:135]
  s_waitcnt lgkmcnt(4)
  v_pk_add_f32 v[40:41], v[40:41], v[136:137]
  v_pk_add_f32 v[42:43], v[42:43], v[138:139]
  s_waitcnt lgkmcnt(3)
  v_pk_add_f32 v[36:37], v[36:37], v[140:141]
  v_pk_add_f32 v[38:39], v[38:39], v[142:143]
  s_waitcnt vmcnt(9)
  v_cmp_eq_u32 vcc, -1, v168
  v_mfma_f32_32x32x16_bf16 v[84:99], a[244:247], v[164:167], v[84:99]
  s_cbranch_vccnz L_tag_2068340_r
L_tag_2068340:
  buffer_load_dwordx4 v[164:167], v213, s[28:31], s66 offen offset:1024 sc1
  s_waitcnt lgkmcnt(2)
  v_pk_add_f32 v[40:41], v[40:41], v[144:145]
  v_pk_add_f32 v[42:43], v[42:43], v[146:147]
  s_waitcnt lgkmcnt(1)
  v_pk_add_f32 v[36:37], v[36:37], v[148:149]
  v_pk_add_f32 v[38:39], v[38:39], v[150:151]
  s_waitcnt lgkmcnt(0)
  v_pk_add_f32 v[40:41], v[40:41], v[152:153]
  v_pk_add_f32 v[42:43], v[42:43], v[154:155]
  v_mfma_f32_32x32x16_bf16 v[68:83], a[248:251], v[168:171], v[68:83]
  v_pk_mul_f32 v[8:9], v[36:37], v[36:37]
  v_pk_mul_f32 v[10:11], v[38:39], v[38:39]
  v_pk_mul_f32 v[12:13], v[40:41], v[40:41]
  v_pk_mul_f32 v[14:15], v[42:43], v[42:43]
  v_pk_fma_f32 v[8:9], v[8:9], v[28:29], v[28:29] op_sel:[0,0,1] op_sel_hi:[1,0,1]
  v_pk_fma_f32 v[10:11], v[10:11], v[28:29], v[28:29] op_sel:[0,0,1] op_sel_hi:[1,0,1]
  s_waitcnt vmcnt(9)
  v_cmp_eq_u32 vcc, -1, v172
  v_mfma_f32_32x32x16_bf16 v[84:99], a[252:255], v[168:171], v[84:99]
  s_cbranch_vccnz L_tag_2070341_r
L_tag_2070341:
  buffer_load_dwordx4 v[168:171], v213, s[28:31], s66 offen offset:2048 sc1
  v_pk_fma_f32 v[12:13], v[12:13], v[28:29], v[28:29] op_sel:[0,0,1] op_sel_hi:[1,0,1]
  v_pk_fma_f32 v[14:15], v[14:15], v[28:29], v[28:29] op_sel:[0,0,1] op_sel_hi:[1,0,1]
  v_pk_mul_f32 v[8:9], v[8:9], v[36:37]
  v_pk_mul_f32 v[10:11], v[10:11], v[38:39]
  v_pk_mul_f32 v[12:13], v[12:13], v[40:41]
  v_pk_mul_f32 v[14:15], v[14:15], v[42:43]
  v_mfma_f32_32x32x16_bf16 v[68:83], a[0:3], v[172:175], v[68:83]
  v_exp_f32 v8, v8
  v_exp_f32 v9, v9
  v_exp_f32 v10, v10
  v_exp_f32 v11, v11
  v_exp_f32 v12, v12
  v_exp_f32 v13, v13
  s_waitcnt vmcnt(9)
  v_cmp_eq_u32 vcc, -1, v176
  v_mfma_f32_32x32x16_bf16 v[84:99], a[4:7], v[172:175], v[84:99]
  s_cbranch_vccnz L_tag_2072342_r
L_tag_2072342:
  buffer_load_dwordx4 v[172:175], v213, s[28:31], s66 offen offset:3072 sc1
  v_exp_f32 v14, v14
  v_exp_f32 v15, v15
  v_pk_add_f32 v[8:9], v[8:9], v[30:31] op_sel_hi:[1,0]
  v_pk_add_f32 v[10:11], v[10:11], v[30:31] op_sel_hi:[1,0]
  v_pk_add_f32 v[12:13], v[12:13], v[30:31] op_sel_hi:[1,0]
  v_pk_add_f32 v[14:15], v[14:15], v[30:31] op_sel_hi:[1,0]
  v_mfma_f32_32x32x16_bf16 v[68:83], a[8:11], v[176:179], v[68:83]
  v_rcp_f32 v8, v8
  v_rcp_f32 v9, v9
  v_rcp_f32 v10, v10
  v_rcp_f32 v11, v11
  v_rcp_f32 v12, v12
  v_rcp_f32 v13, v13
  s_waitcnt vmcnt(9)
  v_cmp_eq_u32 vcc, -1, v180
  v_mfma_f32_32x32x16_bf16 v[84:99], a[12:15], v[176:179], v[84:99]
  s_cbranch_vccnz L_tag_2074343_r
L_tag_2074343:
  s_add_u32 s66, s58, 155648
  buffer_load_dwordx4 v[176:179], v213, s[28:31], s66 offen offset:0 sc1
  v_rcp_f32 v14, v14
  v_rcp_f32 v15, v15
  v_pk_mul_f32 v[8:9], v[8:9], v[36:37]
  v_pk_mul_f32 v[10:11], v[10:11], v[38:39]
  v_pk_mul_f32 v[12:13], v[12:13], v[40:41]
  v_pk_mul_f32 v[14:15], v[14:15], v[42:43]
  v_mfma_f32_32x32x16_bf16 v[68:83], a[16:19], v[180:183], v[68:83]
  v_cvt_pk_bf16_f32 v24, v8, v9
  v_cvt_pk_bf16_f32 v25, v10, v11
  v_cvt_pk_bf16_f32 v26, v12, v13
  v_cvt_pk_bf16_f32 v27, v14, v15
  s_add_u32 s52, s62, 10485760
  buffer_store_dwordx4 v[24:27], v232, s[28:31], s52 offen sc1
  s_cmp_lg_u32 s77, 0
  s_cbranch_scc1 L_sig_2062337
  s_cmp_eq_u32 s95, 0
  s_cbranch_scc1 L_sig_2062337
  s_mov_b32 exec_lo, s95
  s_mov_b32 exec_hi, 0
  buffer_atomic_add v251, v225, s[28:31], 0 offen offset:72 sc1
  s_mov_b64 exec, -1
L_sig_2062337:
  s_waitcnt vmcnt(10)
  v_cmp_eq_u32 vcc, -1, v184
  v_mfma_f32_32x32x16_bf16 v[84:99], a[20:23], v[180:183], v[84:99]
  s_cbranch_vccnz L_tag_2076344_r
L_tag_2076344:
  buffer_load_dwordx4 v[180:183], v213, s[28:31], s66 offen offset:1024 sc1
  v_mfma_f32_32x32x16_bf16 v[68:83], a[24:27], v[184:187], v[68:83]
  s_waitcnt vmcnt(10)
  v_cmp_eq_u32 vcc, -1, v108
  v_mfma_f32_32x32x16_bf16 v[84:99], a[28:31], v[184:187], v[84:99]
  s_cbranch_vccnz L_tag_2078345_r
L_tag_2078345:
  buffer_load_dwordx4 v[184:187], v213, s[28:31], s66 offen offset:2048 sc1
  v_mfma_f32_32x32x16_bf16 v[68:83], a[64:67], v[108:111], v[68:83]
  s_waitcnt vmcnt(10)
  v_cmp_eq_u32 vcc, -1, v112
  v_mfma_f32_32x32x16_bf16 v[84:99], a[68:71], v[108:111], v[84:99]
  s_cbranch_vccnz L_tag_2080346_r
L_tag_2080346:
  buffer_load_dwordx4 v[108:111], v213, s[28:31], s66 offen offset:3072 sc1
  v_mfma_f32_32x32x16_bf16 v[68:83], a[72:75], v[112:115], v[68:83]
  s_waitcnt vmcnt(10)
  v_cmp_eq_u32 vcc, -1, v116
  v_mfma_f32_32x32x16_bf16 v[84:99], a[76:79], v[112:115], v[84:99]
  s_cbranch_vccnz L_tag_2082347_r
L_tag_2082347:
  s_add_u32 s66, s58, 262144
  buffer_load_dwordx4 v[112:115], v213, s[28:31], s66 offen offset:0 sc1
  v_mfma_f32_32x32x16_bf16 v[68:83], a[80:83], v[116:119], v[68:83]
  s_waitcnt vmcnt(10)
  v_cmp_eq_u32 vcc, -1, v156
  v_mfma_f32_32x32x16_bf16 v[84:99], a[84:87], v[116:119], v[84:99]
  s_cbranch_vccnz L_tag_2084348_r
L_tag_2084348:
  buffer_load_dwordx4 v[116:119], v213, s[28:31], s66 offen offset:1024 sc1
  v_mfma_f32_32x32x16_bf16 v[68:83], a[88:91], v[156:159], v[68:83]
  s_waitcnt vmcnt(10)
  v_cmp_eq_u32 vcc, -1, v160
  v_mfma_f32_32x32x16_bf16 v[84:99], a[92:95], v[156:159], v[84:99]
  s_cbranch_vccnz L_tag_2086349_r
L_tag_2086349:
  buffer_load_dwordx4 v[156:159], v213, s[28:31], s66 offen offset:2048 sc1
  v_mfma_f32_32x32x16_bf16 v[68:83], a[128:131], v[160:163], v[68:83]
  s_waitcnt vmcnt(10)
  v_cmp_eq_u32 vcc, -1, v164
  v_mfma_f32_32x32x16_bf16 v[84:99], a[132:135], v[160:163], v[84:99]
  s_cbranch_vccnz L_tag_2088350_r
L_tag_2088350:
  buffer_load_dwordx4 v[160:163], v213, s[28:31], s66 offen offset:3072 sc1
  v_mfma_f32_32x32x16_bf16 v[68:83], a[136:139], v[164:167], v[68:83]
  s_waitcnt vmcnt(10)
  v_cmp_eq_u32 vcc, -1, v168
  v_mfma_f32_32x32x16_bf16 v[84:99], a[140:143], v[164:167], v[84:99]
  s_cbranch_vccnz L_tag_2090351_r
L_tag_2090351:
  s_add_u32 s66, s58, 266240
  buffer_load_dwordx4 v[164:167], v213, s[28:31], s66 offen offset:0 sc1
  v_mfma_f32_32x32x16_bf16 v[68:83], a[144:147], v[168:171], v[68:83]
  s_waitcnt vmcnt(10)
  v_cmp_eq_u32 vcc, -1, v172
  v_mfma_f32_32x32x16_bf16 v[84:99], a[148:151], v[168:171], v[84:99]
  s_cbranch_vccnz L_tag_2092352_r
L_tag_2092352:
  buffer_load_dwordx4 v[168:171], v213, s[28:31], s66 offen offset:1024 sc1
  v_mfma_f32_32x32x16_bf16 v[68:83], a[152:155], v[172:175], v[68:83]
  s_waitcnt vmcnt(10)
  v_cmp_eq_u32 vcc, -1, v176
  v_mfma_f32_32x32x16_bf16 v[84:99], a[156:159], v[172:175], v[84:99]
  s_cbranch_vccnz L_tag_2094353_r
L_tag_2094353:
  buffer_load_dwordx4 v[172:175], v213, s[28:31], s66 offen offset:2048 sc1
  v_mfma_f32_32x32x16_bf16 v[68:83], a[192:195], v[176:179], v[68:83]
  s_waitcnt vmcnt(9)
  v_cmp_eq_u32 vcc, -1, v180
  v_mfma_f32_32x32x16_bf16 v[84:99], a[196:199], v[176:179], v[84:99]
  s_cbranch_vccnz L_tag_2096354_r
L_tag_2096354:
  buffer_load_dwordx4 v[176:179], v213, s[28:31], s66 offen offset:3072 sc1
  v_mfma_f32_32x32x16_bf16 v[68:83], a[200:203], v[180:183], v[68:83]
  s_waitcnt vmcnt(9)
  v_cmp_eq_u32 vcc, -1, v184
  v_mfma_f32_32x32x16_bf16 v[84:99], a[204:207], v[180:183], v[84:99]
  s_cbranch_vccnz L_tag_2098355_r
L_tag_2098355:
  s_add_u32 s66, s58, 270336
  buffer_load_dwordx4 v[180:183], v213, s[28:31], s66 offen offset:0 sc1
  v_mfma_f32_32x32x16_bf16 v[68:83], a[208:211], v[184:187], v[68:83]
  s_waitcnt vmcnt(9)
  v_cmp_eq_u32 vcc, -1, v108
  v_mfma_f32_32x32x16_bf16 v[84:99], a[212:215], v[184:187], v[84:99]
  s_cbranch_vccnz L_tag_2100356_r
L_tag_2100356:
  buffer_load_dwordx4 v[184:187], v213, s[28:31], s66 offen offset:1024 sc1
  v_mfma_f32_32x32x16_bf16 v[68:83], a[216:219], v[108:111], v[68:83]
  s_waitcnt vmcnt(9)
  v_cmp_eq_u32 vcc, -1, v112
  v_mfma_f32_32x32x16_bf16 v[84:99], a[220:223], v[108:111], v[84:99]
  s_cbranch_vccnz L_tag_2102357_r
L_tag_2102357:
  buffer_load_dwordx4 v[108:111], v213, s[28:31], s66 offen offset:2048 sc1
  v_mfma_f32_32x32x16_bf16 v[36:51], a[0:3], v[112:115], 0
  s_nop 5
  ds_write_b128 v253, v[76:79] offset:0
  ds_write_b128 v253, v[80:83] offset:1024
  s_nop 0
  ds_write_b128 v254, v[84:87] offset:0
  s_waitcnt vmcnt(9)
  v_cmp_eq_u32 vcc, -1, v116
  v_mfma_f32_32x32x16_bf16 v[52:67], a[4:7], v[112:115], 0
  s_cbranch_vccnz L_tag_2232358_r
L_tag_2232358:
  buffer_load_dwordx4 v[112:115], v213, s[28:31], s66 offen offset:3072 sc1
  ds_write_b128 v254, v[88:91] offset:1024
  ds_write_b128 v255, v[92:95] offset:0
  ds_write_b128 v255, v[96:99] offset:1024
  v_mfma_f32_32x32x16_bf16 v[36:51], a[8:11], v[116:119], v[36:51]
  v_pk_add_f32 v[68:69], v[68:69], v[16:17]
  v_pk_add_f32 v[70:71], v[70:71], v[18:19]
  v_pk_add_f32 v[72:73], v[72:73], v[20:21]
  v_pk_add_f32 v[74:75], v[74:75], v[22:23]
  s_waitcnt lgkmcnt(0)
  s_barrier
  ds_read_b128 v[132:135], v230 offset:0
  ds_read_b128 v[136:139], v230 offset:1024
  ds_read_b128 v[140:143], v230 offset:2048
  ds_read_b128 v[144:147], v230 offset:3072
  ds_read_b128 v[148:151], v230 offset:4096
  ds_read_b128 v[152:155], v230 offset:5120
  s_waitcnt vmcnt(9)
  v_cmp_eq_u32 vcc, -1, v156
  v_mfma_f32_32x32x16_bf16 v[52:67], a[12:15], v[116:119], v[52:67]
  s_cbranch_vccnz L_tag_2234359_r
L_tag_2234359:
  s_add_u32 s66, s58, 274432
  buffer_load_dwordx4 v[116:119], v213, s[28:31], s66 offen offset:0 sc1
  v_mfma_f32_32x32x16_bf16 v[36:51], a[16:19], v[156:159], v[36:51]
  s_waitcnt lgkmcnt(5)
  v_pk_add_f32 v[68:69], v[68:69], v[132:133]
  v_pk_add_f32 v[70:71], v[70:71], v[134:135]
  s_waitcnt lgkmcnt(4)
  v_pk_add_f32 v[72:73], v[72:73], v[136:137]
  v_pk_add_f32 v[74:75], v[74:75], v[138:139]
  s_waitcnt lgkmcnt(3)
  v_pk_add_f32 v[68:69], v[68:69], v[140:141]
  v_pk_add_f32 v[70:71], v[70:71], v[142:143]
  s_waitcnt vmcnt(9)
  v_cmp_eq_u32 vcc, -1, v160
  v_mfma_f32_32x32x16_bf16 v[52:67], a[20:23], v[156:159], v[52:67]
  s_cbranch_vccnz L_tag_2236360_r
L_tag_2236360:
  buffer_load_dwordx4 v[156:159], v213, s[28:31], s66 offen offset:1024 sc1
  s_waitcnt lgkmcnt(2)
  v_pk_add_f32 v[72:73], v[72:73], v[144:145]
  v_pk_add_f32 v[74:75], v[74:75], v[146:147]
  s_waitcnt lgkmcnt(1)
  v_pk_add_f32 v[68:69], v[68:69], v[148:149]
  v_pk_add_f32 v[70:71], v[70:71], v[150:151]
  s_waitcnt lgkmcnt(0)
  v_pk_add_f32 v[72:73], v[72:73], v[152:153]
  v_pk_add_f32 v[74:75], v[74:75], v[154:155]
  v_mfma_f32_32x32x16_bf16 v[36:51], a[24:27], v[160:163], v[36:51]
  v_pk_mul_f32 v[8:9], v[68:69], v[68:69]
  v_pk_mul_f32 v[10:11], v[70:71], v[70:71]
  v_pk_mul_f32 v[12:13], v[72:73], v[72:73]
  v_pk_mul_f32 v[14:15], v[74:75], v[74:75]
  v_pk_fma_f32 v[8:9], v[8:9], v[28:29], v[28:29] op_sel:[0,0,1] op_sel_hi:[1,0,1]
  v_pk_fma_f32 v[10:11], v[10:11], v[28:29], v[28:29] op_sel:[0,0,1] op_sel_hi:[1,0,1]
  s_waitcnt vmcnt(9)
  v_cmp_eq_u32 vcc, -1, v164
  v_mfma_f32_32x32x16_bf16 v[52:67], a[28:31], v[160:163], v[52:67]
  s_cbranch_vccnz L_tag_2238361_r
L_tag_2238361:
  buffer_load_dwordx4 v[160:163], v213, s[28:31], s66 offen offset:2048 sc1
  v_pk_fma_f32 v[12:13], v[12:13], v[28:29], v[28:29] op_sel:[0,0,1] op_sel_hi:[1,0,1]
  v_pk_fma_f32 v[14:15], v[14:15], v[28:29], v[28:29] op_sel:[0,0,1] op_sel_hi:[1,0,1]
  v_pk_mul_f32 v[8:9], v[8:9], v[68:69]
  v_pk_mul_f32 v[10:11], v[10:11], v[70:71]
  v_pk_mul_f32 v[12:13], v[12:13], v[72:73]
  v_pk_mul_f32 v[14:15], v[14:15], v[74:75]
  v_mfma_f32_32x32x16_bf16 v[36:51], a[32:35], v[164:167], v[36:51]
  v_exp_f32 v8, v8
  v_exp_f32 v9, v9
  v_exp_f32 v10, v10
  v_exp_f32 v11, v11
  v_exp_f32 v12, v12
  v_exp_f32 v13, v13
  s_waitcnt vmcnt(9)
  v_cmp_eq_u32 vcc, -1, v168
  v_mfma_f32_32x32x16_bf16 v[52:67], a[36:39], v[164:167], v[52:67]
  s_cbranch_vccnz L_tag_2240362_r
L_tag_2240362:
  buffer_load_dwordx4 v[164:167], v213, s[28:31], s66 offen offset:3072 sc1
  v_exp_f32 v14, v14
  v_exp_f32 v15, v15
  v_pk_add_f32 v[8:9], v[8:9], v[30:31] op_sel_hi:[1,0]
  v_pk_add_f32 v[10:11], v[10:11], v[30:31] op_sel_hi:[1,0]
  v_pk_add_f32 v[12:13], v[12:13], v[30:31] op_sel_hi:[1,0]
  v_pk_add_f32 v[14:15], v[14:15], v[30:31] op_sel_hi:[1,0]
  v_mfma_f32_32x32x16_bf16 v[36:51], a[40:43], v[168:171], v[36:51]
  v_rcp_f32 v8, v8
  v_rcp_f32 v9, v9
  v_rcp_f32 v10, v10
  v_rcp_f32 v11, v11
  v_rcp_f32 v12, v12
  v_rcp_f32 v13, v13
  s_waitcnt vmcnt(9)
  v_cmp_eq_u32 vcc, -1, v172
  v_mfma_f32_32x32x16_bf16 v[52:67], a[44:47], v[168:171], v[52:67]
  s_cbranch_vccnz L_tag_2242363_r
L_tag_2242363:
  s_add_u32 s66, s58, 278528
  buffer_load_dwordx4 v[168:171], v213, s[28:31], s66 offen offset:0 sc1
  v_rcp_f32 v14, v14
  v_rcp_f32 v15, v15
  v_pk_mul_f32 v[8:9], v[8:9], v[68:69]
  v_pk_mul_f32 v[10:11], v[10:11], v[70:71]
  v_pk_mul_f32 v[12:13], v[12:13], v[72:73]
  v_pk_mul_f32 v[14:15], v[14:15], v[74:75]
  v_mfma_f32_32x32x16_bf16 v[36:51], a[48:51], v[172:175], v[36:51]
  v_cvt_pk_bf16_f32 v24, v8, v9
  v_cvt_pk_bf16_f32 v25, v10, v11
  v_cvt_pk_bf16_f32 v26, v12, v13
  v_cvt_pk_bf16_f32 v27, v14, v15
  s_add_u32 s52, s62, 10600448
  buffer_store_dwordx4 v[24:27], v232, s[28:31], s52 offen sc1
  s_waitcnt vmcnt(10)
  v_cmp_eq_u32 vcc, -1, v176
  v_mfma_f32_32x32x16_bf16 v[52:67], a[52:55], v[172:175], v[52:67]
  s_cbranch_vccnz L_tag_2244364_r
L_tag_2244364:
  buffer_load_dwordx4 v[172:175], v213, s[28:31], s66 offen offset:1024 sc1
  v_mfma_f32_32x32x16_bf16 v[36:51], a[56:59], v[176:179], v[36:51]
  s_waitcnt vmcnt(10)
  v_cmp_eq_u32 vcc, -1, v180
  v_mfma_f32_32x32x16_bf16 v[52:67], a[60:63], v[176:179], v[52:67]
  s_cbranch_vccnz L_tag_2246365_r
L_tag_2246365:
  buffer_load_dwordx4 v[176:179], v213, s[28:31], s66 offen offset:2048 sc1
  v_mfma_f32_32x32x16_bf16 v[36:51], a[64:67], v[180:183], v[36:51]
  s_waitcnt vmcnt(10)
  v_cmp_eq_u32 vcc, -1, v184
  v_mfma_f32_32x32x16_bf16 v[52:67], a[68:71], v[180:183], v[52:67]
  s_cbranch_vccnz L_tag_2248366_r
L_tag_2248366:
  buffer_load_dwordx4 v[180:183], v213, s[28:31], s66 offen offset:3072 sc1
  v_mfma_f32_32x32x16_bf16 v[36:51], a[72:75], v[184:187], v[36:51]
  s_waitcnt vmcnt(10)
  v_cmp_eq_u32 vcc, -1, v108
  v_mfma_f32_32x32x16_bf16 v[52:67], a[76:79], v[184:187], v[52:67]
  s_cbranch_vccnz L_tag_2250367_r
L_tag_2250367:
  s_add_u32 s66, s58, 282624
  buffer_load_dwordx4 v[184:187], v213, s[28:31], s66 offen offset:0 sc1
  v_mfma_f32_32x32x16_bf16 v[36:51], a[80:83], v[108:111], v[36:51]
  s_waitcnt vmcnt(10)
  v_cmp_eq_u32 vcc, -1, v112
  v_mfma_f32_32x32x16_bf16 v[52:67], a[84:87], v[108:111], v[52:67]
  s_cbranch_vccnz L_tag_2252368_r
L_tag_2252368:
  buffer_load_dwordx4 v[108:111], v213, s[28:31], s66 offen offset:1024 sc1
  v_mfma_f32_32x32x16_bf16 v[36:51], a[88:91], v[112:115], v[36:51]
  s_waitcnt vmcnt(10)
  v_cmp_eq_u32 vcc, -1, v116
  v_mfma_f32_32x32x16_bf16 v[52:67], a[92:95], v[112:115], v[52:67]
  s_cbranch_vccnz L_tag_2254369_r
L_tag_2254369:
  buffer_load_dwordx4 v[112:115], v213, s[28:31], s66 offen offset:2048 sc1
  v_mfma_f32_32x32x16_bf16 v[36:51], a[96:99], v[116:119], v[36:51]
  s_waitcnt vmcnt(10)
  v_cmp_eq_u32 vcc, -1, v156
  v_mfma_f32_32x32x16_bf16 v[52:67], a[100:103], v[116:119], v[52:67]
  s_cbranch_vccnz L_tag_2256370_r
L_tag_2256370:
  buffer_load_dwordx4 v[116:119], v213, s[28:31], s66 offen offset:3072 sc1
  v_mfma_f32_32x32x16_bf16 v[36:51], a[104:107], v[156:159], v[36:51]
  s_waitcnt vmcnt(10)
  v_cmp_eq_u32 vcc, -1, v160
  v_mfma_f32_32x32x16_bf16 v[52:67], a[108:111], v[156:159], v[52:67]
  s_cbranch_vccnz L_tag_2258371_r
L_tag_2258371:
  s_add_u32 s66, s58, 286720
  buffer_load_dwordx4 v[156:159], v213, s[28:31], s66 offen offset:0 sc1
  v_mfma_f32_32x32x16_bf16 v[36:51], a[112:115], v[160:163], v[36:51]
  s_waitcnt vmcnt(10)
  v_cmp_eq_u32 vcc, -1, v164
  v_mfma_f32_32x32x16_bf16 v[52:67], a[116:119], v[160:163], v[52:67]
  s_cbranch_vccnz L_tag_2260372_r
L_tag_2260372:
  buffer_load_dwordx4 v[160:163], v213, s[28:31], s66 offen offset:1024 sc1
  v_mfma_f32_32x32x16_bf16 v[36:51], a[120:123], v[164:167], v[36:51]
  s_waitcnt vmcnt(10)
  v_cmp_eq_u32 vcc, -1, v168
  v_mfma_f32_32x32x16_bf16 v[52:67], a[124:127], v[164:167], v[52:67]
  s_cbranch_vccnz L_tag_2262373_r
L_tag_2262373:
  buffer_load_dwordx4 v[164:167], v213, s[28:31], s66 offen offset:2048 sc1
  v_mfma_f32_32x32x16_bf16 v[36:51], a[128:131], v[168:171], v[36:51]
  s_waitcnt vmcnt(9)
  v_cmp_eq_u32 vcc, -1, v172
  v_mfma_f32_32x32x16_bf16 v[52:67], a[132:135], v[168:171], v[52:67]
  s_cbranch_vccnz L_tag_2264374_r
L_tag_2264374:
  buffer_load_dwordx4 v[168:171], v213, s[28:31], s66 offen offset:3072 sc1
  v_mfma_f32_32x32x16_bf16 v[36:51], a[136:139], v[172:175], v[36:51]
  s_waitcnt vmcnt(9)
  v_cmp_eq_u32 vcc, -1, v176
  v_mfma_f32_32x32x16_bf16 v[52:67], a[140:143], v[172:175], v[52:67]
  s_cbranch_vccnz L_tag_2266375_r
L_tag_2266375:
  s_add_u32 s66, s58, 290816
  buffer_load_dwordx4 v[172:175], v213, s[28:31], s66 offen offset:0 sc1
  v_mfma_f32_32x32x16_bf16 v[36:51], a[144:147], v[176:179], v[36:51]
  s_waitcnt vmcnt(9)
  v_cmp_eq_u32 vcc, -1, v180
  v_mfma_f32_32x32x16_bf16 v[52:67], a[148:151], v[176:179], v[52:67]
  s_cbranch_vccnz L_tag_2268376_r
L_tag_2268376:
  buffer_load_dwordx4 v[176:179], v213, s[28:31], s66 offen offset:1024 sc1
  v_mfma_f32_32x32x16_bf16 v[36:51], a[152:155], v[180:183], v[36:51]
  s_waitcnt vmcnt(9)
  v_cmp_eq_u32 vcc, -1, v184
  v_mfma_f32_32x32x16_bf16 v[52:67], a[156:159], v[180:183], v[52:67]
  s_cbranch_vccnz L_tag_2270377_r
L_tag_2270377:
  buffer_load_dwordx4 v[180:183], v213, s[28:31], s66 offen offset:2048 sc1
  v_mfma_f32_32x32x16_bf16 v[36:51], a[160:163], v[184:187], v[36:51]
  s_waitcnt vmcnt(9)
  v_cmp_eq_u32 vcc, -1, v108
  v_mfma_f32_32x32x16_bf16 v[52:67], a[164:167], v[184:187], v[52:67]
  s_cbranch_vccnz L_tag_2272378_r
L_tag_2272378:
  buffer_load_dwordx4 v[184:187], v213, s[28:31], s66 offen offset:3072 sc1
  v_mfma_f32_32x32x16_bf16 v[36:51], a[168:171], v[108:111], v[36:51]
  s_waitcnt vmcnt(9)
  v_cmp_eq_u32 vcc, -1, v112
  v_mfma_f32_32x32x16_bf16 v[52:67], a[172:175], v[108:111], v[52:67]
  s_cbranch_vccnz L_tag_2274379_r
L_tag_2274379:
  s_add_u32 s66, s58, 393216
  buffer_load_dwordx4 v[108:111], v213, s[28:31], s66 offen offset:0 sc1
  v_mfma_f32_32x32x16_bf16 v[36:51], a[176:179], v[112:115], v[36:51]
  s_waitcnt vmcnt(9)
  v_cmp_eq_u32 vcc, -1, v116
  v_mfma_f32_32x32x16_bf16 v[52:67], a[180:183], v[112:115], v[52:67]
  s_cbranch_vccnz L_tag_2276380_r
L_tag_2276380:
  buffer_load_dwordx4 v[112:115], v213, s[28:31], s66 offen offset:1024 sc1
  v_mfma_f32_32x32x16_bf16 v[36:51], a[184:187], v[116:119], v[36:51]
  s_waitcnt vmcnt(9)
  v_cmp_eq_u32 vcc, -1, v156
  v_mfma_f32_32x32x16_bf16 v[52:67], a[188:191], v[116:119], v[52:67]
  s_cbranch_vccnz L_tag_2278381_r
L_tag_2278381:
  buffer_load_dwordx4 v[116:119], v213, s[28:31], s66 offen offset:2048 sc1
  v_mfma_f32_32x32x16_bf16 v[36:51], a[192:195], v[156:159], v[36:51]
  s_waitcnt vmcnt(9)
  v_cmp_eq_u32 vcc, -1, v160
  v_mfma_f32_32x32x16_bf16 v[52:67], a[196:199], v[156:159], v[52:67]
  s_cbranch_vccnz L_tag_2280382_r
L_tag_2280382:
  buffer_load_dwordx4 v[156:159], v213, s[28:31], s66 offen offset:3072 sc1
  v_mfma_f32_32x32x16_bf16 v[36:51], a[200:203], v[160:163], v[36:51]
  s_waitcnt vmcnt(9)
  v_cmp_eq_u32 vcc, -1, v164
  v_mfma_f32_32x32x16_bf16 v[52:67], a[204:207], v[160:163], v[52:67]
  s_cbranch_vccnz L_tag_2282383_r
L_tag_2282383:
  s_add_u32 s66, s58, 397312
  buffer_load_dwordx4 v[160:163], v213, s[28:31], s66 offen offset:0 sc1
  v_mfma_f32_32x32x16_bf16 v[36:51], a[208:211], v[164:167], v[36:51]
  s_waitcnt vmcnt(9)
  v_cmp_eq_u32 vcc, -1, v168
  v_mfma_f32_32x32x16_bf16 v[52:67], a[212:215], v[164:167], v[52:67]
  s_cbranch_vccnz L_tag_2284384_r
L_tag_2284384:
  buffer_load_dwordx4 v[164:167], v213, s[28:31], s66 offen offset:1024 sc1
  v_mfma_f32_32x32x16_bf16 v[36:51], a[216:219], v[168:171], v[36:51]
  s_waitcnt vmcnt(9)
  v_cmp_eq_u32 vcc, -1, v172
  v_mfma_f32_32x32x16_bf16 v[52:67], a[220:223], v[168:171], v[52:67]
  s_cbranch_vccnz L_tag_2286385_r
L_tag_2286385:
  buffer_load_dwordx4 v[168:171], v213, s[28:31], s66 offen offset:2048 sc1
  v_mfma_f32_32x32x16_bf16 v[36:51], a[224:227], v[172:175], v[36:51]
  s_waitcnt vmcnt(9)
  v_cmp_eq_u32 vcc, -1, v176
  v_mfma_f32_32x32x16_bf16 v[52:67], a[228:231], v[172:175], v[52:67]
  s_cbranch_vccnz L_tag_2288386_r
L_tag_2288386:
  buffer_load_dwordx4 v[172:175], v213, s[28:31], s66 offen offset:3072 sc1
  v_mfma_f32_32x32x16_bf16 v[36:51], a[232:235], v[176:179], v[36:51]
  s_waitcnt vmcnt(9)
  v_cmp_eq_u32 vcc, -1, v180
  v_mfma_f32_32x32x16_bf16 v[52:67], a[236:239], v[176:179], v[52:67]
  s_cbranch_vccnz L_tag_2290387_r
L_tag_2290387:
  s_add_u32 s66, s58, 401408
  buffer_load_dwordx4 v[176:179], v213, s[28:31], s66 offen offset:0 sc1
  v_mfma_f32_32x32x16_bf16 v[36:51], a[240:243], v[180:183], v[36:51]
  s_waitcnt vmcnt(9)
  v_cmp_eq_u32 vcc, -1, v184
  v_mfma_f32_32x32x16_bf16 v[52:67], a[244:247], v[180:183], v[52:67]
  s_cbranch_vccnz L_tag_2292388_r
L_tag_2292388:
  buffer_load_dwordx4 v[180:183], v213, s[28:31], s66 offen offset:1024 sc1
  v_mfma_f32_32x32x16_bf16 v[36:51], a[248:251], v[184:187], v[36:51]
  s_waitcnt vmcnt(9)
  v_cmp_eq_u32 vcc, -1, v108
  v_mfma_f32_32x32x16_bf16 v[52:67], a[252:255], v[184:187], v[52:67]
  s_cbranch_vccnz L_tag_2294389_r
L_tag_2294389:
  buffer_load_dwordx4 v[184:187], v213, s[28:31], s66 offen offset:2048 sc1
  v_mfma_f32_32x32x16_bf16 v[68:83], a[0:3], v[108:111], 0
  s_nop 5
  ds_write_b128 v253, v[44:47] offset:0
  ds_write_b128 v253, v[48:51] offset:1024
  s_nop 0
  ds_write_b128 v254, v[52:55] offset:0
  s_waitcnt vmcnt(9)
  v_cmp_eq_u32 vcc, -1, v112
  v_mfma_f32_32x32x16_bf16 v[84:99], a[4:7], v[108:111], 0
  s_cbranch_vccnz L_tag_2424390_r
L_tag_2424390:
  buffer_load_dwordx4 v[108:111], v213, s[28:31], s66 offen offset:3072 sc1
  ds_write_b128 v254, v[56:59] offset:1024
  ds_write_b128 v255, v[60:63] offset:0
  ds_write_b128 v255, v[64:67] offset:1024
  v_mfma_f32_32x32x16_bf16 v[68:83], a[8:11], v[112:115], v[68:83]
  v_pk_add_f32 v[36:37], v[36:37], v[16:17]
  v_pk_add_f32 v[38:39], v[38:39], v[18:19]
  v_pk_add_f32 v[40:41], v[40:41], v[20:21]
  v_pk_add_f32 v[42:43], v[42:43], v[22:23]
  s_waitcnt lgkmcnt(0)
  s_barrier
  ds_read_b128 v[132:135], v230 offset:0
  ds_read_b128 v[136:139], v230 offset:1024
  ds_read_b128 v[140:143], v230 offset:2048
  ds_read_b128 v[144:147], v230 offset:3072
  ds_read_b128 v[148:151], v230 offset:4096
  ds_read_b128 v[152:155], v230 offset:5120
  s_waitcnt vmcnt(9)
  v_cmp_eq_u32 vcc, -1, v116
  v_mfma_f32_32x32x16_bf16 v[84:99], a[12:15], v[112:115], v[84:99]
  s_cbranch_vccnz L_tag_2426391_r
L_tag_2426391:
  s_add_u32 s66, s58, 405504
  buffer_load_dwordx4 v[112:115], v213, s[28:31], s66 offen offset:0 sc1
  v_mfma_f32_32x32x16_bf16 v[68:83], a[16:19], v[116:119], v[68:83]
  s_waitcnt lgkmcnt(5)
  v_pk_add_f32 v[36:37], v[36:37], v[132:133]
  v_pk_add_f32 v[38:39], v[38:39], v[134:135]
  s_waitcnt lgkmcnt(4)
  v_pk_add_f32 v[40:41], v[40:41], v[136:137]
  v_pk_add_f32 v[42:43], v[42:43], v[138:139]
  s_waitcnt lgkmcnt(3)
  v_pk_add_f32 v[36:37], v[36:37], v[140:141]
  v_pk_add_f32 v[38:39], v[38:39], v[142:143]
  s_waitcnt vmcnt(9)
  v_cmp_eq_u32 vcc, -1, v156
  v_mfma_f32_32x32x16_bf16 v[84:99], a[20:23], v[116:119], v[84:99]
  s_cbranch_vccnz L_tag_2428392_r
L_tag_2428392:
  buffer_load_dwordx4 v[116:119], v213, s[28:31], s66 offen offset:1024 sc1
  s_waitcnt lgkmcnt(2)
  v_pk_add_f32 v[40:41], v[40:41], v[144:145]
  v_pk_add_f32 v[42:43], v[42:43], v[146:147]
  s_waitcnt lgkmcnt(1)
  v_pk_add_f32 v[36:37], v[36:37], v[148:149]
  v_pk_add_f32 v[38:39], v[38:39], v[150:151]
  s_waitcnt lgkmcnt(0)
  v_pk_add_f32 v[40:41], v[40:41], v[152:153]
  v_pk_add_f32 v[42:43], v[42:43], v[154:155]
  v_mfma_f32_32x32x16_bf16 v[68:83], a[24:27], v[156:159], v[68:83]
  v_pk_mul_f32 v[8:9], v[36:37], v[36:37]
  v_pk_mul_f32 v[10:11], v[38:39], v[38:39]
  v_pk_mul_f32 v[12:13], v[40:41], v[40:41]
  v_pk_mul_f32 v[14:15], v[42:43], v[42:43]
  v_pk_fma_f32 v[8:9], v[8:9], v[28:29], v[28:29] op_sel:[0,0,1] op_sel_hi:[1,0,1]
  v_pk_fma_f32 v[10:11], v[10:11], v[28:29], v[28:29] op_sel:[0,0,1] op_sel_hi:[1,0,1]
  s_waitcnt vmcnt(9)
  v_cmp_eq_u32 vcc, -1, v160
  v_mfma_f32_32x32x16_bf16 v[84:99], a[28:31], v[156:159], v[84:99]
  s_cbranch_vccnz L_tag_2430393_r
L_tag_2430393:
  buffer_load_dwordx4 v[156:159], v213, s[28:31], s66 offen offset:2048 sc1
  v_pk_fma_f32 v[12:13], v[12:13], v[28:29], v[28:29] op_sel:[0,0,1] op_sel_hi:[1,0,1]
  v_pk_fma_f32 v[14:15], v[14:15], v[28:29], v[28:29] op_sel:[0,0,1] op_sel_hi:[1,0,1]
  v_pk_mul_f32 v[8:9], v[8:9], v[36:37]
  v_pk_mul_f32 v[10:11], v[10:11], v[38:39]
  v_pk_mul_f32 v[12:13], v[12:13], v[40:41]
  v_pk_mul_f32 v[14:15], v[14:15], v[42:43]
  v_mfma_f32_32x32x16_bf16 v[68:83], a[32:35], v[160:163], v[68:83]
  v_exp_f32 v8, v8
  v_exp_f32 v9, v9
  v_exp_f32 v10, v10
  v_exp_f32 v11, v11
  v_exp_f32 v12, v12
  v_exp_f32 v13, v13
  s_waitcnt vmcnt(9)
  v_cmp_eq_u32 vcc, -1, v164
  v_mfma_f32_32x32x16_bf16 v[84:99], a[36:39], v[160:163], v[84:99]
  s_cbranch_vccnz L_tag_2432394_r
L_tag_2432394:
  buffer_load_dwordx4 v[160:163], v213, s[28:31], s66 offen offset:3072 sc1
  v_exp_f32 v14, v14
  v_exp_f32 v15, v15
  v_pk_add_f32 v[8:9], v[8:9], v[30:31] op_sel_hi:[1,0]
  v_pk_add_f32 v[10:11], v[10:11], v[30:31] op_sel_hi:[1,0]
  v_pk_add_f32 v[12:13], v[12:13], v[30:31] op_sel_hi:[1,0]
  v_pk_add_f32 v[14:15], v[14:15], v[30:31] op_sel_hi:[1,0]
  v_mfma_f32_32x32x16_bf16 v[68:83], a[40:43], v[164:167], v[68:83]
  v_rcp_f32 v8, v8
  v_rcp_f32 v9, v9
  v_rcp_f32 v10, v10
  v_rcp_f32 v11, v11
  v_rcp_f32 v12, v12
  v_rcp_f32 v13, v13
  s_waitcnt vmcnt(9)
  v_cmp_eq_u32 vcc, -1, v168
  v_mfma_f32_32x32x16_bf16 v[84:99], a[44:47], v[164:167], v[84:99]
  s_cbranch_vccnz L_tag_2434395_r
L_tag_2434395:
  s_add_u32 s66, s58, 409600
  buffer_load_dwordx4 v[164:167], v213, s[28:31], s66 offen offset:0 sc1
  v_rcp_f32 v14, v14
  v_rcp_f32 v15, v15
  v_pk_mul_f32 v[8:9], v[8:9], v[36:37]
  v_pk_mul_f32 v[10:11], v[10:11], v[38:39]
  v_pk_mul_f32 v[12:13], v[12:13], v[40:41]
  v_pk_mul_f32 v[14:15], v[14:15], v[42:43]
  v_mfma_f32_32x32x16_bf16 v[68:83], a[48:51], v[168:171], v[68:83]
  v_cvt_pk_bf16_f32 v24, v8, v9
  v_cvt_pk_bf16_f32 v25, v10, v11
  v_cvt_pk_bf16_f32 v26, v12, v13
  v_cvt_pk_bf16_f32 v27, v14, v15
  s_add_u32 s52, s62, 10715136
  buffer_store_dwordx4 v[24:27], v232, s[28:31], s52 offen sc1
  s_waitcnt vmcnt(10)
  v_cmp_eq_u32 vcc, -1, v172
  v_mfma_f32_32x32x16_bf16 v[84:99], a[52:55], v[168:171], v[84:99]
  s_cbranch_vccnz L_tag_2436396_r
L_tag_2436396:
  buffer_load_dwordx4 v[168:171], v213, s[28:31], s66 offen offset:1024 sc1
  v_mfma_f32_32x32x16_bf16 v[68:83], a[56:59], v[172:175], v[68:83]
  s_waitcnt vmcnt(10)
  v_cmp_eq_u32 vcc, -1, v176
  v_mfma_f32_32x32x16_bf16 v[84:99], a[60:63], v[172:175], v[84:99]
  s_cbranch_vccnz L_tag_2438397_r
L_tag_2438397:
  buffer_load_dwordx4 v[172:175], v213, s[28:31], s66 offen offset:2048 sc1
  v_mfma_f32_32x32x16_bf16 v[68:83], a[64:67], v[176:179], v[68:83]
  s_waitcnt vmcnt(10)
  v_cmp_eq_u32 vcc, -1, v180
  v_mfma_f32_32x32x16_bf16 v[84:99], a[68:71], v[176:179], v[84:99]
  s_cbranch_vccnz L_tag_2440398_r
L_tag_2440398:
  buffer_load_dwordx4 v[176:179], v213, s[28:31], s66 offen offset:3072 sc1
  v_mfma_f32_32x32x16_bf16 v[68:83], a[72:75], v[180:183], v[68:83]
  s_waitcnt vmcnt(10)
  v_cmp_eq_u32 vcc, -1, v184
  v_mfma_f32_32x32x16_bf16 v[84:99], a[76:79], v[180:183], v[84:99]
  s_cbranch_vccnz L_tag_2442399_r
L_tag_2442399:
  s_add_u32 s66, s58, 413696
  buffer_load_dwordx4 v[180:183], v213, s[28:31], s66 offen offset:0 sc1
  v_mfma_f32_32x32x16_bf16 v[68:83], a[80:83], v[184:187], v[68:83]
  s_waitcnt vmcnt(10)
  v_cmp_eq_u32 vcc, -1, v108
  v_mfma_f32_32x32x16_bf16 v[84:99], a[84:87], v[184:187], v[84:99]
  s_cbranch_vccnz L_tag_2444400_r
L_tag_2444400:
  buffer_load_dwordx4 v[184:187], v213, s[28:31], s66 offen offset:1024 sc1
  v_mfma_f32_32x32x16_bf16 v[68:83], a[88:91], v[108:111], v[68:83]
  s_waitcnt vmcnt(10)
  v_cmp_eq_u32 vcc, -1, v112
  v_mfma_f32_32x32x16_bf16 v[84:99], a[92:95], v[108:111], v[84:99]
  s_cbranch_vccnz L_tag_2446401_r
L_tag_2446401:
  buffer_load_dwordx4 v[108:111], v213, s[28:31], s66 offen offset:2048 sc1
  v_mfma_f32_32x32x16_bf16 v[68:83], a[96:99], v[112:115], v[68:83]
  s_waitcnt vmcnt(10)
  v_cmp_eq_u32 vcc, -1, v116
  v_mfma_f32_32x32x16_bf16 v[84:99], a[100:103], v[112:115], v[84:99]
  s_cbranch_vccnz L_tag_2448402_r
L_tag_2448402:
  buffer_load_dwordx4 v[112:115], v213, s[28:31], s66 offen offset:3072 sc1
  v_mfma_f32_32x32x16_bf16 v[68:83], a[104:107], v[116:119], v[68:83]
  s_waitcnt vmcnt(10)
  v_cmp_eq_u32 vcc, -1, v156
  v_mfma_f32_32x32x16_bf16 v[84:99], a[108:111], v[116:119], v[84:99]
  s_cbranch_vccnz L_tag_2450403_r
L_tag_2450403:
  s_add_u32 s66, s58, 417792
  buffer_load_dwordx4 v[116:119], v213, s[28:31], s66 offen offset:0 sc1
  v_mfma_f32_32x32x16_bf16 v[68:83], a[112:115], v[156:159], v[68:83]
  s_waitcnt vmcnt(10)
  v_cmp_eq_u32 vcc, -1, v160
  v_mfma_f32_32x32x16_bf16 v[84:99], a[116:119], v[156:159], v[84:99]
  s_cbranch_vccnz L_tag_2452404_r
L_tag_2452404:
  buffer_load_dwordx4 v[156:159], v213, s[28:31], s66 offen offset:1024 sc1
  v_mfma_f32_32x32x16_bf16 v[68:83], a[120:123], v[160:163], v[68:83]
  s_waitcnt vmcnt(10)
  v_cmp_eq_u32 vcc, -1, v164
  v_mfma_f32_32x32x16_bf16 v[84:99], a[124:127], v[160:163], v[84:99]
  s_cbranch_vccnz L_tag_2454405_r
L_tag_2454405:
  buffer_load_dwordx4 v[160:163], v213, s[28:31], s66 offen offset:2048 sc1
  v_mfma_f32_32x32x16_bf16 v[68:83], a[128:131], v[164:167], v[68:83]
  s_waitcnt vmcnt(9)
  v_cmp_eq_u32 vcc, -1, v168
  v_mfma_f32_32x32x16_bf16 v[84:99], a[132:135], v[164:167], v[84:99]
  s_cbranch_vccnz L_tag_2456406_r
L_tag_2456406:
  buffer_load_dwordx4 v[164:167], v213, s[28:31], s66 offen offset:3072 sc1
  v_mfma_f32_32x32x16_bf16 v[68:83], a[136:139], v[168:171], v[68:83]
  s_waitcnt vmcnt(9)
  v_cmp_eq_u32 vcc, -1, v172
  v_mfma_f32_32x32x16_bf16 v[84:99], a[140:143], v[168:171], v[84:99]
  s_cbranch_vccnz L_tag_2458407_r
L_tag_2458407:
  s_add_u32 s66, s58, 421888
  buffer_load_dwordx4 v[168:171], v213, s[28:31], s66 offen offset:0 sc1
  v_mfma_f32_32x32x16_bf16 v[68:83], a[144:147], v[172:175], v[68:83]
  s_waitcnt vmcnt(9)
  v_cmp_eq_u32 vcc, -1, v176
  v_mfma_f32_32x32x16_bf16 v[84:99], a[148:151], v[172:175], v[84:99]
  s_cbranch_vccnz L_tag_2460408_r
L_tag_2460408:
  buffer_load_dwordx4 v[172:175], v213, s[28:31], s66 offen offset:1024 sc1
  v_mfma_f32_32x32x16_bf16 v[68:83], a[152:155], v[176:179], v[68:83]
  s_waitcnt vmcnt(9)
  v_cmp_eq_u32 vcc, -1, v180
  v_mfma_f32_32x32x16_bf16 v[84:99], a[156:159], v[176:179], v[84:99]
  s_cbranch_vccnz L_tag_2462409_r
L_tag_2462409:
  buffer_load_dwordx4 v[176:179], v213, s[28:31], s66 offen offset:2048 sc1
  v_mfma_f32_32x32x16_bf16 v[68:83], a[160:163], v[180:183], v[68:83]
  s_waitcnt vmcnt(9)
  v_cmp_eq_u32 vcc, -1, v184
  v_mfma_f32_32x32x16_bf16 v[84:99], a[164:167], v[180:183], v[84:99]
  s_cbranch_vccnz L_tag_2464410_r
L_tag_2464410:
  buffer_load_dwordx4 v[180:183], v213, s[28:31], s66 offen offset:3072 sc1
  v_mfma_f32_32x32x16_bf16 v[68:83], a[168:171], v[184:187], v[68:83]
  s_waitcnt vmcnt(9)
  v_cmp_eq_u32 vcc, -1, v108
  v_mfma_f32_32x32x16_bf16 v[84:99], a[172:175], v[184:187], v[84:99]
  s_cbranch_vccnz L_tag_2466411_r
L_tag_2466411:
  v_mfma_f32_32x32x16_bf16 v[68:83], a[176:179], v[108:111], v[68:83]
  s_waitcnt vmcnt(8)
  v_cmp_eq_u32 vcc, -1, v112
  v_mfma_f32_32x32x16_bf16 v[84:99], a[180:183], v[108:111], v[84:99]
  s_cbranch_vccnz L_tag_2468412_r
L_tag_2468412:
  v_mfma_f32_32x32x16_bf16 v[68:83], a[184:187], v[112:115], v[68:83]
  s_waitcnt vmcnt(7)
  v_cmp_eq_u32 vcc, -1, v116
  v_mfma_f32_32x32x16_bf16 v[84:99], a[188:191], v[112:115], v[84:99]
  s_cbranch_vccnz L_tag_2470413_r
L_tag_2470413:
  v_mfma_f32_32x32x16_bf16 v[68:83], a[192:195], v[116:119], v[68:83]
  s_waitcnt vmcnt(6)
  v_cmp_eq_u32 vcc, -1, v156
  v_mfma_f32_32x32x16_bf16 v[84:99], a[196:199], v[116:119], v[84:99]
  s_cbranch_vccnz L_tag_2472414_r
L_tag_2472414:
  v_mfma_f32_32x32x16_bf16 v[68:83], a[200:203], v[156:159], v[68:83]
  s_waitcnt vmcnt(5)
  v_cmp_eq_u32 vcc, -1, v160
  v_mfma_f32_32x32x16_bf16 v[84:99], a[204:207], v[156:159], v[84:99]
  s_cbranch_vccnz L_tag_2474415_r
L_tag_2474415:
  v_mfma_f32_32x32x16_bf16 v[68:83], a[208:211], v[160:163], v[68:83]
  s_waitcnt vmcnt(4)
  v_cmp_eq_u32 vcc, -1, v164
  v_mfma_f32_32x32x16_bf16 v[84:99], a[212:215], v[160:163], v[84:99]
  s_cbranch_vccnz L_tag_2476416_r
L_tag_2476416:
  v_mfma_f32_32x32x16_bf16 v[68:83], a[216:219], v[164:167], v[68:83]
  s_waitcnt vmcnt(3)
  v_cmp_eq_u32 vcc, -1, v168
  v_mfma_f32_32x32x16_bf16 v[84:99], a[220:223], v[164:167], v[84:99]
  s_cbranch_vccnz L_tag_2478417_r
L_tag_2478417:
  v_mfma_f32_32x32x16_bf16 v[68:83], a[224:227], v[168:171], v[68:83]
  s_waitcnt vmcnt(2)
  v_cmp_eq_u32 vcc, -1, v172
  v_mfma_f32_32x32x16_bf16 v[84:99], a[228:231], v[168:171], v[84:99]
  s_cbranch_vccnz L_tag_2480418_r
L_tag_2480418:
  v_mfma_f32_32x32x16_bf16 v[68:83], a[232:235], v[172:175], v[68:83]
  s_waitcnt vmcnt(1)
  v_cmp_eq_u32 vcc, -1, v176
  v_mfma_f32_32x32x16_bf16 v[84:99], a[236:239], v[172:175], v[84:99]
  s_cbranch_vccnz L_tag_2482419_r
L_tag_2482419:
  v_mfma_f32_32x32x16_bf16 v[68:83], a[240:243], v[176:179], v[68:83]
  s_waitcnt vmcnt(0)
  v_cmp_eq_u32 vcc, -1, v180
  v_mfma_f32_32x32x16_bf16 v[84:99], a[244:247], v[176:179], v[84:99]
  s_cbranch_vccnz L_tag_2484420_r
L_tag_2484420:
  v_mfma_f32_32x32x16_bf16 v[68:83], a[248:251], v[180:183], v[68:83]
  v_mfma_f32_32x32x16_bf16 v[84:99], a[252:255], v[180:183], v[84:99]
  s_nop 10
  ds_write_b128 v253, v[76:79] offset:0
  ds_write_b128 v253, v[80:83] offset:1024
  ds_write_b128 v254, v[84:87] offset:0
  ds_write_b128 v254, v[88:91] offset:1024
  ds_write_b128 v255, v[92:95] offset:0
  ds_write_b128 v255, v[96:99] offset:1024
  v_pk_add_f32 v[68:69], v[68:69], v[16:17]
  v_pk_add_f32 v[70:71], v[70:71], v[18:19]
  v_pk_add_f32 v[72:73], v[72:73], v[20:21]
  v_pk_add_f32 v[74:75], v[74:75], v[22:23]
  s_waitcnt lgkmcnt(0)
  s_barrier
  ds_read_b128 v[132:135], v230 offset:0
  ds_read_b128 v[136:139], v230 offset:1024
  ds_read_b128 v[140:143], v230 offset:2048
  ds_read_b128 v[144:147], v230 offset:3072
  ds_read_b128 v[148:151], v230 offset:4096
  ds_read_b128 v[152:155], v230 offset:5120
  s_waitcnt lgkmcnt(5)
  v_pk_add_f32 v[68:69], v[68:69], v[132:133]
  v_pk_add_f32 v[70:71], v[70:71], v[134:135]
  s_waitcnt lgkmcnt(4)
  v_pk_add_f32 v[72:73], v[72:73], v[136:137]
  v_pk_add_f32 v[74:75], v[74:75], v[138:139]
  s_waitcnt lgkmcnt(3)
  v_pk_add_f32 v[68:69], v[68:69], v[140:141]
  v_pk_add_f32 v[70:71], v[70:71], v[142:143]
  s_waitcnt lgkmcnt(2)
  v_pk_add_f32 v[72:73], v[72:73], v[144:145]
  v_pk_add_f32 v[74:75], v[74:75], v[146:147]
  s_waitcnt lgkmcnt(1)
  v_pk_add_f32 v[68:69], v[68:69], v[148:149]
  v_pk_add_f32 v[70:71], v[70:71], v[150:151]
  s_waitcnt lgkmcnt(0)
  v_pk_add_f32 v[72:73], v[72:73], v[152:153]
  v_pk_add_f32 v[74:75], v[74:75], v[154:155]
  v_pk_mul_f32 v[8:9], v[68:69], v[68:69]
  v_pk_mul_f32 v[10:11], v[70:71], v[70:71]
  v_pk_mul_f32 v[12:13], v[72:73], v[72:73]
  v_pk_mul_f32 v[14:15], v[74:75], v[74:75]
  v_pk_fma_f32 v[8:9], v[8:9], v[28:29], v[28:29] op_sel:[0,0,1] op_sel_hi:[1,0,1]
  v_pk_fma_f32 v[10:11], v[10:11], v[28:29], v[28:29] op_sel:[0,0,1] op_sel_hi:[1,0,1]
  v_pk_fma_f32 v[12:13], v[12:13], v[28:29], v[28:29] op_sel:[0,0,1] op_sel_hi:[1,0,1]
  v_pk_fma_f32 v[14:15], v[14:15], v[28:29], v[28:29] op_sel:[0,0,1] op_sel_hi:[1,0,1]
  v_pk_mul_f32 v[8:9], v[8:9], v[68:69]
  v_pk_mul_f32 v[10:11], v[10:11], v[70:71]
  v_pk_mul_f32 v[12:13], v[12:13], v[72:73]
  v_pk_mul_f32 v[14:15], v[14:15], v[74:75]
  v_exp_f32 v8, v8
  v_exp_f32 v9, v9
  v_exp_f32 v10, v10
  v_exp_f32 v11, v11
  v_exp_f32 v12, v12
  v_exp_f32 v13, v13
  v_exp_f32 v14, v14
  v_exp_f32 v15, v15
  v_pk_add_f32 v[8:9], v[8:9], v[30:31] op_sel_hi:[1,0]
  v_pk_add_f32 v[10:11], v[10:11], v[30:31] op_sel_hi:[1,0]
  v_pk_add_f32 v[12:13], v[12:13], v[30:31] op_sel_hi:[1,0]
  v_pk_add_f32 v[14:15], v[14:15], v[30:31] op_sel_hi:[1,0]
  v_rcp_f32 v8, v8
  v_rcp_f32 v9, v9
  v_rcp_f32 v10, v10
  v_rcp_f32 v11, v11
  v_rcp_f32 v12, v12
  v_rcp_f32 v13, v13
  v_rcp_f32 v14, v14
  v_rcp_f32 v15, v15
  v_pk_mul_f32 v[8:9], v[8:9], v[68:69]
  v_pk_mul_f32 v[10:11], v[10:11], v[70:71]
  v_pk_mul_f32 v[12:13], v[12:13], v[72:73]
  v_pk_mul_f32 v[14:15], v[14:15], v[74:75]
  v_cvt_pk_bf16_f32 v24, v8, v9
  v_cvt_pk_bf16_f32 v25, v10, v11
  v_cvt_pk_bf16_f32 v26, v12, v13
  v_cvt_pk_bf16_f32 v27, v14, v15
  s_add_u32 s52, s62, 10829824
  buffer_store_dwordx4 v[24:27], v232, s[28:31], s52 offen sc1
  s_branch L_join_1834289
L_role4_1834288:
  s_mul_i32 s58, s74, 458752
  s_mul_i32 s66, s77, 28672
  s_add_u32 s58, s58, s66
  s_add_u32 s58, s58, 18874368
  v_lshlrev_b32 v32, 16, v32
  s_barrier
  s_mov_b64 exec, 1
  v_mov_b32 v233, 0
  buffer_atomic_add v233, v210, s[28:31], 0 offen offset:72 sc0 sc1
  s_mov_b64 exec, -1
  s_add_u32 s66, s58, 0
  s_waitcnt vmcnt(0)
  v_readfirstlane_b32 s3, v233
  s_cmp_lt_u32 s3, 7
  s_cbranch_scc1 L_poll_2616421_r
L_poll_2616421:
  buffer_load_dwordx4 v[156:159], v231, s[28:31], s66 offen offset:0 sc1
  buffer_load_dwordx4 v[160:163], v231, s[28:31], s66 offen offset:1024 sc1
  buffer_load_dwordx4 v[164:167], v231, s[28:31], s66 offen offset:2048 sc1
  buffer_load_dwordx4 v[168:171], v231, s[28:31], s66 offen offset:3072 sc1
  s_add_u32 s66, s58, 4096
  buffer_load_dwordx4 v[172:175], v231, s[28:31], s66 offen offset:0 sc1
  buffer_load_dwordx4 v[176:179], v231, s[28:31], s66 offen offset:1024 sc1
  buffer_load_dwordx4 v[180:183], v231, s[28:31], s66 offen offset:2048 sc1
  buffer_load_dwordx4 v[184:187], v231, s[28:31], s66 offen offset:3072 sc1
  s_add_u32 s66, s58, 8192
  buffer_load_dwordx4 v[108:111], v231, s[28:31], s66 offen offset:0 sc1
  buffer_load_dwordx4 v[112:115], v231, s[28:31], s66 offen offset:1024 sc1
  buffer_load_dwordx4 v[116:119], v231, s[28:31], s66 offen offset:2048 sc1
  s_waitcnt vmcnt(10)
  v_cmp_eq_u32 vcc, -1, v156
  s_cbranch_vccnz L_tag_2618422_r
L_tag_2618422:
  v_mfma_f32_32x32x16_bf16 v[36:51], v[156:159], a[0:3], 0
  s_waitcnt vmcnt(9)
  v_cmp_eq_u32 vcc, -1, v160
  v_mfma_f32_32x32x16_bf16 v[52:67], v[156:159], a[4:7], 0
  s_cbranch_vccnz L_tag_2622423_r
L_tag_2622423:
  buffer_load_dwordx4 v[156:159], v231, s[28:31], s66 offen offset:3072 sc1
  v_mfma_f32_32x32x16_bf16 v[36:51], v[160:163], a[8:11], v[36:51]
  s_waitcnt vmcnt(9)
  v_cmp_eq_u32 vcc, -1, v164
  v_mfma_f32_32x32x16_bf16 v[52:67], v[160:163], a[12:15], v[52:67]
  s_cbranch_vccnz L_tag_2624424_r
L_tag_2624424:
  s_add_u32 s66, s58, 12288
  buffer_load_dwordx4 v[160:163], v231, s[28:31], s66 offen offset:0 sc1
  v_mfma_f32_32x32x16_bf16 v[36:51], v[164:167], a[16:19], v[36:51]
  s_waitcnt vmcnt(9)
  v_cmp_eq_u32 vcc, -1, v168
  v_mfma_f32_32x32x16_bf16 v[52:67], v[164:167], a[20:23], v[52:67]
  s_cbranch_vccnz L_tag_2626425_r
L_tag_2626425:
  buffer_load_dwordx4 v[164:167], v231, s[28:31], s66 offen offset:1024 sc1
  v_mfma_f32_32x32x16_bf16 v[36:51], v[168:171], a[24:27], v[36:51]
  s_waitcnt vmcnt(9)
  v_cmp_eq_u32 vcc, -1, v172
  v_mfma_f32_32x32x16_bf16 v[52:67], v[168:171], a[28:31], v[52:67]
  s_cbranch_vccnz L_tag_2628426_r
L_tag_2628426:
  buffer_load_dwordx4 v[168:171], v231, s[28:31], s66 offen offset:2048 sc1
  v_mfma_f32_32x32x16_bf16 v[36:51], v[172:175], a[32:35], v[36:51]
  s_waitcnt vmcnt(9)
  v_cmp_eq_u32 vcc, -1, v176
  v_mfma_f32_32x32x16_bf16 v[52:67], v[172:175], a[36:39], v[52:67]
  s_cbranch_vccnz L_tag_2630427_r
L_tag_2630427:
  buffer_load_dwordx4 v[172:175], v231, s[28:31], s66 offen offset:3072 sc1
  v_mfma_f32_32x32x16_bf16 v[36:51], v[176:179], a[40:43], v[36:51]
  s_waitcnt vmcnt(9)
  v_cmp_eq_u32 vcc, -1, v180
  v_mfma_f32_32x32x16_bf16 v[52:67], v[176:179], a[44:47], v[52:67]
  s_cbranch_vccnz L_tag_2632428_r
L_tag_2632428:
  s_add_u32 s66, s58, 16384
  buffer_load_dwordx4 v[176:179], v231, s[28:31], s66 offen offset:0 sc1
  v_mfma_f32_32x32x16_bf16 v[36:51], v[180:183], a[48:51], v[36:51]
  s_waitcnt vmcnt(9)
  v_cmp_eq_u32 vcc, -1, v184
  v_mfma_f32_32x32x16_bf16 v[52:67], v[180:183], a[52:55], v[52:67]
  s_cbranch_vccnz L_tag_2634429_r
L_tag_2634429:
  buffer_load_dwordx4 v[180:183], v231, s[28:31], s66 offen offset:1024 sc1
  v_mfma_f32_32x32x16_bf16 v[36:51], v[184:187], a[56:59], v[36:51]
  s_waitcnt vmcnt(9)
  v_cmp_eq_u32 vcc, -1, v108
  v_mfma_f32_32x32x16_bf16 v[52:67], v[184:187], a[60:63], v[52:67]
  s_cbranch_vccnz L_tag_2636430_r
L_tag_2636430:
  buffer_load_dwordx4 v[184:187], v231, s[28:31], s66 offen offset:2048 sc1
  v_mfma_f32_32x32x16_bf16 v[36:51], v[108:111], a[64:67], v[36:51]
  s_waitcnt vmcnt(9)
  v_cmp_eq_u32 vcc, -1, v112
  v_mfma_f32_32x32x16_bf16 v[52:67], v[108:111], a[68:71], v[52:67]
  s_cbranch_vccnz L_tag_2638431_r
L_tag_2638431:
  buffer_load_dwordx4 v[108:111], v231, s[28:31], s66 offen offset:3072 sc1
  v_mfma_f32_32x32x16_bf16 v[36:51], v[112:115], a[72:75], v[36:51]
  s_waitcnt vmcnt(9)
  v_cmp_eq_u32 vcc, -1, v116
  v_mfma_f32_32x32x16_bf16 v[52:67], v[112:115], a[76:79], v[52:67]
  s_cbranch_vccnz L_tag_2640432_r
L_tag_2640432:
  s_add_u32 s66, s58, 20480
  buffer_load_dwordx4 v[112:115], v231, s[28:31], s66 offen offset:0 sc1
  v_mfma_f32_32x32x16_bf16 v[36:51], v[116:119], a[80:83], v[36:51]
  s_waitcnt vmcnt(9)
  v_cmp_eq_u32 vcc, -1, v156
  v_mfma_f32_32x32x16_bf16 v[52:67], v[116:119], a[84:87], v[52:67]
  s_cbranch_vccnz L_tag_2642433_r
L_tag_2642433:
  buffer_load_dwordx4 v[116:119], v231, s[28:31], s66 offen offset:1024 sc1
  v_mfma_f32_32x32x16_bf16 v[36:51], v[156:159], a[88:91], v[36:51]
  s_waitcnt vmcnt(9)
  v_cmp_eq_u32 vcc, -1, v160
  v_mfma_f32_32x32x16_bf16 v[52:67], v[156:159], a[92:95], v[52:67]
  s_cbranch_vccnz L_tag_2644434_r
L_tag_2644434:
  buffer_load_dwordx4 v[156:159], v231, s[28:31], s66 offen offset:2048 sc1
  v_mfma_f32_32x32x16_bf16 v[36:51], v[160:163], a[96:99], v[36:51]
  s_waitcnt vmcnt(9)
  v_cmp_eq_u32 vcc, -1, v164
  v_mfma_f32_32x32x16_bf16 v[52:67], v[160:163], a[100:103], v[52:67]
  s_cbranch_vccnz L_tag_2646435_r
L_tag_2646435:
  buffer_load_dwordx4 v[160:163], v231, s[28:31], s66 offen offset:3072 sc1
  v_mfma_f32_32x32x16_bf16 v[36:51], v[164:167], a[104:107], v[36:51]
  s_waitcnt vmcnt(9)
  v_cmp_eq_u32 vcc, -1, v168
  v_mfma_f32_32x32x16_bf16 v[52:67], v[164:167], a[108:111], v[52:67]
  s_cbranch_vccnz L_tag_2648436_r
L_tag_2648436:
  s_add_u32 s66, s58, 24576
  buffer_load_dwordx4 v[164:167], v231, s[28:31], s66 offen offset:0 sc1
  v_mfma_f32_32x32x16_bf16 v[36:51], v[168:171], a[112:115], v[36:51]
  s_waitcnt vmcnt(9)
  v_cmp_eq_u32 vcc, -1, v172
  v_mfma_f32_32x32x16_bf16 v[52:67], v[168:171], a[116:119], v[52:67]
  s_cbranch_vccnz L_tag_2650437_r
L_tag_2650437:
  buffer_load_dwordx4 v[168:171], v231, s[28:31], s66 offen offset:1024 sc1
  s_add_u32 s52, s63, 14680064
  buffer_load_dwordx4 v[100:103], v227, s[28:31], s52 offen sc1
  v_mfma_f32_32x32x16_bf16 v[36:51], v[172:175], a[120:123], v[36:51]
  s_waitcnt vmcnt(10)
  v_cmp_eq_u32 vcc, -1, v176
  v_mfma_f32_32x32x16_bf16 v[52:67], v[172:175], a[124:127], v[52:67]
  s_cbranch_vccnz L_tag_2652438_r
L_tag_2652438:
  buffer_load_dwordx4 v[172:175], v231, s[28:31], s66 offen offset:2048 sc1
  v_mfma_f32_32x32x16_bf16 v[36:51], v[176:179], a[128:131], v[36:51]
  s_waitcnt vmcnt(10)
  v_cmp_eq_u32 vcc, -1, v180
  v_mfma_f32_32x32x16_bf16 v[52:67], v[176:179], a[132:135], v[52:67]
  s_cbranch_vccnz L_tag_2654439_r
L_tag_2654439:
  buffer_load_dwordx4 v[176:179], v231, s[28:31], s66 offen offset:3072 sc1
  v_mfma_f32_32x32x16_bf16 v[36:51], v[180:183], a[136:139], v[36:51]
  s_waitcnt vmcnt(10)
  v_cmp_eq_u32 vcc, -1, v184
  v_mfma_f32_32x32x16_bf16 v[52:67], v[180:183], a[140:143], v[52:67]
  s_cbranch_vccnz L_tag_2656440_r
L_tag_2656440:
  s_add_u32 s66, s58, 114688
  buffer_load_dwordx4 v[180:183], v231, s[28:31], s66 offen offset:0 sc1
  v_mfma_f32_32x32x16_bf16 v[36:51], v[184:187], a[144:147], v[36:51]
  s_waitcnt vmcnt(10)
  v_cmp_eq_u32 vcc, -1, v108
  v_mfma_f32_32x32x16_bf16 v[52:67], v[184:187], a[148:151], v[52:67]
  s_cbranch_vccnz L_tag_2658441_r
L_tag_2658441:
  buffer_load_dwordx4 v[184:187], v231, s[28:31], s66 offen offset:1024 sc1
  v_mfma_f32_32x32x16_bf16 v[36:51], v[108:111], a[152:155], v[36:51]
  s_waitcnt vmcnt(10)
  v_cmp_eq_u32 vcc, -1, v112
  v_mfma_f32_32x32x16_bf16 v[52:67], v[108:111], a[156:159], v[52:67]
  s_cbranch_vccnz L_tag_2660442_r
L_tag_2660442:
  buffer_load_dwordx4 v[108:111], v231, s[28:31], s66 offen offset:2048 sc1
  v_mfma_f32_32x32x16_bf16 v[36:51], v[112:115], a[160:163], v[36:51]
  s_waitcnt vmcnt(10)
  v_cmp_eq_u32 vcc, -1, v116
  v_mfma_f32_32x32x16_bf16 v[52:67], v[112:115], a[164:167], v[52:67]
  s_cbranch_vccnz L_tag_2662443_r
L_tag_2662443:
  buffer_load_dwordx4 v[112:115], v231, s[28:31], s66 offen offset:3072 sc1
  v_mfma_f32_32x32x16_bf16 v[36:51], v[116:119], a[168:171], v[36:51]
  s_waitcnt vmcnt(10)
  v_cmp_eq_u32 vcc, -1, v156
  v_mfma_f32_32x32x16_bf16 v[52:67], v[116:119], a[172:175], v[52:67]
  s_cbranch_vccnz L_tag_2664444_r
L_tag_2664444:
  s_add_u32 s66, s58, 118784
  buffer_load_dwordx4 v[116:119], v231, s[28:31], s66 offen offset:0 sc1
  v_mfma_f32_32x32x16_bf16 v[36:51], v[156:159], a[176:179], v[36:51]
  s_waitcnt vmcnt(10)
  v_cmp_eq_u32 vcc, -1, v160
  v_mfma_f32_32x32x16_bf16 v[52:67], v[156:159], a[180:183], v[52:67]
  s_cbranch_vccnz L_tag_2666445_r
L_tag_2666445:
  buffer_load_dwordx4 v[156:159], v231, s[28:31], s66 offen offset:1024 sc1
  v_mfma_f32_32x32x16_bf16 v[36:51], v[160:163], a[184:187], v[36:51]
  s_waitcnt vmcnt(10)
  v_cmp_eq_u32 vcc, -1, v164
  v_mfma_f32_32x32x16_bf16 v[52:67], v[160:163], a[188:191], v[52:67]
  s_cbranch_vccnz L_tag_2668446_r
L_tag_2668446:
  buffer_load_dwordx4 v[160:163], v231, s[28:31], s66 offen offset:2048 sc1
  v_mfma_f32_32x32x16_bf16 v[36:51], v[164:167], a[192:195], v[36:51]
  s_waitcnt vmcnt(10)
  v_cmp_eq_u32 vcc, -1, v168
  v_mfma_f32_32x32x16_bf16 v[52:67], v[164:167], a[196:199], v[52:67]
  s_cbranch_vccnz L_tag_2670447_r
L_tag_2670447:
  buffer_load_dwordx4 v[164:167], v231, s[28:31], s66 offen offset:3072 sc1
  v_mfma_f32_32x32x16_bf16 v[36:51], v[168:171], a[200:203], v[36:51]
  s_waitcnt vmcnt(9)
  v_cmp_eq_u32 vcc, -1, v172
  v_mfma_f32_32x32x16_bf16 v[52:67], v[168:171], a[204:207], v[52:67]
  s_cbranch_vccnz L_tag_2672448_r
L_tag_2672448:
  s_add_u32 s66, s58, 122880
  buffer_load_dwordx4 v[168:171], v231, s[28:31], s66 offen offset:0 sc1
  v_mfma_f32_32x32x16_bf16 v[36:51], v[172:175], a[208:211], v[36:51]
  s_waitcnt vmcnt(9)
  v_cmp_eq_u32 vcc, -1, v176
  v_mfma_f32_32x32x16_bf16 v[52:67], v[172:175], a[212:215], v[52:67]
  s_cbranch_vccnz L_tag_2674449_r
L_tag_2674449:
  buffer_load_dwordx4 v[172:175], v231, s[28:31], s66 offen offset:1024 sc1
  v_mfma_f32_32x32x16_bf16 v[36:51], v[176:179], a[216:219], v[36:51]
  s_waitcnt vmcnt(9)
  v_cmp_eq_u32 vcc, -1, v180
  v_mfma_f32_32x32x16_bf16 v[52:67], v[176:179], a[220:223], v[52:67]
  s_cbranch_vccnz L_tag_2676450_r
L_tag_2676450:
  buffer_load_dwordx4 v[176:179], v231, s[28:31], s66 offen offset:2048 sc1
  v_mfma_f32_32x32x16_bf16 v[68:83], v[180:183], a[0:3], 0
  s_nop 5
  ds_write_b128 v253, v[44:47] offset:0
  s_waitcnt vmcnt(9)
  v_cmp_eq_u32 vcc, -1, v184
  v_mfma_f32_32x32x16_bf16 v[84:99], v[180:183], a[4:7], 0
  s_cbranch_vccnz L_tag_2798451_r
L_tag_2798451:
  buffer_load_dwordx4 v[180:183], v231, s[28:31], s66 offen offset:3072 sc1
  ds_write_b128 v253, v[48:51] offset:1024
  v_mfma_f32_32x32x16_bf16 v[68:83], v[184:187], a[8:11], v[68:83]
  ds_write_b128 v254, v[52:55] offset:0
  s_waitcnt vmcnt(9)
  v_cmp_eq_u32 vcc, -1, v108
  v_mfma_f32_32x32x16_bf16 v[84:99], v[184:187], a[12:15], v[84:99]
  s_cbranch_vccnz L_tag_2800452_r
L_tag_2800452:
  s_add_u32 s66, s58, 126976
  buffer_load_dwordx4 v[184:187], v231, s[28:31], s66 offen offset:0 sc1
  ds_write_b128 v254, v[56:59] offset:1024
  v_mfma_f32_32x32x16_bf16 v[68:83], v[108:111], a[16:19], v[68:83]
  ds_write_b128 v255, v[60:63] offset:0
  s_waitcnt vmcnt(9)
  v_cmp_eq_u32 vcc, -1, v112
  v_mfma_f32_32x32x16_bf16 v[84:99], v[108:111], a[20:23], v[84:99]
  s_cbranch_vccnz L_tag_2802453_r
L_tag_2802453:
  buffer_load_dwordx4 v[108:111], v231, s[28:31], s66 offen offset:1024 sc1
  ds_write_b128 v255, v[64:67] offset:1024
  v_mfma_f32_32x32x16_bf16 v[68:83], v[112:115], a[24:27], v[68:83]
  v_lshlrev_b32 v8, 16, v100
  v_and_b32 v9, 0xffff0000, v100
  v_lshlrev_b32 v10, 16, v101
  v_and_b32 v11, 0xffff0000, v101
  s_waitcnt vmcnt(9)
  v_cmp_eq_u32 vcc, -1, v116
  v_mfma_f32_32x32x16_bf16 v[84:99], v[112:115], a[28:31], v[84:99]
  s_cbranch_vccnz L_tag_2804454_r
L_tag_2804454:
  buffer_load_dwordx4 v[112:115], v231, s[28:31], s66 offen offset:2048 sc1
  v_lshlrev_b32 v12, 16, v102
  v_and_b32 v13, 0xffff0000, v102
  v_lshlrev_b32 v14, 16, v103
  v_and_b32 v15, 0xffff0000, v103
  v_mfma_f32_32x32x16_bf16 v[68:83], v[116:119], a[32:35], v[68:83]
  v_add_f32 v8, v8, v32
  v_add_f32 v9, v9, v32
  v_add_f32 v10, v10, v32
  v_add_f32 v11, v11, v32
  s_waitcnt vmcnt(9)
  v_cmp_eq_u32 vcc, -1, v156
  v_mfma_f32_32x32x16_bf16 v[84:99], v[116:119], a[36:39], v[84:99]
  s_cbranch_vccnz L_tag_2806455_r
L_tag_2806455:
  buffer_load_dwordx4 v[116:119], v231, s[28:31], s66 offen offset:3072 sc1
  v_add_f32 v12, v12, v32
  v_add_f32 v13, v13, v32
  v_add_f32 v14, v14, v32
  v_add_f32 v15, v15, v32
  v_mfma_f32_32x32x16_bf16 v[68:83], v[156:159], a[40:43], v[68:83]
  v_add_f32 v36, v36, v8
  v_add_f32 v37, v37, v9
  v_add_f32 v38, v38, v10
  v_add_f32 v39, v39, v11
  s_waitcnt vmcnt(9)
  v_cmp_eq_u32 vcc, -1, v160
  v_mfma_f32_32x32x16_bf16 v[84:99], v[156:159], a[44:47], v[84:99]
  s_cbranch_vccnz L_tag_2808456_r
L_tag_2808456:
  s_add_u32 s66, s58, 131072
  buffer_load_dwordx4 v[156:159], v231, s[28:31], s66 offen offset:0 sc1
  v_add_f32 v40, v40, v12
  v_add_f32 v41, v41, v13
  v_add_f32 v42, v42, v14
  v_add_f32 v43, v43, v15
  v_mfma_f32_32x32x16_bf16 v[68:83], v[160:163], a[48:51], v[68:83]
  s_waitcnt lgkmcnt(0)
  s_barrier
  ds_read_b128 v[132:135], v230 offset:0
  ds_read_b128 v[136:139], v230 offset:1024
  ds_read_b128 v[140:143], v230 offset:2048
  ds_read_b128 v[144:147], v230 offset:3072
  ds_read_b128 v[148:151], v230 offset:4096
  ds_read_b128 v[152:155], v230 offset:5120
  s_waitcnt vmcnt(9)
  v_cmp_eq_u32 vcc, -1, v164
  v_mfma_f32_32x32x16_bf16 v[84:99], v[160:163], a[52:55], v[84:99]
  s_cbranch_vccnz L_tag_2810457_r
L_tag_2810457:
  buffer_load_dwordx4 v[160:163], v231, s[28:31], s66 offen offset:1024 sc1
  v_mfma_f32_32x32x16_bf16 v[68:83], v[164:167], a[56:59], v[68:83]
  s_waitcnt lgkmcnt(5)
  v_add_f32 v36, v36, v132
  v_add_f32 v37, v37, v133
  v_add_f32 v38, v38, v134
  v_add_f32 v39, v39, v135
  s_waitcnt vmcnt(9)
  v_cmp_eq_u32 vcc, -1, v168
  v_mfma_f32_32x32x16_bf16 v[84:99], v[164:167], a[60:63], v[84:99]
  s_cbranch_vccnz L_tag_2812458_r
L_tag_2812458:
  buffer_load_dwordx4 v[164:167], v231, s[28:31], s66 offen offset:2048 sc1
  s_waitcnt lgkmcnt(4)
  v_add_f32 v40, v40, v136
  v_add_f32 v41, v41, v137
  v_add_f32 v42, v42, v138
  v_add_f32 v43, v43, v139
  v_mfma_f32_32x32x16_bf16 v[68:83], v[168:171], a[64:67], v[68:83]
  s_waitcnt lgkmcnt(3)
  v_add_f32 v36, v36, v140
  v_add_f32 v37, v37, v141
  v_add_f32 v38, v38, v142
  v_add_f32 v39, v39, v143
  s_waitcnt vmcnt(9)
  v_cmp_eq_u32 vcc, -1, v172
  v_mfma_f32_32x32x16_bf16 v[84:99], v[168:171], a[68:71], v[84:99]
  s_cbranch_vccnz L_tag_2814459_r
L_tag_2814459:
  buffer_load_dwordx4 v[168:171], v231, s[28:31], s66 offen offset:3072 sc1
  s_waitcnt lgkmcnt(2)
  v_add_f32 v40, v40, v144
  v_add_f32 v41, v41, v145
  v_add_f32 v42, v42, v146
  v_add_f32 v43, v43, v147
  v_mfma_f32_32x32x16_bf16 v[68:83], v[172:175], a[72:75], v[68:83]
  s_waitcnt lgkmcnt(1)
  v_add_f32 v36, v36, v148
  v_add_f32 v37, v37, v149
  v_add_f32 v38, v38, v150
  v_add_f32 v39, v39, v151
  s_waitcnt vmcnt(9)
  v_cmp_eq_u32 vcc, -1, v176
  v_mfma_f32_32x32x16_bf16 v[84:99], v[172:175], a[76:79], v[84:99]
  s_cbranch_vccnz L_tag_2816460_r
L_tag_2816460:
  s_add_u32 s66, s58, 135168
  buffer_load_dwordx4 v[172:175], v231, s[28:31], s66 offen offset:0 sc1
  s_waitcnt lgkmcnt(0)
  v_add_f32 v40, v40, v152
  v_add_f32 v41, v41, v153
  v_add_f32 v42, v42, v154
  v_add_f32 v43, v43, v155
  v_mfma_f32_32x32x16_bf16 v[68:83], v[176:179], a[80:83], v[68:83]
  v_cvt_pk_bf16_f32 v24, v36, v37
  v_cvt_pk_bf16_f32 v25, v38, v39
  v_cvt_pk_bf16_f32 v26, v40, v41
  v_cvt_pk_bf16_f32 v27, v42, v43
  s_waitcnt vmcnt(9)
  v_cmp_eq_u32 vcc, -1, v180
  v_mfma_f32_32x32x16_bf16 v[84:99], v[176:179], a[84:87], v[84:99]
  s_cbranch_vccnz L_tag_2818461_r
L_tag_2818461:
  buffer_load_dwordx4 v[176:179], v231, s[28:31], s66 offen offset:1024 sc1
  v_permlane32_swap_b32 v24, v26
  v_permlane32_swap_b32 v25, v27
  buffer_store_dwordx4 v[24:27], v31, s[32:35], s64 offen offset:0
  v_mfma_f32_32x32x16_bf16 v[68:83], v[180:183], a[88:91], v[68:83]
  s_waitcnt vmcnt(10)
  v_cmp_eq_u32 vcc, -1, v184
  v_mfma_f32_32x32x16_bf16 v[84:99], v[180:183], a[92:95], v[84:99]
  s_cbranch_vccnz L_tag_2820462_r
L_tag_2820462:
  buffer_load_dwordx4 v[180:183], v231, s[28:31], s66 offen offset:2048 sc1
  v_mfma_f32_32x32x16_bf16 v[68:83], v[184:187], a[96:99], v[68:83]
  s_waitcnt vmcnt(10)
  v_cmp_eq_u32 vcc, -1, v108
  v_mfma_f32_32x32x16_bf16 v[84:99], v[184:187], a[100:103], v[84:99]
  s_cbranch_vccnz L_tag_2822463_r
L_tag_2822463:
  buffer_load_dwordx4 v[184:187], v231, s[28:31], s66 offen offset:3072 sc1
  v_mfma_f32_32x32x16_bf16 v[68:83], v[108:111], a[104:107], v[68:83]
  s_waitcnt vmcnt(10)
  v_cmp_eq_u32 vcc, -1, v112
  v_mfma_f32_32x32x16_bf16 v[84:99], v[108:111], a[108:111], v[84:99]
  s_cbranch_vccnz L_tag_2824464_r
L_tag_2824464:
  s_add_u32 s66, s58, 139264
  buffer_load_dwordx4 v[108:111], v231, s[28:31], s66 offen offset:0 sc1
  v_mfma_f32_32x32x16_bf16 v[68:83], v[112:115], a[112:115], v[68:83]
  s_waitcnt vmcnt(10)
  v_cmp_eq_u32 vcc, -1, v116
  v_mfma_f32_32x32x16_bf16 v[84:99], v[112:115], a[116:119], v[84:99]
  s_cbranch_vccnz L_tag_2826465_r
L_tag_2826465:
  buffer_load_dwordx4 v[112:115], v231, s[28:31], s66 offen offset:1024 sc1
  s_add_u32 s52, s63, 14681088
  buffer_load_dwordx4 v[104:107], v227, s[28:31], s52 offen sc1
  v_mfma_f32_32x32x16_bf16 v[68:83], v[116:119], a[120:123], v[68:83]
  s_waitcnt vmcnt(11)
  v_cmp_eq_u32 vcc, -1, v156
  v_mfma_f32_32x32x16_bf16 v[84:99], v[116:119], a[124:127], v[84:99]
  s_cbranch_vccnz L_tag_2828466_r
L_tag_2828466:
  buffer_load_dwordx4 v[116:119], v231, s[28:31], s66 offen offset:2048 sc1
  v_mfma_f32_32x32x16_bf16 v[68:83], v[156:159], a[128:131], v[68:83]
  s_waitcnt vmcnt(11)
  v_cmp_eq_u32 vcc, -1, v160
  v_mfma_f32_32x32x16_bf16 v[84:99], v[156:159], a[132:135], v[84:99]
  s_cbranch_vccnz L_tag_2830467_r
L_tag_2830467:
  buffer_load_dwordx4 v[156:159], v231, s[28:31], s66 offen offset:3072 sc1
  v_mfma_f32_32x32x16_bf16 v[68:83], v[160:163], a[136:139], v[68:83]
  s_waitcnt vmcnt(11)
  v_cmp_eq_u32 vcc, -1, v164
  v_mfma_f32_32x32x16_bf16 v[84:99], v[160:163], a[140:143], v[84:99]
  s_cbranch_vccnz L_tag_2832468_r
L_tag_2832468:
  s_add_u32 s66, s58, 229376
  buffer_load_dwordx4 v[160:163], v231, s[28:31], s66 offen offset:0 sc1
  v_mfma_f32_32x32x16_bf16 v[68:83], v[164:167], a[144:147], v[68:83]
  s_waitcnt vmcnt(11)
  v_cmp_eq_u32 vcc, -1, v168
  v_mfma_f32_32x32x16_bf16 v[84:99], v[164:167], a[148:151], v[84:99]
  s_cbranch_vccnz L_tag_2834469_r
L_tag_2834469:
  buffer_load_dwordx4 v[164:167], v231, s[28:31], s66 offen offset:1024 sc1
  v_mfma_f32_32x32x16_bf16 v[68:83], v[168:171], a[152:155], v[68:83]
  s_waitcnt vmcnt(11)
  v_cmp_eq_u32 vcc, -1, v172
  v_mfma_f32_32x32x16_bf16 v[84:99], v[168:171], a[156:159], v[84:99]
  s_cbranch_vccnz L_tag_2836470_r
L_tag_2836470:
  buffer_load_dwordx4 v[168:171], v231, s[28:31], s66 offen offset:2048 sc1
  v_mfma_f32_32x32x16_bf16 v[68:83], v[172:175], a[160:163], v[68:83]
  s_waitcnt vmcnt(11)
  v_cmp_eq_u32 vcc, -1, v176
  v_mfma_f32_32x32x16_bf16 v[84:99], v[172:175], a[164:167], v[84:99]
  s_cbranch_vccnz L_tag_2838471_r
L_tag_2838471:
  buffer_load_dwordx4 v[172:175], v231, s[28:31], s66 offen offset:3072 sc1
  v_mfma_f32_32x32x16_bf16 v[68:83], v[176:179], a[168:171], v[68:83]
  s_waitcnt vmcnt(10)
  v_cmp_eq_u32 vcc, -1, v180
  v_mfma_f32_32x32x16_bf16 v[84:99], v[176:179], a[172:175], v[84:99]
  s_cbranch_vccnz L_tag_2840472_r
L_tag_2840472:
  s_add_u32 s66, s58, 233472
  buffer_load_dwordx4 v[176:179], v231, s[28:31], s66 offen offset:0 sc1
  v_mfma_f32_32x32x16_bf16 v[68:83], v[180:183], a[176:179], v[68:83]
  s_waitcnt vmcnt(10)
  v_cmp_eq_u32 vcc, -1, v184
  v_mfma_f32_32x32x16_bf16 v[84:99], v[180:183], a[180:183], v[84:99]
  s_cbranch_vccnz L_tag_2842473_r
L_tag_2842473:
  buffer_load_dwordx4 v[180:183], v231, s[28:31], s66 offen offset:1024 sc1
  v_mfma_f32_32x32x16_bf16 v[68:83], v[184:187], a[184:187], v[68:83]
  s_waitcnt vmcnt(10)
  v_cmp_eq_u32 vcc, -1, v108
  v_mfma_f32_32x32x16_bf16 v[84:99], v[184:187], a[188:191], v[84:99]
  s_cbranch_vccnz L_tag_2844474_r
L_tag_2844474:
  buffer_load_dwordx4 v[184:187], v231, s[28:31], s66 offen offset:2048 sc1
  v_mfma_f32_32x32x16_bf16 v[68:83], v[108:111], a[192:195], v[68:83]
  s_waitcnt vmcnt(10)
  v_cmp_eq_u32 vcc, -1, v112
  v_mfma_f32_32x32x16_bf16 v[84:99], v[108:111], a[196:199], v[84:99]
  s_cbranch_vccnz L_tag_2846475_r
L_tag_2846475:
  buffer_load_dwordx4 v[108:111], v231, s[28:31], s66 offen offset:3072 sc1
  v_mfma_f32_32x32x16_bf16 v[68:83], v[112:115], a[200:203], v[68:83]
  s_waitcnt vmcnt(9)
  v_cmp_eq_u32 vcc, -1, v116
  v_mfma_f32_32x32x16_bf16 v[84:99], v[112:115], a[204:207], v[84:99]
  s_cbranch_vccnz L_tag_2848476_r
L_tag_2848476:
  s_add_u32 s66, s58, 237568
  buffer_load_dwordx4 v[112:115], v231, s[28:31], s66 offen offset:0 sc1
  v_mfma_f32_32x32x16_bf16 v[68:83], v[116:119], a[208:211], v[68:83]
  s_waitcnt vmcnt(9)
  v_cmp_eq_u32 vcc, -1, v156
  v_mfma_f32_32x32x16_bf16 v[84:99], v[116:119], a[212:215], v[84:99]
  s_cbranch_vccnz L_tag_2850477_r
L_tag_2850477:
  buffer_load_dwordx4 v[116:119], v231, s[28:31], s66 offen offset:1024 sc1
  v_mfma_f32_32x32x16_bf16 v[68:83], v[156:159], a[216:219], v[68:83]
  s_waitcnt vmcnt(9)
  v_cmp_eq_u32 vcc, -1, v160
  v_mfma_f32_32x32x16_bf16 v[84:99], v[156:159], a[220:223], v[84:99]
  s_cbranch_vccnz L_tag_2852478_r
L_tag_2852478:
  buffer_load_dwordx4 v[156:159], v231, s[28:31], s66 offen offset:2048 sc1
  v_mfma_f32_32x32x16_bf16 v[36:51], v[160:163], a[0:3], 0
  s_nop 5
  ds_write_b128 v253, v[76:79] offset:0
  s_waitcnt vmcnt(9)
  v_cmp_eq_u32 vcc, -1, v164
  v_mfma_f32_32x32x16_bf16 v[52:67], v[160:163], a[4:7], 0
  s_cbranch_vccnz L_tag_2974479_r
L_tag_2974479:
  buffer_load_dwordx4 v[160:163], v231, s[28:31], s66 offen offset:3072 sc1
  ds_write_b128 v253, v[80:83] offset:1024
  v_mfma_f32_32x32x16_bf16 v[36:51], v[164:167], a[8:11], v[36:51]
  ds_write_b128 v254, v[84:87] offset:0
  s_waitcnt vmcnt(9)
  v_cmp_eq_u32 vcc, -1, v168
  v_mfma_f32_32x32x16_bf16 v[52:67], v[164:167], a[12:15], v[52:67]
  s_cbranch_vccnz L_tag_2976480_r
L_tag_2976480:
  s_add_u32 s66, s58, 241664
  buffer_load_dwordx4 v[164:167], v231, s[28:31], s66 offen offset:0 sc1
  ds_write_b128 v254, v[88:91] offset:1024
  v_mfma_f32_32x32x16_bf16 v[36:51], v[168:171], a[16:19], v[36:51]
  ds_write_b128 v255, v[92:95] offset:0
  s_waitcnt vmcnt(9)
  v_cmp_eq_u32 vcc, -1, v172
  v_mfma_f32_32x32x16_bf16 v[52:67], v[168:171], a[20:23], v[52:67]
  s_cbranch_vccnz L_tag_2978481_r
L_tag_2978481:
  buffer_load_dwordx4 v[168:171], v231, s[28:31], s66 offen offset:1024 sc1
  ds_write_b128 v255, v[96:99] offset:1024
  v_mfma_f32_32x32x16_bf16 v[36:51], v[172:175], a[24:27], v[36:51]
  v_lshlrev_b32 v8, 16, v104
  v_and_b32 v9, 0xffff0000, v104
  v_lshlrev_b32 v10, 16, v105
  v_and_b32 v11, 0xffff0000, v105
  s_waitcnt vmcnt(9)
  v_cmp_eq_u32 vcc, -1, v176
  v_mfma_f32_32x32x16_bf16 v[52:67], v[172:175], a[28:31], v[52:67]
  s_cbranch_vccnz L_tag_2980482_r
L_tag_2980482:
  buffer_load_dwordx4 v[172:175], v231, s[28:31], s66 offen offset:2048 sc1
  v_lshlrev_b32 v12, 16, v106
  v_and_b32 v13, 0xffff0000, v106
  v_lshlrev_b32 v14, 16, v107
  v_and_b32 v15, 0xffff0000, v107
  v_mfma_f32_32x32x16_bf16 v[36:51], v[176:179], a[32:35], v[36:51]
  v_add_f32 v8, v8, v32
  v_add_f32 v9, v9, v32
  v_add_f32 v10, v10, v32
  v_add_f32 v11, v11, v32
  s_waitcnt vmcnt(9)
  v_cmp_eq_u32 vcc, -1, v180
  v_mfma_f32_32x32x16_bf16 v[52:67], v[176:179], a[36:39], v[52:67]
  s_cbranch_vccnz L_tag_2982483_r
L_tag_2982483:
  buffer_load_dwordx4 v[176:179], v231, s[28:31], s66 offen offset:3072 sc1
  v_add_f32 v12, v12, v32
  v_add_f32 v13, v13, v32
  v_add_f32 v14, v14, v32
  v_add_f32 v15, v15, v32
  v_mfma_f32_32x32x16_bf16 v[36:51], v[180:183], a[40:43], v[36:51]
  v_add_f32 v68, v68, v8
  v_add_f32 v69, v69, v9
  v_add_f32 v70, v70, v10
  v_add_f32 v71, v71, v11
  s_waitcnt vmcnt(9)
  v_cmp_eq_u32 vcc, -1, v184
  v_mfma_f32_32x32x16_bf16 v[52:67], v[180:183], a[44:47], v[52:67]
  s_cbranch_vccnz L_tag_2984484_r
L_tag_2984484:
  s_add_u32 s66, s58, 245760
  buffer_load_dwordx4 v[180:183], v231, s[28:31], s66 offen offset:0 sc1
  v_add_f32 v72, v72, v12
  v_add_f32 v73, v73, v13
  v_add_f32 v74, v74, v14
  v_add_f32 v75, v75, v15
  v_mfma_f32_32x32x16_bf16 v[36:51], v[184:187], a[48:51], v[36:51]
  s_waitcnt lgkmcnt(0)
  s_barrier
  ds_read_b128 v[132:135], v230 offset:0
  ds_read_b128 v[136:139], v230 offset:1024
  ds_read_b128 v[140:143], v230 offset:2048
  ds_read_b128 v[144:147], v230 offset:3072
  ds_read_b128 v[148:151], v230 offset:4096
  ds_read_b128 v[152:155], v230 offset:5120
  s_waitcnt vmcnt(9)
  v_cmp_eq_u32 vcc, -1, v108
  v_mfma_f32_32x32x16_bf16 v[52:67], v[184:187], a[52:55], v[52:67]
  s_cbranch_vccnz L_tag_2986485_r
L_tag_2986485:
  buffer_load_dwordx4 v[184:187], v231, s[28:31], s66 offen offset:1024 sc1
  v_mfma_f32_32x32x16_bf16 v[36:51], v[108:111], a[56:59], v[36:51]
  s_waitcnt lgkmcnt(5)
  v_add_f32 v68, v68, v132
  v_add_f32 v69, v69, v133
  v_add_f32 v70, v70, v134
  v_add_f32 v71, v71, v135
  s_waitcnt vmcnt(9)
  v_cmp_eq_u32 vcc, -1, v112
  v_mfma_f32_32x32x16_bf16 v[52:67], v[108:111], a[60:63], v[52:67]
  s_cbranch_vccnz L_tag_2988486_r
L_tag_2988486:
  buffer_load_dwordx4 v[108:111], v231, s[28:31], s66 offen offset:2048 sc1
  s_waitcnt lgkmcnt(4)
  v_add_f32 v72, v72, v136
  v_add_f32 v73, v73, v137
  v_add_f32 v74, v74, v138
  v_add_f32 v75, v75, v139
  v_mfma_f32_32x32x16_bf16 v[36:51], v[112:115], a[64:67], v[36:51]
  s_waitcnt lgkmcnt(3)
  v_add_f32 v68, v68, v140
  v_add_f32 v69, v69, v141
  v_add_f32 v70, v70, v142
  v_add_f32 v71, v71, v143
  s_waitcnt vmcnt(9)
  v_cmp_eq_u32 vcc, -1, v116
  v_mfma_f32_32x32x16_bf16 v[52:67], v[112:115], a[68:71], v[52:67]
  s_cbranch_vccnz L_tag_2990487_r
L_tag_2990487:
  buffer_load_dwordx4 v[112:115], v231, s[28:31], s66 offen offset:3072 sc1
  s_waitcnt lgkmcnt(2)
  v_add_f32 v72, v72, v144
  v_add_f32 v73, v73, v145
  v_add_f32 v74, v74, v146
  v_add_f32 v75, v75, v147
  v_mfma_f32_32x32x16_bf16 v[36:51], v[116:119], a[72:75], v[36:51]
  s_waitcnt lgkmcnt(1)
  v_add_f32 v68, v68, v148
  v_add_f32 v69, v69, v149
  v_add_f32 v70, v70, v150
  v_add_f32 v71, v71, v151
  s_waitcnt vmcnt(9)
  v_cmp_eq_u32 vcc, -1, v156
  v_mfma_f32_32x32x16_bf16 v[52:67], v[116:119], a[76:79], v[52:67]
  s_cbranch_vccnz L_tag_2992488_r
L_tag_2992488:
  s_add_u32 s66, s58, 249856
  buffer_load_dwordx4 v[116:119], v231, s[28:31], s66 offen offset:0 sc1
  s_waitcnt lgkmcnt(0)
  v_add_f32 v72, v72, v152
  v_add_f32 v73, v73, v153
  v_add_f32 v74, v74, v154
  v_add_f32 v75, v75, v155
  v_mfma_f32_32x32x16_bf16 v[36:51], v[156:159], a[80:83], v[36:51]
  v_cvt_pk_bf16_f32 v24, v68, v69
  v_cvt_pk_bf16_f32 v25, v70, v71
  v_cvt_pk_bf16_f32 v26, v72, v73
  v_cvt_pk_bf16_f32 v27, v74, v75
  s_waitcnt vmcnt(9)
  v_cmp_eq_u32 vcc, -1, v160
  v_mfma_f32_32x32x16_bf16 v[52:67], v[156:159], a[84:87], v[52:67]
  s_cbranch_vccnz L_tag_2994489_r
L_tag_2994489:
  buffer_load_dwordx4 v[156:159], v231, s[28:31], s66 offen offset:1024 sc1
  v_permlane32_swap_b32 v24, v26
  v_permlane32_swap_b32 v25, v27
  buffer_store_dwordx4 v[24:27], v31, s[32:35], s64 offen offset:64
  v_mfma_f32_32x32x16_bf16 v[36:51], v[160:163], a[88:91], v[36:51]
  s_waitcnt vmcnt(10)
  v_cmp_eq_u32 vcc, -1, v164
  v_mfma_f32_32x32x16_bf16 v[52:67], v[160:163], a[92:95], v[52:67]
  s_cbranch_vccnz L_tag_2996490_r
L_tag_2996490:
  buffer_load_dwordx4 v[160:163], v231, s[28:31], s66 offen offset:2048 sc1
  v_mfma_f32_32x32x16_bf16 v[36:51], v[164:167], a[96:99], v[36:51]
  s_waitcnt vmcnt(10)
  v_cmp_eq_u32 vcc, -1, v168
  v_mfma_f32_32x32x16_bf16 v[52:67], v[164:167], a[100:103], v[52:67]
  s_cbranch_vccnz L_tag_2998491_r
L_tag_2998491:
  buffer_load_dwordx4 v[164:167], v231, s[28:31], s66 offen offset:3072 sc1
  v_mfma_f32_32x32x16_bf16 v[36:51], v[168:171], a[104:107], v[36:51]
  s_waitcnt vmcnt(10)
  v_cmp_eq_u32 vcc, -1, v172
  v_mfma_f32_32x32x16_bf16 v[52:67], v[168:171], a[108:111], v[52:67]
  s_cbranch_vccnz L_tag_3000492_r
L_tag_3000492:
  s_add_u32 s66, s58, 253952
  buffer_load_dwordx4 v[168:171], v231, s[28:31], s66 offen offset:0 sc1
  v_mfma_f32_32x32x16_bf16 v[36:51], v[172:175], a[112:115], v[36:51]
  s_waitcnt vmcnt(10)
  v_cmp_eq_u32 vcc, -1, v176
  v_mfma_f32_32x32x16_bf16 v[52:67], v[172:175], a[116:119], v[52:67]
  s_cbranch_vccnz L_tag_3002493_r
L_tag_3002493:
  buffer_load_dwordx4 v[172:175], v231, s[28:31], s66 offen offset:1024 sc1
  s_add_u32 s52, s63, 14682112
  buffer_load_dwordx4 v[100:103], v227, s[28:31], s52 offen sc1
  v_mfma_f32_32x32x16_bf16 v[36:51], v[176:179], a[120:123], v[36:51]
  s_waitcnt vmcnt(11)
  v_cmp_eq_u32 vcc, -1, v180
  v_mfma_f32_32x32x16_bf16 v[52:67], v[176:179], a[124:127], v[52:67]
  s_cbranch_vccnz L_tag_3004494_r
L_tag_3004494:
  buffer_load_dwordx4 v[176:179], v231, s[28:31], s66 offen offset:2048 sc1
  v_mfma_f32_32x32x16_bf16 v[36:51], v[180:183], a[128:131], v[36:51]
  s_waitcnt vmcnt(11)
  v_cmp_eq_u32 vcc, -1, v184
  v_mfma_f32_32x32x16_bf16 v[52:67], v[180:183], a[132:135], v[52:67]
  s_cbranch_vccnz L_tag_3006495_r
L_tag_3006495:
  buffer_load_dwordx4 v[180:183], v231, s[28:31], s66 offen offset:3072 sc1
  v_mfma_f32_32x32x16_bf16 v[36:51], v[184:187], a[136:139], v[36:51]
  s_waitcnt vmcnt(11)
  v_cmp_eq_u32 vcc, -1, v108
  v_mfma_f32_32x32x16_bf16 v[52:67], v[184:187], a[140:143], v[52:67]
  s_cbranch_vccnz L_tag_3008496_r
L_tag_3008496:
  s_add_u32 s66, s58, 344064
  buffer_load_dwordx4 v[184:187], v231, s[28:31], s66 offen offset:0 sc1
  v_mfma_f32_32x32x16_bf16 v[36:51], v[108:111], a[144:147], v[36:51]
  s_waitcnt vmcnt(11)
  v_cmp_eq_u32 vcc, -1, v112
  v_mfma_f32_32x32x16_bf16 v[52:67], v[108:111], a[148:151], v[52:67]
  s_cbranch_vccnz L_tag_3010497_r
L_tag_3010497:
  buffer_load_dwordx4 v[108:111], v231, s[28:31], s66 offen offset:1024 sc1
  v_mfma_f32_32x32x16_bf16 v[36:51], v[112:115], a[152:155], v[36:51]
  s_waitcnt vmcnt(11)
  v_cmp_eq_u32 vcc, -1, v116
  v_mfma_f32_32x32x16_bf16 v[52:67], v[112:115], a[156:159], v[52:67]
  s_cbranch_vccnz L_tag_3012498_r
L_tag_3012498:
  buffer_load_dwordx4 v[112:115], v231, s[28:31], s66 offen offset:2048 sc1
  v_mfma_f32_32x32x16_bf16 v[36:51], v[116:119], a[160:163], v[36:51]
  s_waitcnt vmcnt(11)
  v_cmp_eq_u32 vcc, -1, v156
  v_mfma_f32_32x32x16_bf16 v[52:67], v[116:119], a[164:167], v[52:67]
  s_cbranch_vccnz L_tag_3014499_r
L_tag_3014499:
  buffer_load_dwordx4 v[116:119], v231, s[28:31], s66 offen offset:3072 sc1
  v_mfma_f32_32x32x16_bf16 v[36:51], v[156:159], a[168:171], v[36:51]
  s_waitcnt vmcnt(10)
  v_cmp_eq_u32 vcc, -1, v160
  v_mfma_f32_32x32x16_bf16 v[52:67], v[156:159], a[172:175], v[52:67]
  s_cbranch_vccnz L_tag_3016500_r
L_tag_3016500:
  s_add_u32 s66, s58, 348160
  buffer_load_dwordx4 v[156:159], v231, s[28:31], s66 offen offset:0 sc1
  v_mfma_f32_32x32x16_bf16 v[36:51], v[160:163], a[176:179], v[36:51]
  s_waitcnt vmcnt(10)
  v_cmp_eq_u32 vcc, -1, v164
  v_mfma_f32_32x32x16_bf16 v[52:67], v[160:163], a[180:183], v[52:67]
  s_cbranch_vccnz L_tag_3018501_r
L_tag_3018501:
  buffer_load_dwordx4 v[160:163], v231, s[28:31], s66 offen offset:1024 sc1
  v_mfma_f32_32x32x16_bf16 v[36:51], v[164:167], a[184:187], v[36:51]
  s_waitcnt vmcnt(10)
  v_cmp_eq_u32 vcc, -1, v168
  v_mfma_f32_32x32x16_bf16 v[52:67], v[164:167], a[188:191], v[52:67]
  s_cbranch_vccnz L_tag_3020502_r
L_tag_3020502:
  buffer_load_dwordx4 v[164:167], v231, s[28:31], s66 offen offset:2048 sc1
  v_mfma_f32_32x32x16_bf16 v[36:51], v[168:171], a[192:195], v[36:51]
  s_waitcnt vmcnt(10)
  v_cmp_eq_u32 vcc, -1, v172
  v_mfma_f32_32x32x16_bf16 v[52:67], v[168:171], a[196:199], v[52:67]
  s_cbranch_vccnz L_tag_3022503_r
L_tag_3022503:
  buffer_load_dwordx4 v[168:171], v231, s[28:31], s66 offen offset:3072 sc1
  v_mfma_f32_32x32x16_bf16 v[36:51], v[172:175], a[200:203], v[36:51]
  s_waitcnt vmcnt(9)
  v_cmp_eq_u32 vcc, -1, v176
  v_mfma_f32_32x32x16_bf16 v[52:67], v[172:175], a[204:207], v[52:67]
  s_cbranch_vccnz L_tag_3024504_r
L_tag_3024504:
  s_add_u32 s66, s58, 352256
  buffer_load_dwordx4 v[172:175], v231, s[28:31], s66 offen offset:0 sc1
  v_mfma_f32_32x32x16_bf16 v[36:51], v[176:179], a[208:211], v[36:51]
  s_waitcnt vmcnt(9)
  v_cmp_eq_u32 vcc, -1, v180
  v_mfma_f32_32x32x16_bf16 v[52:67], v[176:179], a[212:215], v[52:67]
  s_cbranch_vccnz L_tag_3026505_r
L_tag_3026505:
  buffer_load_dwordx4 v[176:179], v231, s[28:31], s66 offen offset:1024 sc1
  v_mfma_f32_32x32x16_bf16 v[36:51], v[180:183], a[216:219], v[36:51]
  s_waitcnt vmcnt(9)
  v_cmp_eq_u32 vcc, -1, v184
  v_mfma_f32_32x32x16_bf16 v[52:67], v[180:183], a[220:223], v[52:67]
  s_cbranch_vccnz L_tag_3028506_r
L_tag_3028506:
  buffer_load_dwordx4 v[180:183], v231, s[28:31], s66 offen offset:2048 sc1
  v_mfma_f32_32x32x16_bf16 v[68:83], v[184:187], a[0:3], 0
  s_nop 5
  ds_write_b128 v253, v[44:47] offset:0
  s_waitcnt vmcnt(9)
  v_cmp_eq_u32 vcc, -1, v108
  v_mfma_f32_32x32x16_bf16 v[84:99], v[184:187], a[4:7], 0
  s_cbranch_vccnz L_tag_3150507_r
L_tag_3150507:
  buffer_load_dwordx4 v[184:187], v231, s[28:31], s66 offen offset:3072 sc1
  ds_write_b128 v253, v[48:51] offset:1024
  v_mfma_f32_32x32x16_bf16 v[68:83], v[108:111], a[8:11], v[68:83]
  ds_write_b128 v254, v[52:55] offset:0
  s_waitcnt vmcnt(9)
  v_cmp_eq_u32 vcc, -1, v112
  v_mfma_f32_32x32x16_bf16 v[84:99], v[108:111], a[12:15], v[84:99]
  s_cbranch_vccnz L_tag_3152508_r
L_tag_3152508:
  s_add_u32 s66, s58, 356352
  buffer_load_dwordx4 v[108:111], v231, s[28:31], s66 offen offset:0 sc1
  ds_write_b128 v254, v[56:59] offset:1024
  v_mfma_f32_32x32x16_bf16 v[68:83], v[112:115], a[16:19], v[68:83]
  ds_write_b128 v255, v[60:63] offset:0
  s_waitcnt vmcnt(9)
  v_cmp_eq_u32 vcc, -1, v116
  v_mfma_f32_32x32x16_bf16 v[84:99], v[112:115], a[20:23], v[84:99]
  s_cbranch_vccnz L_tag_3154509_r
L_tag_3154509:
  buffer_load_dwordx4 v[112:115], v231, s[28:31], s66 offen offset:1024 sc1
  ds_write_b128 v255, v[64:67] offset:1024
  v_mfma_f32_32x32x16_bf16 v[68:83], v[116:119], a[24:27], v[68:83]
  v_lshlrev_b32 v8, 16, v100
  v_and_b32 v9, 0xffff0000, v100
  v_lshlrev_b32 v10, 16, v101
  v_and_b32 v11, 0xffff0000, v101
  s_waitcnt vmcnt(9)
  v_cmp_eq_u32 vcc, -1, v156
  v_mfma_f32_32x32x16_bf16 v[84:99], v[116:119], a[28:31], v[84:99]
  s_cbranch_vccnz L_tag_3156510_r
L_tag_3156510:
  buffer_load_dwordx4 v[116:119], v231, s[28:31], s66 offen offset:2048 sc1
  v_lshlrev_b32 v12, 16, v102
  v_and_b32 v13, 0xffff0000, v102
  v_lshlrev_b32 v14, 16, v103
  v_and_b32 v15, 0xffff0000, v103
  v_mfma_f32_32x32x16_bf16 v[68:83], v[156:159], a[32:35], v[68:83]
  v_add_f32 v8, v8, v32
  v_add_f32 v9, v9, v32
  v_add_f32 v10, v10, v32
  v_add_f32 v11, v11, v32
  s_waitcnt vmcnt(9)
  v_cmp_eq_u32 vcc, -1, v160
  v_mfma_f32_32x32x16_bf16 v[84:99], v[156:159], a[36:39], v[84:99]
  s_cbranch_vccnz L_tag_3158511_r
L_tag_3158511:
  buffer_load_dwordx4 v[156:159], v231, s[28:31], s66 offen offset:3072 sc1
  v_add_f32 v12, v12, v32
  v_add_f32 v13, v13, v32
  v_add_f32 v14, v14, v32
  v_add_f32 v15, v15, v32
  v_mfma_f32_32x32x16_bf16 v[68:83], v[160:163], a[40:43], v[68:83]
  v_add_f32 v36, v36, v8
  v_add_f32 v37, v37, v9
  v_add_f32 v38, v38, v10
  v_add_f32 v39, v39, v11
  s_waitcnt vmcnt(9)
  v_cmp_eq_u32 vcc, -1, v164
  v_mfma_f32_32x32x16_bf16 v[84:99], v[160:163], a[44:47], v[84:99]
  s_cbranch_vccnz L_tag_3160512_r
L_tag_3160512:
  s_add_u32 s66, s58, 360448
  buffer_load_dwordx4 v[160:163], v231, s[28:31], s66 offen offset:0 sc1
  v_add_f32 v40, v40, v12
  v_add_f32 v41, v41, v13
  v_add_f32 v42, v42, v14
  v_add_f32 v43, v43, v15
  v_mfma_f32_32x32x16_bf16 v[68:83], v[164:167], a[48:51], v[68:83]
  s_waitcnt lgkmcnt(0)
  s_barrier
  ds_read_b128 v[132:135], v230 offset:0
  ds_read_b128 v[136:139], v230 offset:1024
  ds_read_b128 v[140:143], v230 offset:2048
  ds_read_b128 v[144:147], v230 offset:3072
  ds_read_b128 v[148:151], v230 offset:4096
  ds_read_b128 v[152:155], v230 offset:5120
  s_waitcnt vmcnt(9)
  v_cmp_eq_u32 vcc, -1, v168
  v_mfma_f32_32x32x16_bf16 v[84:99], v[164:167], a[52:55], v[84:99]
  s_cbranch_vccnz L_tag_3162513_r
L_tag_3162513:
  buffer_load_dwordx4 v[164:167], v231, s[28:31], s66 offen offset:1024 sc1
  v_mfma_f32_32x32x16_bf16 v[68:83], v[168:171], a[56:59], v[68:83]
  s_waitcnt lgkmcnt(5)
  v_add_f32 v36, v36, v132
  v_add_f32 v37, v37, v133
  v_add_f32 v38, v38, v134
  v_add_f32 v39, v39, v135
  s_waitcnt vmcnt(9)
  v_cmp_eq_u32 vcc, -1, v172
  v_mfma_f32_32x32x16_bf16 v[84:99], v[168:171], a[60:63], v[84:99]
  s_cbranch_vccnz L_tag_3164514_r
L_tag_3164514:
  buffer_load_dwordx4 v[168:171], v231, s[28:31], s66 offen offset:2048 sc1
  s_waitcnt lgkmcnt(4)
  v_add_f32 v40, v40, v136
  v_add_f32 v41, v41, v137
  v_add_f32 v42, v42, v138
  v_add_f32 v43, v43, v139
  v_mfma_f32_32x32x16_bf16 v[68:83], v[172:175], a[64:67], v[68:83]
  s_waitcnt lgkmcnt(3)
  v_add_f32 v36, v36, v140
  v_add_f32 v37, v37, v141
  v_add_f32 v38, v38, v142
  v_add_f32 v39, v39, v143
  s_waitcnt vmcnt(9)
  v_cmp_eq_u32 vcc, -1, v176
  v_mfma_f32_32x32x16_bf16 v[84:99], v[172:175], a[68:71], v[84:99]
  s_cbranch_vccnz L_tag_3166515_r
L_tag_3166515:
  buffer_load_dwordx4 v[172:175], v231, s[28:31], s66 offen offset:3072 sc1
  s_waitcnt lgkmcnt(2)
  v_add_f32 v40, v40, v144
  v_add_f32 v41, v41, v145
  v_add_f32 v42, v42, v146
  v_add_f32 v43, v43, v147
  v_mfma_f32_32x32x16_bf16 v[68:83], v[176:179], a[72:75], v[68:83]
  s_waitcnt lgkmcnt(1)
  v_add_f32 v36, v36, v148
  v_add_f32 v37, v37, v149
  v_add_f32 v38, v38, v150
  v_add_f32 v39, v39, v151
  s_waitcnt vmcnt(9)
  v_cmp_eq_u32 vcc, -1, v180
  v_mfma_f32_32x32x16_bf16 v[84:99], v[176:179], a[76:79], v[84:99]
  s_cbranch_vccnz L_tag_3168516_r
L_tag_3168516:
  s_add_u32 s66, s58, 364544
  buffer_load_dwordx4 v[176:179], v231, s[28:31], s66 offen offset:0 sc1
  s_waitcnt lgkmcnt(0)
  v_add_f32 v40, v40, v152
  v_add_f32 v41, v41, v153
  v_add_f32 v42, v42, v154
  v_add_f32 v43, v43, v155
  v_mfma_f32_32x32x16_bf16 v[68:83], v[180:183], a[80:83], v[68:83]
  v_cvt_pk_bf16_f32 v24, v36, v37
  v_cvt_pk_bf16_f32 v25, v38, v39
  v_cvt_pk_bf16_f32 v26, v40, v41
  v_cvt_pk_bf16_f32 v27, v42, v43
  s_waitcnt vmcnt(9)
  v_cmp_eq_u32 vcc, -1, v184
  v_mfma_f32_32x32x16_bf16 v[84:99], v[180:183], a[84:87], v[84:99]
  s_cbranch_vccnz L_tag_3170517_r
L_tag_3170517:
  buffer_load_dwordx4 v[180:183], v231, s[28:31], s66 offen offset:1024 sc1
  v_permlane32_swap_b32 v24, v26
  v_permlane32_swap_b32 v25, v27
  buffer_store_dwordx4 v[24:27], v31, s[32:35], s64 offen offset:128
  v_mfma_f32_32x32x16_bf16 v[68:83], v[184:187], a[88:91], v[68:83]
  s_waitcnt vmcnt(10)
  v_cmp_eq_u32 vcc, -1, v108
  v_mfma_f32_32x32x16_bf16 v[84:99], v[184:187], a[92:95], v[84:99]
  s_cbranch_vccnz L_tag_3172518_r
L_tag_3172518:
  buffer_load_dwordx4 v[184:187], v231, s[28:31], s66 offen offset:2048 sc1
  v_mfma_f32_32x32x16_bf16 v[68:83], v[108:111], a[96:99], v[68:83]
  s_waitcnt vmcnt(10)
  v_cmp_eq_u32 vcc, -1, v112
  v_mfma_f32_32x32x16_bf16 v[84:99], v[108:111], a[100:103], v[84:99]
  s_cbranch_vccnz L_tag_3174519_r
L_tag_3174519:
  buffer_load_dwordx4 v[108:111], v231, s[28:31], s66 offen offset:3072 sc1
  v_mfma_f32_32x32x16_bf16 v[68:83], v[112:115], a[104:107], v[68:83]
  s_waitcnt vmcnt(10)
  v_cmp_eq_u32 vcc, -1, v116
  v_mfma_f32_32x32x16_bf16 v[84:99], v[112:115], a[108:111], v[84:99]
  s_cbranch_vccnz L_tag_3176520_r
L_tag_3176520:
  s_add_u32 s66, s58, 368640
  buffer_load_dwordx4 v[112:115], v231, s[28:31], s66 offen offset:0 sc1
  v_mfma_f32_32x32x16_bf16 v[68:83], v[116:119], a[112:115], v[68:83]
  s_waitcnt vmcnt(10)
  v_cmp_eq_u32 vcc, -1, v156
  v_mfma_f32_32x32x16_bf16 v[84:99], v[116:119], a[116:119], v[84:99]
  s_cbranch_vccnz L_tag_3178521_r
L_tag_3178521:
  buffer_load_dwordx4 v[116:119], v231, s[28:31], s66 offen offset:1024 sc1
  s_add_u32 s52, s63, 14683136
  buffer_load_dwordx4 v[104:107], v227, s[28:31], s52 offen sc1
  v_mfma_f32_32x32x16_bf16 v[68:83], v[156:159], a[120:123], v[68:83]
  s_waitcnt vmcnt(11)
  v_cmp_eq_u32 vcc, -1, v160
  v_mfma_f32_32x32x16_bf16 v[84:99], v[156:159], a[124:127], v[84:99]
  s_cbranch_vccnz L_tag_3180522_r
L_tag_3180522:
  buffer_load_dwordx4 v[156:159], v231, s[28:31], s66 offen offset:2048 sc1
  v_mfma_f32_32x32x16_bf16 v[68:83], v[160:163], a[128:131], v[68:83]
  s_waitcnt vmcnt(11)
  v_cmp_eq_u32 vcc, -1, v164
  v_mfma_f32_32x32x16_bf16 v[84:99], v[160:163], a[132:135], v[84:99]
  s_cbranch_vccnz L_tag_3182523_r
L_tag_3182523:
  buffer_load_dwordx4 v[160:163], v231, s[28:31], s66 offen offset:3072 sc1
  v_mfma_f32_32x32x16_bf16 v[68:83], v[164:167], a[136:139], v[68:83]
  s_waitcnt vmcnt(11)
  v_cmp_eq_u32 vcc, -1, v168
  v_mfma_f32_32x32x16_bf16 v[84:99], v[164:167], a[140:143], v[84:99]
  s_cbranch_vccnz L_tag_3184524_r
L_tag_3184524:
  v_mfma_f32_32x32x16_bf16 v[68:83], v[168:171], a[144:147], v[68:83]
  s_waitcnt vmcnt(10)
  v_cmp_eq_u32 vcc, -1, v172
  v_mfma_f32_32x32x16_bf16 v[84:99], v[168:171], a[148:151], v[84:99]
  s_cbranch_vccnz L_tag_3186525_r
L_tag_3186525:
  v_mfma_f32_32x32x16_bf16 v[68:83], v[172:175], a[152:155], v[68:83]
  s_waitcnt vmcnt(9)
  v_cmp_eq_u32 vcc, -1, v176
  v_mfma_f32_32x32x16_bf16 v[84:99], v[172:175], a[156:159], v[84:99]
  s_cbranch_vccnz L_tag_3188526_r
L_tag_3188526:
  v_mfma_f32_32x32x16_bf16 v[68:83], v[176:179], a[160:163], v[68:83]
  s_waitcnt vmcnt(8)
  v_cmp_eq_u32 vcc, -1, v180
  v_mfma_f32_32x32x16_bf16 v[84:99], v[176:179], a[164:167], v[84:99]
  s_cbranch_vccnz L_tag_3190527_r
L_tag_3190527:
  v_mfma_f32_32x32x16_bf16 v[68:83], v[180:183], a[168:171], v[68:83]
  s_waitcnt vmcnt(6)
  v_cmp_eq_u32 vcc, -1, v184
  v_mfma_f32_32x32x16_bf16 v[84:99], v[180:183], a[172:175], v[84:99]
  s_cbranch_vccnz L_tag_3192528_r
L_tag_3192528:
  v_mfma_f32_32x32x16_bf16 v[68:83], v[184:187], a[176:179], v[68:83]
  s_waitcnt vmcnt(5)
  v_cmp_eq_u32 vcc, -1, v108
  v_mfma_f32_32x32x16_bf16 v[84:99], v[184:187], a[180:183], v[84:99]
  s_cbranch_vccnz L_tag_3194529_r
L_tag_3194529:
  v_mfma_f32_32x32x16_bf16 v[68:83], v[108:111], a[184:187], v[68:83]
  s_waitcnt vmcnt(4)
  v_cmp_eq_u32 vcc, -1, v112
  v_mfma_f32_32x32x16_bf16 v[84:99], v[108:111], a[188:191], v[84:99]
  s_cbranch_vccnz L_tag_3196530_r
L_tag_3196530:
  v_mfma_f32_32x32x16_bf16 v[68:83], v[112:115], a[192:195], v[68:83]
  s_waitcnt vmcnt(3)
  v_cmp_eq_u32 vcc, -1, v116
  v_mfma_f32_32x32x16_bf16 v[84:99], v[112:115], a[196:199], v[84:99]
  s_cbranch_vccnz L_tag_3198531_r
L_tag_3198531:
  v_mfma_f32_32x32x16_bf16 v[68:83], v[116:119], a[200:203], v[68:83]
  s_waitcnt vmcnt(1)
  v_cmp_eq_u32 vcc, -1, v156
  v_mfma_f32_32x32x16_bf16 v[84:99], v[116:119], a[204:207], v[84:99]
  s_cbranch_vccnz L_tag_3200532_r
L_tag_3200532:
  v_mfma_f32_32x32x16_bf16 v[68:83], v[156:159], a[208:211], v[68:83]
  s_waitcnt vmcnt(0)
  v_cmp_eq_u32 vcc, -1, v160
  v_mfma_f32_32x32x16_bf16 v[84:99], v[156:159], a[212:215], v[84:99]
  s_cbranch_vccnz L_tag_3202533_r
L_tag_3202533:
  v_mfma_f32_32x32x16_bf16 v[68:83], v[160:163], a[216:219], v[68:83]
  v_mfma_f32_32x32x16_bf16 v[84:99], v[160:163], a[220:223], v[84:99]
  s_nop 10
  ds_write_b128 v253, v[76:79] offset:0
  ds_write_b128 v253, v[80:83] offset:1024
  ds_write_b128 v254, v[84:87] offset:0
  ds_write_b128 v254, v[88:91] offset:1024
  ds_write_b128 v255, v[92:95] offset:0
  ds_write_b128 v255, v[96:99] offset:1024
  v_lshlrev_b32 v8, 16, v104
  v_and_b32 v9, 0xffff0000, v104
  v_lshlrev_b32 v10, 16, v105
  v_and_b32 v11, 0xffff0000, v105
  v_lshlrev_b32 v12, 16, v106
  v_and_b32 v13, 0xffff0000, v106
  v_lshlrev_b32 v14, 16, v107
  v_and_b32 v15, 0xffff0000, v107
  v_pk_add_f32 v[8:9], v[8:9], v[32:33] op_sel_hi:[1,0]
  v_pk_add_f32 v[10:11], v[10:11], v[32:33] op_sel_hi:[1,0]
  v_pk_add_f32 v[12:13], v[12:13], v[32:33] op_sel_hi:[1,0]
  v_pk_add_f32 v[14:15], v[14:15], v[32:33] op_sel_hi:[1,0]
  v_pk_add_f32 v[68:69], v[68:69], v[8:9]
  v_pk_add_f32 v[70:71], v[70:71], v[10:11]
  v_pk_add_f32 v[72:73], v[72:73], v[12:13]
  v_pk_add_f32 v[74:75], v[74:75], v[14:15]
  s_waitcnt lgkmcnt(0)
  s_barrier
  ds_read_b128 v[132:135], v230 offset:0
  ds_read_b128 v[136:139], v230 offset:1024
  ds_read_b128 v[140:143], v230 offset:2048
  ds_read_b128 v[144:147], v230 offset:3072
  ds_read_b128 v[148:151], v230 offset:4096
  ds_read_b128 v[152:155], v230 offset:5120
  s_waitcnt lgkmcnt(5)
  v_pk_add_f32 v[68:69], v[68:69], v[132:133]
  v_pk_add_f32 v[70:71], v[70:71], v[134:135]
  s_waitcnt lgkmcnt(4)
  v_pk_add_f32 v[72:73], v[72:73], v[136:137]
  v_pk_add_f32 v[74:75], v[74:75], v[138:139]
  s_waitcnt lgkmcnt(3)
  v_pk_add_f32 v[68:69], v[68:69], v[140:141]
  v_pk_add_f32 v[70:71], v[70:71], v[142:143]
  s_waitcnt lgkmcnt(2)
  v_pk_add_f32 v[72:73], v[72:73], v[144:145]
  v_pk_add_f32 v[74:75], v[74:75], v[146:147]
  s_waitcnt lgkmcnt(1)
  v_pk_add_f32 v[68:69], v[68:69], v[148:149]
  v_pk_add_f32 v[70:71], v[70:71], v[150:151]
  s_waitcnt lgkmcnt(0)
  v_pk_add_f32 v[72:73], v[72:73], v[152:153]
  v_pk_add_f32 v[74:75], v[74:75], v[154:155]
  v_cvt_pk_bf16_f32 v24, v68, v69
  v_cvt_pk_bf16_f32 v25, v70, v71
  v_cvt_pk_bf16_f32 v26, v72, v73
  v_cvt_pk_bf16_f32 v27, v74, v75
  s_nop 0
  v_permlane32_swap_b32 v24, v26
  v_permlane32_swap_b32 v25, v27
  buffer_store_dwordx4 v[24:27], v31, s[32:35], s64 offen offset:192
L_join_1834289:
  s_nop 0
  s_endpgm
L_poll_68002_r:
  v_mov_b32 v252, 0
L_poll_68002_l:
  s_sleep 1
  buffer_load_dword v233, v252, s[44:47], 0 offen sc1
  s_add_u32 s57, s57, 1
  s_cmp_gt_u32 s57, 0x40000
  s_cbranch_scc1 L_poll_68002
  s_waitcnt vmcnt(0)
  v_cmp_gt_u32 vcc, 8, v233
  s_cbranch_vccnz L_poll_68002_l
  s_branch L_poll_68002
L_poll_70004_r:
L_poll_70004_l:
  s_sleep 1
  s_mov_b64 exec, 1
  v_mov_b32 v233, 0
  buffer_atomic_add v233, v226, s[28:31], 0 offen offset:0 sc0 sc1
  s_mov_b64 exec, -1
  s_add_u32 s57, s57, 1
  s_cmp_gt_u32 s57, 0x40000
  s_cbranch_scc1 L_poll_70004
  s_waitcnt vmcnt(0)
  v_readfirstlane_b32 s3, v233
  s_cmp_lt_u32 s3, 8
  s_cbranch_scc1 L_poll_70004_l
  s_branch L_poll_70004
L_tag_72005_r:
  s_mov_b32 s5, m0
L_tag_72005_l:
  s_add_u32 m0, s53, 0
  s_add_u32 s55, s58, 2097152
  buffer_load_dwordx4 v213, s[28:31], s55 offen sc1 lds
  buffer_load_dwordx4 v213, s[28:31], s55 offen offset:1024 sc1 lds
  buffer_load_dwordx4 v213, s[28:31], s55 offen offset:2048 sc1 lds
  buffer_load_dwordx4 v213, s[28:31], s55 offen offset:3072 sc1 lds
  s_waitcnt vmcnt(0)
  ds_read_b32 v164, v3 offset:0
  ds_read_b32 v165, v3 offset:1024
  ds_read_b32 v166, v3 offset:2048
  ds_read_b32 v167, v3 offset:3072
  s_waitcnt lgkmcnt(0)
  s_mov_b32 m0, s5
  s_add_u32 s57, s57, 1
  s_cmp_gt_u32 s57, 0x40000
  s_cbranch_scc1 L_tag_72005
  v_max3_u32 v7, v164, v165, v166
  v_max_u32 v7, v7, v167
  v_cmp_eq_u32 vcc, -1, v7
  s_cbranch_vccnz L_tag_72005_l
  s_nop 1
  s_branch L_tag_72005
L_tag_74006_r:
  s_mov_b32 s5, m0
L_tag_74006_l:
  s_add_u32 m0, s53, 8192
  s_add_u32 s55, s58, 2105344
  buffer_load_dwordx4 v213, s[28:31], s55 offen sc1 lds
  buffer_load_dwordx4 v213, s[28:31], s55 offen offset:1024 sc1 lds
  buffer_load_dwordx4 v213, s[28:31], s55 offen offset:2048 sc1 lds
  buffer_load_dwordx4 v213, s[28:31], s55 offen offset:3072 sc1 lds
  s_waitcnt vmcnt(0)
  ds_read_b32 v164, v3 offset:8192
  ds_read_b32 v165, v3 offset:9216
  ds_read_b32 v166, v3 offset:10240
  ds_read_b32 v167, v3 offset:11264
  s_waitcnt lgkmcnt(0)
  s_mov_b32 m0, s5
  s_add_u32 s57, s57, 1
  s_cmp_gt_u32 s57, 0x40000
  s_cbranch_scc1 L_tag_74006
  v_max3_u32 v7, v164, v165, v166
  v_max_u32 v7, v7, v167
  v_cmp_eq_u32 vcc, -1, v7
  s_cbranch_vccnz L_tag_74006_l
  s_nop 1
  s_branch L_tag_74006
L_tag_76007_r:
  s_mov_b32 s5, m0
L_tag_76007_l:
  s_add_u32 m0, s53, 16384
  s_add_u32 s55, s58, 2113536
  buffer_load_dwordx4 v213, s[28:31], s55 offen sc1 lds
  buffer_load_dwordx4 v213, s[28:31], s55 offen offset:1024 sc1 lds
  buffer_load_dwordx4 v213, s[28:31], s55 offen offset:2048 sc1 lds
  buffer_load_dwordx4 v213, s[28:31], s55 offen offset:3072 sc1 lds
  s_waitcnt vmcnt(0)
  ds_read_b32 v164, v3 offset:16384
  ds_read_b32 v165, v3 offset:17408
  ds_read_b32 v166, v3 offset:18432
  ds_read_b32 v167, v3 offset:19456
  s_waitcnt lgkmcnt(0)
  s_mov_b32 m0, s5
  s_add_u32 s57, s57, 1
  s_cmp_gt_u32 s57, 0x40000
  s_cbranch_scc1 L_tag_76007
  v_max3_u32 v7, v164, v165, v166
  v_max_u32 v7, v7, v167
  v_cmp_eq_u32 vcc, -1, v7
  s_cbranch_vccnz L_tag_76007_l
  s_nop 1
  s_branch L_tag_76007
L_tag_78008_r:
  s_mov_b32 s5, m0
L_tag_78008_l:
  s_add_u32 m0, s53, 24576
  s_add_u32 s55, s58, 2121728
  buffer_load_dwordx4 v213, s[28:31], s55 offen sc1 lds
  buffer_load_dwordx4 v213, s[28:31], s55 offen offset:1024 sc1 lds
  buffer_load_dwordx4 v213, s[28:31], s55 offen offset:2048 sc1 lds
  buffer_load_dwordx4 v213, s[28:31], s55 offen offset:3072 sc1 lds
  s_waitcnt vmcnt(0)
  ds_read_b32 v164, v3 offset:24576
  ds_read_b32 v165, v3 offset:25600
  ds_read_b32 v166, v3 offset:26624
  ds_read_b32 v167, v3 offset:27648
  s_waitcnt lgkmcnt(0)
  s_mov_b32 m0, s5
  s_add_u32 s57, s57, 1
  s_cmp_gt_u32 s57, 0x40000
  s_cbranch_scc1 L_tag_78008
  v_max3_u32 v7, v164, v165, v166
  v_max_u32 v7, v7, v167
  v_cmp_eq_u32 vcc, -1, v7
  s_cbranch_vccnz L_tag_78008_l
  s_nop 1
  s_branch L_tag_78008
L_tag_80010_r:
  s_mov_b32 s5, m0
L_tag_80010_l:
  buffer_load_dwordx2 v[8:9], v191, s[28:31], s51 offen offset:0 sc1
  buffer_load_dwordx2 v[10:11], v191, s[28:31], s51 offen offset:256 sc1
  buffer_load_dwordx2 v[12:13], v191, s[28:31], s51 offen offset:512 sc1
  buffer_load_dwordx2 v[14:15], v191, s[28:31], s51 offen offset:768 sc1
  buffer_load_dwordx2 v[16:17], v191, s[28:31], s51 offen offset:1024 sc1
  buffer_load_dwordx2 v[18:19], v191, s[28:31], s51 offen offset:1280 sc1
  buffer_load_dwordx2 v[20:21], v191, s[28:31], s51 offen offset:1536 sc1
  buffer_load_dwordx2 v[22:23], v191, s[28:31], s51 offen offset:1792 sc1
  s_waitcnt vmcnt(0)
  s_mov_b32 m0, s5
  s_add_u32 s57, s57, 1
  s_cmp_gt_u32 s57, 0x40000
  s_cbranch_scc1 L_tag_80010
  v_max3_u32 v7, v9, v11, v13
  v_max3_u32 v7, v7, v15, v17
  v_max3_u32 v7, v7, v19, v21
  v_max_u32 v7, v7, v23
  v_cmp_eq_u32 vcc, -1, v7
  s_cbranch_vccnz L_tag_80010_l
  s_nop 1
  s_branch L_tag_80010
L_poll_84014_r:
L_poll_84014_l:
  s_sleep 2
  s_mov_b64 exec, 1
  v_mov_b32 v233, 0
  buffer_atomic_add v233, v210, s[28:31], 0 offen offset:4 sc0 sc1
  s_mov_b64 exec, -1
  s_add_u32 s57, s57, 1
  s_cmp_gt_u32 s57, 0x40000
  s_cbranch_scc1 L_poll_84014
  s_waitcnt vmcnt(0)
  v_readfirstlane_b32 s3, v233
  s_cmp_lt_u32 s3, 16
  s_cbranch_scc1 L_poll_84014_l
  s_branch L_poll_84014
L_poll_866148_r:
L_poll_866148_l:
  s_sleep 2
  s_mov_b64 exec, 1
  v_mov_b32 v233, 0
  buffer_atomic_add v233, v226, s[28:31], 0 offen offset:24 sc0 sc1
  s_mov_b64 exec, -1
  s_add_u32 s57, s57, 1
  s_cmp_gt_u32 s57, 0x40000
  s_cbranch_scc1 L_poll_866148
  s_waitcnt vmcnt(0)
  v_readfirstlane_b32 s3, v233
  s_cmp_lt_u32 s3, s97
  s_cbranch_scc1 L_poll_866148_l
  s_branch L_poll_866148
L_poll_870149_r:
L_poll_870149_l:
  s_sleep 2
  s_mov_b64 exec, 1
  v_mov_b32 v233, 0
  buffer_atomic_add v233, v226, s[28:31], 0 offen offset:28 sc0 sc1
  s_mov_b64 exec, -1
  s_add_u32 s57, s57, 1
  s_cmp_gt_u32 s57, 0x40000
  s_cbranch_scc1 L_poll_870149
  s_waitcnt vmcnt(0)
  v_readfirstlane_b32 s3, v233
  s_cmp_lt_u32 s3, s97
  s_cbranch_scc1 L_poll_870149_l
  s_branch L_poll_870149
L_poll_874150_r:
L_poll_874150_l:
  s_sleep 2
  s_mov_b64 exec, 1
  v_mov_b32 v233, 0
  buffer_atomic_add v233, v210, s[28:31], 0 offen offset:8 sc0 sc1
  s_mov_b64 exec, -1
  s_add_u32 s57, s57, 1
  s_cmp_gt_u32 s57, 0x40000
  s_cbranch_scc1 L_poll_874150
  s_waitcnt vmcnt(0)
  v_readfirstlane_b32 s3, v233
  s_cmp_lt_u32 s3, 7
  s_cbranch_scc1 L_poll_874150_l
  s_branch L_poll_874150
L_poll_926175_r:
L_poll_926175_l:
  s_sleep 1
  s_mov_b64 exec, 1
  v_mov_b32 v233, 0
  buffer_atomic_add v233, v210, s[28:31], 0 offen offset:12 sc0 sc1
  s_mov_b64 exec, -1
  s_add_u32 s57, s57, 1
  s_cmp_gt_u32 s57, 0x40000
  s_cbranch_scc1 L_poll_926175
  s_waitcnt vmcnt(0)
  v_readfirstlane_b32 s3, v233
  s_cmp_lt_u32 s3, 7
  s_cbranch_scc1 L_poll_926175_l
  s_branch L_poll_926175
L_poll_1148202_r:
L_poll_1148202_l:
  s_sleep 1
  s_mov_b64 exec, 1
  v_mov_b32 v233, 0
  buffer_atomic_add v233, v210, s[28:31], 0 offen offset:16 sc0 sc1
  s_mov_b64 exec, -1
  s_add_u32 s57, s57, 1
  s_cmp_gt_u32 s57, 0x40000
  s_cbranch_scc1 L_poll_1148202
  s_waitcnt vmcnt(0)
  v_readfirstlane_b32 s3, v233
  s_cmp_lt_u32 s3, 7
  s_cbranch_scc1 L_poll_1148202_l
  s_branch L_poll_1148202
L_poll_1374230_r:
L_poll_1374230_l:
  s_sleep 1
  s_mov_b64 exec, 1
  v_mov_b32 v233, 0
  buffer_atomic_add v233, v210, s[28:31], 0 offen offset:20 sc0 sc1
  s_mov_b64 exec, -1
  s_add_u32 s57, s57, 1
  s_cmp_gt_u32 s57, 0x40000
  s_cbranch_scc1 L_poll_1374230
  s_waitcnt vmcnt(0)
  v_readfirstlane_b32 s3, v233
  s_cmp_lt_u32 s3, 7
  s_cbranch_scc1 L_poll_1374230_l
  s_branch L_poll_1374230
L_poll_1606261_r:
L_poll_1606261_l:
  s_sleep 1
  s_mov_b64 exec, 1
  v_mov_b32 v233, 0
  buffer_atomic_add v233, v226, s[28:31], 0 offen offset:24 sc0 sc1
  s_mov_b64 exec, -1
  s_add_u32 s57, s57, 1
  s_cmp_gt_u32 s57, 0x40000
  s_cbranch_scc1 L_poll_1606261
  s_waitcnt vmcnt(0)
  v_readfirstlane_b32 s3, v233
  s_cmp_lt_u32 s3, s97
  s_cbranch_scc1 L_poll_1606261_l
  s_branch L_poll_1606261
L_poll_1620267_r:
L_poll_1620267_l:
  s_sleep 1
  s_mov_b64 exec, 1
  v_mov_b32 v233, 0
  buffer_atomic_add v233, v226, s[28:31], 0 offen offset:28 sc0 sc1
  s_mov_b64 exec, -1
  s_add_u32 s57, s57, 1
  s_cmp_gt_u32 s57, 0x40000
  s_cbranch_scc1 L_poll_1620267
  s_waitcnt vmcnt(0)
  v_readfirstlane_b32 s3, v233
  s_cmp_lt_u32 s3, s97
  s_cbranch_scc1 L_poll_1620267_l
  s_branch L_poll_1620267
L_tag_1746272_r:
  s_mov_b32 s5, m0
L_tag_1746272_l:
  s_add_u32 m0, s60, 24576
  s_add_u32 s94, s6, 10485760
  buffer_load_dwordx4 v213, s[28:31], s94 offen sc1 lds
  s_add_u32 m0, s60, 28672
  s_add_u32 s94, s7, 10485760
  buffer_load_dwordx4 v213, s[28:31], s94 offen sc1 lds
  s_add_u32 m0, s60, 32768
  s_add_u32 s94, s7, 10502144
  buffer_load_dwordx4 v213, s[28:31], s94 offen sc1 lds
  s_add_u32 m0, s60, 36864
  s_add_u32 s94, s7, 10518528
  buffer_load_dwordx4 v213, s[28:31], s94 offen sc1 lds
  s_add_u32 m0, s60, 40960
  s_add_u32 s94, s7, 10534912
  buffer_load_dwordx4 v213, s[28:31], s94 offen sc1 lds
  s_waitcnt vmcnt(0)
  ds_read_b32 v160, v215 offset:24576
  ds_read_b32 v161, v215 offset:28672
  ds_read_b32 v162, v215 offset:32768
  ds_read_b32 v163, v215 offset:36864
  ds_read_b32 v156, v215 offset:40960
  s_waitcnt lgkmcnt(0)
  s_mov_b32 m0, s5
  s_add_u32 s57, s57, 1
  s_cmp_gt_u32 s57, 0x40000
  s_cbranch_scc1 L_tag_1746272
  v_max3_u32 v7, v160, v161, v162
  v_max3_u32 v7, v7, v163, v156
  v_cmp_eq_u32 vcc, -1, v7
  s_cbranch_vccnz L_tag_1746272_l
  s_nop 1
  s_branch L_tag_1746272
L_tag_1764273_r:
  s_mov_b32 s5, m0
L_tag_1764273_l:
  s_add_u32 m0, s60, 45056
  s_add_u32 s94, s6, 10486784
  buffer_load_dwordx4 v213, s[28:31], s94 offen sc1 lds
  s_add_u32 m0, s60, 49152
  s_add_u32 s94, s7, 10486784
  buffer_load_dwordx4 v213, s[28:31], s94 offen sc1 lds
  s_add_u32 m0, s60, 53248
  s_add_u32 s94, s7, 10503168
  buffer_load_dwordx4 v213, s[28:31], s94 offen sc1 lds
  s_add_u32 m0, s60, 57344
  s_add_u32 s94, s7, 10519552
  buffer_load_dwordx4 v213, s[28:31], s94 offen sc1 lds
  s_add_u32 m0, s60, 61440
  s_add_u32 s94, s7, 10535936
  buffer_load_dwordx4 v213, s[28:31], s94 offen sc1 lds
  s_waitcnt vmcnt(0)
  ds_read_b32 v160, v215 offset:45056
  ds_read_b32 v161, v215 offset:49152
  ds_read_b32 v162, v215 offset:53248
  ds_read_b32 v163, v215 offset:57344
  ds_read_b32 v156, v215 offset:61440
  s_waitcnt lgkmcnt(0)
  s_mov_b32 m0, s5
  s_add_u32 s57, s57, 1
  s_cmp_gt_u32 s57, 0x40000
  s_cbranch_scc1 L_tag_1764273
  v_max3_u32 v7, v160, v161, v162
  v_max3_u32 v7, v7, v163, v156
  v_cmp_eq_u32 vcc, -1, v7
  s_cbranch_vccnz L_tag_1764273_l
  s_nop 1
  s_branch L_tag_1764273
L_poll_1764274_r:
L_poll_1764274_l:
  s_sleep 1
  s_mov_b64 exec, 1
  v_mov_b32 v233, 0
  buffer_atomic_add v233, v226, s[28:31], 0 offen offset:32 sc0 sc1
  s_mov_b64 exec, -1
  s_add_u32 s57, s57, 1
  s_cmp_gt_u32 s57, 0x40000
  s_cbranch_scc1 L_poll_1764274
  s_waitcnt vmcnt(0)
  v_readfirstlane_b32 s3, v233
  s_cmp_lt_u32 s3, s97
  s_cbranch_scc1 L_poll_1764274_l
  s_branch L_poll_1764274
L_tag_1782275_r:
  s_mov_b32 s5, m0
L_tag_1782275_l:
  s_add_u32 m0, s60, 0
  s_add_u32 s94, s6, 10487808
  buffer_load_dwordx4 v213, s[28:31], s94 offen sc1 lds
  s_add_u32 m0, s60, 4096
  s_add_u32 s94, s7, 10487808
  buffer_load_dwordx4 v213, s[28:31], s94 offen sc1 lds
  s_add_u32 m0, s60, 8192
  s_add_u32 s94, s7, 10504192
  buffer_load_dwordx4 v213, s[28:31], s94 offen sc1 lds
  s_add_u32 m0, s60, 12288
  s_add_u32 s94, s7, 10520576
  buffer_load_dwordx4 v213, s[28:31], s94 offen sc1 lds
  s_add_u32 m0, s60, 16384
  s_add_u32 s94, s7, 10536960
  buffer_load_dwordx4 v213, s[28:31], s94 offen sc1 lds
  s_waitcnt vmcnt(0)
  ds_read_b32 v160, v215 offset:0
  ds_read_b32 v161, v215 offset:4096
  ds_read_b32 v162, v215 offset:8192
  ds_read_b32 v163, v215 offset:12288
  ds_read_b32 v156, v215 offset:16384
  s_waitcnt lgkmcnt(0)
  s_mov_b32 m0, s5
  s_add_u32 s57, s57, 1
  s_cmp_gt_u32 s57, 0x40000
  s_cbranch_scc1 L_tag_1782275
  v_max3_u32 v7, v160, v161, v162
  v_max3_u32 v7, v7, v163, v156
  v_cmp_eq_u32 vcc, -1, v7
  s_cbranch_vccnz L_tag_1782275_l
  s_nop 1
  s_branch L_tag_1782275
L_poll_1786276_r:
L_poll_1786276_l:
  s_sleep 1
  s_mov_b64 exec, 1
  v_mov_b32 v233, 0
  buffer_atomic_add v233, v226, s[28:31], 0 offen offset:36 sc0 sc1
  s_mov_b64 exec, -1
  s_add_u32 s57, s57, 1
  s_cmp_gt_u32 s57, 0x40000
  s_cbranch_scc1 L_poll_1786276
  s_waitcnt vmcnt(0)
  v_readfirstlane_b32 s3, v233
  s_cmp_lt_u32 s3, s97
  s_cbranch_scc1 L_poll_1786276_l
  s_branch L_poll_1786276
L_tag_1800277_r:
  s_mov_b32 s5, m0
L_tag_1800277_l:
  s_add_u32 m0, s60, 24576
  s_add_u32 s94, s6, 10488832
  buffer_load_dwordx4 v213, s[28:31], s94 offen sc1 lds
  s_add_u32 m0, s60, 28672
  s_add_u32 s94, s7, 10488832
  buffer_load_dwordx4 v213, s[28:31], s94 offen sc1 lds
  s_add_u32 m0, s60, 32768
  s_add_u32 s94, s7, 10505216
  buffer_load_dwordx4 v213, s[28:31], s94 offen sc1 lds
  s_add_u32 m0, s60, 36864
  s_add_u32 s94, s7, 10521600
  buffer_load_dwordx4 v213, s[28:31], s94 offen sc1 lds
  s_add_u32 m0, s60, 40960
  s_add_u32 s94, s7, 10537984
  buffer_load_dwordx4 v213, s[28:31], s94 offen sc1 lds
  s_waitcnt vmcnt(0)
  ds_read_b32 v160, v215 offset:24576
  ds_read_b32 v161, v215 offset:28672
  ds_read_b32 v162, v215 offset:32768
  ds_read_b32 v163, v215 offset:36864
  ds_read_b32 v156, v215 offset:40960
  s_waitcnt lgkmcnt(0)
  s_mov_b32 m0, s5
  s_add_u32 s57, s57, 1
  s_cmp_gt_u32 s57, 0x40000
  s_cbranch_scc1 L_tag_1800277
  v_max3_u32 v7, v160, v161, v162
  v_max3_u32 v7, v7, v163, v156
  v_cmp_eq_u32 vcc, -1, v7
  s_cbranch_vccnz L_tag_1800277_l
  s_nop 1
  s_branch L_tag_1800277
L_tag_1804278_r:
  s_mov_b32 s5, m0
L_tag_1804278_l:
  buffer_load_dwordx2 v[144:145], v2, s[28:31], s50 offen offset:0 sc1
  buffer_load_dwordx2 v[146:147], v2, s[28:31], s50 offen offset:256 sc1
  buffer_load_dwordx2 v[148:149], v3, s[28:31], s51 offen offset:128 sc1
  buffer_load_dwordx2 v[150:151], v3, s[28:31], s51 offen offset:384 sc1
  s_waitcnt vmcnt(0)
  s_mov_b32 m0, s5
  s_add_u32 s57, s57, 1
  s_cmp_gt_u32 s57, 0x40000
  s_cbranch_scc1 L_tag_1804278
  v_max3_u32 v7, v145, v147, v149
  v_max_u32 v7, v7, v151
  v_cmp_eq_u32 vcc, -1, v7
  s_cbranch_vccnz L_tag_1804278_l
  s_nop 1
  s_branch L_tag_1804278
L_poll_1822280_r:
L_poll_1822280_l:
  s_sleep 1
  s_mov_b64 exec, 1
  v_mov_b32 v233, 0
  buffer_atomic_add v233, v226, s[28:31], 0 offen offset:64 sc0 sc1
  s_mov_b64 exec, -1
  s_add_u32 s57, s57, 1
  s_cmp_gt_u32 s57, 0x40000
  s_cbranch_scc1 L_poll_1822280
  s_waitcnt vmcnt(0)
  v_readfirstlane_b32 s3, v233
  s_cmp_lt_u32 s3, 8
  s_cbranch_scc1 L_poll_1822280_l
  s_branch L_poll_1822280
L_tag_1824281_r:
  s_mov_b32 s5, m0
L_tag_1824281_l:
  s_add_u32 m0, s53, 0
  s_add_u32 s55, s58, 12582912
  buffer_load_dwordx4 v213, s[28:31], s55 offen sc1 lds
  buffer_load_dwordx4 v213, s[28:31], s55 offen offset:1024 sc1 lds
  buffer_load_dwordx4 v213, s[28:31], s55 offen offset:2048 sc1 lds
  buffer_load_dwordx4 v213, s[28:31], s55 offen offset:3072 sc1 lds
  s_waitcnt vmcnt(0)
  ds_read_b32 v164, v3 offset:0
  ds_read_b32 v165, v3 offset:1024
  ds_read_b32 v166, v3 offset:2048
  ds_read_b32 v167, v3 offset:3072
  s_waitcnt lgkmcnt(0)
  s_mov_b32 m0, s5
  s_add_u32 s57, s57, 1
  s_cmp_gt_u32 s57, 0x40000
  s_cbranch_scc1 L_tag_1824281
  v_max3_u32 v7, v164, v165, v166
  v_max_u32 v7, v7, v167
  v_cmp_eq_u32 vcc, -1, v7
  s_cbranch_vccnz L_tag_1824281_l
  s_nop 1
  s_branch L_tag_1824281
L_tag_1826282_r:
  s_mov_b32 s5, m0
L_tag_1826282_l:
  s_add_u32 m0, s53, 8192
  s_add_u32 s55, s58, 12591104
  buffer_load_dwordx4 v213, s[28:31], s55 offen sc1 lds
  buffer_load_dwordx4 v213, s[28:31], s55 offen offset:1024 sc1 lds
  buffer_load_dwordx4 v213, s[28:31], s55 offen offset:2048 sc1 lds
  buffer_load_dwordx4 v213, s[28:31], s55 offen offset:3072 sc1 lds
  s_waitcnt vmcnt(0)
  ds_read_b32 v164, v3 offset:8192
  ds_read_b32 v165, v3 offset:9216
  ds_read_b32 v166, v3 offset:10240
  ds_read_b32 v167, v3 offset:11264
  s_waitcnt lgkmcnt(0)
  s_mov_b32 m0, s5
  s_add_u32 s57, s57, 1
  s_cmp_gt_u32 s57, 0x40000
  s_cbranch_scc1 L_tag_1826282
  v_max3_u32 v7, v164, v165, v166
  v_max_u32 v7, v7, v167
  v_cmp_eq_u32 vcc, -1, v7
  s_cbranch_vccnz L_tag_1826282_l
  s_nop 1
  s_branch L_tag_1826282
L_tag_1828283_r:
  s_mov_b32 s5, m0
L_tag_1828283_l:
  s_add_u32 m0, s53, 16384
  s_add_u32 s55, s58, 12599296
  buffer_load_dwordx4 v213, s[28:31], s55 offen sc1 lds
  buffer_load_dwordx4 v213, s[28:31], s55 offen offset:1024 sc1 lds
  buffer_load_dwordx4 v213, s[28:31], s55 offen offset:2048 sc1 lds
  buffer_load_dwordx4 v213, s[28:31], s55 offen offset:3072 sc1 lds
  s_waitcnt vmcnt(0)
  ds_read_b32 v164, v3 offset:16384
  ds_read_b32 v165, v3 offset:17408
  ds_read_b32 v166, v3 offset:18432
  ds_read_b32 v167, v3 offset:19456
  s_waitcnt lgkmcnt(0)
  s_mov_b32 m0, s5
  s_add_u32 s57, s57, 1
  s_cmp_gt_u32 s57, 0x40000
  s_cbranch_scc1 L_tag_1828283
  v_max3_u32 v7, v164, v165, v166
  v_max_u32 v7, v7, v167
  v_cmp_eq_u32 vcc, -1, v7
  s_cbranch_vccnz L_tag_1828283_l
  s_nop 1
  s_branch L_tag_1828283
L_tag_1830284_r:
  s_mov_b32 s5, m0
L_tag_1830284_l:
  s_add_u32 m0, s53, 24576
  s_add_u32 s55, s58, 12607488
  buffer_load_dwordx4 v213, s[28:31], s55 offen sc1 lds
  buffer_load_dwordx4 v213, s[28:31], s55 offen offset:1024 sc1 lds
  buffer_load_dwordx4 v213, s[28:31], s55 offen offset:2048 sc1 lds
  buffer_load_dwordx4 v213, s[28:31], s55 offen offset:3072 sc1 lds
  s_waitcnt vmcnt(0)
  ds_read_b32 v164, v3 offset:24576
  ds_read_b32 v165, v3 offset:25600
  ds_read_b32 v166, v3 offset:26624
  ds_read_b32 v167, v3 offset:27648
  s_waitcnt lgkmcnt(0)
  s_mov_b32 m0, s5
  s_add_u32 s57, s57, 1
  s_cmp_gt_u32 s57, 0x40000
  s_cbranch_scc1 L_tag_1830284
  v_max3_u32 v7, v164, v165, v166
  v_max_u32 v7, v7, v167
  v_cmp_eq_u32 vcc, -1, v7
  s_cbranch_vccnz L_tag_1830284_l
  s_nop 1
  s_branch L_tag_1830284
L_tag_1832286_r:
  s_mov_b32 s5, m0
L_tag_1832286_l:
  buffer_load_dwordx2 v[8:9], v191, s[28:31], s51 offen offset:0 sc1
  buffer_load_dwordx2 v[10:11], v191, s[28:31], s51 offen offset:256 sc1
  buffer_load_dwordx2 v[12:13], v191, s[28:31], s51 offen offset:512 sc1
  buffer_load_dwordx2 v[14:15], v191, s[28:31], s51 offen offset:768 sc1
  buffer_load_dwordx2 v[16:17], v191, s[28:31], s51 offen offset:1024 sc1
  buffer_load_dwordx2 v[18:19], v191, s[28:31], s51 offen offset:1280 sc1
  buffer_load_dwordx2 v[20:21], v191, s[28:31], s51 offen offset:1536 sc1
  buffer_load_dwordx2 v[22:23], v191, s[28:31], s51 offen offset:1792 sc1
  s_waitcnt vmcnt(0)
  s_mov_b32 m0, s5
  s_add_u32 s57, s57, 1
  s_cmp_gt_u32 s57, 0x40000
  s_cbranch_scc1 L_tag_1832286
  v_max3_u32 v7, v9, v11, v13
  v_max3_u32 v7, v7, v15, v17
  v_max3_u32 v7, v7, v19, v21
  v_max_u32 v7, v7, v23
  v_cmp_eq_u32 vcc, -1, v7
  s_cbranch_vccnz L_tag_1832286_l
  s_nop 1
  s_branch L_tag_1832286
L_poll_1836290_r:
L_poll_1836290_l:
  s_sleep 2
  s_mov_b64 exec, 1
  v_mov_b32 v233, 0
  buffer_atomic_add v233, v210, s[28:31], 0 offen offset:104 sc0 sc1
  s_mov_b64 exec, -1
  s_add_u32 s57, s57, 1
  s_cmp_gt_u32 s57, 0x40000
  s_cbranch_scc1 L_poll_1836290
  s_waitcnt vmcnt(0)
  v_readfirstlane_b32 s3, v233
  s_cmp_lt_u32 s3, 8
  s_cbranch_scc1 L_poll_1836290_l
  s_branch L_poll_1836290
L_poll_1884313_r:
L_poll_1884313_l:
  s_sleep 1
  s_mov_b64 exec, 1
  v_mov_b32 v233, 0
  buffer_atomic_add v233, v210, s[28:31], 0 offen offset:68 sc0 sc1
  s_mov_b64 exec, -1
  s_add_u32 s57, s57, 1
  s_cmp_gt_u32 s57, 0x40000
  s_cbranch_scc1 L_poll_1884313
  s_waitcnt vmcnt(0)
  v_readfirstlane_b32 s3, v233
  s_cmp_lt_u32 s3, 8
  s_cbranch_scc1 L_poll_1884313_l
  s_branch L_poll_1884313
L_poll_2616421_r:
L_poll_2616421_l:
  s_sleep 2
  s_mov_b64 exec, 1
  v_mov_b32 v233, 0
  buffer_atomic_add v233, v210, s[28:31], 0 offen offset:72 sc0 sc1
  s_mov_b64 exec, -1
  s_add_u32 s57, s57, 1
  s_cmp_gt_u32 s57, 0x40000
  s_cbranch_scc1 L_poll_2616421
  s_waitcnt vmcnt(0)
  v_readfirstlane_b32 s3, v233
  s_cmp_lt_u32 s3, 7
  s_cbranch_scc1 L_poll_2616421_l
  s_branch L_poll_2616421
L_end:
  s_endpgm
L_tag_86015_r:
L_tag_86015_l:
  s_add_u32 s3, s58, 0
  buffer_load_dwordx4 v[156:159], v213, s[28:31], s3 offen offset:0 sc1
  s_waitcnt vmcnt(0)
  s_add_u32 s57, s57, 1
  s_cmp_gt_u32 s57, 0x40000
  s_cbranch_scc1 L_tag_86015
  v_cmp_eq_u32 vcc, -1, v156
  s_cbranch_vccnz L_tag_86015_l
  s_nop 1
  s_branch L_tag_86015
L_tag_90016_r:
L_tag_90016_l:
  s_add_u32 s3, s58, 0
  buffer_load_dwordx4 v[160:163], v213, s[28:31], s3 offen offset:1024 sc1
  s_waitcnt vmcnt(0)
  s_add_u32 s57, s57, 1
  s_cmp_gt_u32 s57, 0x40000
  s_cbranch_scc1 L_tag_90016
  v_cmp_eq_u32 vcc, -1, v160
  s_cbranch_vccnz L_tag_90016_l
  s_nop 1
  s_branch L_tag_90016
L_tag_92017_r:
L_tag_92017_l:
  s_add_u32 s3, s58, 0
  buffer_load_dwordx4 v[164:167], v213, s[28:31], s3 offen offset:2048 sc1
  s_waitcnt vmcnt(0)
  s_add_u32 s57, s57, 1
  s_cmp_gt_u32 s57, 0x40000
  s_cbranch_scc1 L_tag_92017
  v_cmp_eq_u32 vcc, -1, v164
  s_cbranch_vccnz L_tag_92017_l
  s_nop 1
  s_branch L_tag_92017
L_tag_94018_r:
L_tag_94018_l:
  s_add_u32 s3, s58, 0
  buffer_load_dwordx4 v[168:171], v213, s[28:31], s3 offen offset:3072 sc1
  s_waitcnt vmcnt(0)
  s_add_u32 s57, s57, 1
  s_cmp_gt_u32 s57, 0x40000
  s_cbranch_scc1 L_tag_94018
  v_cmp_eq_u32 vcc, -1, v168
  s_cbranch_vccnz L_tag_94018_l
  s_nop 1
  s_branch L_tag_94018
L_tag_96019_r:
L_tag_96019_l:
  s_add_u32 s3, s58, 4096
  buffer_load_dwordx4 v[172:175], v213, s[28:31], s3 offen offset:0 sc1
  s_waitcnt vmcnt(0)
  s_add_u32 s57, s57, 1
  s_cmp_gt_u32 s57, 0x40000
  s_cbranch_scc1 L_tag_96019
  v_cmp_eq_u32 vcc, -1, v172
  s_cbranch_vccnz L_tag_96019_l
  s_nop 1
  s_branch L_tag_96019
L_tag_98020_r:
L_tag_98020_l:
  s_add_u32 s3, s58, 4096
  buffer_load_dwordx4 v[176:179], v213, s[28:31], s3 offen offset:1024 sc1
  s_waitcnt vmcnt(0)
  s_add_u32 s57, s57, 1
  s_cmp_gt_u32 s57, 0x40000
  s_cbranch_scc1 L_tag_98020
  v_cmp_eq_u32 vcc, -1, v176
  s_cbranch_vccnz L_tag_98020_l
  s_nop 1
  s_branch L_tag_98020
L_tag_100021_r:
L_tag_100021_l:
  s_add_u32 s3, s58, 4096
  buffer_load_dwordx4 v[180:183], v213, s[28:31], s3 offen offset:2048 sc1
  s_waitcnt vmcnt(0)
  s_add_u32 s57, s57, 1
  s_cmp_gt_u32 s57, 0x40000
  s_cbranch_scc1 L_tag_100021
  v_cmp_eq_u32 vcc, -1, v180
  s_cbranch_vccnz L_tag_100021_l
  s_nop 1
  s_branch L_tag_100021
L_tag_102022_r:
L_tag_102022_l:
  s_add_u32 s3, s58, 4096
  buffer_load_dwordx4 v[184:187], v213, s[28:31], s3 offen offset:3072 sc1
  s_waitcnt vmcnt(0)
  s_add_u32 s57, s57, 1
  s_cmp_gt_u32 s57, 0x40000
  s_cbranch_scc1 L_tag_102022
  v_cmp_eq_u32 vcc, -1, v184
  s_cbranch_vccnz L_tag_102022_l
  s_nop 1
  s_branch L_tag_102022
L_tag_104023_r:
L_tag_104023_l:
  s_add_u32 s3, s58, 8192
  buffer_load_dwordx4 v[108:111], v213, s[28:31], s3 offen offset:0 sc1
  s_waitcnt vmcnt(0)
  s_add_u32 s57, s57, 1
  s_cmp_gt_u32 s57, 0x40000
  s_cbranch_scc1 L_tag_104023
  v_cmp_eq_u32 vcc, -1, v108
  s_cbranch_vccnz L_tag_104023_l
  s_nop 1
  s_branch L_tag_104023
L_tag_106024_r:
L_tag_106024_l:
  s_add_u32 s3, s58, 8192
  buffer_load_dwordx4 v[112:115], v213, s[28:31], s3 offen offset:1024 sc1
  s_waitcnt vmcnt(0)
  s_add_u32 s57, s57, 1
  s_cmp_gt_u32 s57, 0x40000
  s_cbranch_scc1 L_tag_106024
  v_cmp_eq_u32 vcc, -1, v112
  s_cbranch_vccnz L_tag_106024_l
  s_nop 1
  s_branch L_tag_106024
L_tag_108025_r:
L_tag_108025_l:
  s_add_u32 s3, s58, 8192
  buffer_load_dwordx4 v[116:119], v213, s[28:31], s3 offen offset:2048 sc1
  s_waitcnt vmcnt(0)
  s_add_u32 s57, s57, 1
  s_cmp_gt_u32 s57, 0x40000
  s_cbranch_scc1 L_tag_108025
  v_cmp_eq_u32 vcc, -1, v116
  s_cbranch_vccnz L_tag_108025_l
  s_nop 1
  s_branch L_tag_108025
L_tag_110026_r:
L_tag_110026_l:
  s_add_u32 s3, s58, 8192
  buffer_load_dwordx4 v[156:159], v213, s[28:31], s3 offen offset:3072 sc1
  s_waitcnt vmcnt(0)
  s_add_u32 s57, s57, 1
  s_cmp_gt_u32 s57, 0x40000
  s_cbranch_scc1 L_tag_110026
  v_cmp_eq_u32 vcc, -1, v156
  s_cbranch_vccnz L_tag_110026_l
  s_nop 1
  s_branch L_tag_110026
L_tag_112027_r:
L_tag_112027_l:
  s_add_u32 s3, s58, 12288
  buffer_load_dwordx4 v[160:163], v213, s[28:31], s3 offen offset:0 sc1
  s_waitcnt vmcnt(0)
  s_add_u32 s57, s57, 1
  s_cmp_gt_u32 s57, 0x40000
  s_cbranch_scc1 L_tag_112027
  v_cmp_eq_u32 vcc, -1, v160
  s_cbranch_vccnz L_tag_112027_l
  s_nop 1
  s_branch L_tag_112027
L_tag_114028_r:
L_tag_114028_l:
  s_add_u32 s3, s58, 12288
  buffer_load_dwordx4 v[164:167], v213, s[28:31], s3 offen offset:1024 sc1
  s_waitcnt vmcnt(0)
  s_add_u32 s57, s57, 1
  s_cmp_gt_u32 s57, 0x40000
  s_cbranch_scc1 L_tag_114028
  v_cmp_eq_u32 vcc, -1, v164
  s_cbranch_vccnz L_tag_114028_l
  s_nop 1
  s_branch L_tag_114028
L_tag_116029_r:
L_tag_116029_l:
  s_add_u32 s3, s58, 12288
  buffer_load_dwordx4 v[168:171], v213, s[28:31], s3 offen offset:2048 sc1
  s_waitcnt vmcnt(0)
  s_add_u32 s57, s57, 1
  s_cmp_gt_u32 s57, 0x40000
  s_cbranch_scc1 L_tag_116029
  v_cmp_eq_u32 vcc, -1, v168
  s_cbranch_vccnz L_tag_116029_l
  s_nop 1
  s_branch L_tag_116029
L_tag_118030_r:
L_tag_118030_l:
  s_add_u32 s3, s58, 12288
  buffer_load_dwordx4 v[172:175], v213, s[28:31], s3 offen offset:3072 sc1
  s_waitcnt vmcnt(0)
  s_add_u32 s57, s57, 1
  s_cmp_gt_u32 s57, 0x40000
  s_cbranch_scc1 L_tag_118030
  v_cmp_eq_u32 vcc, -1, v172
  s_cbranch_vccnz L_tag_118030_l
  s_nop 1
  s_branch L_tag_118030
L_tag_120031_r:
L_tag_120031_l:
  s_add_u32 s3, s58, 16384
  buffer_load_dwordx4 v[176:179], v213, s[28:31], s3 offen offset:0 sc1
  s_waitcnt vmcnt(0)
  s_add_u32 s57, s57, 1
  s_cmp_gt_u32 s57, 0x40000
  s_cbranch_scc1 L_tag_120031
  v_cmp_eq_u32 vcc, -1, v176
  s_cbranch_vccnz L_tag_120031_l
  s_nop 1
  s_branch L_tag_120031
L_tag_122032_r:
L_tag_122032_l:
  s_add_u32 s3, s58, 16384
  buffer_load_dwordx4 v[180:183], v213, s[28:31], s3 offen offset:1024 sc1
  s_waitcnt vmcnt(0)
  s_add_u32 s57, s57, 1
  s_cmp_gt_u32 s57, 0x40000
  s_cbranch_scc1 L_tag_122032
  v_cmp_eq_u32 vcc, -1, v180
  s_cbranch_vccnz L_tag_122032_l
  s_nop 1
  s_branch L_tag_122032
L_tag_124033_r:
L_tag_124033_l:
  s_add_u32 s3, s58, 16384
  buffer_load_dwordx4 v[184:187], v213, s[28:31], s3 offen offset:2048 sc1
  s_waitcnt vmcnt(0)
  s_add_u32 s57, s57, 1
  s_cmp_gt_u32 s57, 0x40000
  s_cbranch_scc1 L_tag_124033
  v_cmp_eq_u32 vcc, -1, v184
  s_cbranch_vccnz L_tag_124033_l
  s_nop 1
  s_branch L_tag_124033
L_tag_126034_r:
L_tag_126034_l:
  s_add_u32 s3, s58, 16384
  buffer_load_dwordx4 v[108:111], v213, s[28:31], s3 offen offset:3072 sc1
  s_waitcnt vmcnt(0)
  s_add_u32 s57, s57, 1
  s_cmp_gt_u32 s57, 0x40000
  s_cbranch_scc1 L_tag_126034
  v_cmp_eq_u32 vcc, -1, v108
  s_cbranch_vccnz L_tag_126034_l
  s_nop 1
  s_branch L_tag_126034
L_tag_128035_r:
L_tag_128035_l:
  s_add_u32 s3, s58, 20480
  buffer_load_dwordx4 v[112:115], v213, s[28:31], s3 offen offset:0 sc1
  s_waitcnt vmcnt(0)
  s_add_u32 s57, s57, 1
  s_cmp_gt_u32 s57, 0x40000
  s_cbranch_scc1 L_tag_128035
  v_cmp_eq_u32 vcc, -1, v112
  s_cbranch_vccnz L_tag_128035_l
  s_nop 1
  s_branch L_tag_128035
L_tag_130036_r:
L_tag_130036_l:
  s_add_u32 s3, s58, 20480
  buffer_load_dwordx4 v[116:119], v213, s[28:31], s3 offen offset:1024 sc1
  s_waitcnt vmcnt(0)
  s_add_u32 s57, s57, 1
  s_cmp_gt_u32 s57, 0x40000
  s_cbranch_scc1 L_tag_130036
  v_cmp_eq_u32 vcc, -1, v116
  s_cbranch_vccnz L_tag_130036_l
  s_nop 1
  s_branch L_tag_130036
L_tag_132037_r:
L_tag_132037_l:
  s_add_u32 s3, s58, 20480
  buffer_load_dwordx4 v[156:159], v213, s[28:31], s3 offen offset:2048 sc1
  s_waitcnt vmcnt(0)
  s_add_u32 s57, s57, 1
  s_cmp_gt_u32 s57, 0x40000
  s_cbranch_scc1 L_tag_132037
  v_cmp_eq_u32 vcc, -1, v156
  s_cbranch_vccnz L_tag_132037_l
  s_nop 1
  s_branch L_tag_132037
L_tag_134038_r:
L_tag_134038_l:
  s_add_u32 s3, s58, 20480
  buffer_load_dwordx4 v[160:163], v213, s[28:31], s3 offen offset:3072 sc1
  s_waitcnt vmcnt(0)
  s_add_u32 s57, s57, 1
  s_cmp_gt_u32 s57, 0x40000
  s_cbranch_scc1 L_tag_134038
  v_cmp_eq_u32 vcc, -1, v160
  s_cbranch_vccnz L_tag_134038_l
  s_nop 1
  s_branch L_tag_134038
L_tag_136039_r:
L_tag_136039_l:
  s_add_u32 s3, s58, 24576
  buffer_load_dwordx4 v[164:167], v213, s[28:31], s3 offen offset:0 sc1
  s_waitcnt vmcnt(0)
  s_add_u32 s57, s57, 1
  s_cmp_gt_u32 s57, 0x40000
  s_cbranch_scc1 L_tag_136039
  v_cmp_eq_u32 vcc, -1, v164
  s_cbranch_vccnz L_tag_136039_l
  s_nop 1
  s_branch L_tag_136039
L_tag_138040_r:
L_tag_138040_l:
  s_add_u32 s3, s58, 24576
  buffer_load_dwordx4 v[168:171], v213, s[28:31], s3 offen offset:1024 sc1
  s_waitcnt vmcnt(0)
  s_add_u32 s57, s57, 1
  s_cmp_gt_u32 s57, 0x40000
  s_cbranch_scc1 L_tag_138040
  v_cmp_eq_u32 vcc, -1, v168
  s_cbranch_vccnz L_tag_138040_l
  s_nop 1
  s_branch L_tag_138040
L_tag_140041_r:
L_tag_140041_l:
  s_add_u32 s3, s58, 24576
  buffer_load_dwordx4 v[172:175], v213, s[28:31], s3 offen offset:2048 sc1
  s_waitcnt vmcnt(0)
  s_add_u32 s57, s57, 1
  s_cmp_gt_u32 s57, 0x40000
  s_cbranch_scc1 L_tag_140041
  v_cmp_eq_u32 vcc, -1, v172
  s_cbranch_vccnz L_tag_140041_l
  s_nop 1
  s_branch L_tag_140041
L_tag_142042_r:
L_tag_142042_l:
  s_add_u32 s3, s58, 24576
  buffer_load_dwordx4 v[176:179], v213, s[28:31], s3 offen offset:3072 sc1
  s_waitcnt vmcnt(0)
  s_add_u32 s57, s57, 1
  s_cmp_gt_u32 s57, 0x40000
  s_cbranch_scc1 L_tag_142042
  v_cmp_eq_u32 vcc, -1, v176
  s_cbranch_vccnz L_tag_142042_l
  s_nop 1
  s_branch L_tag_142042
L_tag_144043_r:
L_tag_144043_l:
  s_add_u32 s3, s58, 28672
  buffer_load_dwordx4 v[180:183], v213, s[28:31], s3 offen offset:0 sc1
  s_waitcnt vmcnt(0)
  s_add_u32 s57, s57, 1
  s_cmp_gt_u32 s57, 0x40000
  s_cbranch_scc1 L_tag_144043
  v_cmp_eq_u32 vcc, -1, v180
  s_cbranch_vccnz L_tag_144043_l
  s_nop 1
  s_branch L_tag_144043
L_tag_146044_r:
L_tag_146044_l:
  s_add_u32 s3, s58, 28672
  buffer_load_dwordx4 v[184:187], v213, s[28:31], s3 offen offset:1024 sc1
  s_waitcnt vmcnt(0)
  s_add_u32 s57, s57, 1
  s_cmp_gt_u32 s57, 0x40000
  s_cbranch_scc1 L_tag_146044
  v_cmp_eq_u32 vcc, -1, v184
  s_cbranch_vccnz L_tag_146044_l
  s_nop 1
  s_branch L_tag_146044
L_tag_148045_r:
L_tag_148045_l:
  s_add_u32 s3, s58, 28672
  buffer_load_dwordx4 v[108:111], v213, s[28:31], s3 offen offset:2048 sc1
  s_waitcnt vmcnt(0)
  s_add_u32 s57, s57, 1
  s_cmp_gt_u32 s57, 0x40000
  s_cbranch_scc1 L_tag_148045
  v_cmp_eq_u32 vcc, -1, v108
  s_cbranch_vccnz L_tag_148045_l
  s_nop 1
  s_branch L_tag_148045
L_tag_150046_r:
L_tag_150046_l:
  s_add_u32 s3, s58, 28672
  buffer_load_dwordx4 v[112:115], v213, s[28:31], s3 offen offset:3072 sc1
  s_waitcnt vmcnt(0)
  s_add_u32 s57, s57, 1
  s_cmp_gt_u32 s57, 0x40000
  s_cbranch_scc1 L_tag_150046
  v_cmp_eq_u32 vcc, -1, v112
  s_cbranch_vccnz L_tag_150046_l
  s_nop 1
  s_branch L_tag_150046
L_tag_152047_r:
L_tag_152047_l:
  s_add_u32 s3, s58, 131072
  buffer_load_dwordx4 v[116:119], v213, s[28:31], s3 offen offset:0 sc1
  s_waitcnt vmcnt(0)
  s_add_u32 s57, s57, 1
  s_cmp_gt_u32 s57, 0x40000
  s_cbranch_scc1 L_tag_152047
  v_cmp_eq_u32 vcc, -1, v116
  s_cbranch_vccnz L_tag_152047_l
  s_nop 1
  s_branch L_tag_152047
L_tag_284049_r:
L_tag_284049_l:
  s_add_u32 s3, s58, 131072
  buffer_load_dwordx4 v[156:159], v213, s[28:31], s3 offen offset:1024 sc1
  s_waitcnt vmcnt(0)
  s_add_u32 s57, s57, 1
  s_cmp_gt_u32 s57, 0x40000
  s_cbranch_scc1 L_tag_284049
  v_cmp_eq_u32 vcc, -1, v156
  s_cbranch_vccnz L_tag_284049_l
  s_nop 1
  s_branch L_tag_284049
L_tag_286050_r:
L_tag_286050_l:
  s_add_u32 s3, s58, 131072
  buffer_load_dwordx4 v[160:163], v213, s[28:31], s3 offen offset:2048 sc1
  s_waitcnt vmcnt(0)
  s_add_u32 s57, s57, 1
  s_cmp_gt_u32 s57, 0x40000
  s_cbranch_scc1 L_tag_286050
  v_cmp_eq_u32 vcc, -1, v160
  s_cbranch_vccnz L_tag_286050_l
  s_nop 1
  s_branch L_tag_286050
L_tag_288051_r:
L_tag_288051_l:
  s_add_u32 s3, s58, 131072
  buffer_load_dwordx4 v[164:167], v213, s[28:31], s3 offen offset:3072 sc1
  s_waitcnt vmcnt(0)
  s_add_u32 s57, s57, 1
  s_cmp_gt_u32 s57, 0x40000
  s_cbranch_scc1 L_tag_288051
  v_cmp_eq_u32 vcc, -1, v164
  s_cbranch_vccnz L_tag_288051_l
  s_nop 1
  s_branch L_tag_288051
L_tag_290052_r:
L_tag_290052_l:
  s_add_u32 s3, s58, 135168
  buffer_load_dwordx4 v[168:171], v213, s[28:31], s3 offen offset:0 sc1
  s_waitcnt vmcnt(0)
  s_add_u32 s57, s57, 1
  s_cmp_gt_u32 s57, 0x40000
  s_cbranch_scc1 L_tag_290052
  v_cmp_eq_u32 vcc, -1, v168
  s_cbranch_vccnz L_tag_290052_l
  s_nop 1
  s_branch L_tag_290052
L_tag_292053_r:
L_tag_292053_l:
  s_add_u32 s3, s58, 135168
  buffer_load_dwordx4 v[172:175], v213, s[28:31], s3 offen offset:1024 sc1
  s_waitcnt vmcnt(0)
  s_add_u32 s57, s57, 1
  s_cmp_gt_u32 s57, 0x40000
  s_cbranch_scc1 L_tag_292053
  v_cmp_eq_u32 vcc, -1, v172
  s_cbranch_vccnz L_tag_292053_l
  s_nop 1
  s_branch L_tag_292053
L_tag_294054_r:
L_tag_294054_l:
  s_add_u32 s3, s58, 135168
  buffer_load_dwordx4 v[176:179], v213, s[28:31], s3 offen offset:2048 sc1
  s_waitcnt vmcnt(0)
  s_add_u32 s57, s57, 1
  s_cmp_gt_u32 s57, 0x40000
  s_cbranch_scc1 L_tag_294054
  v_cmp_eq_u32 vcc, -1, v176
  s_cbranch_vccnz L_tag_294054_l
  s_nop 1
  s_branch L_tag_294054
L_tag_296055_r:
L_tag_296055_l:
  s_add_u32 s3, s58, 135168
  buffer_load_dwordx4 v[180:183], v213, s[28:31], s3 offen offset:3072 sc1
  s_waitcnt vmcnt(0)
  s_add_u32 s57, s57, 1
  s_cmp_gt_u32 s57, 0x40000
  s_cbranch_scc1 L_tag_296055
  v_cmp_eq_u32 vcc, -1, v180
  s_cbranch_vccnz L_tag_296055_l
  s_nop 1
  s_branch L_tag_296055
L_tag_298056_r:
L_tag_298056_l:
  s_add_u32 s3, s58, 139264
  buffer_load_dwordx4 v[184:187], v213, s[28:31], s3 offen offset:0 sc1
  s_waitcnt vmcnt(0)
  s_add_u32 s57, s57, 1
  s_cmp_gt_u32 s57, 0x40000
  s_cbranch_scc1 L_tag_298056
  v_cmp_eq_u32 vcc, -1, v184
  s_cbranch_vccnz L_tag_298056_l
  s_nop 1
  s_branch L_tag_298056
L_tag_300057_r:
L_tag_300057_l:
  s_add_u32 s3, s58, 139264
  buffer_load_dwordx4 v[108:111], v213, s[28:31], s3 offen offset:1024 sc1
  s_waitcnt vmcnt(0)
  s_add_u32 s57, s57, 1
  s_cmp_gt_u32 s57, 0x40000
  s_cbranch_scc1 L_tag_300057
  v_cmp_eq_u32 vcc, -1, v108
  s_cbranch_vccnz L_tag_300057_l
  s_nop 1
  s_branch L_tag_300057
L_tag_302058_r:
L_tag_302058_l:
  s_add_u32 s3, s58, 139264
  buffer_load_dwordx4 v[112:115], v213, s[28:31], s3 offen offset:2048 sc1
  s_waitcnt vmcnt(0)
  s_add_u32 s57, s57, 1
  s_cmp_gt_u32 s57, 0x40000
  s_cbranch_scc1 L_tag_302058
  v_cmp_eq_u32 vcc, -1, v112
  s_cbranch_vccnz L_tag_302058_l
  s_nop 1
  s_branch L_tag_302058
L_tag_304059_r:
L_tag_304059_l:
  s_add_u32 s3, s58, 139264
  buffer_load_dwordx4 v[116:119], v213, s[28:31], s3 offen offset:3072 sc1
  s_waitcnt vmcnt(0)
  s_add_u32 s57, s57, 1
  s_cmp_gt_u32 s57, 0x40000
  s_cbranch_scc1 L_tag_304059
  v_cmp_eq_u32 vcc, -1, v116
  s_cbranch_vccnz L_tag_304059_l
  s_nop 1
  s_branch L_tag_304059
L_tag_306060_r:
L_tag_306060_l:
  s_add_u32 s3, s58, 143360
  buffer_load_dwordx4 v[156:159], v213, s[28:31], s3 offen offset:0 sc1
  s_waitcnt vmcnt(0)
  s_add_u32 s57, s57, 1
  s_cmp_gt_u32 s57, 0x40000
  s_cbranch_scc1 L_tag_306060
  v_cmp_eq_u32 vcc, -1, v156
  s_cbranch_vccnz L_tag_306060_l
  s_nop 1
  s_branch L_tag_306060
L_tag_308061_r:
L_tag_308061_l:
  s_add_u32 s3, s58, 143360
  buffer_load_dwordx4 v[160:163], v213, s[28:31], s3 offen offset:1024 sc1
  s_waitcnt vmcnt(0)
  s_add_u32 s57, s57, 1
  s_cmp_gt_u32 s57, 0x40000
  s_cbranch_scc1 L_tag_308061
  v_cmp_eq_u32 vcc, -1, v160
  s_cbranch_vccnz L_tag_308061_l
  s_nop 1
  s_branch L_tag_308061
L_tag_310062_r:
L_tag_310062_l:
  s_add_u32 s3, s58, 143360
  buffer_load_dwordx4 v[164:167], v213, s[28:31], s3 offen offset:2048 sc1
  s_waitcnt vmcnt(0)
  s_add_u32 s57, s57, 1
  s_cmp_gt_u32 s57, 0x40000
  s_cbranch_scc1 L_tag_310062
  v_cmp_eq_u32 vcc, -1, v164
  s_cbranch_vccnz L_tag_310062_l
  s_nop 1
  s_branch L_tag_310062
L_tag_312063_r:
L_tag_312063_l:
  s_add_u32 s3, s58, 143360
  buffer_load_dwordx4 v[168:171], v213, s[28:31], s3 offen offset:3072 sc1
  s_waitcnt vmcnt(0)
  s_add_u32 s57, s57, 1
  s_cmp_gt_u32 s57, 0x40000
  s_cbranch_scc1 L_tag_312063
  v_cmp_eq_u32 vcc, -1, v168
  s_cbranch_vccnz L_tag_312063_l
  s_nop 1
  s_branch L_tag_312063
L_tag_314064_r:
L_tag_314064_l:
  s_add_u32 s3, s58, 147456
  buffer_load_dwordx4 v[172:175], v213, s[28:31], s3 offen offset:0 sc1
  s_waitcnt vmcnt(0)
  s_add_u32 s57, s57, 1
  s_cmp_gt_u32 s57, 0x40000
  s_cbranch_scc1 L_tag_314064
  v_cmp_eq_u32 vcc, -1, v172
  s_cbranch_vccnz L_tag_314064_l
  s_nop 1
  s_branch L_tag_314064
L_tag_316065_r:
L_tag_316065_l:
  s_add_u32 s3, s58, 147456
  buffer_load_dwordx4 v[176:179], v213, s[28:31], s3 offen offset:1024 sc1
  s_waitcnt vmcnt(0)
  s_add_u32 s57, s57, 1
  s_cmp_gt_u32 s57, 0x40000
  s_cbranch_scc1 L_tag_316065
  v_cmp_eq_u32 vcc, -1, v176
  s_cbranch_vccnz L_tag_316065_l
  s_nop 1
  s_branch L_tag_316065
L_tag_318066_r:
L_tag_318066_l:
  s_add_u32 s3, s58, 147456
  buffer_load_dwordx4 v[180:183], v213, s[28:31], s3 offen offset:2048 sc1
  s_waitcnt vmcnt(0)
  s_add_u32 s57, s57, 1
  s_cmp_gt_u32 s57, 0x40000
  s_cbranch_scc1 L_tag_318066
  v_cmp_eq_u32 vcc, -1, v180
  s_cbranch_vccnz L_tag_318066_l
  s_nop 1
  s_branch L_tag_318066
L_tag_320067_r:
L_tag_320067_l:
  s_add_u32 s3, s58, 147456
  buffer_load_dwordx4 v[184:187], v213, s[28:31], s3 offen offset:3072 sc1
  s_waitcnt vmcnt(0)
  s_add_u32 s57, s57, 1
  s_cmp_gt_u32 s57, 0x40000
  s_cbranch_scc1 L_tag_320067
  v_cmp_eq_u32 vcc, -1, v184
  s_cbranch_vccnz L_tag_320067_l
  s_nop 1
  s_branch L_tag_320067
L_tag_322068_r:
L_tag_322068_l:
  s_add_u32 s3, s58, 151552
  buffer_load_dwordx4 v[108:111], v213, s[28:31], s3 offen offset:0 sc1
  s_waitcnt vmcnt(0)
  s_add_u32 s57, s57, 1
  s_cmp_gt_u32 s57, 0x40000
  s_cbranch_scc1 L_tag_322068
  v_cmp_eq_u32 vcc, -1, v108
  s_cbranch_vccnz L_tag_322068_l
  s_nop 1
  s_branch L_tag_322068
L_tag_324069_r:
L_tag_324069_l:
  s_add_u32 s3, s58, 151552
  buffer_load_dwordx4 v[112:115], v213, s[28:31], s3 offen offset:1024 sc1
  s_waitcnt vmcnt(0)
  s_add_u32 s57, s57, 1
  s_cmp_gt_u32 s57, 0x40000
  s_cbranch_scc1 L_tag_324069
  v_cmp_eq_u32 vcc, -1, v112
  s_cbranch_vccnz L_tag_324069_l
  s_nop 1
  s_branch L_tag_324069
L_tag_326070_r:
L_tag_326070_l:
  s_add_u32 s3, s58, 151552
  buffer_load_dwordx4 v[116:119], v213, s[28:31], s3 offen offset:2048 sc1
  s_waitcnt vmcnt(0)
  s_add_u32 s57, s57, 1
  s_cmp_gt_u32 s57, 0x40000
  s_cbranch_scc1 L_tag_326070
  v_cmp_eq_u32 vcc, -1, v116
  s_cbranch_vccnz L_tag_326070_l
  s_nop 1
  s_branch L_tag_326070
L_tag_328071_r:
L_tag_328071_l:
  s_add_u32 s3, s58, 151552
  buffer_load_dwordx4 v[156:159], v213, s[28:31], s3 offen offset:3072 sc1
  s_waitcnt vmcnt(0)
  s_add_u32 s57, s57, 1
  s_cmp_gt_u32 s57, 0x40000
  s_cbranch_scc1 L_tag_328071
  v_cmp_eq_u32 vcc, -1, v156
  s_cbranch_vccnz L_tag_328071_l
  s_nop 1
  s_branch L_tag_328071
L_tag_330072_r:
L_tag_330072_l:
  s_add_u32 s3, s58, 155648
  buffer_load_dwordx4 v[160:163], v213, s[28:31], s3 offen offset:0 sc1
  s_waitcnt vmcnt(0)
  s_add_u32 s57, s57, 1
  s_cmp_gt_u32 s57, 0x40000
  s_cbranch_scc1 L_tag_330072
  v_cmp_eq_u32 vcc, -1, v160
  s_cbranch_vccnz L_tag_330072_l
  s_nop 1
  s_branch L_tag_330072
L_tag_332073_r:
L_tag_332073_l:
  s_add_u32 s3, s58, 155648
  buffer_load_dwordx4 v[164:167], v213, s[28:31], s3 offen offset:1024 sc1
  s_waitcnt vmcnt(0)
  s_add_u32 s57, s57, 1
  s_cmp_gt_u32 s57, 0x40000
  s_cbranch_scc1 L_tag_332073
  v_cmp_eq_u32 vcc, -1, v164
  s_cbranch_vccnz L_tag_332073_l
  s_nop 1
  s_branch L_tag_332073
L_tag_334074_r:
L_tag_334074_l:
  s_add_u32 s3, s58, 155648
  buffer_load_dwordx4 v[168:171], v213, s[28:31], s3 offen offset:2048 sc1
  s_waitcnt vmcnt(0)
  s_add_u32 s57, s57, 1
  s_cmp_gt_u32 s57, 0x40000
  s_cbranch_scc1 L_tag_334074
  v_cmp_eq_u32 vcc, -1, v168
  s_cbranch_vccnz L_tag_334074_l
  s_nop 1
  s_branch L_tag_334074
L_tag_336075_r:
L_tag_336075_l:
  s_add_u32 s3, s58, 155648
  buffer_load_dwordx4 v[172:175], v213, s[28:31], s3 offen offset:3072 sc1
  s_waitcnt vmcnt(0)
  s_add_u32 s57, s57, 1
  s_cmp_gt_u32 s57, 0x40000
  s_cbranch_scc1 L_tag_336075
  v_cmp_eq_u32 vcc, -1, v172
  s_cbranch_vccnz L_tag_336075_l
  s_nop 1
  s_branch L_tag_336075
L_tag_338076_r:
L_tag_338076_l:
  s_add_u32 s3, s58, 159744
  buffer_load_dwordx4 v[176:179], v213, s[28:31], s3 offen offset:0 sc1
  s_waitcnt vmcnt(0)
  s_add_u32 s57, s57, 1
  s_cmp_gt_u32 s57, 0x40000
  s_cbranch_scc1 L_tag_338076
  v_cmp_eq_u32 vcc, -1, v176
  s_cbranch_vccnz L_tag_338076_l
  s_nop 1
  s_branch L_tag_338076
L_tag_340077_r:
L_tag_340077_l:
  s_add_u32 s3, s58, 159744
  buffer_load_dwordx4 v[180:183], v213, s[28:31], s3 offen offset:1024 sc1
  s_waitcnt vmcnt(0)
  s_add_u32 s57, s57, 1
  s_cmp_gt_u32 s57, 0x40000
  s_cbranch_scc1 L_tag_340077
  v_cmp_eq_u32 vcc, -1, v180
  s_cbranch_vccnz L_tag_340077_l
  s_nop 1
  s_branch L_tag_340077
L_tag_342078_r:
L_tag_342078_l:
  s_add_u32 s3, s58, 159744
  buffer_load_dwordx4 v[184:187], v213, s[28:31], s3 offen offset:2048 sc1
  s_waitcnt vmcnt(0)
  s_add_u32 s57, s57, 1
  s_cmp_gt_u32 s57, 0x40000
  s_cbranch_scc1 L_tag_342078
  v_cmp_eq_u32 vcc, -1, v184
  s_cbranch_vccnz L_tag_342078_l
  s_nop 1
  s_branch L_tag_342078
L_tag_344079_r:
L_tag_344079_l:
  s_add_u32 s3, s58, 159744
  buffer_load_dwordx4 v[108:111], v213, s[28:31], s3 offen offset:3072 sc1
  s_waitcnt vmcnt(0)
  s_add_u32 s57, s57, 1
  s_cmp_gt_u32 s57, 0x40000
  s_cbranch_scc1 L_tag_344079
  v_cmp_eq_u32 vcc, -1, v108
  s_cbranch_vccnz L_tag_344079_l
  s_nop 1
  s_branch L_tag_344079
L_tag_346080_r:
L_tag_346080_l:
  s_add_u32 s3, s58, 262144
  buffer_load_dwordx4 v[112:115], v213, s[28:31], s3 offen offset:0 sc1
  s_waitcnt vmcnt(0)
  s_add_u32 s57, s57, 1
  s_cmp_gt_u32 s57, 0x40000
  s_cbranch_scc1 L_tag_346080
  v_cmp_eq_u32 vcc, -1, v112
  s_cbranch_vccnz L_tag_346080_l
  s_nop 1
  s_branch L_tag_346080
L_tag_478082_r:
L_tag_478082_l:
  s_add_u32 s3, s58, 262144
  buffer_load_dwordx4 v[116:119], v213, s[28:31], s3 offen offset:1024 sc1
  s_waitcnt vmcnt(0)
  s_add_u32 s57, s57, 1
  s_cmp_gt_u32 s57, 0x40000
  s_cbranch_scc1 L_tag_478082
  v_cmp_eq_u32 vcc, -1, v116
  s_cbranch_vccnz L_tag_478082_l
  s_nop 1
  s_branch L_tag_478082
L_tag_480083_r:
L_tag_480083_l:
  s_add_u32 s3, s58, 262144
  buffer_load_dwordx4 v[156:159], v213, s[28:31], s3 offen offset:2048 sc1
  s_waitcnt vmcnt(0)
  s_add_u32 s57, s57, 1
  s_cmp_gt_u32 s57, 0x40000
  s_cbranch_scc1 L_tag_480083
  v_cmp_eq_u32 vcc, -1, v156
  s_cbranch_vccnz L_tag_480083_l
  s_nop 1
  s_branch L_tag_480083
L_tag_482084_r:
L_tag_482084_l:
  s_add_u32 s3, s58, 262144
  buffer_load_dwordx4 v[160:163], v213, s[28:31], s3 offen offset:3072 sc1
  s_waitcnt vmcnt(0)
  s_add_u32 s57, s57, 1
  s_cmp_gt_u32 s57, 0x40000
  s_cbranch_scc1 L_tag_482084
  v_cmp_eq_u32 vcc, -1, v160
  s_cbranch_vccnz L_tag_482084_l
  s_nop 1
  s_branch L_tag_482084
L_tag_484085_r:
L_tag_484085_l:
  s_add_u32 s3, s58, 266240
  buffer_load_dwordx4 v[164:167], v213, s[28:31], s3 offen offset:0 sc1
  s_waitcnt vmcnt(0)
  s_add_u32 s57, s57, 1
  s_cmp_gt_u32 s57, 0x40000
  s_cbranch_scc1 L_tag_484085
  v_cmp_eq_u32 vcc, -1, v164
  s_cbranch_vccnz L_tag_484085_l
  s_nop 1
  s_branch L_tag_484085
L_tag_486086_r:
L_tag_486086_l:
  s_add_u32 s3, s58, 266240
  buffer_load_dwordx4 v[168:171], v213, s[28:31], s3 offen offset:1024 sc1
  s_waitcnt vmcnt(0)
  s_add_u32 s57, s57, 1
  s_cmp_gt_u32 s57, 0x40000
  s_cbranch_scc1 L_tag_486086
  v_cmp_eq_u32 vcc, -1, v168
  s_cbranch_vccnz L_tag_486086_l
  s_nop 1
  s_branch L_tag_486086
L_tag_488087_r:
L_tag_488087_l:
  s_add_u32 s3, s58, 266240
  buffer_load_dwordx4 v[172:175], v213, s[28:31], s3 offen offset:2048 sc1
  s_waitcnt vmcnt(0)
  s_add_u32 s57, s57, 1
  s_cmp_gt_u32 s57, 0x40000
  s_cbranch_scc1 L_tag_488087
  v_cmp_eq_u32 vcc, -1, v172
  s_cbranch_vccnz L_tag_488087_l
  s_nop 1
  s_branch L_tag_488087
L_tag_490088_r:
L_tag_490088_l:
  s_add_u32 s3, s58, 266240
  buffer_load_dwordx4 v[176:179], v213, s[28:31], s3 offen offset:3072 sc1
  s_waitcnt vmcnt(0)
  s_add_u32 s57, s57, 1
  s_cmp_gt_u32 s57, 0x40000
  s_cbranch_scc1 L_tag_490088
  v_cmp_eq_u32 vcc, -1, v176
  s_cbranch_vccnz L_tag_490088_l
  s_nop 1
  s_branch L_tag_490088
L_tag_492089_r:
L_tag_492089_l:
  s_add_u32 s3, s58, 270336
  buffer_load_dwordx4 v[180:183], v213, s[28:31], s3 offen offset:0 sc1
  s_waitcnt vmcnt(0)
  s_add_u32 s57, s57, 1
  s_cmp_gt_u32 s57, 0x40000
  s_cbranch_scc1 L_tag_492089
  v_cmp_eq_u32 vcc, -1, v180
  s_cbranch_vccnz L_tag_492089_l
  s_nop 1
  s_branch L_tag_492089
L_tag_494090_r:
L_tag_494090_l:
  s_add_u32 s3, s58, 270336
  buffer_load_dwordx4 v[184:187], v213, s[28:31], s3 offen offset:1024 sc1
  s_waitcnt vmcnt(0)
  s_add_u32 s57, s57, 1
  s_cmp_gt_u32 s57, 0x40000
  s_cbranch_scc1 L_tag_494090
  v_cmp_eq_u32 vcc, -1, v184
  s_cbranch_vccnz L_tag_494090_l
  s_nop 1
  s_branch L_tag_494090
L_tag_496091_r:
L_tag_496091_l:
  s_add_u32 s3, s58, 270336
  buffer_load_dwordx4 v[108:111], v213, s[28:31], s3 offen offset:2048 sc1
  s_waitcnt vmcnt(0)
  s_add_u32 s57, s57, 1
  s_cmp_gt_u32 s57, 0x40000
  s_cbranch_scc1 L_tag_496091
  v_cmp_eq_u32 vcc, -1, v108
  s_cbranch_vccnz L_tag_496091_l
  s_nop 1
  s_branch L_tag_496091
L_tag_498092_r:
L_tag_498092_l:
  s_add_u32 s3, s58, 270336
  buffer_load_dwordx4 v[112:115], v213, s[28:31], s3 offen offset:3072 sc1
  s_waitcnt vmcnt(0)
  s_add_u32 s57, s57, 1
  s_cmp_gt_u32 s57, 0x40000
  s_cbranch_scc1 L_tag_498092
  v_cmp_eq_u32 vcc, -1, v112
  s_cbranch_vccnz L_tag_498092_l
  s_nop 1
  s_branch L_tag_498092
L_tag_500093_r:
L_tag_500093_l:
  s_add_u32 s3, s58, 274432
  buffer_load_dwordx4 v[116:119], v213, s[28:31], s3 offen offset:0 sc1
  s_waitcnt vmcnt(0)
  s_add_u32 s57, s57, 1
  s_cmp_gt_u32 s57, 0x40000
  s_cbranch_scc1 L_tag_500093
  v_cmp_eq_u32 vcc, -1, v116
  s_cbranch_vccnz L_tag_500093_l
  s_nop 1
  s_branch L_tag_500093
L_tag_502094_r:
L_tag_502094_l:
  s_add_u32 s3, s58, 274432
  buffer_load_dwordx4 v[156:159], v213, s[28:31], s3 offen offset:1024 sc1
  s_waitcnt vmcnt(0)
  s_add_u32 s57, s57, 1
  s_cmp_gt_u32 s57, 0x40000
  s_cbranch_scc1 L_tag_502094
  v_cmp_eq_u32 vcc, -1, v156
  s_cbranch_vccnz L_tag_502094_l
  s_nop 1
  s_branch L_tag_502094
L_tag_504095_r:
L_tag_504095_l:
  s_add_u32 s3, s58, 274432
  buffer_load_dwordx4 v[160:163], v213, s[28:31], s3 offen offset:2048 sc1
  s_waitcnt vmcnt(0)
  s_add_u32 s57, s57, 1
  s_cmp_gt_u32 s57, 0x40000
  s_cbranch_scc1 L_tag_504095
  v_cmp_eq_u32 vcc, -1, v160
  s_cbranch_vccnz L_tag_504095_l
  s_nop 1
  s_branch L_tag_504095
L_tag_506096_r:
L_tag_506096_l:
  s_add_u32 s3, s58, 274432
  buffer_load_dwordx4 v[164:167], v213, s[28:31], s3 offen offset:3072 sc1
  s_waitcnt vmcnt(0)
  s_add_u32 s57, s57, 1
  s_cmp_gt_u32 s57, 0x40000
  s_cbranch_scc1 L_tag_506096
  v_cmp_eq_u32 vcc, -1, v164
  s_cbranch_vccnz L_tag_506096_l
  s_nop 1
  s_branch L_tag_506096
L_tag_508097_r:
L_tag_508097_l:
  s_add_u32 s3, s58, 278528
  buffer_load_dwordx4 v[168:171], v213, s[28:31], s3 offen offset:0 sc1
  s_waitcnt vmcnt(0)
  s_add_u32 s57, s57, 1
  s_cmp_gt_u32 s57, 0x40000
  s_cbranch_scc1 L_tag_508097
  v_cmp_eq_u32 vcc, -1, v168
  s_cbranch_vccnz L_tag_508097_l
  s_nop 1
  s_branch L_tag_508097
L_tag_510098_r:
L_tag_510098_l:
  s_add_u32 s3, s58, 278528
  buffer_load_dwordx4 v[172:175], v213, s[28:31], s3 offen offset:1024 sc1
  s_waitcnt vmcnt(0)
  s_add_u32 s57, s57, 1
  s_cmp_gt_u32 s57, 0x40000
  s_cbranch_scc1 L_tag_510098
  v_cmp_eq_u32 vcc, -1, v172
  s_cbranch_vccnz L_tag_510098_l
  s_nop 1
  s_branch L_tag_510098
L_tag_512099_r:
L_tag_512099_l:
  s_add_u32 s3, s58, 278528
  buffer_load_dwordx4 v[176:179], v213, s[28:31], s3 offen offset:2048 sc1
  s_waitcnt vmcnt(0)
  s_add_u32 s57, s57, 1
  s_cmp_gt_u32 s57, 0x40000
  s_cbranch_scc1 L_tag_512099
  v_cmp_eq_u32 vcc, -1, v176
  s_cbranch_vccnz L_tag_512099_l
  s_nop 1
  s_branch L_tag_512099
L_tag_514100_r:
L_tag_514100_l:
  s_add_u32 s3, s58, 278528
  buffer_load_dwordx4 v[180:183], v213, s[28:31], s3 offen offset:3072 sc1
  s_waitcnt vmcnt(0)
  s_add_u32 s57, s57, 1
  s_cmp_gt_u32 s57, 0x40000
  s_cbranch_scc1 L_tag_514100
  v_cmp_eq_u32 vcc, -1, v180
  s_cbranch_vccnz L_tag_514100_l
  s_nop 1
  s_branch L_tag_514100
L_tag_516101_r:
L_tag_516101_l:
  s_add_u32 s3, s58, 282624
  buffer_load_dwordx4 v[184:187], v213, s[28:31], s3 offen offset:0 sc1
  s_waitcnt vmcnt(0)
  s_add_u32 s57, s57, 1
  s_cmp_gt_u32 s57, 0x40000
  s_cbranch_scc1 L_tag_516101
  v_cmp_eq_u32 vcc, -1, v184
  s_cbranch_vccnz L_tag_516101_l
  s_nop 1
  s_branch L_tag_516101
L_tag_518102_r:
L_tag_518102_l:
  s_add_u32 s3, s58, 282624
  buffer_load_dwordx4 v[108:111], v213, s[28:31], s3 offen offset:1024 sc1
  s_waitcnt vmcnt(0)
  s_add_u32 s57, s57, 1
  s_cmp_gt_u32 s57, 0x40000
  s_cbranch_scc1 L_tag_518102
  v_cmp_eq_u32 vcc, -1, v108
  s_cbranch_vccnz L_tag_518102_l
  s_nop 1
  s_branch L_tag_518102
L_tag_520103_r:
L_tag_520103_l:
  s_add_u32 s3, s58, 282624
  buffer_load_dwordx4 v[112:115], v213, s[28:31], s3 offen offset:2048 sc1
  s_waitcnt vmcnt(0)
  s_add_u32 s57, s57, 1
  s_cmp_gt_u32 s57, 0x40000
  s_cbranch_scc1 L_tag_520103
  v_cmp_eq_u32 vcc, -1, v112
  s_cbranch_vccnz L_tag_520103_l
  s_nop 1
  s_branch L_tag_520103
L_tag_522104_r:
L_tag_522104_l:
  s_add_u32 s3, s58, 282624
  buffer_load_dwordx4 v[116:119], v213, s[28:31], s3 offen offset:3072 sc1
  s_waitcnt vmcnt(0)
  s_add_u32 s57, s57, 1
  s_cmp_gt_u32 s57, 0x40000
  s_cbranch_scc1 L_tag_522104
  v_cmp_eq_u32 vcc, -1, v116
  s_cbranch_vccnz L_tag_522104_l
  s_nop 1
  s_branch L_tag_522104
L_tag_524105_r:
L_tag_524105_l:
  s_add_u32 s3, s58, 286720
  buffer_load_dwordx4 v[156:159], v213, s[28:31], s3 offen offset:0 sc1
  s_waitcnt vmcnt(0)
  s_add_u32 s57, s57, 1
  s_cmp_gt_u32 s57, 0x40000
  s_cbranch_scc1 L_tag_524105
  v_cmp_eq_u32 vcc, -1, v156
  s_cbranch_vccnz L_tag_524105_l
  s_nop 1
  s_branch L_tag_524105
L_tag_526106_r:
L_tag_526106_l:
  s_add_u32 s3, s58, 286720
  buffer_load_dwordx4 v[160:163], v213, s[28:31], s3 offen offset:1024 sc1
  s_waitcnt vmcnt(0)
  s_add_u32 s57, s57, 1
  s_cmp_gt_u32 s57, 0x40000
  s_cbranch_scc1 L_tag_526106
  v_cmp_eq_u32 vcc, -1, v160
  s_cbranch_vccnz L_tag_526106_l
  s_nop 1
  s_branch L_tag_526106
L_tag_528107_r:
L_tag_528107_l:
  s_add_u32 s3, s58, 286720
  buffer_load_dwordx4 v[164:167], v213, s[28:31], s3 offen offset:2048 sc1
  s_waitcnt vmcnt(0)
  s_add_u32 s57, s57, 1
  s_cmp_gt_u32 s57, 0x40000
  s_cbranch_scc1 L_tag_528107
  v_cmp_eq_u32 vcc, -1, v164
  s_cbranch_vccnz L_tag_528107_l
  s_nop 1
  s_branch L_tag_528107
L_tag_530108_r:
L_tag_530108_l:
  s_add_u32 s3, s58, 286720
  buffer_load_dwordx4 v[168:171], v213, s[28:31], s3 offen offset:3072 sc1
  s_waitcnt vmcnt(0)
  s_add_u32 s57, s57, 1
  s_cmp_gt_u32 s57, 0x40000
  s_cbranch_scc1 L_tag_530108
  v_cmp_eq_u32 vcc, -1, v168
  s_cbranch_vccnz L_tag_530108_l
  s_nop 1
  s_branch L_tag_530108
L_tag_532109_r:
L_tag_532109_l:
  s_add_u32 s3, s58, 290816
  buffer_load_dwordx4 v[172:175], v213, s[28:31], s3 offen offset:0 sc1
  s_waitcnt vmcnt(0)
  s_add_u32 s57, s57, 1
  s_cmp_gt_u32 s57, 0x40000
  s_cbranch_scc1 L_tag_532109
  v_cmp_eq_u32 vcc, -1, v172
  s_cbranch_vccnz L_tag_532109_l
  s_nop 1
  s_branch L_tag_532109
L_tag_534110_r:
L_tag_534110_l:
  s_add_u32 s3, s58, 290816
  buffer_load_dwordx4 v[176:179], v213, s[28:31], s3 offen offset:1024 sc1
  s_waitcnt vmcnt(0)
  s_add_u32 s57, s57, 1
  s_cmp_gt_u32 s57, 0x40000
  s_cbranch_scc1 L_tag_534110
  v_cmp_eq_u32 vcc, -1, v176
  s_cbranch_vccnz L_tag_534110_l
  s_nop 1
  s_branch L_tag_534110
L_tag_536111_r:
L_tag_536111_l:
  s_add_u32 s3, s58, 290816
  buffer_load_dwordx4 v[180:183], v213, s[28:31], s3 offen offset:2048 sc1
  s_waitcnt vmcnt(0)
  s_add_u32 s57, s57, 1
  s_cmp_gt_u32 s57, 0x40000
  s_cbranch_scc1 L_tag_536111
  v_cmp_eq_u32 vcc, -1, v180
  s_cbranch_vccnz L_tag_536111_l
  s_nop 1
  s_branch L_tag_536111
L_tag_538112_r:
L_tag_538112_l:
  s_add_u32 s3, s58, 290816
  buffer_load_dwordx4 v[184:187], v213, s[28:31], s3 offen offset:3072 sc1
  s_waitcnt vmcnt(0)
  s_add_u32 s57, s57, 1
  s_cmp_gt_u32 s57, 0x40000
  s_cbranch_scc1 L_tag_538112
  v_cmp_eq_u32 vcc, -1, v184
  s_cbranch_vccnz L_tag_538112_l
  s_nop 1
  s_branch L_tag_538112
L_tag_540113_r:
L_tag_540113_l:
  s_add_u32 s3, s58, 393216
  buffer_load_dwordx4 v[108:111], v213, s[28:31], s3 offen offset:0 sc1
  s_waitcnt vmcnt(0)
  s_add_u32 s57, s57, 1
  s_cmp_gt_u32 s57, 0x40000
  s_cbranch_scc1 L_tag_540113
  v_cmp_eq_u32 vcc, -1, v108
  s_cbranch_vccnz L_tag_540113_l
  s_nop 1
  s_branch L_tag_540113
L_tag_672115_r:
L_tag_672115_l:
  s_add_u32 s3, s58, 393216
  buffer_load_dwordx4 v[112:115], v213, s[28:31], s3 offen offset:1024 sc1
  s_waitcnt vmcnt(0)
  s_add_u32 s57, s57, 1
  s_cmp_gt_u32 s57, 0x40000
  s_cbranch_scc1 L_tag_672115
  v_cmp_eq_u32 vcc, -1, v112
  s_cbranch_vccnz L_tag_672115_l
  s_nop 1
  s_branch L_tag_672115
L_tag_674116_r:
L_tag_674116_l:
  s_add_u32 s3, s58, 393216
  buffer_load_dwordx4 v[116:119], v213, s[28:31], s3 offen offset:2048 sc1
  s_waitcnt vmcnt(0)
  s_add_u32 s57, s57, 1
  s_cmp_gt_u32 s57, 0x40000
  s_cbranch_scc1 L_tag_674116
  v_cmp_eq_u32 vcc, -1, v116
  s_cbranch_vccnz L_tag_674116_l
  s_nop 1
  s_branch L_tag_674116
L_tag_676117_r:
L_tag_676117_l:
  s_add_u32 s3, s58, 393216
  buffer_load_dwordx4 v[156:159], v213, s[28:31], s3 offen offset:3072 sc1
  s_waitcnt vmcnt(0)
  s_add_u32 s57, s57, 1
  s_cmp_gt_u32 s57, 0x40000
  s_cbranch_scc1 L_tag_676117
  v_cmp_eq_u32 vcc, -1, v156
  s_cbranch_vccnz L_tag_676117_l
  s_nop 1
  s_branch L_tag_676117
L_tag_678118_r:
L_tag_678118_l:
  s_add_u32 s3, s58, 397312
  buffer_load_dwordx4 v[160:163], v213, s[28:31], s3 offen offset:0 sc1
  s_waitcnt vmcnt(0)
  s_add_u32 s57, s57, 1
  s_cmp_gt_u32 s57, 0x40000
  s_cbranch_scc1 L_tag_678118
  v_cmp_eq_u32 vcc, -1, v160
  s_cbranch_vccnz L_tag_678118_l
  s_nop 1
  s_branch L_tag_678118
L_tag_680119_r:
L_tag_680119_l:
  s_add_u32 s3, s58, 397312
  buffer_load_dwordx4 v[164:167], v213, s[28:31], s3 offen offset:1024 sc1
  s_waitcnt vmcnt(0)
  s_add_u32 s57, s57, 1
  s_cmp_gt_u32 s57, 0x40000
  s_cbranch_scc1 L_tag_680119
  v_cmp_eq_u32 vcc, -1, v164
  s_cbranch_vccnz L_tag_680119_l
  s_nop 1
  s_branch L_tag_680119
L_tag_682120_r:
L_tag_682120_l:
  s_add_u32 s3, s58, 397312
  buffer_load_dwordx4 v[168:171], v213, s[28:31], s3 offen offset:2048 sc1
  s_waitcnt vmcnt(0)
  s_add_u32 s57, s57, 1
  s_cmp_gt_u32 s57, 0x40000
  s_cbranch_scc1 L_tag_682120
  v_cmp_eq_u32 vcc, -1, v168
  s_cbranch_vccnz L_tag_682120_l
  s_nop 1
  s_branch L_tag_682120
L_tag_684121_r:
L_tag_684121_l:
  s_add_u32 s3, s58, 397312
  buffer_load_dwordx4 v[172:175], v213, s[28:31], s3 offen offset:3072 sc1
  s_waitcnt vmcnt(0)
  s_add_u32 s57, s57, 1
  s_cmp_gt_u32 s57, 0x40000
  s_cbranch_scc1 L_tag_684121
  v_cmp_eq_u32 vcc, -1, v172
  s_cbranch_vccnz L_tag_684121_l
  s_nop 1
  s_branch L_tag_684121
L_tag_686122_r:
L_tag_686122_l:
  s_add_u32 s3, s58, 401408
  buffer_load_dwordx4 v[176:179], v213, s[28:31], s3 offen offset:0 sc1
  s_waitcnt vmcnt(0)
  s_add_u32 s57, s57, 1
  s_cmp_gt_u32 s57, 0x40000
  s_cbranch_scc1 L_tag_686122
  v_cmp_eq_u32 vcc, -1, v176
  s_cbranch_vccnz L_tag_686122_l
  s_nop 1
  s_branch L_tag_686122
L_tag_688123_r:
L_tag_688123_l:
  s_add_u32 s3, s58, 401408
  buffer_load_dwordx4 v[180:183], v213, s[28:31], s3 offen offset:1024 sc1
  s_waitcnt vmcnt(0)
  s_add_u32 s57, s57, 1
  s_cmp_gt_u32 s57, 0x40000
  s_cbranch_scc1 L_tag_688123
  v_cmp_eq_u32 vcc, -1, v180
  s_cbranch_vccnz L_tag_688123_l
  s_nop 1
  s_branch L_tag_688123
L_tag_690124_r:
L_tag_690124_l:
  s_add_u32 s3, s58, 401408
  buffer_load_dwordx4 v[184:187], v213, s[28:31], s3 offen offset:2048 sc1
  s_waitcnt vmcnt(0)
  s_add_u32 s57, s57, 1
  s_cmp_gt_u32 s57, 0x40000
  s_cbranch_scc1 L_tag_690124
  v_cmp_eq_u32 vcc, -1, v184
  s_cbranch_vccnz L_tag_690124_l
  s_nop 1
  s_branch L_tag_690124
L_tag_692125_r:
L_tag_692125_l:
  s_add_u32 s3, s58, 401408
  buffer_load_dwordx4 v[108:111], v213, s[28:31], s3 offen offset:3072 sc1
  s_waitcnt vmcnt(0)
  s_add_u32 s57, s57, 1
  s_cmp_gt_u32 s57, 0x40000
  s_cbranch_scc1 L_tag_692125
  v_cmp_eq_u32 vcc, -1, v108
  s_cbranch_vccnz L_tag_692125_l
  s_nop 1
  s_branch L_tag_692125
L_tag_694126_r:
L_tag_694126_l:
  s_add_u32 s3, s58, 405504
  buffer_load_dwordx4 v[112:115], v213, s[28:31], s3 offen offset:0 sc1
  s_waitcnt vmcnt(0)
  s_add_u32 s57, s57, 1
  s_cmp_gt_u32 s57, 0x40000
  s_cbranch_scc1 L_tag_694126
  v_cmp_eq_u32 vcc, -1, v112
  s_cbranch_vccnz L_tag_694126_l
  s_nop 1
  s_branch L_tag_694126
L_tag_696127_r:
L_tag_696127_l:
  s_add_u32 s3, s58, 405504
  buffer_load_dwordx4 v[116:119], v213, s[28:31], s3 offen offset:1024 sc1
  s_waitcnt vmcnt(0)
  s_add_u32 s57, s57, 1
  s_cmp_gt_u32 s57, 0x40000
  s_cbranch_scc1 L_tag_696127
  v_cmp_eq_u32 vcc, -1, v116
  s_cbranch_vccnz L_tag_696127_l
  s_nop 1
  s_branch L_tag_696127
L_tag_698128_r:
L_tag_698128_l:
  s_add_u32 s3, s58, 405504
  buffer_load_dwordx4 v[156:159], v213, s[28:31], s3 offen offset:2048 sc1
  s_waitcnt vmcnt(0)
  s_add_u32 s57, s57, 1
  s_cmp_gt_u32 s57, 0x40000
  s_cbranch_scc1 L_tag_698128
  v_cmp_eq_u32 vcc, -1, v156
  s_cbranch_vccnz L_tag_698128_l
  s_nop 1
  s_branch L_tag_698128
L_tag_700129_r:
L_tag_700129_l:
  s_add_u32 s3, s58, 405504
  buffer_load_dwordx4 v[160:163], v213, s[28:31], s3 offen offset:3072 sc1
  s_waitcnt vmcnt(0)
  s_add_u32 s57, s57, 1
  s_cmp_gt_u32 s57, 0x40000
  s_cbranch_scc1 L_tag_700129
  v_cmp_eq_u32 vcc, -1, v160
  s_cbranch_vccnz L_tag_700129_l
  s_nop 1
  s_branch L_tag_700129
L_tag_702130_r:
L_tag_702130_l:
  s_add_u32 s3, s58, 409600
  buffer_load_dwordx4 v[164:167], v213, s[28:31], s3 offen offset:0 sc1
  s_waitcnt vmcnt(0)
  s_add_u32 s57, s57, 1
  s_cmp_gt_u32 s57, 0x40000
  s_cbranch_scc1 L_tag_702130
  v_cmp_eq_u32 vcc, -1, v164
  s_cbranch_vccnz L_tag_702130_l
  s_nop 1
  s_branch L_tag_702130
L_tag_704131_r:
L_tag_704131_l:
  s_add_u32 s3, s58, 409600
  buffer_load_dwordx4 v[168:171], v213, s[28:31], s3 offen offset:1024 sc1
  s_waitcnt vmcnt(0)
  s_add_u32 s57, s57, 1
  s_cmp_gt_u32 s57, 0x40000
  s_cbranch_scc1 L_tag_704131
  v_cmp_eq_u32 vcc, -1, v168
  s_cbranch_vccnz L_tag_704131_l
  s_nop 1
  s_branch L_tag_704131
L_tag_706132_r:
L_tag_706132_l:
  s_add_u32 s3, s58, 409600
  buffer_load_dwordx4 v[172:175], v213, s[28:31], s3 offen offset:2048 sc1
  s_waitcnt vmcnt(0)
  s_add_u32 s57, s57, 1
  s_cmp_gt_u32 s57, 0x40000
  s_cbranch_scc1 L_tag_706132
  v_cmp_eq_u32 vcc, -1, v172
  s_cbranch_vccnz L_tag_706132_l
  s_nop 1
  s_branch L_tag_706132
L_tag_708133_r:
L_tag_708133_l:
  s_add_u32 s3, s58, 409600
  buffer_load_dwordx4 v[176:179], v213, s[28:31], s3 offen offset:3072 sc1
  s_waitcnt vmcnt(0)
  s_add_u32 s57, s57, 1
  s_cmp_gt_u32 s57, 0x40000
  s_cbranch_scc1 L_tag_708133
  v_cmp_eq_u32 vcc, -1, v176
  s_cbranch_vccnz L_tag_708133_l
  s_nop 1
  s_branch L_tag_708133
L_tag_710134_r:
L_tag_710134_l:
  s_add_u32 s3, s58, 413696
  buffer_load_dwordx4 v[180:183], v213, s[28:31], s3 offen offset:0 sc1
  s_waitcnt vmcnt(0)
  s_add_u32 s57, s57, 1
  s_cmp_gt_u32 s57, 0x40000
  s_cbranch_scc1 L_tag_710134
  v_cmp_eq_u32 vcc, -1, v180
  s_cbranch_vccnz L_tag_710134_l
  s_nop 1
  s_branch L_tag_710134
L_tag_712135_r:
L_tag_712135_l:
  s_add_u32 s3, s58, 413696
  buffer_load_dwordx4 v[184:187], v213, s[28:31], s3 offen offset:1024 sc1
  s_waitcnt vmcnt(0)
  s_add_u32 s57, s57, 1
  s_cmp_gt_u32 s57, 0x40000
  s_cbranch_scc1 L_tag_712135
  v_cmp_eq_u32 vcc, -1, v184
  s_cbranch_vccnz L_tag_712135_l
  s_nop 1
  s_branch L_tag_712135
L_tag_714136_r:
L_tag_714136_l:
  s_add_u32 s3, s58, 413696
  buffer_load_dwordx4 v[108:111], v213, s[28:31], s3 offen offset:2048 sc1
  s_waitcnt vmcnt(0)
  s_add_u32 s57, s57, 1
  s_cmp_gt_u32 s57, 0x40000
  s_cbranch_scc1 L_tag_714136
  v_cmp_eq_u32 vcc, -1, v108
  s_cbranch_vccnz L_tag_714136_l
  s_nop 1
  s_branch L_tag_714136
L_tag_716137_r:
L_tag_716137_l:
  s_add_u32 s3, s58, 413696
  buffer_load_dwordx4 v[112:115], v213, s[28:31], s3 offen offset:3072 sc1
  s_waitcnt vmcnt(0)
  s_add_u32 s57, s57, 1
  s_cmp_gt_u32 s57, 0x40000
  s_cbranch_scc1 L_tag_716137
  v_cmp_eq_u32 vcc, -1, v112
  s_cbranch_vccnz L_tag_716137_l
  s_nop 1
  s_branch L_tag_716137
L_tag_718138_r:
L_tag_718138_l:
  s_add_u32 s3, s58, 417792
  buffer_load_dwordx4 v[116:119], v213, s[28:31], s3 offen offset:0 sc1
  s_waitcnt vmcnt(0)
  s_add_u32 s57, s57, 1
  s_cmp_gt_u32 s57, 0x40000
  s_cbranch_scc1 L_tag_718138
  v_cmp_eq_u32 vcc, -1, v116
  s_cbranch_vccnz L_tag_718138_l
  s_nop 1
  s_branch L_tag_718138
L_tag_720139_r:
L_tag_720139_l:
  s_add_u32 s3, s58, 417792
  buffer_load_dwordx4 v[156:159], v213, s[28:31], s3 offen offset:1024 sc1
  s_waitcnt vmcnt(0)
  s_add_u32 s57, s57, 1
  s_cmp_gt_u32 s57, 0x40000
  s_cbranch_scc1 L_tag_720139
  v_cmp_eq_u32 vcc, -1, v156
  s_cbranch_vccnz L_tag_720139_l
  s_nop 1
  s_branch L_tag_720139
L_tag_722140_r:
L_tag_722140_l:
  s_add_u32 s3, s58, 417792
  buffer_load_dwordx4 v[160:163], v213, s[28:31], s3 offen offset:2048 sc1
  s_waitcnt vmcnt(0)
  s_add_u32 s57, s57, 1
  s_cmp_gt_u32 s57, 0x40000
  s_cbranch_scc1 L_tag_722140
  v_cmp_eq_u32 vcc, -1, v160
  s_cbranch_vccnz L_tag_722140_l
  s_nop 1
  s_branch L_tag_722140
L_tag_724141_r:
L_tag_724141_l:
  s_add_u32 s3, s58, 417792
  buffer_load_dwordx4 v[164:167], v213, s[28:31], s3 offen offset:3072 sc1
  s_waitcnt vmcnt(0)
  s_add_u32 s57, s57, 1
  s_cmp_gt_u32 s57, 0x40000
  s_cbranch_scc1 L_tag_724141
  v_cmp_eq_u32 vcc, -1, v164
  s_cbranch_vccnz L_tag_724141_l
  s_nop 1
  s_branch L_tag_724141
L_tag_726142_r:
L_tag_726142_l:
  s_add_u32 s3, s58, 421888
  buffer_load_dwordx4 v[168:171], v213, s[28:31], s3 offen offset:0 sc1
  s_waitcnt vmcnt(0)
  s_add_u32 s57, s57, 1
  s_cmp_gt_u32 s57, 0x40000
  s_cbranch_scc1 L_tag_726142
  v_cmp_eq_u32 vcc, -1, v168
  s_cbranch_vccnz L_tag_726142_l
  s_nop 1
  s_branch L_tag_726142
L_tag_728143_r:
L_tag_728143_l:
  s_add_u32 s3, s58, 421888
  buffer_load_dwordx4 v[172:175], v213, s[28:31], s3 offen offset:1024 sc1
  s_waitcnt vmcnt(0)
  s_add_u32 s57, s57, 1
  s_cmp_gt_u32 s57, 0x40000
  s_cbranch_scc1 L_tag_728143
  v_cmp_eq_u32 vcc, -1, v172
  s_cbranch_vccnz L_tag_728143_l
  s_nop 1
  s_branch L_tag_728143
L_tag_730144_r:
L_tag_730144_l:
  s_add_u32 s3, s58, 421888
  buffer_load_dwordx4 v[176:179], v213, s[28:31], s3 offen offset:2048 sc1
  s_waitcnt vmcnt(0)
  s_add_u32 s57, s57, 1
  s_cmp_gt_u32 s57, 0x40000
  s_cbranch_scc1 L_tag_730144
  v_cmp_eq_u32 vcc, -1, v176
  s_cbranch_vccnz L_tag_730144_l
  s_nop 1
  s_branch L_tag_730144
L_tag_732145_r:
L_tag_732145_l:
  s_add_u32 s3, s58, 421888
  buffer_load_dwordx4 v[180:183], v213, s[28:31], s3 offen offset:3072 sc1
  s_waitcnt vmcnt(0)
  s_add_u32 s57, s57, 1
  s_cmp_gt_u32 s57, 0x40000
  s_cbranch_scc1 L_tag_732145
  v_cmp_eq_u32 vcc, -1, v180
  s_cbranch_vccnz L_tag_732145_l
  s_nop 1
  s_branch L_tag_732145
L_tag_876151_r:
L_tag_876151_l:
  s_add_u32 s3, s58, 0
  buffer_load_dwordx4 v[156:159], v231, s[28:31], s3 offen offset:0 sc1
  s_waitcnt vmcnt(0)
  s_add_u32 s57, s57, 1
  s_cmp_gt_u32 s57, 0x40000
  s_cbranch_scc1 L_tag_876151
  v_cmp_eq_u32 vcc, -1, v156
  s_cbranch_vccnz L_tag_876151_l
  s_nop 1
  s_branch L_tag_876151
L_tag_880152_r:
L_tag_880152_l:
  s_add_u32 s3, s58, 0
  buffer_load_dwordx4 v[160:163], v231, s[28:31], s3 offen offset:1024 sc1
  s_waitcnt vmcnt(0)
  s_add_u32 s57, s57, 1
  s_cmp_gt_u32 s57, 0x40000
  s_cbranch_scc1 L_tag_880152
  v_cmp_eq_u32 vcc, -1, v160
  s_cbranch_vccnz L_tag_880152_l
  s_nop 1
  s_branch L_tag_880152
L_tag_882153_r:
L_tag_882153_l:
  s_add_u32 s3, s58, 0
  buffer_load_dwordx4 v[164:167], v231, s[28:31], s3 offen offset:2048 sc1
  s_waitcnt vmcnt(0)
  s_add_u32 s57, s57, 1
  s_cmp_gt_u32 s57, 0x40000
  s_cbranch_scc1 L_tag_882153
  v_cmp_eq_u32 vcc, -1, v164
  s_cbranch_vccnz L_tag_882153_l
  s_nop 1
  s_branch L_tag_882153
L_tag_884154_r:
L_tag_884154_l:
  s_add_u32 s3, s58, 0
  buffer_load_dwordx4 v[168:171], v231, s[28:31], s3 offen offset:3072 sc1
  s_waitcnt vmcnt(0)
  s_add_u32 s57, s57, 1
  s_cmp_gt_u32 s57, 0x40000
  s_cbranch_scc1 L_tag_884154
  v_cmp_eq_u32 vcc, -1, v168
  s_cbranch_vccnz L_tag_884154_l
  s_nop 1
  s_branch L_tag_884154
L_tag_886155_r:
L_tag_886155_l:
  s_add_u32 s3, s58, 4096
  buffer_load_dwordx4 v[172:175], v231, s[28:31], s3 offen offset:0 sc1
  s_waitcnt vmcnt(0)
  s_add_u32 s57, s57, 1
  s_cmp_gt_u32 s57, 0x40000
  s_cbranch_scc1 L_tag_886155
  v_cmp_eq_u32 vcc, -1, v172
  s_cbranch_vccnz L_tag_886155_l
  s_nop 1
  s_branch L_tag_886155
L_tag_888156_r:
L_tag_888156_l:
  s_add_u32 s3, s58, 4096
  buffer_load_dwordx4 v[176:179], v231, s[28:31], s3 offen offset:1024 sc1
  s_waitcnt vmcnt(0)
  s_add_u32 s57, s57, 1
  s_cmp_gt_u32 s57, 0x40000
  s_cbranch_scc1 L_tag_888156
  v_cmp_eq_u32 vcc, -1, v176
  s_cbranch_vccnz L_tag_888156_l
  s_nop 1
  s_branch L_tag_888156
L_tag_890157_r:
L_tag_890157_l:
  s_add_u32 s3, s58, 4096
  buffer_load_dwordx4 v[180:183], v231, s[28:31], s3 offen offset:2048 sc1
  s_waitcnt vmcnt(0)
  s_add_u32 s57, s57, 1
  s_cmp_gt_u32 s57, 0x40000
  s_cbranch_scc1 L_tag_890157
  v_cmp_eq_u32 vcc, -1, v180
  s_cbranch_vccnz L_tag_890157_l
  s_nop 1
  s_branch L_tag_890157
L_tag_892158_r:
L_tag_892158_l:
  s_add_u32 s3, s58, 4096
  buffer_load_dwordx4 v[184:187], v231, s[28:31], s3 offen offset:3072 sc1
  s_waitcnt vmcnt(0)
  s_add_u32 s57, s57, 1
  s_cmp_gt_u32 s57, 0x40000
  s_cbranch_scc1 L_tag_892158
  v_cmp_eq_u32 vcc, -1, v184
  s_cbranch_vccnz L_tag_892158_l
  s_nop 1
  s_branch L_tag_892158
L_tag_894159_r:
L_tag_894159_l:
  s_add_u32 s3, s58, 8192
  buffer_load_dwordx4 v[108:111], v231, s[28:31], s3 offen offset:0 sc1
  s_waitcnt vmcnt(0)
  s_add_u32 s57, s57, 1
  s_cmp_gt_u32 s57, 0x40000
  s_cbranch_scc1 L_tag_894159
  v_cmp_eq_u32 vcc, -1, v108
  s_cbranch_vccnz L_tag_894159_l
  s_nop 1
  s_branch L_tag_894159
L_tag_896160_r:
L_tag_896160_l:
  s_add_u32 s3, s58, 8192
  buffer_load_dwordx4 v[112:115], v231, s[28:31], s3 offen offset:1024 sc1
  s_waitcnt vmcnt(0)
  s_add_u32 s57, s57, 1
  s_cmp_gt_u32 s57, 0x40000
  s_cbranch_scc1 L_tag_896160
  v_cmp_eq_u32 vcc, -1, v112
  s_cbranch_vccnz L_tag_896160_l
  s_nop 1
  s_branch L_tag_896160
L_tag_898161_r:
L_tag_898161_l:
  s_add_u32 s3, s58, 8192
  buffer_load_dwordx4 v[116:119], v231, s[28:31], s3 offen offset:2048 sc1
  s_waitcnt vmcnt(0)
  s_add_u32 s57, s57, 1
  s_cmp_gt_u32 s57, 0x40000
  s_cbranch_scc1 L_tag_898161
  v_cmp_eq_u32 vcc, -1, v116
  s_cbranch_vccnz L_tag_898161_l
  s_nop 1
  s_branch L_tag_898161
L_tag_900162_r:
L_tag_900162_l:
  s_add_u32 s3, s58, 8192
  buffer_load_dwordx4 v[156:159], v231, s[28:31], s3 offen offset:3072 sc1
  s_waitcnt vmcnt(0)
  s_add_u32 s57, s57, 1
  s_cmp_gt_u32 s57, 0x40000
  s_cbranch_scc1 L_tag_900162
  v_cmp_eq_u32 vcc, -1, v156
  s_cbranch_vccnz L_tag_900162_l
  s_nop 1
  s_branch L_tag_900162
L_tag_902163_r:
L_tag_902163_l:
  s_add_u32 s3, s58, 12288
  buffer_load_dwordx4 v[160:163], v231, s[28:31], s3 offen offset:0 sc1
  s_waitcnt vmcnt(0)
  s_add_u32 s57, s57, 1
  s_cmp_gt_u32 s57, 0x40000
  s_cbranch_scc1 L_tag_902163
  v_cmp_eq_u32 vcc, -1, v160
  s_cbranch_vccnz L_tag_902163_l
  s_nop 1
  s_branch L_tag_902163
L_tag_904164_r:
L_tag_904164_l:
  s_add_u32 s3, s58, 12288
  buffer_load_dwordx4 v[164:167], v231, s[28:31], s3 offen offset:1024 sc1
  s_waitcnt vmcnt(0)
  s_add_u32 s57, s57, 1
  s_cmp_gt_u32 s57, 0x40000
  s_cbranch_scc1 L_tag_904164
  v_cmp_eq_u32 vcc, -1, v164
  s_cbranch_vccnz L_tag_904164_l
  s_nop 1
  s_branch L_tag_904164
L_tag_906165_r:
L_tag_906165_l:
  s_add_u32 s3, s58, 12288
  buffer_load_dwordx4 v[168:171], v231, s[28:31], s3 offen offset:2048 sc1
  s_waitcnt vmcnt(0)
  s_add_u32 s57, s57, 1
  s_cmp_gt_u32 s57, 0x40000
  s_cbranch_scc1 L_tag_906165
  v_cmp_eq_u32 vcc, -1, v168
  s_cbranch_vccnz L_tag_906165_l
  s_nop 1
  s_branch L_tag_906165
L_tag_908166_r:
L_tag_908166_l:
  s_add_u32 s3, s58, 12288
  buffer_load_dwordx4 v[172:175], v231, s[28:31], s3 offen offset:3072 sc1
  s_waitcnt vmcnt(0)
  s_add_u32 s57, s57, 1
  s_cmp_gt_u32 s57, 0x40000
  s_cbranch_scc1 L_tag_908166
  v_cmp_eq_u32 vcc, -1, v172
  s_cbranch_vccnz L_tag_908166_l
  s_nop 1
  s_branch L_tag_908166
L_tag_912167_r:
L_tag_912167_l:
  s_add_u32 s3, s58, 16384
  buffer_load_dwordx4 v[176:179], v231, s[28:31], s3 offen offset:0 sc1
  s_waitcnt vmcnt(0)
  s_add_u32 s57, s57, 1
  s_cmp_gt_u32 s57, 0x40000
  s_cbranch_scc1 L_tag_912167
  v_cmp_eq_u32 vcc, -1, v176
  s_cbranch_vccnz L_tag_912167_l
  s_nop 1
  s_branch L_tag_912167
L_tag_914168_r:
L_tag_914168_l:
  s_add_u32 s3, s58, 16384
  buffer_load_dwordx4 v[180:183], v231, s[28:31], s3 offen offset:1024 sc1
  s_waitcnt vmcnt(0)
  s_add_u32 s57, s57, 1
  s_cmp_gt_u32 s57, 0x40000
  s_cbranch_scc1 L_tag_914168
  v_cmp_eq_u32 vcc, -1, v180
  s_cbranch_vccnz L_tag_914168_l
  s_nop 1
  s_branch L_tag_914168
L_tag_916169_r:
L_tag_916169_l:
  s_add_u32 s3, s58, 16384
  buffer_load_dwordx4 v[184:187], v231, s[28:31], s3 offen offset:2048 sc1
  s_waitcnt vmcnt(0)
  s_add_u32 s57, s57, 1
  s_cmp_gt_u32 s57, 0x40000
  s_cbranch_scc1 L_tag_916169
  v_cmp_eq_u32 vcc, -1, v184
  s_cbranch_vccnz L_tag_916169_l
  s_nop 1
  s_branch L_tag_916169
L_tag_918170_r:
L_tag_918170_l:
  s_add_u32 s3, s58, 16384
  buffer_load_dwordx4 v[108:111], v231, s[28:31], s3 offen offset:3072 sc1
  s_waitcnt vmcnt(0)
  s_add_u32 s57, s57, 1
  s_cmp_gt_u32 s57, 0x40000
  s_cbranch_scc1 L_tag_918170
  v_cmp_eq_u32 vcc, -1, v108
  s_cbranch_vccnz L_tag_918170_l
  s_nop 1
  s_branch L_tag_918170
L_tag_920171_r:
L_tag_920171_l:
  s_add_u32 s3, s58, 20480
  buffer_load_dwordx4 v[112:115], v231, s[28:31], s3 offen offset:0 sc1
  s_waitcnt vmcnt(0)
  s_add_u32 s57, s57, 1
  s_cmp_gt_u32 s57, 0x40000
  s_cbranch_scc1 L_tag_920171
  v_cmp_eq_u32 vcc, -1, v112
  s_cbranch_vccnz L_tag_920171_l
  s_nop 1
  s_branch L_tag_920171
L_tag_922172_r:
L_tag_922172_l:
  s_add_u32 s3, s58, 20480
  buffer_load_dwordx4 v[116:119], v231, s[28:31], s3 offen offset:1024 sc1
  s_waitcnt vmcnt(0)
  s_add_u32 s57, s57, 1
  s_cmp_gt_u32 s57, 0x40000
  s_cbranch_scc1 L_tag_922172
  v_cmp_eq_u32 vcc, -1, v116
  s_cbranch_vccnz L_tag_922172_l
  s_nop 1
  s_branch L_tag_922172
L_tag_924173_r:
L_tag_924173_l:
  s_add_u32 s3, s58, 20480
  buffer_load_dwordx4 v[156:159], v231, s[28:31], s3 offen offset:2048 sc1
  s_waitcnt vmcnt(0)
  s_add_u32 s57, s57, 1
  s_cmp_gt_u32 s57, 0x40000
  s_cbranch_scc1 L_tag_924173
  v_cmp_eq_u32 vcc, -1, v156
  s_cbranch_vccnz L_tag_924173_l
  s_nop 1
  s_branch L_tag_924173
L_tag_926174_r:
L_tag_926174_l:
  s_add_u32 s3, s58, 20480
  buffer_load_dwordx4 v[160:163], v231, s[28:31], s3 offen offset:3072 sc1
  s_waitcnt vmcnt(0)
  s_add_u32 s57, s57, 1
  s_cmp_gt_u32 s57, 0x40000
  s_cbranch_scc1 L_tag_926174
  v_cmp_eq_u32 vcc, -1, v160
  s_cbranch_vccnz L_tag_926174_l
  s_nop 1
  s_branch L_tag_926174
L_tag_930176_r:
L_tag_930176_l:
  s_add_u32 s3, s58, 24576
  buffer_load_dwordx4 v[164:167], v231, s[28:31], s3 offen offset:0 sc1
  s_waitcnt vmcnt(0)
  s_add_u32 s57, s57, 1
  s_cmp_gt_u32 s57, 0x40000
  s_cbranch_scc1 L_tag_930176
  v_cmp_eq_u32 vcc, -1, v164
  s_cbranch_vccnz L_tag_930176_l
  s_nop 1
  s_branch L_tag_930176
L_tag_932177_r:
L_tag_932177_l:
  s_add_u32 s3, s58, 24576
  buffer_load_dwordx4 v[168:171], v231, s[28:31], s3 offen offset:1024 sc1
  s_waitcnt vmcnt(0)
  s_add_u32 s57, s57, 1
  s_cmp_gt_u32 s57, 0x40000
  s_cbranch_scc1 L_tag_932177
  v_cmp_eq_u32 vcc, -1, v168
  s_cbranch_vccnz L_tag_932177_l
  s_nop 1
  s_branch L_tag_932177
L_tag_934178_r:
L_tag_934178_l:
  s_add_u32 s3, s58, 24576
  buffer_load_dwordx4 v[172:175], v231, s[28:31], s3 offen offset:2048 sc1
  s_waitcnt vmcnt(0)
  s_add_u32 s57, s57, 1
  s_cmp_gt_u32 s57, 0x40000
  s_cbranch_scc1 L_tag_934178
  v_cmp_eq_u32 vcc, -1, v172
  s_cbranch_vccnz L_tag_934178_l
  s_nop 1
  s_branch L_tag_934178
L_tag_936179_r:
L_tag_936179_l:
  s_add_u32 s3, s58, 24576
  buffer_load_dwordx4 v[176:179], v231, s[28:31], s3 offen offset:3072 sc1
  s_waitcnt vmcnt(0)
  s_add_u32 s57, s57, 1
  s_cmp_gt_u32 s57, 0x40000
  s_cbranch_scc1 L_tag_936179
  v_cmp_eq_u32 vcc, -1, v176
  s_cbranch_vccnz L_tag_936179_l
  s_nop 1
  s_branch L_tag_936179
L_tag_938180_r:
L_tag_938180_l:
  s_add_u32 s3, s58, 114688
  buffer_load_dwordx4 v[180:183], v231, s[28:31], s3 offen offset:0 sc1
  s_waitcnt vmcnt(0)
  s_add_u32 s57, s57, 1
  s_cmp_gt_u32 s57, 0x40000
  s_cbranch_scc1 L_tag_938180
  v_cmp_eq_u32 vcc, -1, v180
  s_cbranch_vccnz L_tag_938180_l
  s_nop 1
  s_branch L_tag_938180
L_tag_1108182_r:
L_tag_1108182_l:
  s_add_u32 s3, s58, 114688
  buffer_load_dwordx4 v[184:187], v231, s[28:31], s3 offen offset:1024 sc1
  s_waitcnt vmcnt(0)
  s_add_u32 s57, s57, 1
  s_cmp_gt_u32 s57, 0x40000
  s_cbranch_scc1 L_tag_1108182
  v_cmp_eq_u32 vcc, -1, v184
  s_cbranch_vccnz L_tag_1108182_l
  s_nop 1
  s_branch L_tag_1108182
L_tag_1110183_r:
L_tag_1110183_l:
  s_add_u32 s3, s58, 114688
  buffer_load_dwordx4 v[108:111], v231, s[28:31], s3 offen offset:2048 sc1
  s_waitcnt vmcnt(0)
  s_add_u32 s57, s57, 1
  s_cmp_gt_u32 s57, 0x40000
  s_cbranch_scc1 L_tag_1110183
  v_cmp_eq_u32 vcc, -1, v108
  s_cbranch_vccnz L_tag_1110183_l
  s_nop 1
  s_branch L_tag_1110183
L_tag_1112184_r:
L_tag_1112184_l:
  s_add_u32 s3, s58, 114688
  buffer_load_dwordx4 v[112:115], v231, s[28:31], s3 offen offset:3072 sc1
  s_waitcnt vmcnt(0)
  s_add_u32 s57, s57, 1
  s_cmp_gt_u32 s57, 0x40000
  s_cbranch_scc1 L_tag_1112184
  v_cmp_eq_u32 vcc, -1, v112
  s_cbranch_vccnz L_tag_1112184_l
  s_nop 1
  s_branch L_tag_1112184
L_tag_1114185_r:
L_tag_1114185_l:
  s_add_u32 s3, s58, 118784
  buffer_load_dwordx4 v[116:119], v231, s[28:31], s3 offen offset:0 sc1
  s_waitcnt vmcnt(0)
  s_add_u32 s57, s57, 1
  s_cmp_gt_u32 s57, 0x40000
  s_cbranch_scc1 L_tag_1114185
  v_cmp_eq_u32 vcc, -1, v116
  s_cbranch_vccnz L_tag_1114185_l
  s_nop 1
  s_branch L_tag_1114185
L_tag_1116186_r:
L_tag_1116186_l:
  s_add_u32 s3, s58, 118784
  buffer_load_dwordx4 v[156:159], v231, s[28:31], s3 offen offset:1024 sc1
  s_waitcnt vmcnt(0)
  s_add_u32 s57, s57, 1
  s_cmp_gt_u32 s57, 0x40000
  s_cbranch_scc1 L_tag_1116186
  v_cmp_eq_u32 vcc, -1, v156
  s_cbranch_vccnz L_tag_1116186_l
  s_nop 1
  s_branch L_tag_1116186
L_tag_1118187_r:
L_tag_1118187_l:
  s_add_u32 s3, s58, 118784
  buffer_load_dwordx4 v[160:163], v231, s[28:31], s3 offen offset:2048 sc1
  s_waitcnt vmcnt(0)
  s_add_u32 s57, s57, 1
  s_cmp_gt_u32 s57, 0x40000
  s_cbranch_scc1 L_tag_1118187
  v_cmp_eq_u32 vcc, -1, v160
  s_cbranch_vccnz L_tag_1118187_l
  s_nop 1
  s_branch L_tag_1118187
L_tag_1120188_r:
L_tag_1120188_l:
  s_add_u32 s3, s58, 118784
  buffer_load_dwordx4 v[164:167], v231, s[28:31], s3 offen offset:3072 sc1
  s_waitcnt vmcnt(0)
  s_add_u32 s57, s57, 1
  s_cmp_gt_u32 s57, 0x40000
  s_cbranch_scc1 L_tag_1120188
  v_cmp_eq_u32 vcc, -1, v164
  s_cbranch_vccnz L_tag_1120188_l
  s_nop 1
  s_branch L_tag_1120188
L_tag_1122189_r:
L_tag_1122189_l:
  s_add_u32 s3, s58, 122880
  buffer_load_dwordx4 v[168:171], v231, s[28:31], s3 offen offset:0 sc1
  s_waitcnt vmcnt(0)
  s_add_u32 s57, s57, 1
  s_cmp_gt_u32 s57, 0x40000
  s_cbranch_scc1 L_tag_1122189
  v_cmp_eq_u32 vcc, -1, v168
  s_cbranch_vccnz L_tag_1122189_l
  s_nop 1
  s_branch L_tag_1122189
L_tag_1124190_r:
L_tag_1124190_l:
  s_add_u32 s3, s58, 122880
  buffer_load_dwordx4 v[172:175], v231, s[28:31], s3 offen offset:1024 sc1
  s_waitcnt vmcnt(0)
  s_add_u32 s57, s57, 1
  s_cmp_gt_u32 s57, 0x40000
  s_cbranch_scc1 L_tag_1124190
  v_cmp_eq_u32 vcc, -1, v172
  s_cbranch_vccnz L_tag_1124190_l
  s_nop 1
  s_branch L_tag_1124190
L_tag_1126191_r:
L_tag_1126191_l:
  s_add_u32 s3, s58, 122880
  buffer_load_dwordx4 v[176:179], v231, s[28:31], s3 offen offset:2048 sc1
  s_waitcnt vmcnt(0)
  s_add_u32 s57, s57, 1
  s_cmp_gt_u32 s57, 0x40000
  s_cbranch_scc1 L_tag_1126191
  v_cmp_eq_u32 vcc, -1, v176
  s_cbranch_vccnz L_tag_1126191_l
  s_nop 1
  s_branch L_tag_1126191
L_tag_1128192_r:
L_tag_1128192_l:
  s_add_u32 s3, s58, 122880
  buffer_load_dwordx4 v[180:183], v231, s[28:31], s3 offen offset:3072 sc1
  s_waitcnt vmcnt(0)
  s_add_u32 s57, s57, 1
  s_cmp_gt_u32 s57, 0x40000
  s_cbranch_scc1 L_tag_1128192
  v_cmp_eq_u32 vcc, -1, v180
  s_cbranch_vccnz L_tag_1128192_l
  s_nop 1
  s_branch L_tag_1128192
L_tag_1130193_r:
L_tag_1130193_l:
  s_add_u32 s3, s58, 126976
  buffer_load_dwordx4 v[184:187], v231, s[28:31], s3 offen offset:0 sc1
  s_waitcnt vmcnt(0)
  s_add_u32 s57, s57, 1
  s_cmp_gt_u32 s57, 0x40000
  s_cbranch_scc1 L_tag_1130193
  v_cmp_eq_u32 vcc, -1, v184
  s_cbranch_vccnz L_tag_1130193_l
  s_nop 1
  s_branch L_tag_1130193
L_tag_1134194_r:
L_tag_1134194_l:
  s_add_u32 s3, s58, 126976
  buffer_load_dwordx4 v[108:111], v231, s[28:31], s3 offen offset:1024 sc1
  s_waitcnt vmcnt(0)
  s_add_u32 s57, s57, 1
  s_cmp_gt_u32 s57, 0x40000
  s_cbranch_scc1 L_tag_1134194
  v_cmp_eq_u32 vcc, -1, v108
  s_cbranch_vccnz L_tag_1134194_l
  s_nop 1
  s_branch L_tag_1134194
L_tag_1136195_r:
L_tag_1136195_l:
  s_add_u32 s3, s58, 126976
  buffer_load_dwordx4 v[112:115], v231, s[28:31], s3 offen offset:2048 sc1
  s_waitcnt vmcnt(0)
  s_add_u32 s57, s57, 1
  s_cmp_gt_u32 s57, 0x40000
  s_cbranch_scc1 L_tag_1136195
  v_cmp_eq_u32 vcc, -1, v112
  s_cbranch_vccnz L_tag_1136195_l
  s_nop 1
  s_branch L_tag_1136195
L_tag_1138196_r:
L_tag_1138196_l:
  s_add_u32 s3, s58, 126976
  buffer_load_dwordx4 v[116:119], v231, s[28:31], s3 offen offset:3072 sc1
  s_waitcnt vmcnt(0)
  s_add_u32 s57, s57, 1
  s_cmp_gt_u32 s57, 0x40000
  s_cbranch_scc1 L_tag_1138196
  v_cmp_eq_u32 vcc, -1, v116
  s_cbranch_vccnz L_tag_1138196_l
  s_nop 1
  s_branch L_tag_1138196
L_tag_1140197_r:
L_tag_1140197_l:
  s_add_u32 s3, s58, 131072
  buffer_load_dwordx4 v[156:159], v231, s[28:31], s3 offen offset:0 sc1
  s_waitcnt vmcnt(0)
  s_add_u32 s57, s57, 1
  s_cmp_gt_u32 s57, 0x40000
  s_cbranch_scc1 L_tag_1140197
  v_cmp_eq_u32 vcc, -1, v156
  s_cbranch_vccnz L_tag_1140197_l
  s_nop 1
  s_branch L_tag_1140197
L_tag_1142198_r:
L_tag_1142198_l:
  s_add_u32 s3, s58, 131072
  buffer_load_dwordx4 v[160:163], v231, s[28:31], s3 offen offset:1024 sc1
  s_waitcnt vmcnt(0)
  s_add_u32 s57, s57, 1
  s_cmp_gt_u32 s57, 0x40000
  s_cbranch_scc1 L_tag_1142198
  v_cmp_eq_u32 vcc, -1, v160
  s_cbranch_vccnz L_tag_1142198_l
  s_nop 1
  s_branch L_tag_1142198
L_tag_1144199_r:
L_tag_1144199_l:
  s_add_u32 s3, s58, 131072
  buffer_load_dwordx4 v[164:167], v231, s[28:31], s3 offen offset:2048 sc1
  s_waitcnt vmcnt(0)
  s_add_u32 s57, s57, 1
  s_cmp_gt_u32 s57, 0x40000
  s_cbranch_scc1 L_tag_1144199
  v_cmp_eq_u32 vcc, -1, v164
  s_cbranch_vccnz L_tag_1144199_l
  s_nop 1
  s_branch L_tag_1144199
L_tag_1146200_r:
L_tag_1146200_l:
  s_add_u32 s3, s58, 131072
  buffer_load_dwordx4 v[168:171], v231, s[28:31], s3 offen offset:3072 sc1
  s_waitcnt vmcnt(0)
  s_add_u32 s57, s57, 1
  s_cmp_gt_u32 s57, 0x40000
  s_cbranch_scc1 L_tag_1146200
  v_cmp_eq_u32 vcc, -1, v168
  s_cbranch_vccnz L_tag_1146200_l
  s_nop 1
  s_branch L_tag_1146200
L_tag_1148201_r:
L_tag_1148201_l:
  s_add_u32 s3, s58, 135168
  buffer_load_dwordx4 v[172:175], v231, s[28:31], s3 offen offset:0 sc1
  s_waitcnt vmcnt(0)
  s_add_u32 s57, s57, 1
  s_cmp_gt_u32 s57, 0x40000
  s_cbranch_scc1 L_tag_1148201
  v_cmp_eq_u32 vcc, -1, v172
  s_cbranch_vccnz L_tag_1148201_l
  s_nop 1
  s_branch L_tag_1148201
L_tag_1152203_r:
L_tag_1152203_l:
  s_add_u32 s3, s58, 135168
  buffer_load_dwordx4 v[176:179], v231, s[28:31], s3 offen offset:1024 sc1
  s_waitcnt vmcnt(0)
  s_add_u32 s57, s57, 1
  s_cmp_gt_u32 s57, 0x40000
  s_cbranch_scc1 L_tag_1152203
  v_cmp_eq_u32 vcc, -1, v176
  s_cbranch_vccnz L_tag_1152203_l
  s_nop 1
  s_branch L_tag_1152203
L_tag_1154204_r:
L_tag_1154204_l:
  s_add_u32 s3, s58, 135168
  buffer_load_dwordx4 v[180:183], v231, s[28:31], s3 offen offset:2048 sc1
  s_waitcnt vmcnt(0)
  s_add_u32 s57, s57, 1
  s_cmp_gt_u32 s57, 0x40000
  s_cbranch_scc1 L_tag_1154204
  v_cmp_eq_u32 vcc, -1, v180
  s_cbranch_vccnz L_tag_1154204_l
  s_nop 1
  s_branch L_tag_1154204
L_tag_1156205_r:
L_tag_1156205_l:
  s_add_u32 s3, s58, 135168
  buffer_load_dwordx4 v[184:187], v231, s[28:31], s3 offen offset:3072 sc1
  s_waitcnt vmcnt(0)
  s_add_u32 s57, s57, 1
  s_cmp_gt_u32 s57, 0x40000
  s_cbranch_scc1 L_tag_1156205
  v_cmp_eq_u32 vcc, -1, v184
  s_cbranch_vccnz L_tag_1156205_l
  s_nop 1
  s_branch L_tag_1156205
L_tag_1158206_r:
L_tag_1158206_l:
  s_add_u32 s3, s58, 139264
  buffer_load_dwordx4 v[108:111], v231, s[28:31], s3 offen offset:0 sc1
  s_waitcnt vmcnt(0)
  s_add_u32 s57, s57, 1
  s_cmp_gt_u32 s57, 0x40000
  s_cbranch_scc1 L_tag_1158206
  v_cmp_eq_u32 vcc, -1, v108
  s_cbranch_vccnz L_tag_1158206_l
  s_nop 1
  s_branch L_tag_1158206
L_tag_1160207_r:
L_tag_1160207_l:
  s_add_u32 s3, s58, 139264
  buffer_load_dwordx4 v[112:115], v231, s[28:31], s3 offen offset:1024 sc1
  s_waitcnt vmcnt(0)
  s_add_u32 s57, s57, 1
  s_cmp_gt_u32 s57, 0x40000
  s_cbranch_scc1 L_tag_1160207
  v_cmp_eq_u32 vcc, -1, v112
  s_cbranch_vccnz L_tag_1160207_l
  s_nop 1
  s_branch L_tag_1160207
L_tag_1162208_r:
L_tag_1162208_l:
  s_add_u32 s3, s58, 139264
  buffer_load_dwordx4 v[116:119], v231, s[28:31], s3 offen offset:2048 sc1
  s_waitcnt vmcnt(0)
  s_add_u32 s57, s57, 1
  s_cmp_gt_u32 s57, 0x40000
  s_cbranch_scc1 L_tag_1162208
  v_cmp_eq_u32 vcc, -1, v116
  s_cbranch_vccnz L_tag_1162208_l
  s_nop 1
  s_branch L_tag_1162208
L_tag_1164209_r:
L_tag_1164209_l:
  s_add_u32 s3, s58, 139264
  buffer_load_dwordx4 v[156:159], v231, s[28:31], s3 offen offset:3072 sc1
  s_waitcnt vmcnt(0)
  s_add_u32 s57, s57, 1
  s_cmp_gt_u32 s57, 0x40000
  s_cbranch_scc1 L_tag_1164209
  v_cmp_eq_u32 vcc, -1, v156
  s_cbranch_vccnz L_tag_1164209_l
  s_nop 1
  s_branch L_tag_1164209
L_tag_1166210_r:
L_tag_1166210_l:
  s_add_u32 s3, s58, 229376
  buffer_load_dwordx4 v[160:163], v231, s[28:31], s3 offen offset:0 sc1
  s_waitcnt vmcnt(0)
  s_add_u32 s57, s57, 1
  s_cmp_gt_u32 s57, 0x40000
  s_cbranch_scc1 L_tag_1166210
  v_cmp_eq_u32 vcc, -1, v160
  s_cbranch_vccnz L_tag_1166210_l
  s_nop 1
  s_branch L_tag_1166210
L_tag_1338212_r:
L_tag_1338212_l:
  s_add_u32 s3, s58, 229376
  buffer_load_dwordx4 v[164:167], v231, s[28:31], s3 offen offset:1024 sc1
  s_waitcnt vmcnt(0)
  s_add_u32 s57, s57, 1
  s_cmp_gt_u32 s57, 0x40000
  s_cbranch_scc1 L_tag_1338212
  v_cmp_eq_u32 vcc, -1, v164
  s_cbranch_vccnz L_tag_1338212_l
  s_nop 1
  s_branch L_tag_1338212
L_tag_1340213_r:
L_tag_1340213_l:
  s_add_u32 s3, s58, 229376
  buffer_load_dwordx4 v[168:171], v231, s[28:31], s3 offen offset:2048 sc1
  s_waitcnt vmcnt(0)
  s_add_u32 s57, s57, 1
  s_cmp_gt_u32 s57, 0x40000
  s_cbranch_scc1 L_tag_1340213
  v_cmp_eq_u32 vcc, -1, v168
  s_cbranch_vccnz L_tag_1340213_l
  s_nop 1
  s_branch L_tag_1340213
L_tag_1342214_r:
L_tag_1342214_l:
  s_add_u32 s3, s58, 229376
  buffer_load_dwordx4 v[172:175], v231, s[28:31], s3 offen offset:3072 sc1
  s_waitcnt vmcnt(0)
  s_add_u32 s57, s57, 1
  s_cmp_gt_u32 s57, 0x40000
  s_cbranch_scc1 L_tag_1342214
  v_cmp_eq_u32 vcc, -1, v172
  s_cbranch_vccnz L_tag_1342214_l
  s_nop 1
  s_branch L_tag_1342214
L_tag_1344215_r:
L_tag_1344215_l:
  s_add_u32 s3, s58, 233472
  buffer_load_dwordx4 v[176:179], v231, s[28:31], s3 offen offset:0 sc1
  s_waitcnt vmcnt(0)
  s_add_u32 s57, s57, 1
  s_cmp_gt_u32 s57, 0x40000
  s_cbranch_scc1 L_tag_1344215
  v_cmp_eq_u32 vcc, -1, v176
  s_cbranch_vccnz L_tag_1344215_l
  s_nop 1
  s_branch L_tag_1344215
L_tag_1346216_r:
L_tag_1346216_l:
  s_add_u32 s3, s58, 233472
  buffer_load_dwordx4 v[180:183], v231, s[28:31], s3 offen offset:1024 sc1
  s_waitcnt vmcnt(0)
  s_add_u32 s57, s57, 1
  s_cmp_gt_u32 s57, 0x40000
  s_cbranch_scc1 L_tag_1346216
  v_cmp_eq_u32 vcc, -1, v180
  s_cbranch_vccnz L_tag_1346216_l
  s_nop 1
  s_branch L_tag_1346216
L_tag_1348217_r:
L_tag_1348217_l:
  s_add_u32 s3, s58, 233472
  buffer_load_dwordx4 v[184:187], v231, s[28:31], s3 offen offset:2048 sc1
  s_waitcnt vmcnt(0)
  s_add_u32 s57, s57, 1
  s_cmp_gt_u32 s57, 0x40000
  s_cbranch_scc1 L_tag_1348217
  v_cmp_eq_u32 vcc, -1, v184
  s_cbranch_vccnz L_tag_1348217_l
  s_nop 1
  s_branch L_tag_1348217
L_tag_1350218_r:
L_tag_1350218_l:
  s_add_u32 s3, s58, 233472
  buffer_load_dwordx4 v[108:111], v231, s[28:31], s3 offen offset:3072 sc1
  s_waitcnt vmcnt(0)
  s_add_u32 s57, s57, 1
  s_cmp_gt_u32 s57, 0x40000
  s_cbranch_scc1 L_tag_1350218
  v_cmp_eq_u32 vcc, -1, v108
  s_cbranch_vccnz L_tag_1350218_l
  s_nop 1
  s_branch L_tag_1350218
L_tag_1352219_r:
L_tag_1352219_l:
  s_add_u32 s3, s58, 237568
  buffer_load_dwordx4 v[112:115], v231, s[28:31], s3 offen offset:0 sc1
  s_waitcnt vmcnt(0)
  s_add_u32 s57, s57, 1
  s_cmp_gt_u32 s57, 0x40000
  s_cbranch_scc1 L_tag_1352219
  v_cmp_eq_u32 vcc, -1, v112
  s_cbranch_vccnz L_tag_1352219_l
  s_nop 1
  s_branch L_tag_1352219
L_tag_1354220_r:
L_tag_1354220_l:
  s_add_u32 s3, s58, 237568
  buffer_load_dwordx4 v[116:119], v231, s[28:31], s3 offen offset:1024 sc1
  s_waitcnt vmcnt(0)
  s_add_u32 s57, s57, 1
  s_cmp_gt_u32 s57, 0x40000
  s_cbranch_scc1 L_tag_1354220
  v_cmp_eq_u32 vcc, -1, v116
  s_cbranch_vccnz L_tag_1354220_l
  s_nop 1
  s_branch L_tag_1354220
L_tag_1356221_r:
L_tag_1356221_l:
  s_add_u32 s3, s58, 237568
  buffer_load_dwordx4 v[156:159], v231, s[28:31], s3 offen offset:2048 sc1
  s_waitcnt vmcnt(0)
  s_add_u32 s57, s57, 1
  s_cmp_gt_u32 s57, 0x40000
  s_cbranch_scc1 L_tag_1356221
  v_cmp_eq_u32 vcc, -1, v156
  s_cbranch_vccnz L_tag_1356221_l
  s_nop 1
  s_branch L_tag_1356221
L_tag_1360222_r:
L_tag_1360222_l:
  s_add_u32 s3, s58, 237568
  buffer_load_dwordx4 v[160:163], v231, s[28:31], s3 offen offset:3072 sc1
  s_waitcnt vmcnt(0)
  s_add_u32 s57, s57, 1
  s_cmp_gt_u32 s57, 0x40000
  s_cbranch_scc1 L_tag_1360222
  v_cmp_eq_u32 vcc, -1, v160
  s_cbranch_vccnz L_tag_1360222_l
  s_nop 1
  s_branch L_tag_1360222
L_tag_1362223_r:
L_tag_1362223_l:
  s_add_u32 s3, s58, 241664
  buffer_load_dwordx4 v[164:167], v231, s[28:31], s3 offen offset:0 sc1
  s_waitcnt vmcnt(0)
  s_add_u32 s57, s57, 1
  s_cmp_gt_u32 s57, 0x40000
  s_cbranch_scc1 L_tag_1362223
  v_cmp_eq_u32 vcc, -1, v164
  s_cbranch_vccnz L_tag_1362223_l
  s_nop 1
  s_branch L_tag_1362223
L_tag_1364224_r:
L_tag_1364224_l:
  s_add_u32 s3, s58, 241664
  buffer_load_dwordx4 v[168:171], v231, s[28:31], s3 offen offset:1024 sc1
  s_waitcnt vmcnt(0)
  s_add_u32 s57, s57, 1
  s_cmp_gt_u32 s57, 0x40000
  s_cbranch_scc1 L_tag_1364224
  v_cmp_eq_u32 vcc, -1, v168
  s_cbranch_vccnz L_tag_1364224_l
  s_nop 1
  s_branch L_tag_1364224
L_tag_1366225_r:
L_tag_1366225_l:
  s_add_u32 s3, s58, 241664
  buffer_load_dwordx4 v[172:175], v231, s[28:31], s3 offen offset:2048 sc1
  s_waitcnt vmcnt(0)
  s_add_u32 s57, s57, 1
  s_cmp_gt_u32 s57, 0x40000
  s_cbranch_scc1 L_tag_1366225
  v_cmp_eq_u32 vcc, -1, v172
  s_cbranch_vccnz L_tag_1366225_l
  s_nop 1
  s_branch L_tag_1366225
L_tag_1368226_r:
L_tag_1368226_l:
  s_add_u32 s3, s58, 241664
  buffer_load_dwordx4 v[176:179], v231, s[28:31], s3 offen offset:3072 sc1
  s_waitcnt vmcnt(0)
  s_add_u32 s57, s57, 1
  s_cmp_gt_u32 s57, 0x40000
  s_cbranch_scc1 L_tag_1368226
  v_cmp_eq_u32 vcc, -1, v176
  s_cbranch_vccnz L_tag_1368226_l
  s_nop 1
  s_branch L_tag_1368226
L_tag_1370227_r:
L_tag_1370227_l:
  s_add_u32 s3, s58, 245760
  buffer_load_dwordx4 v[180:183], v231, s[28:31], s3 offen offset:0 sc1
  s_waitcnt vmcnt(0)
  s_add_u32 s57, s57, 1
  s_cmp_gt_u32 s57, 0x40000
  s_cbranch_scc1 L_tag_1370227
  v_cmp_eq_u32 vcc, -1, v180
  s_cbranch_vccnz L_tag_1370227_l
  s_nop 1
  s_branch L_tag_1370227
L_tag_1372228_r:
L_tag_1372228_l:
  s_add_u32 s3, s58, 245760
  buffer_load_dwordx4 v[184:187], v231, s[28:31], s3 offen offset:1024 sc1
  s_waitcnt vmcnt(0)
  s_add_u32 s57, s57, 1
  s_cmp_gt_u32 s57, 0x40000
  s_cbranch_scc1 L_tag_1372228
  v_cmp_eq_u32 vcc, -1, v184
  s_cbranch_vccnz L_tag_1372228_l
  s_nop 1
  s_branch L_tag_1372228
L_tag_1374229_r:
L_tag_1374229_l:
  s_add_u32 s3, s58, 245760
  buffer_load_dwordx4 v[108:111], v231, s[28:31], s3 offen offset:2048 sc1
  s_waitcnt vmcnt(0)
  s_add_u32 s57, s57, 1
  s_cmp_gt_u32 s57, 0x40000
  s_cbranch_scc1 L_tag_1374229
  v_cmp_eq_u32 vcc, -1, v108
  s_cbranch_vccnz L_tag_1374229_l
  s_nop 1
  s_branch L_tag_1374229
L_tag_1378231_r:
L_tag_1378231_l:
  s_add_u32 s3, s58, 245760
  buffer_load_dwordx4 v[112:115], v231, s[28:31], s3 offen offset:3072 sc1
  s_waitcnt vmcnt(0)
  s_add_u32 s57, s57, 1
  s_cmp_gt_u32 s57, 0x40000
  s_cbranch_scc1 L_tag_1378231
  v_cmp_eq_u32 vcc, -1, v112
  s_cbranch_vccnz L_tag_1378231_l
  s_nop 1
  s_branch L_tag_1378231
L_tag_1380232_r:
L_tag_1380232_l:
  s_add_u32 s3, s58, 249856
  buffer_load_dwordx4 v[116:119], v231, s[28:31], s3 offen offset:0 sc1
  s_waitcnt vmcnt(0)
  s_add_u32 s57, s57, 1
  s_cmp_gt_u32 s57, 0x40000
  s_cbranch_scc1 L_tag_1380232
  v_cmp_eq_u32 vcc, -1, v116
  s_cbranch_vccnz L_tag_1380232_l
  s_nop 1
  s_branch L_tag_1380232
L_tag_1382233_r:
L_tag_1382233_l:
  s_add_u32 s3, s58, 249856
  buffer_load_dwordx4 v[156:159], v231, s[28:31], s3 offen offset:1024 sc1
  s_waitcnt vmcnt(0)
  s_add_u32 s57, s57, 1
  s_cmp_gt_u32 s57, 0x40000
  s_cbranch_scc1 L_tag_1382233
  v_cmp_eq_u32 vcc, -1, v156
  s_cbranch_vccnz L_tag_1382233_l
  s_nop 1
  s_branch L_tag_1382233
L_tag_1384234_r:
L_tag_1384234_l:
  s_add_u32 s3, s58, 249856
  buffer_load_dwordx4 v[160:163], v231, s[28:31], s3 offen offset:2048 sc1
  s_waitcnt vmcnt(0)
  s_add_u32 s57, s57, 1
  s_cmp_gt_u32 s57, 0x40000
  s_cbranch_scc1 L_tag_1384234
  v_cmp_eq_u32 vcc, -1, v160
  s_cbranch_vccnz L_tag_1384234_l
  s_nop 1
  s_branch L_tag_1384234
L_tag_1386235_r:
L_tag_1386235_l:
  s_add_u32 s3, s58, 249856
  buffer_load_dwordx4 v[164:167], v231, s[28:31], s3 offen offset:3072 sc1
  s_waitcnt vmcnt(0)
  s_add_u32 s57, s57, 1
  s_cmp_gt_u32 s57, 0x40000
  s_cbranch_scc1 L_tag_1386235
  v_cmp_eq_u32 vcc, -1, v164
  s_cbranch_vccnz L_tag_1386235_l
  s_nop 1
  s_branch L_tag_1386235
L_tag_1388236_r:
L_tag_1388236_l:
  s_add_u32 s3, s58, 253952
  buffer_load_dwordx4 v[168:171], v231, s[28:31], s3 offen offset:0 sc1
  s_waitcnt vmcnt(0)
  s_add_u32 s57, s57, 1
  s_cmp_gt_u32 s57, 0x40000
  s_cbranch_scc1 L_tag_1388236
  v_cmp_eq_u32 vcc, -1, v168
  s_cbranch_vccnz L_tag_1388236_l
  s_nop 1
  s_branch L_tag_1388236
L_tag_1390237_r:
L_tag_1390237_l:
  s_add_u32 s3, s58, 253952
  buffer_load_dwordx4 v[172:175], v231, s[28:31], s3 offen offset:1024 sc1
  s_waitcnt vmcnt(0)
  s_add_u32 s57, s57, 1
  s_cmp_gt_u32 s57, 0x40000
  s_cbranch_scc1 L_tag_1390237
  v_cmp_eq_u32 vcc, -1, v172
  s_cbranch_vccnz L_tag_1390237_l
  s_nop 1
  s_branch L_tag_1390237
L_tag_1392238_r:
L_tag_1392238_l:
  s_add_u32 s3, s58, 253952
  buffer_load_dwordx4 v[176:179], v231, s[28:31], s3 offen offset:2048 sc1
  s_waitcnt vmcnt(0)
  s_add_u32 s57, s57, 1
  s_cmp_gt_u32 s57, 0x40000
  s_cbranch_scc1 L_tag_1392238
  v_cmp_eq_u32 vcc, -1, v176
  s_cbranch_vccnz L_tag_1392238_l
  s_nop 1
  s_branch L_tag_1392238
L_tag_1394239_r:
L_tag_1394239_l:
  s_add_u32 s3, s58, 253952
  buffer_load_dwordx4 v[180:183], v231, s[28:31], s3 offen offset:3072 sc1
  s_waitcnt vmcnt(0)
  s_add_u32 s57, s57, 1
  s_cmp_gt_u32 s57, 0x40000
  s_cbranch_scc1 L_tag_1394239
  v_cmp_eq_u32 vcc, -1, v180
  s_cbranch_vccnz L_tag_1394239_l
  s_nop 1
  s_branch L_tag_1394239
L_tag_1396240_r:
L_tag_1396240_l:
  s_add_u32 s3, s58, 344064
  buffer_load_dwordx4 v[184:187], v231, s[28:31], s3 offen offset:0 sc1
  s_waitcnt vmcnt(0)
  s_add_u32 s57, s57, 1
  s_cmp_gt_u32 s57, 0x40000
  s_cbranch_scc1 L_tag_1396240
  v_cmp_eq_u32 vcc, -1, v184
  s_cbranch_vccnz L_tag_1396240_l
  s_nop 1
  s_branch L_tag_1396240
L_tag_1568242_r:
L_tag_1568242_l:
  s_add_u32 s3, s58, 344064
  buffer_load_dwordx4 v[108:111], v231, s[28:31], s3 offen offset:1024 sc1
  s_waitcnt vmcnt(0)
  s_add_u32 s57, s57, 1
  s_cmp_gt_u32 s57, 0x40000
  s_cbranch_scc1 L_tag_1568242
  v_cmp_eq_u32 vcc, -1, v108
  s_cbranch_vccnz L_tag_1568242_l
  s_nop 1
  s_branch L_tag_1568242
L_tag_1570243_r:
L_tag_1570243_l:
  s_add_u32 s3, s58, 344064
  buffer_load_dwordx4 v[112:115], v231, s[28:31], s3 offen offset:2048 sc1
  s_waitcnt vmcnt(0)
  s_add_u32 s57, s57, 1
  s_cmp_gt_u32 s57, 0x40000
  s_cbranch_scc1 L_tag_1570243
  v_cmp_eq_u32 vcc, -1, v112
  s_cbranch_vccnz L_tag_1570243_l
  s_nop 1
  s_branch L_tag_1570243
L_tag_1572244_r:
L_tag_1572244_l:
  s_add_u32 s3, s58, 344064
  buffer_load_dwordx4 v[116:119], v231, s[28:31], s3 offen offset:3072 sc1
  s_waitcnt vmcnt(0)
  s_add_u32 s57, s57, 1
  s_cmp_gt_u32 s57, 0x40000
  s_cbranch_scc1 L_tag_1572244
  v_cmp_eq_u32 vcc, -1, v116
  s_cbranch_vccnz L_tag_1572244_l
  s_nop 1
  s_branch L_tag_1572244
L_tag_1574245_r:
L_tag_1574245_l:
  s_add_u32 s3, s58, 348160
  buffer_load_dwordx4 v[156:159], v231, s[28:31], s3 offen offset:0 sc1
  s_waitcnt vmcnt(0)
  s_add_u32 s57, s57, 1
  s_cmp_gt_u32 s57, 0x40000
  s_cbranch_scc1 L_tag_1574245
  v_cmp_eq_u32 vcc, -1, v156
  s_cbranch_vccnz L_tag_1574245_l
  s_nop 1
  s_branch L_tag_1574245
L_tag_1576246_r:
L_tag_1576246_l:
  s_add_u32 s3, s58, 348160
  buffer_load_dwordx4 v[160:163], v231, s[28:31], s3 offen offset:1024 sc1
  s_waitcnt vmcnt(0)
  s_add_u32 s57, s57, 1
  s_cmp_gt_u32 s57, 0x40000
  s_cbranch_scc1 L_tag_1576246
  v_cmp_eq_u32 vcc, -1, v160
  s_cbranch_vccnz L_tag_1576246_l
  s_nop 1
  s_branch L_tag_1576246
L_tag_1578247_r:
L_tag_1578247_l:
  s_add_u32 s3, s58, 348160
  buffer_load_dwordx4 v[164:167], v231, s[28:31], s3 offen offset:2048 sc1
  s_waitcnt vmcnt(0)
  s_add_u32 s57, s57, 1
  s_cmp_gt_u32 s57, 0x40000
  s_cbranch_scc1 L_tag_1578247
  v_cmp_eq_u32 vcc, -1, v164
  s_cbranch_vccnz L_tag_1578247_l
  s_nop 1
  s_branch L_tag_1578247
L_tag_1580248_r:
L_tag_1580248_l:
  s_add_u32 s3, s58, 348160
  buffer_load_dwordx4 v[168:171], v231, s[28:31], s3 offen offset:3072 sc1
  s_waitcnt vmcnt(0)
  s_add_u32 s57, s57, 1
  s_cmp_gt_u32 s57, 0x40000
  s_cbranch_scc1 L_tag_1580248
  v_cmp_eq_u32 vcc, -1, v168
  s_cbranch_vccnz L_tag_1580248_l
  s_nop 1
  s_branch L_tag_1580248
L_tag_1582249_r:
L_tag_1582249_l:
  s_add_u32 s3, s58, 352256
  buffer_load_dwordx4 v[172:175], v231, s[28:31], s3 offen offset:0 sc1
  s_waitcnt vmcnt(0)
  s_add_u32 s57, s57, 1
  s_cmp_gt_u32 s57, 0x40000
  s_cbranch_scc1 L_tag_1582249
  v_cmp_eq_u32 vcc, -1, v172
  s_cbranch_vccnz L_tag_1582249_l
  s_nop 1
  s_branch L_tag_1582249
L_tag_1584250_r:
L_tag_1584250_l:
  s_add_u32 s3, s58, 352256
  buffer_load_dwordx4 v[176:179], v231, s[28:31], s3 offen offset:1024 sc1
  s_waitcnt vmcnt(0)
  s_add_u32 s57, s57, 1
  s_cmp_gt_u32 s57, 0x40000
  s_cbranch_scc1 L_tag_1584250
  v_cmp_eq_u32 vcc, -1, v176
  s_cbranch_vccnz L_tag_1584250_l
  s_nop 1
  s_branch L_tag_1584250
L_tag_1588251_r:
L_tag_1588251_l:
  s_add_u32 s3, s58, 352256
  buffer_load_dwordx4 v[180:183], v231, s[28:31], s3 offen offset:2048 sc1
  s_waitcnt vmcnt(0)
  s_add_u32 s57, s57, 1
  s_cmp_gt_u32 s57, 0x40000
  s_cbranch_scc1 L_tag_1588251
  v_cmp_eq_u32 vcc, -1, v180
  s_cbranch_vccnz L_tag_1588251_l
  s_nop 1
  s_branch L_tag_1588251
L_tag_1590252_r:
L_tag_1590252_l:
  s_add_u32 s3, s58, 352256
  buffer_load_dwordx4 v[184:187], v231, s[28:31], s3 offen offset:3072 sc1
  s_waitcnt vmcnt(0)
  s_add_u32 s57, s57, 1
  s_cmp_gt_u32 s57, 0x40000
  s_cbranch_scc1 L_tag_1590252
  v_cmp_eq_u32 vcc, -1, v184
  s_cbranch_vccnz L_tag_1590252_l
  s_nop 1
  s_branch L_tag_1590252
L_tag_1592253_r:
L_tag_1592253_l:
  s_add_u32 s3, s58, 356352
  buffer_load_dwordx4 v[108:111], v231, s[28:31], s3 offen offset:0 sc1
  s_waitcnt vmcnt(0)
  s_add_u32 s57, s57, 1
  s_cmp_gt_u32 s57, 0x40000
  s_cbranch_scc1 L_tag_1592253
  v_cmp_eq_u32 vcc, -1, v108
  s_cbranch_vccnz L_tag_1592253_l
  s_nop 1
  s_branch L_tag_1592253
L_tag_1594254_r:
L_tag_1594254_l:
  s_add_u32 s3, s58, 356352
  buffer_load_dwordx4 v[112:115], v231, s[28:31], s3 offen offset:1024 sc1
  s_waitcnt vmcnt(0)
  s_add_u32 s57, s57, 1
  s_cmp_gt_u32 s57, 0x40000
  s_cbranch_scc1 L_tag_1594254
  v_cmp_eq_u32 vcc, -1, v112
  s_cbranch_vccnz L_tag_1594254_l
  s_nop 1
  s_branch L_tag_1594254
L_tag_1596255_r:
L_tag_1596255_l:
  s_add_u32 s3, s58, 356352
  buffer_load_dwordx4 v[116:119], v231, s[28:31], s3 offen offset:2048 sc1
  s_waitcnt vmcnt(0)
  s_add_u32 s57, s57, 1
  s_cmp_gt_u32 s57, 0x40000
  s_cbranch_scc1 L_tag_1596255
  v_cmp_eq_u32 vcc, -1, v116
  s_cbranch_vccnz L_tag_1596255_l
  s_nop 1
  s_branch L_tag_1596255
L_tag_1598256_r:
L_tag_1598256_l:
  s_add_u32 s3, s58, 356352
  buffer_load_dwordx4 v[156:159], v231, s[28:31], s3 offen offset:3072 sc1
  s_waitcnt vmcnt(0)
  s_add_u32 s57, s57, 1
  s_cmp_gt_u32 s57, 0x40000
  s_cbranch_scc1 L_tag_1598256
  v_cmp_eq_u32 vcc, -1, v156
  s_cbranch_vccnz L_tag_1598256_l
  s_nop 1
  s_branch L_tag_1598256
L_tag_1600257_r:
L_tag_1600257_l:
  s_add_u32 s3, s58, 360448
  buffer_load_dwordx4 v[160:163], v231, s[28:31], s3 offen offset:0 sc1
  s_waitcnt vmcnt(0)
  s_add_u32 s57, s57, 1
  s_cmp_gt_u32 s57, 0x40000
  s_cbranch_scc1 L_tag_1600257
  v_cmp_eq_u32 vcc, -1, v160
  s_cbranch_vccnz L_tag_1600257_l
  s_nop 1
  s_branch L_tag_1600257
L_tag_1602258_r:
L_tag_1602258_l:
  s_add_u32 s3, s58, 360448
  buffer_load_dwordx4 v[164:167], v231, s[28:31], s3 offen offset:1024 sc1
  s_waitcnt vmcnt(0)
  s_add_u32 s57, s57, 1
  s_cmp_gt_u32 s57, 0x40000
  s_cbranch_scc1 L_tag_1602258
  v_cmp_eq_u32 vcc, -1, v164
  s_cbranch_vccnz L_tag_1602258_l
  s_nop 1
  s_branch L_tag_1602258
L_tag_1604259_r:
L_tag_1604259_l:
  s_add_u32 s3, s58, 360448
  buffer_load_dwordx4 v[168:171], v231, s[28:31], s3 offen offset:2048 sc1
  s_waitcnt vmcnt(0)
  s_add_u32 s57, s57, 1
  s_cmp_gt_u32 s57, 0x40000
  s_cbranch_scc1 L_tag_1604259
  v_cmp_eq_u32 vcc, -1, v168
  s_cbranch_vccnz L_tag_1604259_l
  s_nop 1
  s_branch L_tag_1604259
L_tag_1606260_r:
L_tag_1606260_l:
  s_add_u32 s3, s58, 360448
  buffer_load_dwordx4 v[172:175], v231, s[28:31], s3 offen offset:3072 sc1
  s_waitcnt vmcnt(0)
  s_add_u32 s57, s57, 1
  s_cmp_gt_u32 s57, 0x40000
  s_cbranch_scc1 L_tag_1606260
  v_cmp_eq_u32 vcc, -1, v172
  s_cbranch_vccnz L_tag_1606260_l
  s_nop 1
  s_branch L_tag_1606260
L_tag_1610262_r:
L_tag_1610262_l:
  s_add_u32 s3, s58, 364544
  buffer_load_dwordx4 v[176:179], v231, s[28:31], s3 offen offset:0 sc1
  s_waitcnt vmcnt(0)
  s_add_u32 s57, s57, 1
  s_cmp_gt_u32 s57, 0x40000
  s_cbranch_scc1 L_tag_1610262
  v_cmp_eq_u32 vcc, -1, v176
  s_cbranch_vccnz L_tag_1610262_l
  s_nop 1
  s_branch L_tag_1610262
L_tag_1614263_r:
L_tag_1614263_l:
  s_add_u32 s3, s58, 364544
  buffer_load_dwordx4 v[180:183], v231, s[28:31], s3 offen offset:1024 sc1
  s_waitcnt vmcnt(0)
  s_add_u32 s57, s57, 1
  s_cmp_gt_u32 s57, 0x40000
  s_cbranch_scc1 L_tag_1614263
  v_cmp_eq_u32 vcc, -1, v180
  s_cbranch_vccnz L_tag_1614263_l
  s_nop 1
  s_branch L_tag_1614263
L_tag_1616264_r:
L_tag_1616264_l:
  s_add_u32 s3, s58, 364544
  buffer_load_dwordx4 v[184:187], v231, s[28:31], s3 offen offset:2048 sc1
  s_waitcnt vmcnt(0)
  s_add_u32 s57, s57, 1
  s_cmp_gt_u32 s57, 0x40000
  s_cbranch_scc1 L_tag_1616264
  v_cmp_eq_u32 vcc, -1, v184
  s_cbranch_vccnz L_tag_1616264_l
  s_nop 1
  s_branch L_tag_1616264
L_tag_1618265_r:
L_tag_1618265_l:
  s_add_u32 s3, s58, 364544
  buffer_load_dwordx4 v[108:111], v231, s[28:31], s3 offen offset:3072 sc1
  s_waitcnt vmcnt(0)
  s_add_u32 s57, s57, 1
  s_cmp_gt_u32 s57, 0x40000
  s_cbranch_scc1 L_tag_1618265
  v_cmp_eq_u32 vcc, -1, v108
  s_cbranch_vccnz L_tag_1618265_l
  s_nop 1
  s_branch L_tag_1618265
L_tag_1620266_r:
L_tag_1620266_l:
  s_add_u32 s3, s58, 368640
  buffer_load_dwordx4 v[112:115], v231, s[28:31], s3 offen offset:0 sc1
  s_waitcnt vmcnt(0)
  s_add_u32 s57, s57, 1
  s_cmp_gt_u32 s57, 0x40000
  s_cbranch_scc1 L_tag_1620266
  v_cmp_eq_u32 vcc, -1, v112
  s_cbranch_vccnz L_tag_1620266_l
  s_nop 1
  s_branch L_tag_1620266
L_tag_1624268_r:
L_tag_1624268_l:
  s_add_u32 s3, s58, 368640
  buffer_load_dwordx4 v[116:119], v231, s[28:31], s3 offen offset:1024 sc1
  s_waitcnt vmcnt(0)
  s_add_u32 s57, s57, 1
  s_cmp_gt_u32 s57, 0x40000
  s_cbranch_scc1 L_tag_1624268
  v_cmp_eq_u32 vcc, -1, v116
  s_cbranch_vccnz L_tag_1624268_l
  s_nop 1
  s_branch L_tag_1624268
L_tag_1626269_r:
L_tag_1626269_l:
  s_add_u32 s3, s58, 368640
  buffer_load_dwordx4 v[156:159], v231, s[28:31], s3 offen offset:2048 sc1
  s_waitcnt vmcnt(0)
  s_add_u32 s57, s57, 1
  s_cmp_gt_u32 s57, 0x40000
  s_cbranch_scc1 L_tag_1626269
  v_cmp_eq_u32 vcc, -1, v156
  s_cbranch_vccnz L_tag_1626269_l
  s_nop 1
  s_branch L_tag_1626269
L_tag_1628270_r:
L_tag_1628270_l:
  s_add_u32 s3, s58, 368640
  buffer_load_dwordx4 v[160:163], v231, s[28:31], s3 offen offset:3072 sc1
  s_waitcnt vmcnt(0)
  s_add_u32 s57, s57, 1
  s_cmp_gt_u32 s57, 0x40000
  s_cbranch_scc1 L_tag_1628270
  v_cmp_eq_u32 vcc, -1, v160
  s_cbranch_vccnz L_tag_1628270_l
  s_nop 1
  s_branch L_tag_1628270
L_tag_1838291_r:
L_tag_1838291_l:
  s_add_u32 s3, s58, 4096
  buffer_load_dwordx4 v[156:159], v213, s[28:31], s3 offen offset:0 sc1
  s_waitcnt vmcnt(0)
  s_add_u32 s57, s57, 1
  s_cmp_gt_u32 s57, 0x40000
  s_cbranch_scc1 L_tag_1838291
  v_cmp_eq_u32 vcc, -1, v156
  s_cbranch_vccnz L_tag_1838291_l
  s_nop 1
  s_branch L_tag_1838291
L_tag_1842292_r:
L_tag_1842292_l:
  s_add_u32 s3, s58, 4096
  buffer_load_dwordx4 v[160:163], v213, s[28:31], s3 offen offset:1024 sc1
  s_waitcnt vmcnt(0)
  s_add_u32 s57, s57, 1
  s_cmp_gt_u32 s57, 0x40000
  s_cbranch_scc1 L_tag_1842292
  v_cmp_eq_u32 vcc, -1, v160
  s_cbranch_vccnz L_tag_1842292_l
  s_nop 1
  s_branch L_tag_1842292
L_tag_1844293_r:
L_tag_1844293_l:
  s_add_u32 s3, s58, 4096
  buffer_load_dwordx4 v[164:167], v213, s[28:31], s3 offen offset:2048 sc1
  s_waitcnt vmcnt(0)
  s_add_u32 s57, s57, 1
  s_cmp_gt_u32 s57, 0x40000
  s_cbranch_scc1 L_tag_1844293
  v_cmp_eq_u32 vcc, -1, v164
  s_cbranch_vccnz L_tag_1844293_l
  s_nop 1
  s_branch L_tag_1844293
L_tag_1846294_r:
L_tag_1846294_l:
  s_add_u32 s3, s58, 4096
  buffer_load_dwordx4 v[168:171], v213, s[28:31], s3 offen offset:3072 sc1
  s_waitcnt vmcnt(0)
  s_add_u32 s57, s57, 1
  s_cmp_gt_u32 s57, 0x40000
  s_cbranch_scc1 L_tag_1846294
  v_cmp_eq_u32 vcc, -1, v168
  s_cbranch_vccnz L_tag_1846294_l
  s_nop 1
  s_branch L_tag_1846294
L_tag_1848295_r:
L_tag_1848295_l:
  s_add_u32 s3, s58, 12288
  buffer_load_dwordx4 v[172:175], v213, s[28:31], s3 offen offset:0 sc1
  s_waitcnt vmcnt(0)
  s_add_u32 s57, s57, 1
  s_cmp_gt_u32 s57, 0x40000
  s_cbranch_scc1 L_tag_1848295
  v_cmp_eq_u32 vcc, -1, v172
  s_cbranch_vccnz L_tag_1848295_l
  s_nop 1
  s_branch L_tag_1848295
L_tag_1850296_r:
L_tag_1850296_l:
  s_add_u32 s3, s58, 12288
  buffer_load_dwordx4 v[176:179], v213, s[28:31], s3 offen offset:1024 sc1
  s_waitcnt vmcnt(0)
  s_add_u32 s57, s57, 1
  s_cmp_gt_u32 s57, 0x40000
  s_cbranch_scc1 L_tag_1850296
  v_cmp_eq_u32 vcc, -1, v176
  s_cbranch_vccnz L_tag_1850296_l
  s_nop 1
  s_branch L_tag_1850296
L_tag_1852297_r:
L_tag_1852297_l:
  s_add_u32 s3, s58, 12288
  buffer_load_dwordx4 v[180:183], v213, s[28:31], s3 offen offset:2048 sc1
  s_waitcnt vmcnt(0)
  s_add_u32 s57, s57, 1
  s_cmp_gt_u32 s57, 0x40000
  s_cbranch_scc1 L_tag_1852297
  v_cmp_eq_u32 vcc, -1, v180
  s_cbranch_vccnz L_tag_1852297_l
  s_nop 1
  s_branch L_tag_1852297
L_tag_1854298_r:
L_tag_1854298_l:
  s_add_u32 s3, s58, 12288
  buffer_load_dwordx4 v[184:187], v213, s[28:31], s3 offen offset:3072 sc1
  s_waitcnt vmcnt(0)
  s_add_u32 s57, s57, 1
  s_cmp_gt_u32 s57, 0x40000
  s_cbranch_scc1 L_tag_1854298
  v_cmp_eq_u32 vcc, -1, v184
  s_cbranch_vccnz L_tag_1854298_l
  s_nop 1
  s_branch L_tag_1854298
L_tag_1856299_r:
L_tag_1856299_l:
  s_add_u32 s3, s58, 20480
  buffer_load_dwordx4 v[108:111], v213, s[28:31], s3 offen offset:0 sc1
  s_waitcnt vmcnt(0)
  s_add_u32 s57, s57, 1
  s_cmp_gt_u32 s57, 0x40000
  s_cbranch_scc1 L_tag_1856299
  v_cmp_eq_u32 vcc, -1, v108
  s_cbranch_vccnz L_tag_1856299_l
  s_nop 1
  s_branch L_tag_1856299
L_tag_1858300_r:
L_tag_1858300_l:
  s_add_u32 s3, s58, 20480
  buffer_load_dwordx4 v[112:115], v213, s[28:31], s3 offen offset:1024 sc1
  s_waitcnt vmcnt(0)
  s_add_u32 s57, s57, 1
  s_cmp_gt_u32 s57, 0x40000
  s_cbranch_scc1 L_tag_1858300
  v_cmp_eq_u32 vcc, -1, v112
  s_cbranch_vccnz L_tag_1858300_l
  s_nop 1
  s_branch L_tag_1858300
L_tag_1860301_r:
L_tag_1860301_l:
  s_add_u32 s3, s58, 20480
  buffer_load_dwordx4 v[116:119], v213, s[28:31], s3 offen offset:2048 sc1
  s_waitcnt vmcnt(0)
  s_add_u32 s57, s57, 1
  s_cmp_gt_u32 s57, 0x40000
  s_cbranch_scc1 L_tag_1860301
  v_cmp_eq_u32 vcc, -1, v116
  s_cbranch_vccnz L_tag_1860301_l
  s_nop 1
  s_branch L_tag_1860301
L_tag_1862302_r:
L_tag_1862302_l:
  s_add_u32 s3, s58, 20480
  buffer_load_dwordx4 v[156:159], v213, s[28:31], s3 offen offset:3072 sc1
  s_waitcnt vmcnt(0)
  s_add_u32 s57, s57, 1
  s_cmp_gt_u32 s57, 0x40000
  s_cbranch_scc1 L_tag_1862302
  v_cmp_eq_u32 vcc, -1, v156
  s_cbranch_vccnz L_tag_1862302_l
  s_nop 1
  s_branch L_tag_1862302
L_tag_1864303_r:
L_tag_1864303_l:
  s_add_u32 s3, s58, 28672
  buffer_load_dwordx4 v[160:163], v213, s[28:31], s3 offen offset:0 sc1
  s_waitcnt vmcnt(0)
  s_add_u32 s57, s57, 1
  s_cmp_gt_u32 s57, 0x40000
  s_cbranch_scc1 L_tag_1864303
  v_cmp_eq_u32 vcc, -1, v160
  s_cbranch_vccnz L_tag_1864303_l
  s_nop 1
  s_branch L_tag_1864303
L_tag_1866304_r:
L_tag_1866304_l:
  s_add_u32 s3, s58, 28672
  buffer_load_dwordx4 v[164:167], v213, s[28:31], s3 offen offset:1024 sc1
  s_waitcnt vmcnt(0)
  s_add_u32 s57, s57, 1
  s_cmp_gt_u32 s57, 0x40000
  s_cbranch_scc1 L_tag_1866304
  v_cmp_eq_u32 vcc, -1, v164
  s_cbranch_vccnz L_tag_1866304_l
  s_nop 1
  s_branch L_tag_1866304
L_tag_1870305_r:
L_tag_1870305_l:
  s_add_u32 s3, s58, 28672
  buffer_load_dwordx4 v[168:171], v213, s[28:31], s3 offen offset:2048 sc1
  s_waitcnt vmcnt(0)
  s_add_u32 s57, s57, 1
  s_cmp_gt_u32 s57, 0x40000
  s_cbranch_scc1 L_tag_1870305
  v_cmp_eq_u32 vcc, -1, v168
  s_cbranch_vccnz L_tag_1870305_l
  s_nop 1
  s_branch L_tag_1870305
L_tag_1872306_r:
L_tag_1872306_l:
  s_add_u32 s3, s58, 28672
  buffer_load_dwordx4 v[172:175], v213, s[28:31], s3 offen offset:3072 sc1
  s_waitcnt vmcnt(0)
  s_add_u32 s57, s57, 1
  s_cmp_gt_u32 s57, 0x40000
  s_cbranch_scc1 L_tag_1872306
  v_cmp_eq_u32 vcc, -1, v172
  s_cbranch_vccnz L_tag_1872306_l
  s_nop 1
  s_branch L_tag_1872306
L_tag_1874307_r:
L_tag_1874307_l:
  s_add_u32 s3, s58, 135168
  buffer_load_dwordx4 v[176:179], v213, s[28:31], s3 offen offset:0 sc1
  s_waitcnt vmcnt(0)
  s_add_u32 s57, s57, 1
  s_cmp_gt_u32 s57, 0x40000
  s_cbranch_scc1 L_tag_1874307
  v_cmp_eq_u32 vcc, -1, v176
  s_cbranch_vccnz L_tag_1874307_l
  s_nop 1
  s_branch L_tag_1874307
L_tag_1876308_r:
L_tag_1876308_l:
  s_add_u32 s3, s58, 135168
  buffer_load_dwordx4 v[180:183], v213, s[28:31], s3 offen offset:1024 sc1
  s_waitcnt vmcnt(0)
  s_add_u32 s57, s57, 1
  s_cmp_gt_u32 s57, 0x40000
  s_cbranch_scc1 L_tag_1876308
  v_cmp_eq_u32 vcc, -1, v180
  s_cbranch_vccnz L_tag_1876308_l
  s_nop 1
  s_branch L_tag_1876308
L_tag_1878309_r:
L_tag_1878309_l:
  s_add_u32 s3, s58, 135168
  buffer_load_dwordx4 v[184:187], v213, s[28:31], s3 offen offset:2048 sc1
  s_waitcnt vmcnt(0)
  s_add_u32 s57, s57, 1
  s_cmp_gt_u32 s57, 0x40000
  s_cbranch_scc1 L_tag_1878309
  v_cmp_eq_u32 vcc, -1, v184
  s_cbranch_vccnz L_tag_1878309_l
  s_nop 1
  s_branch L_tag_1878309
L_tag_1880310_r:
L_tag_1880310_l:
  s_add_u32 s3, s58, 135168
  buffer_load_dwordx4 v[108:111], v213, s[28:31], s3 offen offset:3072 sc1
  s_waitcnt vmcnt(0)
  s_add_u32 s57, s57, 1
  s_cmp_gt_u32 s57, 0x40000
  s_cbranch_scc1 L_tag_1880310
  v_cmp_eq_u32 vcc, -1, v108
  s_cbranch_vccnz L_tag_1880310_l
  s_nop 1
  s_branch L_tag_1880310
L_tag_1882311_r:
L_tag_1882311_l:
  s_add_u32 s3, s58, 143360
  buffer_load_dwordx4 v[112:115], v213, s[28:31], s3 offen offset:0 sc1
  s_waitcnt vmcnt(0)
  s_add_u32 s57, s57, 1
  s_cmp_gt_u32 s57, 0x40000
  s_cbranch_scc1 L_tag_1882311
  v_cmp_eq_u32 vcc, -1, v112
  s_cbranch_vccnz L_tag_1882311_l
  s_nop 1
  s_branch L_tag_1882311
L_tag_1884312_r:
L_tag_1884312_l:
  s_add_u32 s3, s58, 143360
  buffer_load_dwordx4 v[116:119], v213, s[28:31], s3 offen offset:1024 sc1
  s_waitcnt vmcnt(0)
  s_add_u32 s57, s57, 1
  s_cmp_gt_u32 s57, 0x40000
  s_cbranch_scc1 L_tag_1884312
  v_cmp_eq_u32 vcc, -1, v116
  s_cbranch_vccnz L_tag_1884312_l
  s_nop 1
  s_branch L_tag_1884312
L_tag_1888314_r:
L_tag_1888314_l:
  s_add_u32 s3, s58, 143360
  buffer_load_dwordx4 v[156:159], v213, s[28:31], s3 offen offset:2048 sc1
  s_waitcnt vmcnt(0)
  s_add_u32 s57, s57, 1
  s_cmp_gt_u32 s57, 0x40000
  s_cbranch_scc1 L_tag_1888314
  v_cmp_eq_u32 vcc, -1, v156
  s_cbranch_vccnz L_tag_1888314_l
  s_nop 1
  s_branch L_tag_1888314
L_tag_1890315_r:
L_tag_1890315_l:
  s_add_u32 s3, s58, 143360
  buffer_load_dwordx4 v[160:163], v213, s[28:31], s3 offen offset:3072 sc1
  s_waitcnt vmcnt(0)
  s_add_u32 s57, s57, 1
  s_cmp_gt_u32 s57, 0x40000
  s_cbranch_scc1 L_tag_1890315
  v_cmp_eq_u32 vcc, -1, v160
  s_cbranch_vccnz L_tag_1890315_l
  s_nop 1
  s_branch L_tag_1890315
L_tag_1892316_r:
L_tag_1892316_l:
  s_add_u32 s3, s58, 151552
  buffer_load_dwordx4 v[164:167], v213, s[28:31], s3 offen offset:0 sc1
  s_waitcnt vmcnt(0)
  s_add_u32 s57, s57, 1
  s_cmp_gt_u32 s57, 0x40000
  s_cbranch_scc1 L_tag_1892316
  v_cmp_eq_u32 vcc, -1, v164
  s_cbranch_vccnz L_tag_1892316_l
  s_nop 1
  s_branch L_tag_1892316
L_tag_1894317_r:
L_tag_1894317_l:
  s_add_u32 s3, s58, 151552
  buffer_load_dwordx4 v[168:171], v213, s[28:31], s3 offen offset:1024 sc1
  s_waitcnt vmcnt(0)
  s_add_u32 s57, s57, 1
  s_cmp_gt_u32 s57, 0x40000
  s_cbranch_scc1 L_tag_1894317
  v_cmp_eq_u32 vcc, -1, v168
  s_cbranch_vccnz L_tag_1894317_l
  s_nop 1
  s_branch L_tag_1894317
L_tag_1896318_r:
L_tag_1896318_l:
  s_add_u32 s3, s58, 151552
  buffer_load_dwordx4 v[172:175], v213, s[28:31], s3 offen offset:2048 sc1
  s_waitcnt vmcnt(0)
  s_add_u32 s57, s57, 1
  s_cmp_gt_u32 s57, 0x40000
  s_cbranch_scc1 L_tag_1896318
  v_cmp_eq_u32 vcc, -1, v172
  s_cbranch_vccnz L_tag_1896318_l
  s_nop 1
  s_branch L_tag_1896318
L_tag_1898319_r:
L_tag_1898319_l:
  s_add_u32 s3, s58, 151552
  buffer_load_dwordx4 v[176:179], v213, s[28:31], s3 offen offset:3072 sc1
  s_waitcnt vmcnt(0)
  s_add_u32 s57, s57, 1
  s_cmp_gt_u32 s57, 0x40000
  s_cbranch_scc1 L_tag_1898319
  v_cmp_eq_u32 vcc, -1, v176
  s_cbranch_vccnz L_tag_1898319_l
  s_nop 1
  s_branch L_tag_1898319
L_tag_1900320_r:
L_tag_1900320_l:
  s_add_u32 s3, s58, 0
  buffer_load_dwordx4 v[180:183], v213, s[28:31], s3 offen offset:0 sc1
  s_waitcnt vmcnt(0)
  s_add_u32 s57, s57, 1
  s_cmp_gt_u32 s57, 0x40000
  s_cbranch_scc1 L_tag_1900320
  v_cmp_eq_u32 vcc, -1, v180
  s_cbranch_vccnz L_tag_1900320_l
  s_nop 1
  s_branch L_tag_1900320
L_tag_1902321_r:
L_tag_1902321_l:
  s_add_u32 s3, s58, 0
  buffer_load_dwordx4 v[184:187], v213, s[28:31], s3 offen offset:1024 sc1
  s_waitcnt vmcnt(0)
  s_add_u32 s57, s57, 1
  s_cmp_gt_u32 s57, 0x40000
  s_cbranch_scc1 L_tag_1902321
  v_cmp_eq_u32 vcc, -1, v184
  s_cbranch_vccnz L_tag_1902321_l
  s_nop 1
  s_branch L_tag_1902321
L_tag_1904322_r:
L_tag_1904322_l:
  s_add_u32 s3, s58, 0
  buffer_load_dwordx4 v[108:111], v213, s[28:31], s3 offen offset:2048 sc1
  s_waitcnt vmcnt(0)
  s_add_u32 s57, s57, 1
  s_cmp_gt_u32 s57, 0x40000
  s_cbranch_scc1 L_tag_1904322
  v_cmp_eq_u32 vcc, -1, v108
  s_cbranch_vccnz L_tag_1904322_l
  s_nop 1
  s_branch L_tag_1904322
L_tag_1906323_r:
L_tag_1906323_l:
  s_add_u32 s3, s58, 0
  buffer_load_dwordx4 v[112:115], v213, s[28:31], s3 offen offset:3072 sc1
  s_waitcnt vmcnt(0)
  s_add_u32 s57, s57, 1
  s_cmp_gt_u32 s57, 0x40000
  s_cbranch_scc1 L_tag_1906323
  v_cmp_eq_u32 vcc, -1, v112
  s_cbranch_vccnz L_tag_1906323_l
  s_nop 1
  s_branch L_tag_1906323
L_tag_1908324_r:
L_tag_1908324_l:
  s_add_u32 s3, s58, 8192
  buffer_load_dwordx4 v[116:119], v213, s[28:31], s3 offen offset:0 sc1
  s_waitcnt vmcnt(0)
  s_add_u32 s57, s57, 1
  s_cmp_gt_u32 s57, 0x40000
  s_cbranch_scc1 L_tag_1908324
  v_cmp_eq_u32 vcc, -1, v116
  s_cbranch_vccnz L_tag_1908324_l
  s_nop 1
  s_branch L_tag_1908324
L_tag_1910325_r:
L_tag_1910325_l:
  s_add_u32 s3, s58, 8192
  buffer_load_dwordx4 v[156:159], v213, s[28:31], s3 offen offset:1024 sc1
  s_waitcnt vmcnt(0)
  s_add_u32 s57, s57, 1
  s_cmp_gt_u32 s57, 0x40000
  s_cbranch_scc1 L_tag_1910325
  v_cmp_eq_u32 vcc, -1, v156
  s_cbranch_vccnz L_tag_1910325_l
  s_nop 1
  s_branch L_tag_1910325
L_tag_1912326_r:
L_tag_1912326_l:
  s_add_u32 s3, s58, 8192
  buffer_load_dwordx4 v[160:163], v213, s[28:31], s3 offen offset:2048 sc1
  s_waitcnt vmcnt(0)
  s_add_u32 s57, s57, 1
  s_cmp_gt_u32 s57, 0x40000
  s_cbranch_scc1 L_tag_1912326
  v_cmp_eq_u32 vcc, -1, v160
  s_cbranch_vccnz L_tag_1912326_l
  s_nop 1
  s_branch L_tag_1912326
L_tag_1914327_r:
L_tag_1914327_l:
  s_add_u32 s3, s58, 8192
  buffer_load_dwordx4 v[164:167], v213, s[28:31], s3 offen offset:3072 sc1
  s_waitcnt vmcnt(0)
  s_add_u32 s57, s57, 1
  s_cmp_gt_u32 s57, 0x40000
  s_cbranch_scc1 L_tag_1914327
  v_cmp_eq_u32 vcc, -1, v164
  s_cbranch_vccnz L_tag_1914327_l
  s_nop 1
  s_branch L_tag_1914327
L_tag_1916328_r:
L_tag_1916328_l:
  s_add_u32 s3, s58, 16384
  buffer_load_dwordx4 v[168:171], v213, s[28:31], s3 offen offset:0 sc1
  s_waitcnt vmcnt(0)
  s_add_u32 s57, s57, 1
  s_cmp_gt_u32 s57, 0x40000
  s_cbranch_scc1 L_tag_1916328
  v_cmp_eq_u32 vcc, -1, v168
  s_cbranch_vccnz L_tag_1916328_l
  s_nop 1
  s_branch L_tag_1916328
L_tag_1918329_r:
L_tag_1918329_l:
  s_add_u32 s3, s58, 16384
  buffer_load_dwordx4 v[172:175], v213, s[28:31], s3 offen offset:1024 sc1
  s_waitcnt vmcnt(0)
  s_add_u32 s57, s57, 1
  s_cmp_gt_u32 s57, 0x40000
  s_cbranch_scc1 L_tag_1918329
  v_cmp_eq_u32 vcc, -1, v172
  s_cbranch_vccnz L_tag_1918329_l
  s_nop 1
  s_branch L_tag_1918329
L_tag_1920330_r:
L_tag_1920330_l:
  s_add_u32 s3, s58, 16384
  buffer_load_dwordx4 v[176:179], v213, s[28:31], s3 offen offset:2048 sc1
  s_waitcnt vmcnt(0)
  s_add_u32 s57, s57, 1
  s_cmp_gt_u32 s57, 0x40000
  s_cbranch_scc1 L_tag_1920330
  v_cmp_eq_u32 vcc, -1, v176
  s_cbranch_vccnz L_tag_1920330_l
  s_nop 1
  s_branch L_tag_1920330
L_tag_1922331_r:
L_tag_1922331_l:
  s_add_u32 s3, s58, 16384
  buffer_load_dwordx4 v[180:183], v213, s[28:31], s3 offen offset:3072 sc1
  s_waitcnt vmcnt(0)
  s_add_u32 s57, s57, 1
  s_cmp_gt_u32 s57, 0x40000
  s_cbranch_scc1 L_tag_1922331
  v_cmp_eq_u32 vcc, -1, v180
  s_cbranch_vccnz L_tag_1922331_l
  s_nop 1
  s_branch L_tag_1922331
L_tag_1924332_r:
L_tag_1924332_l:
  s_add_u32 s3, s58, 24576
  buffer_load_dwordx4 v[184:187], v213, s[28:31], s3 offen offset:0 sc1
  s_waitcnt vmcnt(0)
  s_add_u32 s57, s57, 1
  s_cmp_gt_u32 s57, 0x40000
  s_cbranch_scc1 L_tag_1924332
  v_cmp_eq_u32 vcc, -1, v184
  s_cbranch_vccnz L_tag_1924332_l
  s_nop 1
  s_branch L_tag_1924332
L_tag_1926333_r:
L_tag_1926333_l:
  s_add_u32 s3, s58, 24576
  buffer_load_dwordx4 v[108:111], v213, s[28:31], s3 offen offset:1024 sc1
  s_waitcnt vmcnt(0)
  s_add_u32 s57, s57, 1
  s_cmp_gt_u32 s57, 0x40000
  s_cbranch_scc1 L_tag_1926333
  v_cmp_eq_u32 vcc, -1, v108
  s_cbranch_vccnz L_tag_1926333_l
  s_nop 1
  s_branch L_tag_1926333
L_tag_1928334_r:
L_tag_1928334_l:
  s_add_u32 s3, s58, 24576
  buffer_load_dwordx4 v[112:115], v213, s[28:31], s3 offen offset:2048 sc1
  s_waitcnt vmcnt(0)
  s_add_u32 s57, s57, 1
  s_cmp_gt_u32 s57, 0x40000
  s_cbranch_scc1 L_tag_1928334
  v_cmp_eq_u32 vcc, -1, v112
  s_cbranch_vccnz L_tag_1928334_l
  s_nop 1
  s_branch L_tag_1928334
L_tag_1930335_r:
L_tag_1930335_l:
  s_add_u32 s3, s58, 24576
  buffer_load_dwordx4 v[116:119], v213, s[28:31], s3 offen offset:3072 sc1
  s_waitcnt vmcnt(0)
  s_add_u32 s57, s57, 1
  s_cmp_gt_u32 s57, 0x40000
  s_cbranch_scc1 L_tag_1930335
  v_cmp_eq_u32 vcc, -1, v116
  s_cbranch_vccnz L_tag_1930335_l
  s_nop 1
  s_branch L_tag_1930335
L_tag_1932336_r:
L_tag_1932336_l:
  s_add_u32 s3, s58, 159744
  buffer_load_dwordx4 v[156:159], v213, s[28:31], s3 offen offset:0 sc1
  s_waitcnt vmcnt(0)
  s_add_u32 s57, s57, 1
  s_cmp_gt_u32 s57, 0x40000
  s_cbranch_scc1 L_tag_1932336
  v_cmp_eq_u32 vcc, -1, v156
  s_cbranch_vccnz L_tag_1932336_l
  s_nop 1
  s_branch L_tag_1932336
L_tag_2064338_r:
L_tag_2064338_l:
  s_add_u32 s3, s58, 159744
  buffer_load_dwordx4 v[160:163], v213, s[28:31], s3 offen offset:1024 sc1
  s_waitcnt vmcnt(0)
  s_add_u32 s57, s57, 1
  s_cmp_gt_u32 s57, 0x40000
  s_cbranch_scc1 L_tag_2064338
  v_cmp_eq_u32 vcc, -1, v160
  s_cbranch_vccnz L_tag_2064338_l
  s_nop 1
  s_branch L_tag_2064338
L_tag_2066339_r:
L_tag_2066339_l:
  s_add_u32 s3, s58, 159744
  buffer_load_dwordx4 v[164:167], v213, s[28:31], s3 offen offset:2048 sc1
  s_waitcnt vmcnt(0)
  s_add_u32 s57, s57, 1
  s_cmp_gt_u32 s57, 0x40000
  s_cbranch_scc1 L_tag_2066339
  v_cmp_eq_u32 vcc, -1, v164
  s_cbranch_vccnz L_tag_2066339_l
  s_nop 1
  s_branch L_tag_2066339
L_tag_2068340_r:
L_tag_2068340_l:
  s_add_u32 s3, s58, 159744
  buffer_load_dwordx4 v[168:171], v213, s[28:31], s3 offen offset:3072 sc1
  s_waitcnt vmcnt(0)
  s_add_u32 s57, s57, 1
  s_cmp_gt_u32 s57, 0x40000
  s_cbranch_scc1 L_tag_2068340
  v_cmp_eq_u32 vcc, -1, v168
  s_cbranch_vccnz L_tag_2068340_l
  s_nop 1
  s_branch L_tag_2068340
L_tag_2070341_r:
L_tag_2070341_l:
  s_add_u32 s3, s58, 131072
  buffer_load_dwordx4 v[172:175], v213, s[28:31], s3 offen offset:0 sc1
  s_waitcnt vmcnt(0)
  s_add_u32 s57, s57, 1
  s_cmp_gt_u32 s57, 0x40000
  s_cbranch_scc1 L_tag_2070341
  v_cmp_eq_u32 vcc, -1, v172
  s_cbranch_vccnz L_tag_2070341_l
  s_nop 1
  s_branch L_tag_2070341
L_tag_2072342_r:
L_tag_2072342_l:
  s_add_u32 s3, s58, 131072
  buffer_load_dwordx4 v[176:179], v213, s[28:31], s3 offen offset:1024 sc1
  s_waitcnt vmcnt(0)
  s_add_u32 s57, s57, 1
  s_cmp_gt_u32 s57, 0x40000
  s_cbranch_scc1 L_tag_2072342
  v_cmp_eq_u32 vcc, -1, v176
  s_cbranch_vccnz L_tag_2072342_l
  s_nop 1
  s_branch L_tag_2072342
L_tag_2074343_r:
L_tag_2074343_l:
  s_add_u32 s3, s58, 131072
  buffer_load_dwordx4 v[180:183], v213, s[28:31], s3 offen offset:2048 sc1
  s_waitcnt vmcnt(0)
  s_add_u32 s57, s57, 1
  s_cmp_gt_u32 s57, 0x40000
  s_cbranch_scc1 L_tag_2074343
  v_cmp_eq_u32 vcc, -1, v180
  s_cbranch_vccnz L_tag_2074343_l
  s_nop 1
  s_branch L_tag_2074343
L_tag_2076344_r:
L_tag_2076344_l:
  s_add_u32 s3, s58, 131072
  buffer_load_dwordx4 v[184:187], v213, s[28:31], s3 offen offset:3072 sc1
  s_waitcnt vmcnt(0)
  s_add_u32 s57, s57, 1
  s_cmp_gt_u32 s57, 0x40000
  s_cbranch_scc1 L_tag_2076344
  v_cmp_eq_u32 vcc, -1, v184
  s_cbranch_vccnz L_tag_2076344_l
  s_nop 1
  s_branch L_tag_2076344
L_tag_2078345_r:
L_tag_2078345_l:
  s_add_u32 s3, s58, 139264
  buffer_load_dwordx4 v[108:111], v213, s[28:31], s3 offen offset:0 sc1
  s_waitcnt vmcnt(0)
  s_add_u32 s57, s57, 1
  s_cmp_gt_u32 s57, 0x40000
  s_cbranch_scc1 L_tag_2078345
  v_cmp_eq_u32 vcc, -1, v108
  s_cbranch_vccnz L_tag_2078345_l
  s_nop 1
  s_branch L_tag_2078345
L_tag_2080346_r:
L_tag_2080346_l:
  s_add_u32 s3, s58, 139264
  buffer_load_dwordx4 v[112:115], v213, s[28:31], s3 offen offset:1024 sc1
  s_waitcnt vmcnt(0)
  s_add_u32 s57, s57, 1
  s_cmp_gt_u32 s57, 0x40000
  s_cbranch_scc1 L_tag_2080346
  v_cmp_eq_u32 vcc, -1, v112
  s_cbranch_vccnz L_tag_2080346_l
  s_nop 1
  s_branch L_tag_2080346
L_tag_2082347_r:
L_tag_2082347_l:
  s_add_u32 s3, s58, 139264
  buffer_load_dwordx4 v[116:119], v213, s[28:31], s3 offen offset:2048 sc1
  s_waitcnt vmcnt(0)
  s_add_u32 s57, s57, 1
  s_cmp_gt_u32 s57, 0x40000
  s_cbranch_scc1 L_tag_2082347
  v_cmp_eq_u32 vcc, -1, v116
  s_cbranch_vccnz L_tag_2082347_l
  s_nop 1
  s_branch L_tag_2082347
L_tag_2084348_r:
L_tag_2084348_l:
  s_add_u32 s3, s58, 139264
  buffer_load_dwordx4 v[156:159], v213, s[28:31], s3 offen offset:3072 sc1
  s_waitcnt vmcnt(0)
  s_add_u32 s57, s57, 1
  s_cmp_gt_u32 s57, 0x40000
  s_cbranch_scc1 L_tag_2084348
  v_cmp_eq_u32 vcc, -1, v156
  s_cbranch_vccnz L_tag_2084348_l
  s_nop 1
  s_branch L_tag_2084348
L_tag_2086349_r:
L_tag_2086349_l:
  s_add_u32 s3, s58, 147456
  buffer_load_dwordx4 v[160:163], v213, s[28:31], s3 offen offset:0 sc1
  s_waitcnt vmcnt(0)
  s_add_u32 s57, s57, 1
  s_cmp_gt_u32 s57, 0x40000
  s_cbranch_scc1 L_tag_2086349
  v_cmp_eq_u32 vcc, -1, v160
  s_cbranch_vccnz L_tag_2086349_l
  s_nop 1
  s_branch L_tag_2086349
L_tag_2088350_r:
L_tag_2088350_l:
  s_add_u32 s3, s58, 147456
  buffer_load_dwordx4 v[164:167], v213, s[28:31], s3 offen offset:1024 sc1
  s_waitcnt vmcnt(0)
  s_add_u32 s57, s57, 1
  s_cmp_gt_u32 s57, 0x40000
  s_cbranch_scc1 L_tag_2088350
  v_cmp_eq_u32 vcc, -1, v164
  s_cbranch_vccnz L_tag_2088350_l
  s_nop 1
  s_branch L_tag_2088350
L_tag_2090351_r:
L_tag_2090351_l:
  s_add_u32 s3, s58, 147456
  buffer_load_dwordx4 v[168:171], v213, s[28:31], s3 offen offset:2048 sc1
  s_waitcnt vmcnt(0)
  s_add_u32 s57, s57, 1
  s_cmp_gt_u32 s57, 0x40000
  s_cbranch_scc1 L_tag_2090351
  v_cmp_eq_u32 vcc, -1, v168
  s_cbranch_vccnz L_tag_2090351_l
  s_nop 1
  s_branch L_tag_2090351
L_tag_2092352_r:
L_tag_2092352_l:
  s_add_u32 s3, s58, 147456
  buffer_load_dwordx4 v[172:175], v213, s[28:31], s3 offen offset:3072 sc1
  s_waitcnt vmcnt(0)
  s_add_u32 s57, s57, 1
  s_cmp_gt_u32 s57, 0x40000
  s_cbranch_scc1 L_tag_2092352
  v_cmp_eq_u32 vcc, -1, v172
  s_cbranch_vccnz L_tag_2092352_l
  s_nop 1
  s_branch L_tag_2092352
L_tag_2094353_r:
L_tag_2094353_l:
  s_add_u32 s3, s58, 155648
  buffer_load_dwordx4 v[176:179], v213, s[28:31], s3 offen offset:0 sc1
  s_waitcnt vmcnt(0)
  s_add_u32 s57, s57, 1
  s_cmp_gt_u32 s57, 0x40000
  s_cbranch_scc1 L_tag_2094353
  v_cmp_eq_u32 vcc, -1, v176
  s_cbranch_vccnz L_tag_2094353_l
  s_nop 1
  s_branch L_tag_2094353
L_tag_2096354_r:
L_tag_2096354_l:
  s_add_u32 s3, s58, 155648
  buffer_load_dwordx4 v[180:183], v213, s[28:31], s3 offen offset:1024 sc1
  s_waitcnt vmcnt(0)
  s_add_u32 s57, s57, 1
  s_cmp_gt_u32 s57, 0x40000
  s_cbranch_scc1 L_tag_2096354
  v_cmp_eq_u32 vcc, -1, v180
  s_cbranch_vccnz L_tag_2096354_l
  s_nop 1
  s_branch L_tag_2096354
L_tag_2098355_r:
L_tag_2098355_l:
  s_add_u32 s3, s58, 155648
  buffer_load_dwordx4 v[184:187], v213, s[28:31], s3 offen offset:2048 sc1
  s_waitcnt vmcnt(0)
  s_add_u32 s57, s57, 1
  s_cmp_gt_u32 s57, 0x40000
  s_cbranch_scc1 L_tag_2098355
  v_cmp_eq_u32 vcc, -1, v184
  s_cbranch_vccnz L_tag_2098355_l
  s_nop 1
  s_branch L_tag_2098355
L_tag_2100356_r:
L_tag_2100356_l:
  s_add_u32 s3, s58, 155648
  buffer_load_dwordx4 v[108:111], v213, s[28:31], s3 offen offset:3072 sc1
  s_waitcnt vmcnt(0)
  s_add_u32 s57, s57, 1
  s_cmp_gt_u32 s57, 0x40000
  s_cbranch_scc1 L_tag_2100356
  v_cmp_eq_u32 vcc, -1, v108
  s_cbranch_vccnz L_tag_2100356_l
  s_nop 1
  s_branch L_tag_2100356
L_tag_2102357_r:
L_tag_2102357_l:
  s_add_u32 s3, s58, 262144
  buffer_load_dwordx4 v[112:115], v213, s[28:31], s3 offen offset:0 sc1
  s_waitcnt vmcnt(0)
  s_add_u32 s57, s57, 1
  s_cmp_gt_u32 s57, 0x40000
  s_cbranch_scc1 L_tag_2102357
  v_cmp_eq_u32 vcc, -1, v112
  s_cbranch_vccnz L_tag_2102357_l
  s_nop 1
  s_branch L_tag_2102357
L_tag_2232358_r:
L_tag_2232358_l:
  s_add_u32 s3, s58, 262144
  buffer_load_dwordx4 v[116:119], v213, s[28:31], s3 offen offset:1024 sc1
  s_waitcnt vmcnt(0)
  s_add_u32 s57, s57, 1
  s_cmp_gt_u32 s57, 0x40000
  s_cbranch_scc1 L_tag_2232358
  v_cmp_eq_u32 vcc, -1, v116
  s_cbranch_vccnz L_tag_2232358_l
  s_nop 1
  s_branch L_tag_2232358
L_tag_2234359_r:
L_tag_2234359_l:
  s_add_u32 s3, s58, 262144
  buffer_load_dwordx4 v[156:159], v213, s[28:31], s3 offen offset:2048 sc1
  s_waitcnt vmcnt(0)
  s_add_u32 s57, s57, 1
  s_cmp_gt_u32 s57, 0x40000
  s_cbranch_scc1 L_tag_2234359
  v_cmp_eq_u32 vcc, -1, v156
  s_cbranch_vccnz L_tag_2234359_l
  s_nop 1
  s_branch L_tag_2234359
L_tag_2236360_r:
L_tag_2236360_l:
  s_add_u32 s3, s58, 262144
  buffer_load_dwordx4 v[160:163], v213, s[28:31], s3 offen offset:3072 sc1
  s_waitcnt vmcnt(0)
  s_add_u32 s57, s57, 1
  s_cmp_gt_u32 s57, 0x40000
  s_cbranch_scc1 L_tag_2236360
  v_cmp_eq_u32 vcc, -1, v160
  s_cbranch_vccnz L_tag_2236360_l
  s_nop 1
  s_branch L_tag_2236360
L_tag_2238361_r:
L_tag_2238361_l:
  s_add_u32 s3, s58, 266240
  buffer_load_dwordx4 v[164:167], v213, s[28:31], s3 offen offset:0 sc1
  s_waitcnt vmcnt(0)
  s_add_u32 s57, s57, 1
  s_cmp_gt_u32 s57, 0x40000
  s_cbranch_scc1 L_tag_2238361
  v_cmp_eq_u32 vcc, -1, v164
  s_cbranch_vccnz L_tag_2238361_l
  s_nop 1
  s_branch L_tag_2238361
L_tag_2240362_r:
L_tag_2240362_l:
  s_add_u32 s3, s58, 266240
  buffer_load_dwordx4 v[168:171], v213, s[28:31], s3 offen offset:1024 sc1
  s_waitcnt vmcnt(0)
  s_add_u32 s57, s57, 1
  s_cmp_gt_u32 s57, 0x40000
  s_cbranch_scc1 L_tag_2240362
  v_cmp_eq_u32 vcc, -1, v168
  s_cbranch_vccnz L_tag_2240362_l
  s_nop 1
  s_branch L_tag_2240362
L_tag_2242363_r:
L_tag_2242363_l:
  s_add_u32 s3, s58, 266240
  buffer_load_dwordx4 v[172:175], v213, s[28:31], s3 offen offset:2048 sc1
  s_waitcnt vmcnt(0)
  s_add_u32 s57, s57, 1
  s_cmp_gt_u32 s57, 0x40000
  s_cbranch_scc1 L_tag_2242363
  v_cmp_eq_u32 vcc, -1, v172
  s_cbranch_vccnz L_tag_2242363_l
  s_nop 1
  s_branch L_tag_2242363
L_tag_2244364_r:
L_tag_2244364_l:
  s_add_u32 s3, s58, 266240
  buffer_load_dwordx4 v[176:179], v213, s[28:31], s3 offen offset:3072 sc1
  s_waitcnt vmcnt(0)
  s_add_u32 s57, s57, 1
  s_cmp_gt_u32 s57, 0x40000
  s_cbranch_scc1 L_tag_2244364
  v_cmp_eq_u32 vcc, -1, v176
  s_cbranch_vccnz L_tag_2244364_l
  s_nop 1
  s_branch L_tag_2244364
L_tag_2246365_r:
L_tag_2246365_l:
  s_add_u32 s3, s58, 270336
  buffer_load_dwordx4 v[180:183], v213, s[28:31], s3 offen offset:0 sc1
  s_waitcnt vmcnt(0)
  s_add_u32 s57, s57, 1
  s_cmp_gt_u32 s57, 0x40000
  s_cbranch_scc1 L_tag_2246365
  v_cmp_eq_u32 vcc, -1, v180
  s_cbranch_vccnz L_tag_2246365_l
  s_nop 1
  s_branch L_tag_2246365
L_tag_2248366_r:
L_tag_2248366_l:
  s_add_u32 s3, s58, 270336
  buffer_load_dwordx4 v[184:187], v213, s[28:31], s3 offen offset:1024 sc1
  s_waitcnt vmcnt(0)
  s_add_u32 s57, s57, 1
  s_cmp_gt_u32 s57, 0x40000
  s_cbranch_scc1 L_tag_2248366
  v_cmp_eq_u32 vcc, -1, v184
  s_cbranch_vccnz L_tag_2248366_l
  s_nop 1
  s_branch L_tag_2248366
L_tag_2250367_r:
L_tag_2250367_l:
  s_add_u32 s3, s58, 270336
  buffer_load_dwordx4 v[108:111], v213, s[28:31], s3 offen offset:2048 sc1
  s_waitcnt vmcnt(0)
  s_add_u32 s57, s57, 1
  s_cmp_gt_u32 s57, 0x40000
  s_cbranch_scc1 L_tag_2250367
  v_cmp_eq_u32 vcc, -1, v108
  s_cbranch_vccnz L_tag_2250367_l
  s_nop 1
  s_branch L_tag_2250367
L_tag_2252368_r:
L_tag_2252368_l:
  s_add_u32 s3, s58, 270336
  buffer_load_dwordx4 v[112:115], v213, s[28:31], s3 offen offset:3072 sc1
  s_waitcnt vmcnt(0)
  s_add_u32 s57, s57, 1
  s_cmp_gt_u32 s57, 0x40000
  s_cbranch_scc1 L_tag_2252368
  v_cmp_eq_u32 vcc, -1, v112
  s_cbranch_vccnz L_tag_2252368_l
  s_nop 1
  s_branch L_tag_2252368
L_tag_2254369_r:
L_tag_2254369_l:
  s_add_u32 s3, s58, 274432
  buffer_load_dwordx4 v[116:119], v213, s[28:31], s3 offen offset:0 sc1
  s_waitcnt vmcnt(0)
  s_add_u32 s57, s57, 1
  s_cmp_gt_u32 s57, 0x40000
  s_cbranch_scc1 L_tag_2254369
  v_cmp_eq_u32 vcc, -1, v116
  s_cbranch_vccnz L_tag_2254369_l
  s_nop 1
  s_branch L_tag_2254369
L_tag_2256370_r:
L_tag_2256370_l:
  s_add_u32 s3, s58, 274432
  buffer_load_dwordx4 v[156:159], v213, s[28:31], s3 offen offset:1024 sc1
  s_waitcnt vmcnt(0)
  s_add_u32 s57, s57, 1
  s_cmp_gt_u32 s57, 0x40000
  s_cbranch_scc1 L_tag_2256370
  v_cmp_eq_u32 vcc, -1, v156
  s_cbranch_vccnz L_tag_2256370_l
  s_nop 1
  s_branch L_tag_2256370
L_tag_2258371_r:
L_tag_2258371_l:
  s_add_u32 s3, s58, 274432
  buffer_load_dwordx4 v[160:163], v213, s[28:31], s3 offen offset:2048 sc1
  s_waitcnt vmcnt(0)
  s_add_u32 s57, s57, 1
  s_cmp_gt_u32 s57, 0x40000
  s_cbranch_scc1 L_tag_2258371
  v_cmp_eq_u32 vcc, -1, v160
  s_cbranch_vccnz L_tag_2258371_l
  s_nop 1
  s_branch L_tag_2258371
L_tag_2260372_r:
L_tag_2260372_l:
  s_add_u32 s3, s58, 274432
  buffer_load_dwordx4 v[164:167], v213, s[28:31], s3 offen offset:3072 sc1
  s_waitcnt vmcnt(0)
  s_add_u32 s57, s57, 1
  s_cmp_gt_u32 s57, 0x40000
  s_cbranch_scc1 L_tag_2260372
  v_cmp_eq_u32 vcc, -1, v164
  s_cbranch_vccnz L_tag_2260372_l
  s_nop 1
  s_branch L_tag_2260372
L_tag_2262373_r:
L_tag_2262373_l:
  s_add_u32 s3, s58, 278528
  buffer_load_dwordx4 v[168:171], v213, s[28:31], s3 offen offset:0 sc1
  s_waitcnt vmcnt(0)
  s_add_u32 s57, s57, 1
  s_cmp_gt_u32 s57, 0x40000
  s_cbranch_scc1 L_tag_2262373
  v_cmp_eq_u32 vcc, -1, v168
  s_cbranch_vccnz L_tag_2262373_l
  s_nop 1
  s_branch L_tag_2262373
L_tag_2264374_r:
L_tag_2264374_l:
  s_add_u32 s3, s58, 278528
  buffer_load_dwordx4 v[172:175], v213, s[28:31], s3 offen offset:1024 sc1
  s_waitcnt vmcnt(0)
  s_add_u32 s57, s57, 1
  s_cmp_gt_u32 s57, 0x40000
  s_cbranch_scc1 L_tag_2264374
  v_cmp_eq_u32 vcc, -1, v172
  s_cbranch_vccnz L_tag_2264374_l
  s_nop 1
  s_branch L_tag_2264374
L_tag_2266375_r:
L_tag_2266375_l:
  s_add_u32 s3, s58, 278528
  buffer_load_dwordx4 v[176:179], v213, s[28:31], s3 offen offset:2048 sc1
  s_waitcnt vmcnt(0)
  s_add_u32 s57, s57, 1
  s_cmp_gt_u32 s57, 0x40000
  s_cbranch_scc1 L_tag_2266375
  v_cmp_eq_u32 vcc, -1, v176
  s_cbranch_vccnz L_tag_2266375_l
  s_nop 1
  s_branch L_tag_2266375
L_tag_2268376_r:
L_tag_2268376_l:
  s_add_u32 s3, s58, 278528
  buffer_load_dwordx4 v[180:183], v213, s[28:31], s3 offen offset:3072 sc1
  s_waitcnt vmcnt(0)
  s_add_u32 s57, s57, 1
  s_cmp_gt_u32 s57, 0x40000
  s_cbranch_scc1 L_tag_2268376
  v_cmp_eq_u32 vcc, -1, v180
  s_cbranch_vccnz L_tag_2268376_l
  s_nop 1
  s_branch L_tag_2268376
L_tag_2270377_r:
L_tag_2270377_l:
  s_add_u32 s3, s58, 282624
  buffer_load_dwordx4 v[184:187], v213, s[28:31], s3 offen offset:0 sc1
  s_waitcnt vmcnt(0)
  s_add_u32 s57, s57, 1
  s_cmp_gt_u32 s57, 0x40000
  s_cbranch_scc1 L_tag_2270377
  v_cmp_eq_u32 vcc, -1, v184
  s_cbranch_vccnz L_tag_2270377_l
  s_nop 1
  s_branch L_tag_2270377
L_tag_2272378_r:
L_tag_2272378_l:
  s_add_u32 s3, s58, 282624
  buffer_load_dwordx4 v[108:111], v213, s[28:31], s3 offen offset:1024 sc1
  s_waitcnt vmcnt(0)
  s_add_u32 s57, s57, 1
  s_cmp_gt_u32 s57, 0x40000
  s_cbranch_scc1 L_tag_2272378
  v_cmp_eq_u32 vcc, -1, v108
  s_cbranch_vccnz L_tag_2272378_l
  s_nop 1
  s_branch L_tag_2272378
L_tag_2274379_r:
L_tag_2274379_l:
  s_add_u32 s3, s58, 282624
  buffer_load_dwordx4 v[112:115], v213, s[28:31], s3 offen offset:2048 sc1
  s_waitcnt vmcnt(0)
  s_add_u32 s57, s57, 1
  s_cmp_gt_u32 s57, 0x40000
  s_cbranch_scc1 L_tag_2274379
  v_cmp_eq_u32 vcc, -1, v112
  s_cbranch_vccnz L_tag_2274379_l
  s_nop 1
  s_branch L_tag_2274379
L_tag_2276380_r:
L_tag_2276380_l:
  s_add_u32 s3, s58, 282624
  buffer_load_dwordx4 v[116:119], v213, s[28:31], s3 offen offset:3072 sc1
  s_waitcnt vmcnt(0)
  s_add_u32 s57, s57, 1
  s_cmp_gt_u32 s57, 0x40000
  s_cbranch_scc1 L_tag_2276380
  v_cmp_eq_u32 vcc, -1, v116
  s_cbranch_vccnz L_tag_2276380_l
  s_nop 1
  s_branch L_tag_2276380
L_tag_2278381_r:
L_tag_2278381_l:
  s_add_u32 s3, s58, 286720
  buffer_load_dwordx4 v[156:159], v213, s[28:31], s3 offen offset:0 sc1
  s_waitcnt vmcnt(0)
  s_add_u32 s57, s57, 1
  s_cmp_gt_u32 s57, 0x40000
  s_cbranch_scc1 L_tag_2278381
  v_cmp_eq_u32 vcc, -1, v156
  s_cbranch_vccnz L_tag_2278381_l
  s_nop 1
  s_branch L_tag_2278381
L_tag_2280382_r:
L_tag_2280382_l:
  s_add_u32 s3, s58, 286720
  buffer_load_dwordx4 v[160:163], v213, s[28:31], s3 offen offset:1024 sc1
  s_waitcnt vmcnt(0)
  s_add_u32 s57, s57, 1
  s_cmp_gt_u32 s57, 0x40000
  s_cbranch_scc1 L_tag_2280382
  v_cmp_eq_u32 vcc, -1, v160
  s_cbranch_vccnz L_tag_2280382_l
  s_nop 1
  s_branch L_tag_2280382
L_tag_2282383_r:
L_tag_2282383_l:
  s_add_u32 s3, s58, 286720
  buffer_load_dwordx4 v[164:167], v213, s[28:31], s3 offen offset:2048 sc1
  s_waitcnt vmcnt(0)
  s_add_u32 s57, s57, 1
  s_cmp_gt_u32 s57, 0x40000
  s_cbranch_scc1 L_tag_2282383
  v_cmp_eq_u32 vcc, -1, v164
  s_cbranch_vccnz L_tag_2282383_l
  s_nop 1
  s_branch L_tag_2282383
L_tag_2284384_r:
L_tag_2284384_l:
  s_add_u32 s3, s58, 286720
  buffer_load_dwordx4 v[168:171], v213, s[28:31], s3 offen offset:3072 sc1
  s_waitcnt vmcnt(0)
  s_add_u32 s57, s57, 1
  s_cmp_gt_u32 s57, 0x40000
  s_cbranch_scc1 L_tag_2284384
  v_cmp_eq_u32 vcc, -1, v168
  s_cbranch_vccnz L_tag_2284384_l
  s_nop 1
  s_branch L_tag_2284384
L_tag_2286385_r:
L_tag_2286385_l:
  s_add_u32 s3, s58, 290816
  buffer_load_dwordx4 v[172:175], v213, s[28:31], s3 offen offset:0 sc1
  s_waitcnt vmcnt(0)
  s_add_u32 s57, s57, 1
  s_cmp_gt_u32 s57, 0x40000
  s_cbranch_scc1 L_tag_2286385
  v_cmp_eq_u32 vcc, -1, v172
  s_cbranch_vccnz L_tag_2286385_l
  s_nop 1
  s_branch L_tag_2286385
L_tag_2288386_r:
L_tag_2288386_l:
  s_add_u32 s3, s58, 290816
  buffer_load_dwordx4 v[176:179], v213, s[28:31], s3 offen offset:1024 sc1
  s_waitcnt vmcnt(0)
  s_add_u32 s57, s57, 1
  s_cmp_gt_u32 s57, 0x40000
  s_cbranch_scc1 L_tag_2288386
  v_cmp_eq_u32 vcc, -1, v176
  s_cbranch_vccnz L_tag_2288386_l
  s_nop 1
  s_branch L_tag_2288386
L_tag_2290387_r:
L_tag_2290387_l:
  s_add_u32 s3, s58, 290816
  buffer_load_dwordx4 v[180:183], v213, s[28:31], s3 offen offset:2048 sc1
  s_waitcnt vmcnt(0)
  s_add_u32 s57, s57, 1
  s_cmp_gt_u32 s57, 0x40000
  s_cbranch_scc1 L_tag_2290387
  v_cmp_eq_u32 vcc, -1, v180
  s_cbranch_vccnz L_tag_2290387_l
  s_nop 1
  s_branch L_tag_2290387
L_tag_2292388_r:
L_tag_2292388_l:
  s_add_u32 s3, s58, 290816
  buffer_load_dwordx4 v[184:187], v213, s[28:31], s3 offen offset:3072 sc1
  s_waitcnt vmcnt(0)
  s_add_u32 s57, s57, 1
  s_cmp_gt_u32 s57, 0x40000
  s_cbranch_scc1 L_tag_2292388
  v_cmp_eq_u32 vcc, -1, v184
  s_cbranch_vccnz L_tag_2292388_l
  s_nop 1
  s_branch L_tag_2292388
L_tag_2294389_r:
L_tag_2294389_l:
  s_add_u32 s3, s58, 393216
  buffer_load_dwordx4 v[108:111], v213, s[28:31], s3 offen offset:0 sc1
  s_waitcnt vmcnt(0)
  s_add_u32 s57, s57, 1
  s_cmp_gt_u32 s57, 0x40000
  s_cbranch_scc1 L_tag_2294389
  v_cmp_eq_u32 vcc, -1, v108
  s_cbranch_vccnz L_tag_2294389_l
  s_nop 1
  s_branch L_tag_2294389
L_tag_2424390_r:
L_tag_2424390_l:
  s_add_u32 s3, s58, 393216
  buffer_load_dwordx4 v[112:115], v213, s[28:31], s3 offen offset:1024 sc1
  s_waitcnt vmcnt(0)
  s_add_u32 s57, s57, 1
  s_cmp_gt_u32 s57, 0x40000
  s_cbranch_scc1 L_tag_2424390
  v_cmp_eq_u32 vcc, -1, v112
  s_cbranch_vccnz L_tag_2424390_l
  s_nop 1
  s_branch L_tag_2424390
L_tag_2426391_r:
L_tag_2426391_l:
  s_add_u32 s3, s58, 393216
  buffer_load_dwordx4 v[116:119], v213, s[28:31], s3 offen offset:2048 sc1
  s_waitcnt vmcnt(0)
  s_add_u32 s57, s57, 1
  s_cmp_gt_u32 s57, 0x40000
  s_cbranch_scc1 L_tag_2426391
  v_cmp_eq_u32 vcc, -1, v116
  s_cbranch_vccnz L_tag_2426391_l
  s_nop 1
  s_branch L_tag_2426391
L_tag_2428392_r:
L_tag_2428392_l:
  s_add_u32 s3, s58, 393216
  buffer_load_dwordx4 v[156:159], v213, s[28:31], s3 offen offset:3072 sc1
  s_waitcnt vmcnt(0)
  s_add_u32 s57, s57, 1
  s_cmp_gt_u32 s57, 0x40000
  s_cbranch_scc1 L_tag_2428392
  v_cmp_eq_u32 vcc, -1, v156
  s_cbranch_vccnz L_tag_2428392_l
  s_nop 1
  s_branch L_tag_2428392
L_tag_2430393_r:
L_tag_2430393_l:
  s_add_u32 s3, s58, 397312
  buffer_load_dwordx4 v[160:163], v213, s[28:31], s3 offen offset:0 sc1
  s_waitcnt vmcnt(0)
  s_add_u32 s57, s57, 1
  s_cmp_gt_u32 s57, 0x40000
  s_cbranch_scc1 L_tag_2430393
  v_cmp_eq_u32 vcc, -1, v160
  s_cbranch_vccnz L_tag_2430393_l
  s_nop 1
  s_branch L_tag_2430393
L_tag_2432394_r:
L_tag_2432394_l:
  s_add_u32 s3, s58, 397312
  buffer_load_dwordx4 v[164:167], v213, s[28:31], s3 offen offset:1024 sc1
  s_waitcnt vmcnt(0)
  s_add_u32 s57, s57, 1
  s_cmp_gt_u32 s57, 0x40000
  s_cbranch_scc1 L_tag_2432394
  v_cmp_eq_u32 vcc, -1, v164
  s_cbranch_vccnz L_tag_2432394_l
  s_nop 1
  s_branch L_tag_2432394
L_tag_2434395_r:
L_tag_2434395_l:
  s_add_u32 s3, s58, 397312
  buffer_load_dwordx4 v[168:171], v213, s[28:31], s3 offen offset:2048 sc1
  s_waitcnt vmcnt(0)
  s_add_u32 s57, s57, 1
  s_cmp_gt_u32 s57, 0x40000
  s_cbranch_scc1 L_tag_2434395
  v_cmp_eq_u32 vcc, -1, v168
  s_cbranch_vccnz L_tag_2434395_l
  s_nop 1
  s_branch L_tag_2434395
L_tag_2436396_r:
L_tag_2436396_l:
  s_add_u32 s3, s58, 397312
  buffer_load_dwordx4 v[172:175], v213, s[28:31], s3 offen offset:3072 sc1
  s_waitcnt vmcnt(0)
  s_add_u32 s57, s57, 1
  s_cmp_gt_u32 s57, 0x40000
  s_cbranch_scc1 L_tag_2436396
  v_cmp_eq_u32 vcc, -1, v172
  s_cbranch_vccnz L_tag_2436396_l
  s_nop 1
  s_branch L_tag_2436396
L_tag_2438397_r:
L_tag_2438397_l:
  s_add_u32 s3, s58, 401408
  buffer_load_dwordx4 v[176:179], v213, s[28:31], s3 offen offset:0 sc1
  s_waitcnt vmcnt(0)
  s_add_u32 s57, s57, 1
  s_cmp_gt_u32 s57, 0x40000
  s_cbranch_scc1 L_tag_2438397
  v_cmp_eq_u32 vcc, -1, v176
  s_cbranch_vccnz L_tag_2438397_l
  s_nop 1
  s_branch L_tag_2438397
L_tag_2440398_r:
L_tag_2440398_l:
  s_add_u32 s3, s58, 401408
  buffer_load_dwordx4 v[180:183], v213, s[28:31], s3 offen offset:1024 sc1
  s_waitcnt vmcnt(0)
  s_add_u32 s57, s57, 1
  s_cmp_gt_u32 s57, 0x40000
  s_cbranch_scc1 L_tag_2440398
  v_cmp_eq_u32 vcc, -1, v180
  s_cbranch_vccnz L_tag_2440398_l
  s_nop 1
  s_branch L_tag_2440398
L_tag_2442399_r:
L_tag_2442399_l:
  s_add_u32 s3, s58, 401408
  buffer_load_dwordx4 v[184:187], v213, s[28:31], s3 offen offset:2048 sc1
  s_waitcnt vmcnt(0)
  s_add_u32 s57, s57, 1
  s_cmp_gt_u32 s57, 0x40000
  s_cbranch_scc1 L_tag_2442399
  v_cmp_eq_u32 vcc, -1, v184
  s_cbranch_vccnz L_tag_2442399_l
  s_nop 1
  s_branch L_tag_2442399
L_tag_2444400_r:
L_tag_2444400_l:
  s_add_u32 s3, s58, 401408
  buffer_load_dwordx4 v[108:111], v213, s[28:31], s3 offen offset:3072 sc1
  s_waitcnt vmcnt(0)
  s_add_u32 s57, s57, 1
  s_cmp_gt_u32 s57, 0x40000
  s_cbranch_scc1 L_tag_2444400
  v_cmp_eq_u32 vcc, -1, v108
  s_cbranch_vccnz L_tag_2444400_l
  s_nop 1
  s_branch L_tag_2444400
L_tag_2446401_r:
L_tag_2446401_l:
  s_add_u32 s3, s58, 405504
  buffer_load_dwordx4 v[112:115], v213, s[28:31], s3 offen offset:0 sc1
  s_waitcnt vmcnt(0)
  s_add_u32 s57, s57, 1
  s_cmp_gt_u32 s57, 0x40000
  s_cbranch_scc1 L_tag_2446401
  v_cmp_eq_u32 vcc, -1, v112
  s_cbranch_vccnz L_tag_2446401_l
  s_nop 1
  s_branch L_tag_2446401
L_tag_2448402_r:
L_tag_2448402_l:
  s_add_u32 s3, s58, 405504
  buffer_load_dwordx4 v[116:119], v213, s[28:31], s3 offen offset:1024 sc1
  s_waitcnt vmcnt(0)
  s_add_u32 s57, s57, 1
  s_cmp_gt_u32 s57, 0x40000
  s_cbranch_scc1 L_tag_2448402
  v_cmp_eq_u32 vcc, -1, v116
  s_cbranch_vccnz L_tag_2448402_l
  s_nop 1
  s_branch L_tag_2448402
L_tag_2450403_r:
L_tag_2450403_l:
  s_add_u32 s3, s58, 405504
  buffer_load_dwordx4 v[156:159], v213, s[28:31], s3 offen offset:2048 sc1
  s_waitcnt vmcnt(0)
  s_add_u32 s57, s57, 1
  s_cmp_gt_u32 s57, 0x40000
  s_cbranch_scc1 L_tag_2450403
  v_cmp_eq_u32 vcc, -1, v156
  s_cbranch_vccnz L_tag_2450403_l
  s_nop 1
  s_branch L_tag_2450403
L_tag_2452404_r:
L_tag_2452404_l:
  s_add_u32 s3, s58, 405504
  buffer_load_dwordx4 v[160:163], v213, s[28:31], s3 offen offset:3072 sc1
  s_waitcnt vmcnt(0)
  s_add_u32 s57, s57, 1
  s_cmp_gt_u32 s57, 0x40000
  s_cbranch_scc1 L_tag_2452404
  v_cmp_eq_u32 vcc, -1, v160
  s_cbranch_vccnz L_tag_2452404_l
  s_nop 1
  s_branch L_tag_2452404
L_tag_2454405_r:
L_tag_2454405_l:
  s_add_u32 s3, s58, 409600
  buffer_load_dwordx4 v[164:167], v213, s[28:31], s3 offen offset:0 sc1
  s_waitcnt vmcnt(0)
  s_add_u32 s57, s57, 1
  s_cmp_gt_u32 s57, 0x40000
  s_cbranch_scc1 L_tag_2454405
  v_cmp_eq_u32 vcc, -1, v164
  s_cbranch_vccnz L_tag_2454405_l
  s_nop 1
  s_branch L_tag_2454405
L_tag_2456406_r:
L_tag_2456406_l:
  s_add_u32 s3, s58, 409600
  buffer_load_dwordx4 v[168:171], v213, s[28:31], s3 offen offset:1024 sc1
  s_waitcnt vmcnt(0)
  s_add_u32 s57, s57, 1
  s_cmp_gt_u32 s57, 0x40000
  s_cbranch_scc1 L_tag_2456406
  v_cmp_eq_u32 vcc, -1, v168
  s_cbranch_vccnz L_tag_2456406_l
  s_nop 1
  s_branch L_tag_2456406
L_tag_2458407_r:
L_tag_2458407_l:
  s_add_u32 s3, s58, 409600
  buffer_load_dwordx4 v[172:175], v213, s[28:31], s3 offen offset:2048 sc1
  s_waitcnt vmcnt(0)
  s_add_u32 s57, s57, 1
  s_cmp_gt_u32 s57, 0x40000
  s_cbranch_scc1 L_tag_2458407
  v_cmp_eq_u32 vcc, -1, v172
  s_cbranch_vccnz L_tag_2458407_l
  s_nop 1
  s_branch L_tag_2458407
L_tag_2460408_r:
L_tag_2460408_l:
  s_add_u32 s3, s58, 409600
  buffer_load_dwordx4 v[176:179], v213, s[28:31], s3 offen offset:3072 sc1
  s_waitcnt vmcnt(0)
  s_add_u32 s57, s57, 1
  s_cmp_gt_u32 s57, 0x40000
  s_cbranch_scc1 L_tag_2460408
  v_cmp_eq_u32 vcc, -1, v176
  s_cbranch_vccnz L_tag_2460408_l
  s_nop 1
  s_branch L_tag_2460408
L_tag_2462409_r:
L_tag_2462409_l:
  s_add_u32 s3, s58, 413696
  buffer_load_dwordx4 v[180:183], v213, s[28:31], s3 offen offset:0 sc1
  s_waitcnt vmcnt(0)
  s_add_u32 s57, s57, 1
  s_cmp_gt_u32 s57, 0x40000
  s_cbranch_scc1 L_tag_2462409
  v_cmp_eq_u32 vcc, -1, v180
  s_cbranch_vccnz L_tag_2462409_l
  s_nop 1
  s_branch L_tag_2462409
L_tag_2464410_r:
L_tag_2464410_l:
  s_add_u32 s3, s58, 413696
  buffer_load_dwordx4 v[184:187], v213, s[28:31], s3 offen offset:1024 sc1
  s_waitcnt vmcnt(0)
  s_add_u32 s57, s57, 1
  s_cmp_gt_u32 s57, 0x40000
  s_cbranch_scc1 L_tag_2464410
  v_cmp_eq_u32 vcc, -1, v184
  s_cbranch_vccnz L_tag_2464410_l
  s_nop 1
  s_branch L_tag_2464410
L_tag_2466411_r:
L_tag_2466411_l:
  s_add_u32 s3, s58, 413696
  buffer_load_dwordx4 v[108:111], v213, s[28:31], s3 offen offset:2048 sc1
  s_waitcnt vmcnt(0)
  s_add_u32 s57, s57, 1
  s_cmp_gt_u32 s57, 0x40000
  s_cbranch_scc1 L_tag_2466411
  v_cmp_eq_u32 vcc, -1, v108
  s_cbranch_vccnz L_tag_2466411_l
  s_nop 1
  s_branch L_tag_2466411
L_tag_2468412_r:
L_tag_2468412_l:
  s_add_u32 s3, s58, 413696
  buffer_load_dwordx4 v[112:115], v213, s[28:31], s3 offen offset:3072 sc1
  s_waitcnt vmcnt(0)
  s_add_u32 s57, s57, 1
  s_cmp_gt_u32 s57, 0x40000
  s_cbranch_scc1 L_tag_2468412
  v_cmp_eq_u32 vcc, -1, v112
  s_cbranch_vccnz L_tag_2468412_l
  s_nop 1
  s_branch L_tag_2468412
L_tag_2470413_r:
L_tag_2470413_l:
  s_add_u32 s3, s58, 417792
  buffer_load_dwordx4 v[116:119], v213, s[28:31], s3 offen offset:0 sc1
  s_waitcnt vmcnt(0)
  s_add_u32 s57, s57, 1
  s_cmp_gt_u32 s57, 0x40000
  s_cbranch_scc1 L_tag_2470413
  v_cmp_eq_u32 vcc, -1, v116
  s_cbranch_vccnz L_tag_2470413_l
  s_nop 1
  s_branch L_tag_2470413
L_tag_2472414_r:
L_tag_2472414_l:
  s_add_u32 s3, s58, 417792
  buffer_load_dwordx4 v[156:159], v213, s[28:31], s3 offen offset:1024 sc1
  s_waitcnt vmcnt(0)
  s_add_u32 s57, s57, 1
  s_cmp_gt_u32 s57, 0x40000
  s_cbranch_scc1 L_tag_2472414
  v_cmp_eq_u32 vcc, -1, v156
  s_cbranch_vccnz L_tag_2472414_l
  s_nop 1
  s_branch L_tag_2472414
L_tag_2474415_r:
L_tag_2474415_l:
  s_add_u32 s3, s58, 417792
  buffer_load_dwordx4 v[160:163], v213, s[28:31], s3 offen offset:2048 sc1
  s_waitcnt vmcnt(0)
  s_add_u32 s57, s57, 1
  s_cmp_gt_u32 s57, 0x40000
  s_cbranch_scc1 L_tag_2474415
  v_cmp_eq_u32 vcc, -1, v160
  s_cbranch_vccnz L_tag_2474415_l
  s_nop 1
  s_branch L_tag_2474415
L_tag_2476416_r:
L_tag_2476416_l:
  s_add_u32 s3, s58, 417792
  buffer_load_dwordx4 v[164:167], v213, s[28:31], s3 offen offset:3072 sc1
  s_waitcnt vmcnt(0)
  s_add_u32 s57, s57, 1
  s_cmp_gt_u32 s57, 0x40000
  s_cbranch_scc1 L_tag_2476416
  v_cmp_eq_u32 vcc, -1, v164
  s_cbranch_vccnz L_tag_2476416_l
  s_nop 1
  s_branch L_tag_2476416
L_tag_2478417_r:
L_tag_2478417_l:
  s_add_u32 s3, s58, 421888
  buffer_load_dwordx4 v[168:171], v213, s[28:31], s3 offen offset:0 sc1
  s_waitcnt vmcnt(0)
  s_add_u32 s57, s57, 1
  s_cmp_gt_u32 s57, 0x40000
  s_cbranch_scc1 L_tag_2478417
  v_cmp_eq_u32 vcc, -1, v168
  s_cbranch_vccnz L_tag_2478417_l
  s_nop 1
  s_branch L_tag_2478417
L_tag_2480418_r:
L_tag_2480418_l:
  s_add_u32 s3, s58, 421888
  buffer_load_dwordx4 v[172:175], v213, s[28:31], s3 offen offset:1024 sc1
  s_waitcnt vmcnt(0)
  s_add_u32 s57, s57, 1
  s_cmp_gt_u32 s57, 0x40000
  s_cbranch_scc1 L_tag_2480418
  v_cmp_eq_u32 vcc, -1, v172
  s_cbranch_vccnz L_tag_2480418_l
  s_nop 1
  s_branch L_tag_2480418
L_tag_2482419_r:
L_tag_2482419_l:
  s_add_u32 s3, s58, 421888
  buffer_load_dwordx4 v[176:179], v213, s[28:31], s3 offen offset:2048 sc1
  s_waitcnt vmcnt(0)
  s_add_u32 s57, s57, 1
  s_cmp_gt_u32 s57, 0x40000
  s_cbranch_scc1 L_tag_2482419
  v_cmp_eq_u32 vcc, -1, v176
  s_cbranch_vccnz L_tag_2482419_l
  s_nop 1
  s_branch L_tag_2482419
L_tag_2484420_r:
L_tag_2484420_l:
  s_add_u32 s3, s58, 421888
  buffer_load_dwordx4 v[180:183], v213, s[28:31], s3 offen offset:3072 sc1
  s_waitcnt vmcnt(0)
  s_add_u32 s57, s57, 1
  s_cmp_gt_u32 s57, 0x40000
  s_cbranch_scc1 L_tag_2484420
  v_cmp_eq_u32 vcc, -1, v180
  s_cbranch_vccnz L_tag_2484420_l
  s_nop 1
  s_branch L_tag_2484420
L_tag_2618422_r:
L_tag_2618422_l:
  s_add_u32 s3, s58, 0
  buffer_load_dwordx4 v[156:159], v231, s[28:31], s3 offen offset:0 sc1
  s_waitcnt vmcnt(0)
  s_add_u32 s57, s57, 1
  s_cmp_gt_u32 s57, 0x40000
  s_cbranch_scc1 L_tag_2618422
  v_cmp_eq_u32 vcc, -1, v156
  s_cbranch_vccnz L_tag_2618422_l
  s_nop 1
  s_branch L_tag_2618422
L_tag_2622423_r:
L_tag_2622423_l:
  s_add_u32 s3, s58, 0
  buffer_load_dwordx4 v[160:163], v231, s[28:31], s3 offen offset:1024 sc1
  s_waitcnt vmcnt(0)
  s_add_u32 s57, s57, 1
  s_cmp_gt_u32 s57, 0x40000
  s_cbranch_scc1 L_tag_2622423
  v_cmp_eq_u32 vcc, -1, v160
  s_cbranch_vccnz L_tag_2622423_l
  s_nop 1
  s_branch L_tag_2622423
L_tag_2624424_r:
L_tag_2624424_l:
  s_add_u32 s3, s58, 0
  buffer_load_dwordx4 v[164:167], v231, s[28:31], s3 offen offset:2048 sc1
  s_waitcnt vmcnt(0)
  s_add_u32 s57, s57, 1
  s_cmp_gt_u32 s57, 0x40000
  s_cbranch_scc1 L_tag_2624424
  v_cmp_eq_u32 vcc, -1, v164
  s_cbranch_vccnz L_tag_2624424_l
  s_nop 1
  s_branch L_tag_2624424
L_tag_2626425_r:
L_tag_2626425_l:
  s_add_u32 s3, s58, 0
  buffer_load_dwordx4 v[168:171], v231, s[28:31], s3 offen offset:3072 sc1
  s_waitcnt vmcnt(0)
  s_add_u32 s57, s57, 1
  s_cmp_gt_u32 s57, 0x40000
  s_cbranch_scc1 L_tag_2626425
  v_cmp_eq_u32 vcc, -1, v168
  s_cbranch_vccnz L_tag_2626425_l
  s_nop 1
  s_branch L_tag_2626425
L_tag_2628426_r:
L_tag_2628426_l:
  s_add_u32 s3, s58, 4096
  buffer_load_dwordx4 v[172:175], v231, s[28:31], s3 offen offset:0 sc1
  s_waitcnt vmcnt(0)
  s_add_u32 s57, s57, 1
  s_cmp_gt_u32 s57, 0x40000
  s_cbranch_scc1 L_tag_2628426
  v_cmp_eq_u32 vcc, -1, v172
  s_cbranch_vccnz L_tag_2628426_l
  s_nop 1
  s_branch L_tag_2628426
L_tag_2630427_r:
L_tag_2630427_l:
  s_add_u32 s3, s58, 4096
  buffer_load_dwordx4 v[176:179], v231, s[28:31], s3 offen offset:1024 sc1
  s_waitcnt vmcnt(0)
  s_add_u32 s57, s57, 1
  s_cmp_gt_u32 s57, 0x40000
  s_cbranch_scc1 L_tag_2630427
  v_cmp_eq_u32 vcc, -1, v176
  s_cbranch_vccnz L_tag_2630427_l
  s_nop 1
  s_branch L_tag_2630427
L_tag_2632428_r:
L_tag_2632428_l:
  s_add_u32 s3, s58, 4096
  buffer_load_dwordx4 v[180:183], v231, s[28:31], s3 offen offset:2048 sc1
  s_waitcnt vmcnt(0)
  s_add_u32 s57, s57, 1
  s_cmp_gt_u32 s57, 0x40000
  s_cbranch_scc1 L_tag_2632428
  v_cmp_eq_u32 vcc, -1, v180
  s_cbranch_vccnz L_tag_2632428_l
  s_nop 1
  s_branch L_tag_2632428
L_tag_2634429_r:
L_tag_2634429_l:
  s_add_u32 s3, s58, 4096
  buffer_load_dwordx4 v[184:187], v231, s[28:31], s3 offen offset:3072 sc1
  s_waitcnt vmcnt(0)
  s_add_u32 s57, s57, 1
  s_cmp_gt_u32 s57, 0x40000
  s_cbranch_scc1 L_tag_2634429
  v_cmp_eq_u32 vcc, -1, v184
  s_cbranch_vccnz L_tag_2634429_l
  s_nop 1
  s_branch L_tag_2634429
L_tag_2636430_r:
L_tag_2636430_l:
  s_add_u32 s3, s58, 8192
  buffer_load_dwordx4 v[108:111], v231, s[28:31], s3 offen offset:0 sc1
  s_waitcnt vmcnt(0)
  s_add_u32 s57, s57, 1
  s_cmp_gt_u32 s57, 0x40000
  s_cbranch_scc1 L_tag_2636430
  v_cmp_eq_u32 vcc, -1, v108
  s_cbranch_vccnz L_tag_2636430_l
  s_nop 1
  s_branch L_tag_2636430
L_tag_2638431_r:
L_tag_2638431_l:
  s_add_u32 s3, s58, 8192
  buffer_load_dwordx4 v[112:115], v231, s[28:31], s3 offen offset:1024 sc1
  s_waitcnt vmcnt(0)
  s_add_u32 s57, s57, 1
  s_cmp_gt_u32 s57, 0x40000
  s_cbranch_scc1 L_tag_2638431
  v_cmp_eq_u32 vcc, -1, v112
  s_cbranch_vccnz L_tag_2638431_l
  s_nop 1
  s_branch L_tag_2638431
L_tag_2640432_r:
L_tag_2640432_l:
  s_add_u32 s3, s58, 8192
  buffer_load_dwordx4 v[116:119], v231, s[28:31], s3 offen offset:2048 sc1
  s_waitcnt vmcnt(0)
  s_add_u32 s57, s57, 1
  s_cmp_gt_u32 s57, 0x40000
  s_cbranch_scc1 L_tag_2640432
  v_cmp_eq_u32 vcc, -1, v116
  s_cbranch_vccnz L_tag_2640432_l
  s_nop 1
  s_branch L_tag_2640432
L_tag_2642433_r:
L_tag_2642433_l:
  s_add_u32 s3, s58, 8192
  buffer_load_dwordx4 v[156:159], v231, s[28:31], s3 offen offset:3072 sc1
  s_waitcnt vmcnt(0)
  s_add_u32 s57, s57, 1
  s_cmp_gt_u32 s57, 0x40000
  s_cbranch_scc1 L_tag_2642433
  v_cmp_eq_u32 vcc, -1, v156
  s_cbranch_vccnz L_tag_2642433_l
  s_nop 1
  s_branch L_tag_2642433
L_tag_2644434_r:
L_tag_2644434_l:
  s_add_u32 s3, s58, 12288
  buffer_load_dwordx4 v[160:163], v231, s[28:31], s3 offen offset:0 sc1
  s_waitcnt vmcnt(0)
  s_add_u32 s57, s57, 1
  s_cmp_gt_u32 s57, 0x40000
  s_cbranch_scc1 L_tag_2644434
  v_cmp_eq_u32 vcc, -1, v160
  s_cbranch_vccnz L_tag_2644434_l
  s_nop 1
  s_branch L_tag_2644434
L_tag_2646435_r:
L_tag_2646435_l:
  s_add_u32 s3, s58, 12288
  buffer_load_dwordx4 v[164:167], v231, s[28:31], s3 offen offset:1024 sc1
  s_waitcnt vmcnt(0)
  s_add_u32 s57, s57, 1
  s_cmp_gt_u32 s57, 0x40000
  s_cbranch_scc1 L_tag_2646435
  v_cmp_eq_u32 vcc, -1, v164
  s_cbranch_vccnz L_tag_2646435_l
  s_nop 1
  s_branch L_tag_2646435
L_tag_2648436_r:
L_tag_2648436_l:
  s_add_u32 s3, s58, 12288
  buffer_load_dwordx4 v[168:171], v231, s[28:31], s3 offen offset:2048 sc1
  s_waitcnt vmcnt(0)
  s_add_u32 s57, s57, 1
  s_cmp_gt_u32 s57, 0x40000
  s_cbranch_scc1 L_tag_2648436
  v_cmp_eq_u32 vcc, -1, v168
  s_cbranch_vccnz L_tag_2648436_l
  s_nop 1
  s_branch L_tag_2648436
L_tag_2650437_r:
L_tag_2650437_l:
  s_add_u32 s3, s58, 12288
  buffer_load_dwordx4 v[172:175], v231, s[28:31], s3 offen offset:3072 sc1
  s_waitcnt vmcnt(0)
  s_add_u32 s57, s57, 1
  s_cmp_gt_u32 s57, 0x40000
  s_cbranch_scc1 L_tag_2650437
  v_cmp_eq_u32 vcc, -1, v172
  s_cbranch_vccnz L_tag_2650437_l
  s_nop 1
  s_branch L_tag_2650437
L_tag_2652438_r:
L_tag_2652438_l:
  s_add_u32 s3, s58, 16384
  buffer_load_dwordx4 v[176:179], v231, s[28:31], s3 offen offset:0 sc1
  s_waitcnt vmcnt(0)
  s_add_u32 s57, s57, 1
  s_cmp_gt_u32 s57, 0x40000
  s_cbranch_scc1 L_tag_2652438
  v_cmp_eq_u32 vcc, -1, v176
  s_cbranch_vccnz L_tag_2652438_l
  s_nop 1
  s_branch L_tag_2652438
L_tag_2654439_r:
L_tag_2654439_l:
  s_add_u32 s3, s58, 16384
  buffer_load_dwordx4 v[180:183], v231, s[28:31], s3 offen offset:1024 sc1
  s_waitcnt vmcnt(0)
  s_add_u32 s57, s57, 1
  s_cmp_gt_u32 s57, 0x40000
  s_cbranch_scc1 L_tag_2654439
  v_cmp_eq_u32 vcc, -1, v180
  s_cbranch_vccnz L_tag_2654439_l
  s_nop 1
  s_branch L_tag_2654439
L_tag_2656440_r:
L_tag_2656440_l:
  s_add_u32 s3, s58, 16384
  buffer_load_dwordx4 v[184:187], v231, s[28:31], s3 offen offset:2048 sc1
  s_waitcnt vmcnt(0)
  s_add_u32 s57, s57, 1
  s_cmp_gt_u32 s57, 0x40000
  s_cbranch_scc1 L_tag_2656440
  v_cmp_eq_u32 vcc, -1, v184
  s_cbranch_vccnz L_tag_2656440_l
  s_nop 1
  s_branch L_tag_2656440
L_tag_2658441_r:
L_tag_2658441_l:
  s_add_u32 s3, s58, 16384
  buffer_load_dwordx4 v[108:111], v231, s[28:31], s3 offen offset:3072 sc1
  s_waitcnt vmcnt(0)
  s_add_u32 s57, s57, 1
  s_cmp_gt_u32 s57, 0x40000
  s_cbranch_scc1 L_tag_2658441
  v_cmp_eq_u32 vcc, -1, v108
  s_cbranch_vccnz L_tag_2658441_l
  s_nop 1
  s_branch L_tag_2658441
L_tag_2660442_r:
L_tag_2660442_l:
  s_add_u32 s3, s58, 20480
  buffer_load_dwordx4 v[112:115], v231, s[28:31], s3 offen offset:0 sc1
  s_waitcnt vmcnt(0)
  s_add_u32 s57, s57, 1
  s_cmp_gt_u32 s57, 0x40000
  s_cbranch_scc1 L_tag_2660442
  v_cmp_eq_u32 vcc, -1, v112
  s_cbranch_vccnz L_tag_2660442_l
  s_nop 1
  s_branch L_tag_2660442
L_tag_2662443_r:
L_tag_2662443_l:
  s_add_u32 s3, s58, 20480
  buffer_load_dwordx4 v[116:119], v231, s[28:31], s3 offen offset:1024 sc1
  s_waitcnt vmcnt(0)
  s_add_u32 s57, s57, 1
  s_cmp_gt_u32 s57, 0x40000
  s_cbranch_scc1 L_tag_2662443
  v_cmp_eq_u32 vcc, -1, v116
  s_cbranch_vccnz L_tag_2662443_l
  s_nop 1
  s_branch L_tag_2662443
L_tag_2664444_r:
L_tag_2664444_l:
  s_add_u32 s3, s58, 20480
  buffer_load_dwordx4 v[156:159], v231, s[28:31], s3 offen offset:2048 sc1
  s_waitcnt vmcnt(0)
  s_add_u32 s57, s57, 1
  s_cmp_gt_u32 s57, 0x40000
  s_cbranch_scc1 L_tag_2664444
  v_cmp_eq_u32 vcc, -1, v156
  s_cbranch_vccnz L_tag_2664444_l
  s_nop 1
  s_branch L_tag_2664444
L_tag_2666445_r:
L_tag_2666445_l:
  s_add_u32 s3, s58, 20480
  buffer_load_dwordx4 v[160:163], v231, s[28:31], s3 offen offset:3072 sc1
  s_waitcnt vmcnt(0)
  s_add_u32 s57, s57, 1
  s_cmp_gt_u32 s57, 0x40000
  s_cbranch_scc1 L_tag_2666445
  v_cmp_eq_u32 vcc, -1, v160
  s_cbranch_vccnz L_tag_2666445_l
  s_nop 1
  s_branch L_tag_2666445
L_tag_2668446_r:
L_tag_2668446_l:
  s_add_u32 s3, s58, 24576
  buffer_load_dwordx4 v[164:167], v231, s[28:31], s3 offen offset:0 sc1
  s_waitcnt vmcnt(0)
  s_add_u32 s57, s57, 1
  s_cmp_gt_u32 s57, 0x40000
  s_cbranch_scc1 L_tag_2668446
  v_cmp_eq_u32 vcc, -1, v164
  s_cbranch_vccnz L_tag_2668446_l
  s_nop 1
  s_branch L_tag_2668446
L_tag_2670447_r:
L_tag_2670447_l:
  s_add_u32 s3, s58, 24576
  buffer_load_dwordx4 v[168:171], v231, s[28:31], s3 offen offset:1024 sc1
  s_waitcnt vmcnt(0)
  s_add_u32 s57, s57, 1
  s_cmp_gt_u32 s57, 0x40000
  s_cbranch_scc1 L_tag_2670447
  v_cmp_eq_u32 vcc, -1, v168
  s_cbranch_vccnz L_tag_2670447_l
  s_nop 1
  s_branch L_tag_2670447
L_tag_2672448_r:
L_tag_2672448_l:
  s_add_u32 s3, s58, 24576
  buffer_load_dwordx4 v[172:175], v231, s[28:31], s3 offen offset:2048 sc1
  s_waitcnt vmcnt(0)
  s_add_u32 s57, s57, 1
  s_cmp_gt_u32 s57, 0x40000
  s_cbranch_scc1 L_tag_2672448
  v_cmp_eq_u32 vcc, -1, v172
  s_cbranch_vccnz L_tag_2672448_l
  s_nop 1
  s_branch L_tag_2672448
L_tag_2674449_r:
L_tag_2674449_l:
  s_add_u32 s3, s58, 24576
  buffer_load_dwordx4 v[176:179], v231, s[28:31], s3 offen offset:3072 sc1
  s_waitcnt vmcnt(0)
  s_add_u32 s57, s57, 1
  s_cmp_gt_u32 s57, 0x40000
  s_cbranch_scc1 L_tag_2674449
  v_cmp_eq_u32 vcc, -1, v176
  s_cbranch_vccnz L_tag_2674449_l
  s_nop 1
  s_branch L_tag_2674449
L_tag_2676450_r:
L_tag_2676450_l:
  s_add_u32 s3, s58, 114688
  buffer_load_dwordx4 v[180:183], v231, s[28:31], s3 offen offset:0 sc1
  s_waitcnt vmcnt(0)
  s_add_u32 s57, s57, 1
  s_cmp_gt_u32 s57, 0x40000
  s_cbranch_scc1 L_tag_2676450
  v_cmp_eq_u32 vcc, -1, v180
  s_cbranch_vccnz L_tag_2676450_l
  s_nop 1
  s_branch L_tag_2676450
L_tag_2798451_r:
L_tag_2798451_l:
  s_add_u32 s3, s58, 114688
  buffer_load_dwordx4 v[184:187], v231, s[28:31], s3 offen offset:1024 sc1
  s_waitcnt vmcnt(0)
  s_add_u32 s57, s57, 1
  s_cmp_gt_u32 s57, 0x40000
  s_cbranch_scc1 L_tag_2798451
  v_cmp_eq_u32 vcc, -1, v184
  s_cbranch_vccnz L_tag_2798451_l
  s_nop 1
  s_branch L_tag_2798451
L_tag_2800452_r:
L_tag_2800452_l:
  s_add_u32 s3, s58, 114688
  buffer_load_dwordx4 v[108:111], v231, s[28:31], s3 offen offset:2048 sc1
  s_waitcnt vmcnt(0)
  s_add_u32 s57, s57, 1
  s_cmp_gt_u32 s57, 0x40000
  s_cbranch_scc1 L_tag_2800452
  v_cmp_eq_u32 vcc, -1, v108
  s_cbranch_vccnz L_tag_2800452_l
  s_nop 1
  s_branch L_tag_2800452
L_tag_2802453_r:
L_tag_2802453_l:
  s_add_u32 s3, s58, 114688
  buffer_load_dwordx4 v[112:115], v231, s[28:31], s3 offen offset:3072 sc1
  s_waitcnt vmcnt(0)
  s_add_u32 s57, s57, 1
  s_cmp_gt_u32 s57, 0x40000
  s_cbranch_scc1 L_tag_2802453
  v_cmp_eq_u32 vcc, -1, v112
  s_cbranch_vccnz L_tag_2802453_l
  s_nop 1
  s_branch L_tag_2802453
L_tag_2804454_r:
L_tag_2804454_l:
  s_add_u32 s3, s58, 118784
  buffer_load_dwordx4 v[116:119], v231, s[28:31], s3 offen offset:0 sc1
  s_waitcnt vmcnt(0)
  s_add_u32 s57, s57, 1
  s_cmp_gt_u32 s57, 0x40000
  s_cbranch_scc1 L_tag_2804454
  v_cmp_eq_u32 vcc, -1, v116
  s_cbranch_vccnz L_tag_2804454_l
  s_nop 1
  s_branch L_tag_2804454
L_tag_2806455_r:
L_tag_2806455_l:
  s_add_u32 s3, s58, 118784
  buffer_load_dwordx4 v[156:159], v231, s[28:31], s3 offen offset:1024 sc1
  s_waitcnt vmcnt(0)
  s_add_u32 s57, s57, 1
  s_cmp_gt_u32 s57, 0x40000
  s_cbranch_scc1 L_tag_2806455
  v_cmp_eq_u32 vcc, -1, v156
  s_cbranch_vccnz L_tag_2806455_l
  s_nop 1
  s_branch L_tag_2806455
L_tag_2808456_r:
L_tag_2808456_l:
  s_add_u32 s3, s58, 118784
  buffer_load_dwordx4 v[160:163], v231, s[28:31], s3 offen offset:2048 sc1
  s_waitcnt vmcnt(0)
  s_add_u32 s57, s57, 1
  s_cmp_gt_u32 s57, 0x40000
  s_cbranch_scc1 L_tag_2808456
  v_cmp_eq_u32 vcc, -1, v160
  s_cbranch_vccnz L_tag_2808456_l
  s_nop 1
  s_branch L_tag_2808456
L_tag_2810457_r:
L_tag_2810457_l:
  s_add_u32 s3, s58, 118784
  buffer_load_dwordx4 v[164:167], v231, s[28:31], s3 offen offset:3072 sc1
  s_waitcnt vmcnt(0)
  s_add_u32 s57, s57, 1
  s_cmp_gt_u32 s57, 0x40000
  s_cbranch_scc1 L_tag_2810457
  v_cmp_eq_u32 vcc, -1, v164
  s_cbranch_vccnz L_tag_2810457_l
  s_nop 1
  s_branch L_tag_2810457
L_tag_2812458_r:
L_tag_2812458_l:
  s_add_u32 s3, s58, 122880
  buffer_load_dwordx4 v[168:171], v231, s[28:31], s3 offen offset:0 sc1
  s_waitcnt vmcnt(0)
  s_add_u32 s57, s57, 1
  s_cmp_gt_u32 s57, 0x40000
  s_cbranch_scc1 L_tag_2812458
  v_cmp_eq_u32 vcc, -1, v168
  s_cbranch_vccnz L_tag_2812458_l
  s_nop 1
  s_branch L_tag_2812458
L_tag_2814459_r:
L_tag_2814459_l:
  s_add_u32 s3, s58, 122880
  buffer_load_dwordx4 v[172:175], v231, s[28:31], s3 offen offset:1024 sc1
  s_waitcnt vmcnt(0)
  s_add_u32 s57, s57, 1
  s_cmp_gt_u32 s57, 0x40000
  s_cbranch_scc1 L_tag_2814459
  v_cmp_eq_u32 vcc, -1, v172
  s_cbranch_vccnz L_tag_2814459_l
  s_nop 1
  s_branch L_tag_2814459
L_tag_2816460_r:
L_tag_2816460_l:
  s_add_u32 s3, s58, 122880
  buffer_load_dwordx4 v[176:179], v231, s[28:31], s3 offen offset:2048 sc1
  s_waitcnt vmcnt(0)
  s_add_u32 s57, s57, 1
  s_cmp_gt_u32 s57, 0x40000
  s_cbranch_scc1 L_tag_2816460
  v_cmp_eq_u32 vcc, -1, v176
  s_cbranch_vccnz L_tag_2816460_l
  s_nop 1
  s_branch L_tag_2816460
L_tag_2818461_r:
L_tag_2818461_l:
  s_add_u32 s3, s58, 122880
  buffer_load_dwordx4 v[180:183], v231, s[28:31], s3 offen offset:3072 sc1
  s_waitcnt vmcnt(0)
  s_add_u32 s57, s57, 1
  s_cmp_gt_u32 s57, 0x40000
  s_cbranch_scc1 L_tag_2818461
  v_cmp_eq_u32 vcc, -1, v180
  s_cbranch_vccnz L_tag_2818461_l
  s_nop 1
  s_branch L_tag_2818461
L_tag_2820462_r:
L_tag_2820462_l:
  s_add_u32 s3, s58, 126976
  buffer_load_dwordx4 v[184:187], v231, s[28:31], s3 offen offset:0 sc1
  s_waitcnt vmcnt(0)
  s_add_u32 s57, s57, 1
  s_cmp_gt_u32 s57, 0x40000
  s_cbranch_scc1 L_tag_2820462
  v_cmp_eq_u32 vcc, -1, v184
  s_cbranch_vccnz L_tag_2820462_l
  s_nop 1
  s_branch L_tag_2820462
L_tag_2822463_r:
L_tag_2822463_l:
  s_add_u32 s3, s58, 126976
  buffer_load_dwordx4 v[108:111], v231, s[28:31], s3 offen offset:1024 sc1
  s_waitcnt vmcnt(0)
  s_add_u32 s57, s57, 1
  s_cmp_gt_u32 s57, 0x40000
  s_cbranch_scc1 L_tag_2822463
  v_cmp_eq_u32 vcc, -1, v108
  s_cbranch_vccnz L_tag_2822463_l
  s_nop 1
  s_branch L_tag_2822463
L_tag_2824464_r:
L_tag_2824464_l:
  s_add_u32 s3, s58, 126976
  buffer_load_dwordx4 v[112:115], v231, s[28:31], s3 offen offset:2048 sc1
  s_waitcnt vmcnt(0)
  s_add_u32 s57, s57, 1
  s_cmp_gt_u32 s57, 0x40000
  s_cbranch_scc1 L_tag_2824464
  v_cmp_eq_u32 vcc, -1, v112
  s_cbranch_vccnz L_tag_2824464_l
  s_nop 1
  s_branch L_tag_2824464
L_tag_2826465_r:
L_tag_2826465_l:
  s_add_u32 s3, s58, 126976
  buffer_load_dwordx4 v[116:119], v231, s[28:31], s3 offen offset:3072 sc1
  s_waitcnt vmcnt(0)
  s_add_u32 s57, s57, 1
  s_cmp_gt_u32 s57, 0x40000
  s_cbranch_scc1 L_tag_2826465
  v_cmp_eq_u32 vcc, -1, v116
  s_cbranch_vccnz L_tag_2826465_l
  s_nop 1
  s_branch L_tag_2826465
L_tag_2828466_r:
L_tag_2828466_l:
  s_add_u32 s3, s58, 131072
  buffer_load_dwordx4 v[156:159], v231, s[28:31], s3 offen offset:0 sc1
  s_waitcnt vmcnt(0)
  s_add_u32 s57, s57, 1
  s_cmp_gt_u32 s57, 0x40000
  s_cbranch_scc1 L_tag_2828466
  v_cmp_eq_u32 vcc, -1, v156
  s_cbranch_vccnz L_tag_2828466_l
  s_nop 1
  s_branch L_tag_2828466
L_tag_2830467_r:
L_tag_2830467_l:
  s_add_u32 s3, s58, 131072
  buffer_load_dwordx4 v[160:163], v231, s[28:31], s3 offen offset:1024 sc1
  s_waitcnt vmcnt(0)
  s_add_u32 s57, s57, 1
  s_cmp_gt_u32 s57, 0x40000
  s_cbranch_scc1 L_tag_2830467
  v_cmp_eq_u32 vcc, -1, v160
  s_cbranch_vccnz L_tag_2830467_l
  s_nop 1
  s_branch L_tag_2830467
L_tag_2832468_r:
L_tag_2832468_l:
  s_add_u32 s3, s58, 131072
  buffer_load_dwordx4 v[164:167], v231, s[28:31], s3 offen offset:2048 sc1
  s_waitcnt vmcnt(0)
  s_add_u32 s57, s57, 1
  s_cmp_gt_u32 s57, 0x40000
  s_cbranch_scc1 L_tag_2832468
  v_cmp_eq_u32 vcc, -1, v164
  s_cbranch_vccnz L_tag_2832468_l
  s_nop 1
  s_branch L_tag_2832468
L_tag_2834469_r:
L_tag_2834469_l:
  s_add_u32 s3, s58, 131072
  buffer_load_dwordx4 v[168:171], v231, s[28:31], s3 offen offset:3072 sc1
  s_waitcnt vmcnt(0)
  s_add_u32 s57, s57, 1
  s_cmp_gt_u32 s57, 0x40000
  s_cbranch_scc1 L_tag_2834469
  v_cmp_eq_u32 vcc, -1, v168
  s_cbranch_vccnz L_tag_2834469_l
  s_nop 1
  s_branch L_tag_2834469
L_tag_2836470_r:
L_tag_2836470_l:
  s_add_u32 s3, s58, 135168
  buffer_load_dwordx4 v[172:175], v231, s[28:31], s3 offen offset:0 sc1
  s_waitcnt vmcnt(0)
  s_add_u32 s57, s57, 1
  s_cmp_gt_u32 s57, 0x40000
  s_cbranch_scc1 L_tag_2836470
  v_cmp_eq_u32 vcc, -1, v172
  s_cbranch_vccnz L_tag_2836470_l
  s_nop 1
  s_branch L_tag_2836470
L_tag_2838471_r:
L_tag_2838471_l:
  s_add_u32 s3, s58, 135168
  buffer_load_dwordx4 v[176:179], v231, s[28:31], s3 offen offset:1024 sc1
  s_waitcnt vmcnt(0)
  s_add_u32 s57, s57, 1
  s_cmp_gt_u32 s57, 0x40000
  s_cbranch_scc1 L_tag_2838471
  v_cmp_eq_u32 vcc, -1, v176
  s_cbranch_vccnz L_tag_2838471_l
  s_nop 1
  s_branch L_tag_2838471
L_tag_2840472_r:
L_tag_2840472_l:
  s_add_u32 s3, s58, 135168
  buffer_load_dwordx4 v[180:183], v231, s[28:31], s3 offen offset:2048 sc1
  s_waitcnt vmcnt(0)
  s_add_u32 s57, s57, 1
  s_cmp_gt_u32 s57, 0x40000
  s_cbranch_scc1 L_tag_2840472
  v_cmp_eq_u32 vcc, -1, v180
  s_cbranch_vccnz L_tag_2840472_l
  s_nop 1
  s_branch L_tag_2840472
L_tag_2842473_r:
L_tag_2842473_l:
  s_add_u32 s3, s58, 135168
  buffer_load_dwordx4 v[184:187], v231, s[28:31], s3 offen offset:3072 sc1
  s_waitcnt vmcnt(0)
  s_add_u32 s57, s57, 1
  s_cmp_gt_u32 s57, 0x40000
  s_cbranch_scc1 L_tag_2842473
  v_cmp_eq_u32 vcc, -1, v184
  s_cbranch_vccnz L_tag_2842473_l
  s_nop 1
  s_branch L_tag_2842473
L_tag_2844474_r:
L_tag_2844474_l:
  s_add_u32 s3, s58, 139264
  buffer_load_dwordx4 v[108:111], v231, s[28:31], s3 offen offset:0 sc1
  s_waitcnt vmcnt(0)
  s_add_u32 s57, s57, 1
  s_cmp_gt_u32 s57, 0x40000
  s_cbranch_scc1 L_tag_2844474
  v_cmp_eq_u32 vcc, -1, v108
  s_cbranch_vccnz L_tag_2844474_l
  s_nop 1
  s_branch L_tag_2844474
L_tag_2846475_r:
L_tag_2846475_l:
  s_add_u32 s3, s58, 139264
  buffer_load_dwordx4 v[112:115], v231, s[28:31], s3 offen offset:1024 sc1
  s_waitcnt vmcnt(0)
  s_add_u32 s57, s57, 1
  s_cmp_gt_u32 s57, 0x40000
  s_cbranch_scc1 L_tag_2846475
  v_cmp_eq_u32 vcc, -1, v112
  s_cbranch_vccnz L_tag_2846475_l
  s_nop 1
  s_branch L_tag_2846475
L_tag_2848476_r:
L_tag_2848476_l:
  s_add_u32 s3, s58, 139264
  buffer_load_dwordx4 v[116:119], v231, s[28:31], s3 offen offset:2048 sc1
  s_waitcnt vmcnt(0)
  s_add_u32 s57, s57, 1
  s_cmp_gt_u32 s57, 0x40000
  s_cbranch_scc1 L_tag_2848476
  v_cmp_eq_u32 vcc, -1, v116
  s_cbranch_vccnz L_tag_2848476_l
  s_nop 1
  s_branch L_tag_2848476
L_tag_2850477_r:
L_tag_2850477_l:
  s_add_u32 s3, s58, 139264
  buffer_load_dwordx4 v[156:159], v231, s[28:31], s3 offen offset:3072 sc1
  s_waitcnt vmcnt(0)
  s_add_u32 s57, s57, 1
  s_cmp_gt_u32 s57, 0x40000
  s_cbranch_scc1 L_tag_2850477
  v_cmp_eq_u32 vcc, -1, v156
  s_cbranch_vccnz L_tag_2850477_l
  s_nop 1
  s_branch L_tag_2850477
L_tag_2852478_r:
L_tag_2852478_l:
  s_add_u32 s3, s58, 229376
  buffer_load_dwordx4 v[160:163], v231, s[28:31], s3 offen offset:0 sc1
  s_waitcnt vmcnt(0)
  s_add_u32 s57, s57, 1
  s_cmp_gt_u32 s57, 0x40000
  s_cbranch_scc1 L_tag_2852478
  v_cmp_eq_u32 vcc, -1, v160
  s_cbranch_vccnz L_tag_2852478_l
  s_nop 1
  s_branch L_tag_2852478
L_tag_2974479_r:
L_tag_2974479_l:
  s_add_u32 s3, s58, 229376
  buffer_load_dwordx4 v[164:167], v231, s[28:31], s3 offen offset:1024 sc1
  s_waitcnt vmcnt(0)
  s_add_u32 s57, s57, 1
  s_cmp_gt_u32 s57, 0x40000
  s_cbranch_scc1 L_tag_2974479
  v_cmp_eq_u32 vcc, -1, v164
  s_cbranch_vccnz L_tag_2974479_l
  s_nop 1
  s_branch L_tag_2974479
L_tag_2976480_r:
L_tag_2976480_l:
  s_add_u32 s3, s58, 229376
  buffer_load_dwordx4 v[168:171], v231, s[28:31], s3 offen offset:2048 sc1
  s_waitcnt vmcnt(0)
  s_add_u32 s57, s57, 1
  s_cmp_gt_u32 s57, 0x40000
  s_cbranch_scc1 L_tag_2976480
  v_cmp_eq_u32 vcc, -1, v168
  s_cbranch_vccnz L_tag_2976480_l
  s_nop 1
  s_branch L_tag_2976480
L_tag_2978481_r:
L_tag_2978481_l:
  s_add_u32 s3, s58, 229376
  buffer_load_dwordx4 v[172:175], v231, s[28:31], s3 offen offset:3072 sc1
  s_waitcnt vmcnt(0)
  s_add_u32 s57, s57, 1
  s_cmp_gt_u32 s57, 0x40000
  s_cbranch_scc1 L_tag_2978481
  v_cmp_eq_u32 vcc, -1, v172
  s_cbranch_vccnz L_tag_2978481_l
  s_nop 1
  s_branch L_tag_2978481
L_tag_2980482_r:
L_tag_2980482_l:
  s_add_u32 s3, s58, 233472
  buffer_load_dwordx4 v[176:179], v231, s[28:31], s3 offen offset:0 sc1
  s_waitcnt vmcnt(0)
  s_add_u32 s57, s57, 1
  s_cmp_gt_u32 s57, 0x40000
  s_cbranch_scc1 L_tag_2980482
  v_cmp_eq_u32 vcc, -1, v176
  s_cbranch_vccnz L_tag_2980482_l
  s_nop 1
  s_branch L_tag_2980482
L_tag_2982483_r:
L_tag_2982483_l:
  s_add_u32 s3, s58, 233472
  buffer_load_dwordx4 v[180:183], v231, s[28:31], s3 offen offset:1024 sc1
  s_waitcnt vmcnt(0)
  s_add_u32 s57, s57, 1
  s_cmp_gt_u32 s57, 0x40000
  s_cbranch_scc1 L_tag_2982483
  v_cmp_eq_u32 vcc, -1, v180
  s_cbranch_vccnz L_tag_2982483_l
  s_nop 1
  s_branch L_tag_2982483
L_tag_2984484_r:
L_tag_2984484_l:
  s_add_u32 s3, s58, 233472
  buffer_load_dwordx4 v[184:187], v231, s[28:31], s3 offen offset:2048 sc1
  s_waitcnt vmcnt(0)
  s_add_u32 s57, s57, 1
  s_cmp_gt_u32 s57, 0x40000
  s_cbranch_scc1 L_tag_2984484
  v_cmp_eq_u32 vcc, -1, v184
  s_cbranch_vccnz L_tag_2984484_l
  s_nop 1
  s_branch L_tag_2984484
L_tag_2986485_r:
L_tag_2986485_l:
  s_add_u32 s3, s58, 233472
  buffer_load_dwordx4 v[108:111], v231, s[28:31], s3 offen offset:3072 sc1
  s_waitcnt vmcnt(0)
  s_add_u32 s57, s57, 1
  s_cmp_gt_u32 s57, 0x40000
  s_cbranch_scc1 L_tag_2986485
  v_cmp_eq_u32 vcc, -1, v108
  s_cbranch_vccnz L_tag_2986485_l
  s_nop 1
  s_branch L_tag_2986485
L_tag_2988486_r:
L_tag_2988486_l:
  s_add_u32 s3, s58, 237568
  buffer_load_dwordx4 v[112:115], v231, s[28:31], s3 offen offset:0 sc1
  s_waitcnt vmcnt(0)
  s_add_u32 s57, s57, 1
  s_cmp_gt_u32 s57, 0x40000
  s_cbranch_scc1 L_tag_2988486
  v_cmp_eq_u32 vcc, -1, v112
  s_cbranch_vccnz L_tag_2988486_l
  s_nop 1
  s_branch L_tag_2988486
L_tag_2990487_r:
L_tag_2990487_l:
  s_add_u32 s3, s58, 237568
  buffer_load_dwordx4 v[116:119], v231, s[28:31], s3 offen offset:1024 sc1
  s_waitcnt vmcnt(0)
  s_add_u32 s57, s57, 1
  s_cmp_gt_u32 s57, 0x40000
  s_cbranch_scc1 L_tag_2990487
  v_cmp_eq_u32 vcc, -1, v116
  s_cbranch_vccnz L_tag_2990487_l
  s_nop 1
  s_branch L_tag_2990487
L_tag_2992488_r:
L_tag_2992488_l:
  s_add_u32 s3, s58, 237568
  buffer_load_dwordx4 v[156:159], v231, s[28:31], s3 offen offset:2048 sc1
  s_waitcnt vmcnt(0)
  s_add_u32 s57, s57, 1
  s_cmp_gt_u32 s57, 0x40000
  s_cbranch_scc1 L_tag_2992488
  v_cmp_eq_u32 vcc, -1, v156
  s_cbranch_vccnz L_tag_2992488_l
  s_nop 1
  s_branch L_tag_2992488
L_tag_2994489_r:
L_tag_2994489_l:
  s_add_u32 s3, s58, 237568
  buffer_load_dwordx4 v[160:163], v231, s[28:31], s3 offen offset:3072 sc1
  s_waitcnt vmcnt(0)
  s_add_u32 s57, s57, 1
  s_cmp_gt_u32 s57, 0x40000
  s_cbranch_scc1 L_tag_2994489
  v_cmp_eq_u32 vcc, -1, v160
  s_cbranch_vccnz L_tag_2994489_l
  s_nop 1
  s_branch L_tag_2994489
L_tag_2996490_r:
L_tag_2996490_l:
  s_add_u32 s3, s58, 241664
  buffer_load_dwordx4 v[164:167], v231, s[28:31], s3 offen offset:0 sc1
  s_waitcnt vmcnt(0)
  s_add_u32 s57, s57, 1
  s_cmp_gt_u32 s57, 0x40000
  s_cbranch_scc1 L_tag_2996490
  v_cmp_eq_u32 vcc, -1, v164
  s_cbranch_vccnz L_tag_2996490_l
  s_nop 1
  s_branch L_tag_2996490
L_tag_2998491_r:
L_tag_2998491_l:
  s_add_u32 s3, s58, 241664
  buffer_load_dwordx4 v[168:171], v231, s[28:31], s3 offen offset:1024 sc1
  s_waitcnt vmcnt(0)
  s_add_u32 s57, s57, 1
  s_cmp_gt_u32 s57, 0x40000
  s_cbranch_scc1 L_tag_2998491
  v_cmp_eq_u32 vcc, -1, v168
  s_cbranch_vccnz L_tag_2998491_l
  s_nop 1
  s_branch L_tag_2998491
L_tag_3000492_r:
L_tag_3000492_l:
  s_add_u32 s3, s58, 241664
  buffer_load_dwordx4 v[172:175], v231, s[28:31], s3 offen offset:2048 sc1
  s_waitcnt vmcnt(0)
  s_add_u32 s57, s57, 1
  s_cmp_gt_u32 s57, 0x40000
  s_cbranch_scc1 L_tag_3000492
  v_cmp_eq_u32 vcc, -1, v172
  s_cbranch_vccnz L_tag_3000492_l
  s_nop 1
  s_branch L_tag_3000492
L_tag_3002493_r:
L_tag_3002493_l:
  s_add_u32 s3, s58, 241664
  buffer_load_dwordx4 v[176:179], v231, s[28:31], s3 offen offset:3072 sc1
  s_waitcnt vmcnt(0)
  s_add_u32 s57, s57, 1
  s_cmp_gt_u32 s57, 0x40000
  s_cbranch_scc1 L_tag_3002493
  v_cmp_eq_u32 vcc, -1, v176
  s_cbranch_vccnz L_tag_3002493_l
  s_nop 1
  s_branch L_tag_3002493
L_tag_3004494_r:
L_tag_3004494_l:
  s_add_u32 s3, s58, 245760
  buffer_load_dwordx4 v[180:183], v231, s[28:31], s3 offen offset:0 sc1
  s_waitcnt vmcnt(0)
  s_add_u32 s57, s57, 1
  s_cmp_gt_u32 s57, 0x40000
  s_cbranch_scc1 L_tag_3004494
  v_cmp_eq_u32 vcc, -1, v180
  s_cbranch_vccnz L_tag_3004494_l
  s_nop 1
  s_branch L_tag_3004494
L_tag_3006495_r:
L_tag_3006495_l:
  s_add_u32 s3, s58, 245760
  buffer_load_dwordx4 v[184:187], v231, s[28:31], s3 offen offset:1024 sc1
  s_waitcnt vmcnt(0)
  s_add_u32 s57, s57, 1
  s_cmp_gt_u32 s57, 0x40000
  s_cbranch_scc1 L_tag_3006495
  v_cmp_eq_u32 vcc, -1, v184
  s_cbranch_vccnz L_tag_3006495_l
  s_nop 1
  s_branch L_tag_3006495
L_tag_3008496_r:
L_tag_3008496_l:
  s_add_u32 s3, s58, 245760
  buffer_load_dwordx4 v[108:111], v231, s[28:31], s3 offen offset:2048 sc1
  s_waitcnt vmcnt(0)
  s_add_u32 s57, s57, 1
  s_cmp_gt_u32 s57, 0x40000
  s_cbranch_scc1 L_tag_3008496
  v_cmp_eq_u32 vcc, -1, v108
  s_cbranch_vccnz L_tag_3008496_l
  s_nop 1
  s_branch L_tag_3008496
L_tag_3010497_r:
L_tag_3010497_l:
  s_add_u32 s3, s58, 245760
  buffer_load_dwordx4 v[112:115], v231, s[28:31], s3 offen offset:3072 sc1
  s_waitcnt vmcnt(0)
  s_add_u32 s57, s57, 1
  s_cmp_gt_u32 s57, 0x40000
  s_cbranch_scc1 L_tag_3010497
  v_cmp_eq_u32 vcc, -1, v112
  s_cbranch_vccnz L_tag_3010497_l
  s_nop 1
  s_branch L_tag_3010497
L_tag_3012498_r:
L_tag_3012498_l:
  s_add_u32 s3, s58, 249856
  buffer_load_dwordx4 v[116:119], v231, s[28:31], s3 offen offset:0 sc1
  s_waitcnt vmcnt(0)
  s_add_u32 s57, s57, 1
  s_cmp_gt_u32 s57, 0x40000
  s_cbranch_scc1 L_tag_3012498
  v_cmp_eq_u32 vcc, -1, v116
  s_cbranch_vccnz L_tag_3012498_l
  s_nop 1
  s_branch L_tag_3012498
L_tag_3014499_r:
L_tag_3014499_l:
  s_add_u32 s3, s58, 249856
  buffer_load_dwordx4 v[156:159], v231, s[28:31], s3 offen offset:1024 sc1
  s_waitcnt vmcnt(0)
  s_add_u32 s57, s57, 1
  s_cmp_gt_u32 s57, 0x40000
  s_cbranch_scc1 L_tag_3014499
  v_cmp_eq_u32 vcc, -1, v156
  s_cbranch_vccnz L_tag_3014499_l
  s_nop 1
  s_branch L_tag_3014499
L_tag_3016500_r:
L_tag_3016500_l:
  s_add_u32 s3, s58, 249856
  buffer_load_dwordx4 v[160:163], v231, s[28:31], s3 offen offset:2048 sc1
  s_waitcnt vmcnt(0)
  s_add_u32 s57, s57, 1
  s_cmp_gt_u32 s57, 0x40000
  s_cbranch_scc1 L_tag_3016500
  v_cmp_eq_u32 vcc, -1, v160
  s_cbranch_vccnz L_tag_3016500_l
  s_nop 1
  s_branch L_tag_3016500
L_tag_3018501_r:
L_tag_3018501_l:
  s_add_u32 s3, s58, 249856
  buffer_load_dwordx4 v[164:167], v231, s[28:31], s3 offen offset:3072 sc1
  s_waitcnt vmcnt(0)
  s_add_u32 s57, s57, 1
  s_cmp_gt_u32 s57, 0x40000
  s_cbranch_scc1 L_tag_3018501
  v_cmp_eq_u32 vcc, -1, v164
  s_cbranch_vccnz L_tag_3018501_l
  s_nop 1
  s_branch L_tag_3018501
L_tag_3020502_r:
L_tag_3020502_l:
  s_add_u32 s3, s58, 253952
  buffer_load_dwordx4 v[168:171], v231, s[28:31], s3 offen offset:0 sc1
  s_waitcnt vmcnt(0)
  s_add_u32 s57, s57, 1
  s_cmp_gt_u32 s57, 0x40000
  s_cbranch_scc1 L_tag_3020502
  v_cmp_eq_u32 vcc, -1, v168
  s_cbranch_vccnz L_tag_3020502_l
  s_nop 1
  s_branch L_tag_3020502
L_tag_3022503_r:
L_tag_3022503_l:
  s_add_u32 s3, s58, 253952
  buffer_load_dwordx4 v[172:175], v231, s[28:31], s3 offen offset:1024 sc1
  s_waitcnt vmcnt(0)
  s_add_u32 s57, s57, 1
  s_cmp_gt_u32 s57, 0x40000
  s_cbranch_scc1 L_tag_3022503
  v_cmp_eq_u32 vcc, -1, v172
  s_cbranch_vccnz L_tag_3022503_l
  s_nop 1
  s_branch L_tag_3022503
L_tag_3024504_r:
L_tag_3024504_l:
  s_add_u32 s3, s58, 253952
  buffer_load_dwordx4 v[176:179], v231, s[28:31], s3 offen offset:2048 sc1
  s_waitcnt vmcnt(0)
  s_add_u32 s57, s57, 1
  s_cmp_gt_u32 s57, 0x40000
  s_cbranch_scc1 L_tag_3024504
  v_cmp_eq_u32 vcc, -1, v176
  s_cbranch_vccnz L_tag_3024504_l
  s_nop 1
  s_branch L_tag_3024504
L_tag_3026505_r:
L_tag_3026505_l:
  s_add_u32 s3, s58, 253952
  buffer_load_dwordx4 v[180:183], v231, s[28:31], s3 offen offset:3072 sc1
  s_waitcnt vmcnt(0)
  s_add_u32 s57, s57, 1
  s_cmp_gt_u32 s57, 0x40000
  s_cbranch_scc1 L_tag_3026505
  v_cmp_eq_u32 vcc, -1, v180
  s_cbranch_vccnz L_tag_3026505_l
  s_nop 1
  s_branch L_tag_3026505
L_tag_3028506_r:
L_tag_3028506_l:
  s_add_u32 s3, s58, 344064
  buffer_load_dwordx4 v[184:187], v231, s[28:31], s3 offen offset:0 sc1
  s_waitcnt vmcnt(0)
  s_add_u32 s57, s57, 1
  s_cmp_gt_u32 s57, 0x40000
  s_cbranch_scc1 L_tag_3028506
  v_cmp_eq_u32 vcc, -1, v184
  s_cbranch_vccnz L_tag_3028506_l
  s_nop 1
  s_branch L_tag_3028506
L_tag_3150507_r:
L_tag_3150507_l:
  s_add_u32 s3, s58, 344064
  buffer_load_dwordx4 v[108:111], v231, s[28:31], s3 offen offset:1024 sc1
  s_waitcnt vmcnt(0)
  s_add_u32 s57, s57, 1
  s_cmp_gt_u32 s57, 0x40000
  s_cbranch_scc1 L_tag_3150507
  v_cmp_eq_u32 vcc, -1, v108
  s_cbranch_vccnz L_tag_3150507_l
  s_nop 1
  s_branch L_tag_3150507
L_tag_3152508_r:
L_tag_3152508_l:
  s_add_u32 s3, s58, 344064
  buffer_load_dwordx4 v[112:115], v231, s[28:31], s3 offen offset:2048 sc1
  s_waitcnt vmcnt(0)
  s_add_u32 s57, s57, 1
  s_cmp_gt_u32 s57, 0x40000
  s_cbranch_scc1 L_tag_3152508
  v_cmp_eq_u32 vcc, -1, v112
  s_cbranch_vccnz L_tag_3152508_l
  s_nop 1
  s_branch L_tag_3152508
L_tag_3154509_r:
L_tag_3154509_l:
  s_add_u32 s3, s58, 344064
  buffer_load_dwordx4 v[116:119], v231, s[28:31], s3 offen offset:3072 sc1
  s_waitcnt vmcnt(0)
  s_add_u32 s57, s57, 1
  s_cmp_gt_u32 s57, 0x40000
  s_cbranch_scc1 L_tag_3154509
  v_cmp_eq_u32 vcc, -1, v116
  s_cbranch_vccnz L_tag_3154509_l
  s_nop 1
  s_branch L_tag_3154509
L_tag_3156510_r:
L_tag_3156510_l:
  s_add_u32 s3, s58, 348160
  buffer_load_dwordx4 v[156:159], v231, s[28:31], s3 offen offset:0 sc1
  s_waitcnt vmcnt(0)
  s_add_u32 s57, s57, 1
  s_cmp_gt_u32 s57, 0x40000
  s_cbranch_scc1 L_tag_3156510
  v_cmp_eq_u32 vcc, -1, v156
  s_cbranch_vccnz L_tag_3156510_l
  s_nop 1
  s_branch L_tag_3156510
L_tag_3158511_r:
L_tag_3158511_l:
  s_add_u32 s3, s58, 348160
  buffer_load_dwordx4 v[160:163], v231, s[28:31], s3 offen offset:1024 sc1
  s_waitcnt vmcnt(0)
  s_add_u32 s57, s57, 1
  s_cmp_gt_u32 s57, 0x40000
  s_cbranch_scc1 L_tag_3158511
  v_cmp_eq_u32 vcc, -1, v160
  s_cbranch_vccnz L_tag_3158511_l
  s_nop 1
  s_branch L_tag_3158511
L_tag_3160512_r:
L_tag_3160512_l:
  s_add_u32 s3, s58, 348160
  buffer_load_dwordx4 v[164:167], v231, s[28:31], s3 offen offset:2048 sc1
  s_waitcnt vmcnt(0)
  s_add_u32 s57, s57, 1
  s_cmp_gt_u32 s57, 0x40000
  s_cbranch_scc1 L_tag_3160512
  v_cmp_eq_u32 vcc, -1, v164
  s_cbranch_vccnz L_tag_3160512_l
  s_nop 1
  s_branch L_tag_3160512
L_tag_3162513_r:
L_tag_3162513_l:
  s_add_u32 s3, s58, 348160
  buffer_load_dwordx4 v[168:171], v231, s[28:31], s3 offen offset:3072 sc1
  s_waitcnt vmcnt(0)
  s_add_u32 s57, s57, 1
  s_cmp_gt_u32 s57, 0x40000
  s_cbranch_scc1 L_tag_3162513
  v_cmp_eq_u32 vcc, -1, v168
  s_cbranch_vccnz L_tag_3162513_l
  s_nop 1
  s_branch L_tag_3162513
L_tag_3164514_r:
L_tag_3164514_l:
  s_add_u32 s3, s58, 352256
  buffer_load_dwordx4 v[172:175], v231, s[28:31], s3 offen offset:0 sc1
  s_waitcnt vmcnt(0)
  s_add_u32 s57, s57, 1
  s_cmp_gt_u32 s57, 0x40000
  s_cbranch_scc1 L_tag_3164514
  v_cmp_eq_u32 vcc, -1, v172
  s_cbranch_vccnz L_tag_3164514_l
  s_nop 1
  s_branch L_tag_3164514
L_tag_3166515_r:
L_tag_3166515_l:
  s_add_u32 s3, s58, 352256
  buffer_load_dwordx4 v[176:179], v231, s[28:31], s3 offen offset:1024 sc1
  s_waitcnt vmcnt(0)
  s_add_u32 s57, s57, 1
  s_cmp_gt_u32 s57, 0x40000
  s_cbranch_scc1 L_tag_3166515
  v_cmp_eq_u32 vcc, -1, v176
  s_cbranch_vccnz L_tag_3166515_l
  s_nop 1
  s_branch L_tag_3166515
L_tag_3168516_r:
L_tag_3168516_l:
  s_add_u32 s3, s58, 352256
  buffer_load_dwordx4 v[180:183], v231, s[28:31], s3 offen offset:2048 sc1
  s_waitcnt vmcnt(0)
  s_add_u32 s57, s57, 1
  s_cmp_gt_u32 s57, 0x40000
  s_cbranch_scc1 L_tag_3168516
  v_cmp_eq_u32 vcc, -1, v180
  s_cbranch_vccnz L_tag_3168516_l
  s_nop 1
  s_branch L_tag_3168516
L_tag_3170517_r:
L_tag_3170517_l:
  s_add_u32 s3, s58, 352256
  buffer_load_dwordx4 v[184:187], v231, s[28:31], s3 offen offset:3072 sc1
  s_waitcnt vmcnt(0)
  s_add_u32 s57, s57, 1
  s_cmp_gt_u32 s57, 0x40000
  s_cbranch_scc1 L_tag_3170517
  v_cmp_eq_u32 vcc, -1, v184
  s_cbranch_vccnz L_tag_3170517_l
  s_nop 1
  s_branch L_tag_3170517
L_tag_3172518_r:
L_tag_3172518_l:
  s_add_u32 s3, s58, 356352
  buffer_load_dwordx4 v[108:111], v231, s[28:31], s3 offen offset:0 sc1
  s_waitcnt vmcnt(0)
  s_add_u32 s57, s57, 1
  s_cmp_gt_u32 s57, 0x40000
  s_cbranch_scc1 L_tag_3172518
  v_cmp_eq_u32 vcc, -1, v108
  s_cbranch_vccnz L_tag_3172518_l
  s_nop 1
  s_branch L_tag_3172518
L_tag_3174519_r:
L_tag_3174519_l:
  s_add_u32 s3, s58, 356352
  buffer_load_dwordx4 v[112:115], v231, s[28:31], s3 offen offset:1024 sc1
  s_waitcnt vmcnt(0)
  s_add_u32 s57, s57, 1
  s_cmp_gt_u32 s57, 0x40000
  s_cbranch_scc1 L_tag_3174519
  v_cmp_eq_u32 vcc, -1, v112
  s_cbranch_vccnz L_tag_3174519_l
  s_nop 1
  s_branch L_tag_3174519
L_tag_3176520_r:
L_tag_3176520_l:
  s_add_u32 s3, s58, 356352
  buffer_load_dwordx4 v[116:119], v231, s[28:31], s3 offen offset:2048 sc1
  s_waitcnt vmcnt(0)
  s_add_u32 s57, s57, 1
  s_cmp_gt_u32 s57, 0x40000
  s_cbranch_scc1 L_tag_3176520
  v_cmp_eq_u32 vcc, -1, v116
  s_cbranch_vccnz L_tag_3176520_l
  s_nop 1
  s_branch L_tag_3176520
L_tag_3178521_r:
L_tag_3178521_l:
  s_add_u32 s3, s58, 356352
  buffer_load_dwordx4 v[156:159], v231, s[28:31], s3 offen offset:3072 sc1
  s_waitcnt vmcnt(0)
  s_add_u32 s57, s57, 1
  s_cmp_gt_u32 s57, 0x40000
  s_cbranch_scc1 L_tag_3178521
  v_cmp_eq_u32 vcc, -1, v156
  s_cbranch_vccnz L_tag_3178521_l
  s_nop 1
  s_branch L_tag_3178521
L_tag_3180522_r:
L_tag_3180522_l:
  s_add_u32 s3, s58, 360448
  buffer_load_dwordx4 v[160:163], v231, s[28:31], s3 offen offset:0 sc1
  s_waitcnt vmcnt(0)
  s_add_u32 s57, s57, 1
  s_cmp_gt_u32 s57, 0x40000
  s_cbranch_scc1 L_tag_3180522
  v_cmp_eq_u32 vcc, -1, v160
  s_cbranch_vccnz L_tag_3180522_l
  s_nop 1
  s_branch L_tag_3180522
L_tag_3182523_r:
L_tag_3182523_l:
  s_add_u32 s3, s58, 360448
  buffer_load_dwordx4 v[164:167], v231, s[28:31], s3 offen offset:1024 sc1
  s_waitcnt vmcnt(0)
  s_add_u32 s57, s57, 1
  s_cmp_gt_u32 s57, 0x40000
  s_cbranch_scc1 L_tag_3182523
  v_cmp_eq_u32 vcc, -1, v164
  s_cbranch_vccnz L_tag_3182523_l
  s_nop 1
  s_branch L_tag_3182523
L_tag_3184524_r:
L_tag_3184524_l:
  s_add_u32 s3, s58, 360448
  buffer_load_dwordx4 v[168:171], v231, s[28:31], s3 offen offset:2048 sc1
  s_waitcnt vmcnt(0)
  s_add_u32 s57, s57, 1
  s_cmp_gt_u32 s57, 0x40000
  s_cbranch_scc1 L_tag_3184524
  v_cmp_eq_u32 vcc, -1, v168
  s_cbranch_vccnz L_tag_3184524_l
  s_nop 1
  s_branch L_tag_3184524
L_tag_3186525_r:
L_tag_3186525_l:
  s_add_u32 s3, s58, 360448
  buffer_load_dwordx4 v[172:175], v231, s[28:31], s3 offen offset:3072 sc1
  s_waitcnt vmcnt(0)
  s_add_u32 s57, s57, 1
  s_cmp_gt_u32 s57, 0x40000
  s_cbranch_scc1 L_tag_3186525
  v_cmp_eq_u32 vcc, -1, v172
  s_cbranch_vccnz L_tag_3186525_l
  s_nop 1
  s_branch L_tag_3186525
L_tag_3188526_r:
L_tag_3188526_l:
  s_add_u32 s3, s58, 364544
  buffer_load_dwordx4 v[176:179], v231, s[28:31], s3 offen offset:0 sc1
  s_waitcnt vmcnt(0)
  s_add_u32 s57, s57, 1
  s_cmp_gt_u32 s57, 0x40000
  s_cbranch_scc1 L_tag_3188526
  v_cmp_eq_u32 vcc, -1, v176
  s_cbranch_vccnz L_tag_3188526_l
  s_nop 1
  s_branch L_tag_3188526
L_tag_3190527_r:
L_tag_3190527_l:
  s_add_u32 s3, s58, 364544
  buffer_load_dwordx4 v[180:183], v231, s[28:31], s3 offen offset:1024 sc1
  s_waitcnt vmcnt(0)
  s_add_u32 s57, s57, 1
  s_cmp_gt_u32 s57, 0x40000
  s_cbranch_scc1 L_tag_3190527
  v_cmp_eq_u32 vcc, -1, v180
  s_cbranch_vccnz L_tag_3190527_l
  s_nop 1
  s_branch L_tag_3190527
L_tag_3192528_r:
L_tag_3192528_l:
  s_add_u32 s3, s58, 364544
  buffer_load_dwordx4 v[184:187], v231, s[28:31], s3 offen offset:2048 sc1
  s_waitcnt vmcnt(0)
  s_add_u32 s57, s57, 1
  s_cmp_gt_u32 s57, 0x40000
  s_cbranch_scc1 L_tag_3192528
  v_cmp_eq_u32 vcc, -1, v184
  s_cbranch_vccnz L_tag_3192528_l
  s_nop 1
  s_branch L_tag_3192528
L_tag_3194529_r:
L_tag_3194529_l:
  s_add_u32 s3, s58, 364544
  buffer_load_dwordx4 v[108:111], v231, s[28:31], s3 offen offset:3072 sc1
  s_waitcnt vmcnt(0)
  s_add_u32 s57, s57, 1
  s_cmp_gt_u32 s57, 0x40000
  s_cbranch_scc1 L_tag_3194529
  v_cmp_eq_u32 vcc, -1, v108
  s_cbranch_vccnz L_tag_3194529_l
  s_nop 1
  s_branch L_tag_3194529
L_tag_3196530_r:
L_tag_3196530_l:
  s_add_u32 s3, s58, 368640
  buffer_load_dwordx4 v[112:115], v231, s[28:31], s3 offen offset:0 sc1
  s_waitcnt vmcnt(0)
  s_add_u32 s57, s57, 1
  s_cmp_gt_u32 s57, 0x40000
  s_cbranch_scc1 L_tag_3196530
  v_cmp_eq_u32 vcc, -1, v112
  s_cbranch_vccnz L_tag_3196530_l
  s_nop 1
  s_branch L_tag_3196530
L_tag_3198531_r:
L_tag_3198531_l:
  s_add_u32 s3, s58, 368640
  buffer_load_dwordx4 v[116:119], v231, s[28:31], s3 offen offset:1024 sc1
  s_waitcnt vmcnt(0)
  s_add_u32 s57, s57, 1
  s_cmp_gt_u32 s57, 0x40000
  s_cbranch_scc1 L_tag_3198531
  v_cmp_eq_u32 vcc, -1, v116
  s_cbranch_vccnz L_tag_3198531_l
  s_nop 1
  s_branch L_tag_3198531
L_tag_3200532_r:
L_tag_3200532_l:
  s_add_u32 s3, s58, 368640
  buffer_load_dwordx4 v[156:159], v231, s[28:31], s3 offen offset:2048 sc1
  s_waitcnt vmcnt(0)
  s_add_u32 s57, s57, 1
  s_cmp_gt_u32 s57, 0x40000
  s_cbranch_scc1 L_tag_3200532
  v_cmp_eq_u32 vcc, -1, v156
  s_cbranch_vccnz L_tag_3200532_l
  s_nop 1
  s_branch L_tag_3200532
L_tag_3202533_r:
L_tag_3202533_l:
  s_add_u32 s3, s58, 368640
  buffer_load_dwordx4 v[160:163], v231, s[28:31], s3 offen offset:3072 sc1
  s_waitcnt vmcnt(0)
  s_add_u32 s57, s57, 1
  s_cmp_gt_u32 s57, 0x40000
  s_cbranch_scc1 L_tag_3202533
  v_cmp_eq_u32 vcc, -1, v160
  s_cbranch_vccnz L_tag_3202533_l
  s_nop 1
  s_branch L_tag_3202533
.section .rodata,"a"
.p2align 6
.amdhsa_kernel interleave_layers__sliding_local_dilated__mixer_token_mlp__prompt_kernel
  .amdhsa_next_free_vgpr 512
  .amdhsa_next_free_sgpr 102
  .amdhsa_accum_offset 256
  .amdhsa_group_segment_fixed_size 0
  .amdhsa_kernarg_size 88
  .amdhsa_user_sgpr_count 2
  .amdhsa_user_sgpr_kernarg_segment_ptr 1
  .amdhsa_system_sgpr_workgroup_id_x 1
.end_amdhsa_kernel
```
